```python
import torch

def _softmax(x, axis=-1):
    return torch.softmax(x, dim=axis)

def _gelu(x):
    return torch.nn.functional.gelu(x, approximate='tanh')

def _silu(x):
    return torch.nn.functional.silu(x)

def _sigmoid(x):
    return torch.sigmoid(x)

def _layernorm(x, axis=-1, eps=1e-05):
    m = x.mean(dim=axis, keepdim=True)
    v = x.var(dim=axis, keepdim=True, unbiased=False)
    return (x - m) / torch.sqrt(v + eps)

def _scatter_add(tgt, idx, src, axis=0):
    return tgt.clone().index_add_(axis, idx, src)

def _segment_sum(src, seg, n):
    out = torch.zeros((n,) + src.shape[1:], dtype=src.dtype)
    return out.index_add_(0, seg, src)

def _pad(x, pw):
    flat = tuple((v for pair in reversed(pw) for v in pair))
    return torch.nn.functional.pad(x, flat)
kernel_name = 'adaLN_cond__sliding_block_cached__swiglu_ffn__prompt'

def setup_inputs():

    _w = lambda a: (lambda t: t.to(torch.bfloat16) if t.is_floating_point() else t)(torch.as_tensor(a))

    def _A_setup():
        B, Sq, D = (1, 2048, 576)
        Hq, Hkv, Sk, Dh = (32, 16, 2048, 128)
        assert Hq % Hkv == 0, (Hq, Hkv)
        return {'x': _w((lambda *s: torch.randn(*s, dtype=torch.bfloat16) * 0.05)(B, Sq, D)), 'k_cache': _w((lambda *s: torch.randn(*s, dtype=torch.bfloat16) * 3.2)(B, Hkv, Sk, Dh)), 'v_cache': _w((lambda *s: torch.randn(*s, dtype=torch.bfloat16) * 0.4)(B, Hkv, Sk, Dh)), 'wq': _w((lambda *s: torch.randn(*s, dtype=torch.bfloat16) * 3.2)(D, Hq * Dh) * D ** (-0.5)), 'wo': _w((lambda *s: torch.randn(*s, dtype=torch.bfloat16) * 0.4)(Hq * Dh, D) * (Hq * Dh) ** (-0.5))}
    _A_in = _A_setup()

    def _B_setup():
        B, S, D, F = (1, 2048, 576, 4608)
        return {'x': _w((lambda *s: torch.randn(*s, dtype=torch.bfloat16) * 0.05)(B, S, D)), 'w_gate': _w((lambda *s: torch.randn(*s, dtype=torch.bfloat16) * 0.05)(D, F)), 'w_up': _w((lambda *s: torch.randn(*s, dtype=torch.bfloat16) * 0.05)(D, F)), 'w_down': _w((lambda *s: torch.randn(*s, dtype=torch.bfloat16) * 0.05)(F, D))}
    _B_in = _B_setup()
    return {'A_x': _A_in['x'], 'A_k_cache': _A_in['k_cache'], 'A_v_cache': _A_in['v_cache'], 'A_wq': _A_in['wq'], 'A_wo': _A_in['wo'], 'B_x': _B_in['x'], 'B_w_gate': _B_in['w_gate'], 'B_w_up': _B_in['w_up'], 'B_w_down': _B_in['w_down'], 'c': _w((lambda *s: torch.randn(*s, dtype=torch.bfloat16) * 0.1)(1, 576) * 8.0), 'w_mod': _w((lambda *s: torch.randn(*s, dtype=torch.bfloat16) * 0.1)(576, 6 * 576) * 576 ** (-0.5) * 8.0)}

def reference(A_x, A_k_cache, A_v_cache, A_wq, A_wo, B_x, B_w_gate, B_w_up, B_w_down, c, w_mod):

    def _A_ref(x, k_cache, v_cache, wq, wo):
        B, Sq, D = x.shape
        Hq, Dh = (32, 128)
        Hkv, Sk = (k_cache.shape[1], k_cache.shape[2])
        W = min(4096, max(256, Sk // 4))
        rep = Hq // Hkv
        q = (lambda x, *d: x.permute(*d))((x @ wq).reshape(B, Sq, Hq, Dh), 0, 2, 1, 3)
        k = (lambda x, n, axis: torch.repeat_interleave(x, n, dim=axis))(k_cache[:, :, Sk - W:, :], rep, axis=1)
        v = (lambda x, n, axis: torch.repeat_interleave(x, n, dim=axis))(v_cache[:, :, Sk - W:, :], rep, axis=1)
        scores = torch.einsum('bhqd,bhkd->bhqk', q, k) * Dh ** (-0.5)
        p = _softmax(scores, axis=-1)
        o = torch.einsum('bhqk,bhkd->bhqd', p, v)
        return (lambda x, *d: x.permute(*d))(o, 0, 2, 1, 3).reshape(B, Sq, Hq * Dh) @ wo

    def _B_ref(x, w_gate, w_up, w_down):
        g = _silu(x @ w_gate)
        u = x @ w_up
        return g * u @ w_down
    x = A_x
    mod = (_silu(c) @ w_mod).reshape(c.shape[0], 6, 1, -1)
    sa, ca, ga, sb, cb, gb = (mod[:, 0].clone(), mod[:, 1].clone(), mod[:, 2].clone(), mod[:, 3].clone(), mod[:, 4].clone(), mod[:, 5].clone())
    h = _layernorm(x, axis=-1) * (1 + ca) + sa
    x = x + ga * _A_ref(h, A_k_cache, A_v_cache, A_wq, A_wo)
    h = _layernorm(x, axis=-1) * (1 + cb) + sb
    x = x + gb * _B_ref(h, B_w_gate, B_w_up, B_w_down)
    return x
```

```asm
; @launch grid=(256,1,1) block=(512,1,1) lds=163840
.amdgcn_target "amdgcn-amd-amdhsa--gfx950"
.text
.globl adaLN_cond__sliding_block_cached__swiglu_ffn__prompt_kernel
.p2align 8
.type adaLN_cond__sliding_block_cached__swiglu_ffn__prompt_kernel,@function
adaLN_cond__sliding_block_cached__swiglu_ffn__prompt_kernel:
    s_cmp_ge_u32 s2, 256
    s_cbranch_scc1 L_mega_end
    s_load_dwordx2 s[12:13], s[0:1], 72
    s_load_dwordx2 s[14:15], s[0:1], 80
    s_load_dwordx2 s[40:41], s[0:1], 104
    s_load_dwordx2 s[42:43], s[0:1], 0
    s_load_dwordx2 s[44:45], s[0:1], 88
    s_load_dwordx2 s[46:47], s[0:1], 96
    v_lshrrev_b32 v1, 6, v0
    s_nop 0
    v_readfirstlane_b32 s32, v1
    s_and_b32 s33, s2, 7
    s_lshl_b32 s33, s33, 1
    s_bfe_u32 s34, s2, 0x10003
    s_add_u32 s33, s33, s34
    s_lshr_b32 s34, s2, 4
    s_and_b32 s35, s32, 3
    s_lshr_b32 s36, s32, 2
    s_lshl_b32 s37, s34, 2
    s_add_u32 s37, s37, s35
    v_and_b32 v7, 63, v0
    s_cmp_ge_u32 s2, 108
    s_cbranch_scc1 L_modskipa_1
    v_and_b32 v112, 3, v7
    v_lshrrev_b32 v113, 2, v7
    s_lshl_b32 s50, s32, 4
    v_add_u32 v113, s50, v113
    s_mov_b32 s50, 6912
    v_mul_lo_u32 v114, v113, s50
    v_lshl_add_u32 v114, v112, 4, v114
    v_lshlrev_b32 v115, 1, v113
    s_lshl_b32 s51, s2, 6
    s_waitcnt lgkmcnt(0)
    s_mov_b32 s92, s14
    s_mov_b32 s93, s15
    s_mov_b32 s94, 0x3cc000
    s_add_u32 s92, s92, s51
    s_addc_u32 s93, s93, 0
    s_sub_u32 s94, s94, s51
    s_mov_b32 s95, 0x00020000
    s_mov_b32 s8, s12
    s_mov_b32 s9, s13
    s_mov_b32 s10, 0x480
    s_mov_b32 s11, 0x00020000
    buffer_load_ushort v120, v115, s[8:11], 0 offen offset:0
    buffer_load_ushort v121, v115, s[8:11], 0 offen offset:256
    buffer_load_ushort v122, v115, s[8:11], 0 offen offset:512
    buffer_load_ushort v123, v115, s[8:11], 0 offen offset:768
    buffer_load_ushort v124, v115, s[8:11], 0 offen offset:1024
    s_mov_b32 s56, 0
    buffer_load_dwordx4 v[128:131], v114, s[92:95], s56 offen
    s_mov_b32 s57, 884736
    buffer_load_dwordx4 v[132:135], v114, s[92:95], s57 offen
    s_mov_b32 s58, 1769472
    buffer_load_dwordx4 v[136:139], v114, s[92:95], s58 offen
    s_mov_b32 s59, 2654208
    buffer_load_dwordx4 v[140:143], v114, s[92:95], s59 offen
    s_mov_b32 s60, 3538944
    buffer_load_dwordx4 v[144:147], v114, s[92:95], s60 offen
L_modskipa_1:
    s_nop 1
    s_waitcnt lgkmcnt(0)
    s_mov_b32 s76, s40
    s_mov_b32 s77, s41
    s_mov_b32 s78, 0x6a00000
    s_mov_b32 s79, 0x00020000
    s_mov_b32 s80, s42
    s_mov_b32 s81, s43
    s_mov_b32 s82, 0x240000
    s_mov_b32 s83, 0x00020000
    s_mov_b32 s84, s44
    s_mov_b32 s85, s45
    s_mov_b32 s86, 0x240000
    s_mov_b32 s87, 0x00020000
    s_mov_b32 s88, s46
    s_mov_b32 s89, s47
    s_mov_b32 s90, 0x100
    s_mov_b32 s91, 0x00020000
    s_lshl_b32 s38, s34, 4
    s_add_u32 s38, s38, s33
    s_mov_b32 s98, s38
    s_or_b32 s50, s2, s32
    s_cmp_lg_u32 s50, 0
    s_cbranch_scc1 L_nw_2
    s_memrealtime s[52:53]
    s_waitcnt lgkmcnt(0)
    s_or_b32 s53, s53, 0x40000000
    v_mov_b32 v16, s52
    v_mov_b32 v17, s53
    v_mov_b32 v18, 0
    buffer_store_dwordx2 v[16:17], v18, s[88:91], 0 offen offset:8 sc1
L_nw_2:
    s_nop 1
    v_and_b32 v246, 7, v7
    v_bfe_u32 v247, v7, 3, 2
    v_lshrrev_b32 v248, 5, v7
    s_lshl_b32 s50, s32, 1
    v_add_u32 v248, s50, v248
    s_lshr_b32 s50, s98, 2
    s_mul_i32 s50, s50, 36864
    s_bfe_u32 s51, s98, 0x10001
    s_lshl_b32 s51, s51, 10
    s_add_u32 s50, s50, s51
    s_and_b32 s51, s98, 1
    s_lshl_b32 s51, s51, 7
    s_add_u32 s50, s50, s51
    v_lshlrev_b32 v16, 11, v248
    v_lshl_add_u32 v16, v247, 8, v16
    v_lshl_add_u32 v16, v246, 4, v16
    v_add_u32 v16, s50, v16
    s_mul_i32 s50, s98, 9216
    v_mul_u32_u24 v17, 1152, v246
    v_lshl_add_u32 v17, v248, 6, v17
    v_lshl_add_u32 v17, v247, 3, v17
    v_add_u32 v17, s50, v17
    v_lshlrev_b32 v18, 7, v248
    v_lshl_add_u32 v18, v247, 4, v18
    s_cmp_lg_u32 s32, 0
    s_cbranch_scc1 L_itb_3
    buffer_load_dwordx2 v[24:25], v17, s[80:83], 0 offen offset:1024
    buffer_load_dwordx2 v[26:27], v17, s[80:83], 0 offen offset:1056
L_itb_3:
    buffer_load_dwordx2 v[20:21], v17, s[80:83], 0 offen offset:0
    buffer_load_dwordx2 v[22:23], v17, s[80:83], 0 offen offset:32
    s_cmp_lg_u32 s32, 7
    s_cbranch_scc1 L_cpf_4
    s_getpc_b64 s[50:51]
L_pc_5:
    s_lshr_b32 s4, s2, 3
    s_mul_i32 s4, s4, 18
    v_min_u32 v246, 17, v7
    v_add_u32 v246, s4, v246
    v_lshlrev_b32 v246, 7, v246
    v_min_u32 v246, (L_main_end - L_pc_5 - 4), v246
    v_mov_b32 v247, s51
    v_add_co_u32 v246, vcc, s50, v246
    s_nop 1
    v_addc_co_u32 v247, vcc, 0, v247, vcc
    global_load_dword v200, v[246:247], off
L_cpf_4:
    s_nop 1
    s_load_dwordx2 s[40:41], s[0:1], 24
    s_load_dwordx2 s[48:49], s[0:1], 104
    s_load_dwordx2 s[42:43], s[0:1], 8
    s_load_dwordx2 s[44:45], s[0:1], 16
    s_load_dwordx2 s[46:47], s[0:1], 32
    v_lshlrev_b32 v1, 4, v7
    s_lshl_b32 s39, s32, 10
    s_lshl_b32 s51, s32, 15
    v_lshrrev_b32 v36, 4, v7
    s_and_b32 s50, s32, 1
    s_lshl_b32 s50, s50, 2
    v_add_u32 v37, s50, v36
    v_lshlrev_b32 v37, 1, v37
    v_and_b32 v2, 15, v7
    v_xor_b32 v2, v2, v37
    v_lshlrev_b32 v2, 4, v2
    s_mov_b32 s50, 8192
    v_mul_lo_u32 v36, v36, s50
    v_add_u32 v2, v2, v36
    v_add_u32 v2, s51, v2
    s_lshr_b32 s50, s32, 1
    s_mul_i32 s50, s50, 36864
    s_and_b32 s51, s32, 1
    s_lshl_b32 s51, s51, 10
    s_add_u32 s50, s50, s51
    v_add_u32 v230, s50, v1
    s_lshl_b32 s50, s33, 9
    s_waitcnt lgkmcnt(0)
    s_mov_b32 s8, s40
    s_mov_b32 s9, s41
    s_mov_b32 s10, 0x480000
    s_add_u32 s8, s8, s50
    s_addc_u32 s9, s9, 0
    s_sub_u32 s10, s10, s50
    s_mov_b32 s11, 0x00020000
    s_mul_i32 s50, s34, 147456
    s_add_u32 s24, s48, 0x10000
    s_addc_u32 s25, s49, 0
    s_mov_b32 s26, 0x240000
    s_add_u32 s24, s24, s50
    s_addc_u32 s25, s25, 0
    s_sub_u32 s26, s26, s50
    s_mov_b32 s27, 0x00020000
    s_cmp_ge_u32 s2, 108
    s_cbranch_scc0 L_cd_6
    s_add_u32 m0, s39, 0x4000
    s_mov_b32 s57, 0x0
    buffer_load_dwordx4 v2, s[8:11], s57 offen lds
    s_add_u32 m0, s39, 0x6000
    s_mov_b32 s58, 0x100
    buffer_load_dwordx4 v2, s[8:11], s58 offen lds
    s_add_u32 m0, s39, 0x8000
    s_mov_b32 s59, 0x40000
    buffer_load_dwordx4 v2, s[8:11], s59 offen lds
    s_add_u32 m0, s39, 0xa000
    s_mov_b32 s60, 0x40100
    buffer_load_dwordx4 v2, s[8:11], s60 offen lds
    s_add_u32 m0, s39, 0x10000
    s_mov_b32 s61, 0x80000
    buffer_load_dwordx4 v2, s[8:11], s61 offen lds
    s_add_u32 m0, s39, 0x12000
    s_mov_b32 s62, 0x80100
    buffer_load_dwordx4 v2, s[8:11], s62 offen lds
    s_add_u32 m0, s39, 0x14000
    s_mov_b32 s63, 0xc0000
    buffer_load_dwordx4 v2, s[8:11], s63 offen lds
    s_add_u32 m0, s39, 0x16000
    s_mov_b32 s56, 0xc0100
    buffer_load_dwordx4 v2, s[8:11], s56 offen lds
    s_add_u32 m0, s39, 0x1c000
    s_mov_b32 s57, 0x100000
    buffer_load_dwordx4 v2, s[8:11], s57 offen lds
    s_add_u32 m0, s39, 0x1e000
    s_mov_b32 s58, 0x100100
    buffer_load_dwordx4 v2, s[8:11], s58 offen lds
    s_add_u32 m0, s39, 0x20000
    s_mov_b32 s59, 0x140000
    buffer_load_dwordx4 v2, s[8:11], s59 offen lds
    s_add_u32 m0, s39, 0x22000
    s_mov_b32 s60, 0x140100
    buffer_load_dwordx4 v2, s[8:11], s60 offen lds
L_cd_6:
    s_nop 1
    s_cmp_lt_u32 s34, 7
    s_cbranch_scc1 L_pfq_7
    s_sub_u32 s50, s34, 7
    s_lshl_b32 s50, s50, 3
    s_add_u32 s50, s50, s32
    s_mul_i32 s50, s50, 32
    v_add_u32 v250, s50, v7
    v_lshrrev_b32 v251, 2, v250
    s_mov_b32 s50, 8192
    v_mul_lo_u32 v251, v251, s50
    v_and_b32 v250, 3, v250
    v_lshl_add_u32 v251, v250, 7, v251
    v_cmp_gt_u32 vcc, 32, v7
    s_nop 1
    v_cndmask_b32 v251, -16, v251, vcc
    buffer_load_dword v240, v251, s[8:11], 0 offen
L_pfq_7:
    s_nop 1
    s_lshl_b32 s50, s33, 19
    s_add_u32 s12, s42, 0x60000
    s_addc_u32 s13, s43, 0
    s_mov_b32 s14, 0x7a0000
    s_add_u32 s12, s12, s50
    s_addc_u32 s13, s13, 0
    s_sub_u32 s14, s14, s50
    s_mov_b32 s15, 0x00020000
    s_add_u32 s16, s44, 0x60000
    s_addc_u32 s17, s45, 0
    s_mov_b32 s18, 0x7a0000
    s_add_u32 s16, s16, s50
    s_addc_u32 s17, s17, 0
    s_sub_u32 s18, s18, s50
    s_mov_b32 s19, 0x00020000
    s_mul_i32 s50, s33, 294912
    s_mov_b32 s20, s46
    s_mov_b32 s21, s47
    s_mov_b32 s22, 0x480000
    s_add_u32 s20, s20, s50
    s_addc_u32 s21, s21, 0
    s_sub_u32 s22, s22, s50
    s_mov_b32 s23, 0x00020000
    s_mul_i32 s50, s37, 589824
    s_mul_i32 s51, s33, 9216
    s_add_u32 s50, s50, s51
    s_add_u32 s28, s48, 0x800000
    s_addc_u32 s29, s49, 0
    s_mov_b32 s30, 0x2400000
    s_add_u32 s28, s28, s50
    s_addc_u32 s29, s29, 0
    s_sub_u32 s30, s30, s50
    s_mov_b32 s31, 0x00020000
    v_bfe_u32 v36, v7, 3, 1
    s_mov_b32 s50, 147456
    v_mul_lo_u32 v245, v36, s50
    v_lshrrev_b32 v36, 4, v7
    v_lshl_add_u32 v245, v36, 7, v245
    v_and_b32 v36, 7, v7
    v_lshl_add_u32 v245, v36, 4, v245
    s_mov_b32 s52, 0x5f800000
    s_mov_b32 s53, 0x3e0293ee
    v_lshrrev_b32 v36, 4, v7
    s_and_b32 s50, s32, 1
    s_lshl_b32 s50, s50, 2
    v_add_u32 v37, s50, v36
    v_lshlrev_b32 v37, 1, v37
    v_and_b32 v4, 15, v7
    v_xor_b32 v4, v4, v37
    v_lshlrev_b32 v4, 4, v4
    s_mov_b32 s50, 256
    v_mul_lo_u32 v36, v36, s50
    v_add_u32 v4, v4, v36
    v_add_u32 v4, s39, v4
    s_mul_i32 s51, s32, 4608
    v_lshrrev_b32 v36, 4, v7
    s_and_b32 s50, s32, 1
    s_lshl_b32 s50, s50, 2
    v_add_u32 v37, s50, v36
    v_lshlrev_b32 v37, 1, v37
    v_and_b32 v5, 15, v7
    v_xor_b32 v5, v5, v37
    v_lshlrev_b32 v5, 4, v5
    s_mov_b32 s50, 1152
    v_mul_lo_u32 v36, v36, s50
    v_add_u32 v5, v5, v36
    v_add_u32 v5, s51, v5
    s_mul_i32 s51, s32, 9216
    v_lshrrev_b32 v36, 3, v7
    v_bfe_u32 v37, v36, 1, 2
    v_lshlrev_b32 v37, 1, v37
    v_and_b32 v6, 7, v7
    v_xor_b32 v6, v6, v37
    v_lshlrev_b32 v6, 4, v6
    s_mov_b32 s50, 1152
    v_mul_lo_u32 v36, v36, s50
    v_add_u32 v6, v6, v36
    v_add_u32 v6, s51, v6
    v_lshrrev_b32 v36, 4, v7
    s_lshl_b32 s50, s35, 2
    v_add_u32 v37, s50, v36
    v_and_b32 v3, 15, v7
    v_xor_b32 v3, v3, v37
    v_lshlrev_b32 v3, 4, v3
    v_lshl_add_u32 v3, v36, 8, v3
    v_add_u32 v3, s39, v3
    v_lshrrev_b32 v36, 2, v7
    v_and_b32 v37, 7, v36
    v_lshlrev_b32 v37, 5, v37
    v_lshl_add_u32 v37, v36, 8, v37
    v_and_b32 v36, 3, v7
    v_lshl_add_u32 v232, v36, 3, v37
    s_lshl_b32 s54, s36, 13
    v_add_u32 v8, s54, v232
    v_xor_b32 v9, 32, v8
    v_xor_b32 v233, 32, v232
    v_xor_b32 v10, 64, v8
    v_xor_b32 v234, 64, v232
    v_xor_b32 v11, 96, v8
    v_xor_b32 v235, 96, v232
    v_xor_b32 v12, 128, v8
    v_xor_b32 v236, 128, v232
    v_xor_b32 v13, 160, v8
    v_xor_b32 v237, 160, v232
    v_xor_b32 v14, 192, v8
    v_xor_b32 v238, 192, v232
    v_xor_b32 v15, 224, v8
    v_xor_b32 v239, 224, v232
    s_lshl_b32 s50, s35, 11
    v_add_u32 v231, s50, v1
    v_and_b32 v36, 15, v7
    v_lshrrev_b32 v37, 5, v7
    v_xor_b32 v37, v37, v36
    v_lshlrev_b32 v37, 4, v37
    v_lshl_add_u32 v37, v36, 8, v37
    v_bfe_u32 v36, v7, 4, 1
    v_lshl_add_u32 v208, v36, 3, v37
    v_xor_b32 v209, 32, v208
    v_xor_b32 v210, 64, v208
    v_xor_b32 v211, 96, v208
    v_xor_b32 v212, 128, v208
    v_xor_b32 v213, 160, v208
    v_xor_b32 v214, 192, v208
    v_xor_b32 v215, 224, v208
    s_lshl_b32 s55, s36, 7
    v_xor_b32 v216, s55, v232
    s_lshl_b32 s50, s36, 14
    s_xor_b32 s51, s50, 16384
    v_add_u32 v220, s51, v216
    v_add_u32 v216, s50, v216
    v_xor_b32 v217, 32, v216
    v_xor_b32 v221, 32, v220
    v_xor_b32 v218, 64, v216
    v_xor_b32 v222, 64, v220
    v_xor_b32 v219, 96, v216
    v_xor_b32 v223, 96, v220
    s_lshl_b32 s55, s36, 1
    v_lshrrev_b32 v36, 2, v7
    v_bfe_u32 v37, v36, 1, 2
    v_xor_b32 v37, s55, v37
    v_lshlrev_b32 v37, 5, v37
    v_lshl_add_u32 v37, v36, 7, v37
    v_and_b32 v36, 3, v7
    v_lshl_add_u32 v224, v36, 3, v37
    v_add_u32 v226, s51, v224
    v_add_u32 v224, s50, v224
    v_xor_b32 v225, 32, v224
    v_xor_b32 v227, 32, v226
    s_lshl_b32 s50, s32, 13
    s_add_u32 s50, s50, 49152
    v_add_u32 v228, s50, v1
    s_xor_b32 s50, s32, 4
    s_lshl_b32 s50, s50, 13
    s_add_u32 s50, s50, 49152
    v_add_u32 v229, s50, v1
    v_mov_b32 v246, 0
    buffer_load_dwordx2 v[156:157], v246, s[88:91], 0 offen offset:8 sc1
    s_cmp_ge_u32 s2, 108
    s_cbranch_scc1 L_modskip_8
    s_waitcnt vmcnt(8)
    v_lshlrev_b32 v120, 16, v120
    v_mul_f32 v116, 0xbfb8aa3b, v120
    v_exp_f32 v116, v116
    s_nop 0
    v_add_f32 v116, 1.0, v116
    v_rcp_f32 v116, v116
    s_nop 0
    v_mul_f32 v120, v120, v116
    v_cvt_pk_bf16_f32 v116, v120, v120
    v_and_b32 v120, 0xffff0000, v116
    v_lshlrev_b32 v121, 16, v121
    v_mul_f32 v116, 0xbfb8aa3b, v121
    v_exp_f32 v116, v116
    s_nop 0
    v_add_f32 v116, 1.0, v116
    v_rcp_f32 v116, v116
    s_nop 0
    v_mul_f32 v121, v121, v116
    v_cvt_pk_bf16_f32 v116, v121, v121
    v_and_b32 v121, 0xffff0000, v116
    v_lshlrev_b32 v122, 16, v122
    v_mul_f32 v116, 0xbfb8aa3b, v122
    v_exp_f32 v116, v116
    s_nop 0
    v_add_f32 v116, 1.0, v116
    v_rcp_f32 v116, v116
    s_nop 0
    v_mul_f32 v122, v122, v116
    v_cvt_pk_bf16_f32 v116, v122, v122
    v_and_b32 v122, 0xffff0000, v116
    v_lshlrev_b32 v123, 16, v123
    v_mul_f32 v116, 0xbfb8aa3b, v123
    v_exp_f32 v116, v116
    s_nop 0
    v_add_f32 v116, 1.0, v116
    v_rcp_f32 v116, v116
    s_nop 0
    v_mul_f32 v123, v123, v116
    v_cvt_pk_bf16_f32 v116, v123, v123
    v_and_b32 v123, 0xffff0000, v116
    v_lshlrev_b32 v124, 16, v124
    v_mul_f32 v116, 0xbfb8aa3b, v124
    v_exp_f32 v116, v116
    s_nop 0
    v_add_f32 v116, 1.0, v116
    v_rcp_f32 v116, v116
    s_nop 0
    v_mul_f32 v124, v124, v116
    v_cvt_pk_bf16_f32 v116, v124, v124
    v_and_b32 v124, 0xffff0000, v116
    s_waitcnt vmcnt(7)
    v_lshlrev_b32 v116, 16, v128
    v_and_b32 v117, 0xffff0000, v128
    v_mul_f32 v148, v116, v120
    v_mul_f32 v149, v117, v120
    v_lshlrev_b32 v116, 16, v129
    v_and_b32 v117, 0xffff0000, v129
    v_mul_f32 v150, v116, v120
    v_mul_f32 v151, v117, v120
    v_lshlrev_b32 v116, 16, v130
    v_and_b32 v117, 0xffff0000, v130
    v_mul_f32 v152, v116, v120
    v_mul_f32 v153, v117, v120
    v_lshlrev_b32 v116, 16, v131
    v_and_b32 v117, 0xffff0000, v131
    v_mul_f32 v154, v116, v120
    v_mul_f32 v155, v117, v120
    s_waitcnt vmcnt(6)
    v_lshlrev_b32 v116, 16, v132
    v_and_b32 v117, 0xffff0000, v132
    v_fmac_f32 v148, v116, v121
    v_fmac_f32 v149, v117, v121
    v_lshlrev_b32 v116, 16, v133
    v_and_b32 v117, 0xffff0000, v133
    v_fmac_f32 v150, v116, v121
    v_fmac_f32 v151, v117, v121
    v_lshlrev_b32 v116, 16, v134
    v_and_b32 v117, 0xffff0000, v134
    v_fmac_f32 v152, v116, v121
    v_fmac_f32 v153, v117, v121
    v_lshlrev_b32 v116, 16, v135
    v_and_b32 v117, 0xffff0000, v135
    v_fmac_f32 v154, v116, v121
    v_fmac_f32 v155, v117, v121
    s_waitcnt vmcnt(5)
    v_lshlrev_b32 v116, 16, v136
    v_and_b32 v117, 0xffff0000, v136
    v_fmac_f32 v148, v116, v122
    v_fmac_f32 v149, v117, v122
    v_lshlrev_b32 v116, 16, v137
    v_and_b32 v117, 0xffff0000, v137
    v_fmac_f32 v150, v116, v122
    v_fmac_f32 v151, v117, v122
    v_lshlrev_b32 v116, 16, v138
    v_and_b32 v117, 0xffff0000, v138
    v_fmac_f32 v152, v116, v122
    v_fmac_f32 v153, v117, v122
    v_lshlrev_b32 v116, 16, v139
    v_and_b32 v117, 0xffff0000, v139
    v_fmac_f32 v154, v116, v122
    v_fmac_f32 v155, v117, v122
    s_waitcnt vmcnt(4)
    v_lshlrev_b32 v116, 16, v140
    v_and_b32 v117, 0xffff0000, v140
    v_fmac_f32 v148, v116, v123
    v_fmac_f32 v149, v117, v123
    v_lshlrev_b32 v116, 16, v141
    v_and_b32 v117, 0xffff0000, v141
    v_fmac_f32 v150, v116, v123
    v_fmac_f32 v151, v117, v123
    v_lshlrev_b32 v116, 16, v142
    v_and_b32 v117, 0xffff0000, v142
    v_fmac_f32 v152, v116, v123
    v_fmac_f32 v153, v117, v123
    v_lshlrev_b32 v116, 16, v143
    v_and_b32 v117, 0xffff0000, v143
    v_fmac_f32 v154, v116, v123
    v_fmac_f32 v155, v117, v123
    s_waitcnt vmcnt(3)
    v_lshlrev_b32 v116, 16, v144
    v_and_b32 v117, 0xffff0000, v144
    v_fmac_f32 v148, v116, v124
    v_fmac_f32 v149, v117, v124
    v_lshlrev_b32 v116, 16, v145
    v_and_b32 v117, 0xffff0000, v145
    v_fmac_f32 v150, v116, v124
    v_fmac_f32 v151, v117, v124
    v_lshlrev_b32 v116, 16, v146
    v_and_b32 v117, 0xffff0000, v146
    v_fmac_f32 v152, v116, v124
    v_fmac_f32 v153, v117, v124
    v_lshlrev_b32 v116, 16, v147
    v_and_b32 v117, 0xffff0000, v147
    v_fmac_f32 v154, v116, v124
    v_fmac_f32 v155, v117, v124
    v_add_f32_dpp v148, v148, v148 row_ror:8 row_mask:0xf bank_mask:0xf
    v_add_f32_dpp v149, v149, v149 row_ror:8 row_mask:0xf bank_mask:0xf
    v_add_f32_dpp v150, v150, v150 row_ror:8 row_mask:0xf bank_mask:0xf
    v_add_f32_dpp v151, v151, v151 row_ror:8 row_mask:0xf bank_mask:0xf
    v_add_f32_dpp v152, v152, v152 row_ror:8 row_mask:0xf bank_mask:0xf
    v_add_f32_dpp v153, v153, v153 row_ror:8 row_mask:0xf bank_mask:0xf
    v_add_f32_dpp v154, v154, v154 row_ror:8 row_mask:0xf bank_mask:0xf
    v_add_f32_dpp v155, v155, v155 row_ror:8 row_mask:0xf bank_mask:0xf
    v_add_f32_dpp v148, v148, v148 row_ror:4 row_mask:0xf bank_mask:0xf
    v_add_f32_dpp v149, v149, v149 row_ror:4 row_mask:0xf bank_mask:0xf
    v_add_f32_dpp v150, v150, v150 row_ror:4 row_mask:0xf bank_mask:0xf
    v_add_f32_dpp v151, v151, v151 row_ror:4 row_mask:0xf bank_mask:0xf
    v_add_f32_dpp v152, v152, v152 row_ror:4 row_mask:0xf bank_mask:0xf
    v_add_f32_dpp v153, v153, v153 row_ror:4 row_mask:0xf bank_mask:0xf
    v_add_f32_dpp v154, v154, v154 row_ror:4 row_mask:0xf bank_mask:0xf
    v_add_f32_dpp v155, v155, v155 row_ror:4 row_mask:0xf bank_mask:0xf
    s_lshl_b32 s50, s32, 9
    s_add_u32 s50, s50, 147456
    v_lshrrev_b32 v116, 4, v7
    v_lshlrev_b32 v117, 7, v116
    v_lshl_add_u32 v117, v112, 5, v117
    v_add_u32 v117, s50, v117
    v_and_b32 v116, 12, v7
    v_cmp_eq_u32 vcc, 0, v116
    s_nop 0
    s_and_saveexec_b64 s[50:51], vcc
    ds_write_b128 v117, v[148:151]
    ds_write_b128 v117, v[152:155] offset:16
    s_mov_b64 exec, s[50:51]
    s_waitcnt lgkmcnt(0)
    s_barrier
    s_cmp_lg_u32 s32, 0
    s_cbranch_scc1 L_modw_9
    v_and_b32 v112, 31, v7
    v_lshrrev_b32 v116, 5, v7
    v_lshlrev_b32 v116, 11, v116
    v_lshl_add_u32 v116, v112, 2, v116
    v_add_u32 v116, 147456, v116
    ds_read_b32 v128, v116 offset:0
    ds_read_b32 v129, v116 offset:128
    ds_read_b32 v130, v116 offset:256
    ds_read_b32 v131, v116 offset:384
    ds_read_b32 v132, v116 offset:512
    ds_read_b32 v133, v116 offset:640
    ds_read_b32 v134, v116 offset:768
    ds_read_b32 v135, v116 offset:896
    ds_read_b32 v136, v116 offset:1024
    ds_read_b32 v137, v116 offset:1152
    ds_read_b32 v138, v116 offset:1280
    ds_read_b32 v139, v116 offset:1408
    ds_read_b32 v140, v116 offset:1536
    ds_read_b32 v141, v116 offset:1664
    ds_read_b32 v142, v116 offset:1792
    ds_read_b32 v143, v116 offset:1920
    s_waitcnt lgkmcnt(14)
    v_add_f32 v128, v128, v129
    s_waitcnt lgkmcnt(13)
    v_add_f32 v128, v128, v130
    s_waitcnt lgkmcnt(12)
    v_add_f32 v128, v128, v131
    s_waitcnt lgkmcnt(11)
    v_add_f32 v128, v128, v132
    s_waitcnt lgkmcnt(10)
    v_add_f32 v128, v128, v133
    s_waitcnt lgkmcnt(9)
    v_add_f32 v128, v128, v134
    s_waitcnt lgkmcnt(8)
    v_add_f32 v128, v128, v135
    s_waitcnt lgkmcnt(7)
    v_add_f32 v128, v128, v136
    s_waitcnt lgkmcnt(6)
    v_add_f32 v128, v128, v137
    s_waitcnt lgkmcnt(5)
    v_add_f32 v128, v128, v138
    s_waitcnt lgkmcnt(4)
    v_add_f32 v128, v128, v139
    s_waitcnt lgkmcnt(3)
    v_add_f32 v128, v128, v140
    s_waitcnt lgkmcnt(2)
    v_add_f32 v128, v128, v141
    s_waitcnt lgkmcnt(1)
    v_add_f32 v128, v128, v142
    s_waitcnt lgkmcnt(0)
    v_add_f32 v128, v128, v143
    v_mov_b32 v116, v128
    s_nop 0
    s_nop 0
    v_permlane32_swap_b32 v128, v116
    v_add_f32 v128, v128, v116
    v_cvt_pk_bf16_f32 v116, v128, v128
    v_and_b32 v128, 0xffff0000, v116
    s_waitcnt vmcnt(0)
    v_readfirstlane_b32 s96, v156
    v_readfirstlane_b32 s97, v157
    s_nop 0
    s_cmp_lg_u32 s97, 0
    s_cbranch_scc1 L_ng_10
    v_mov_b32 v120, 0
    s_mov_b32 s50, 0
L_nrl_11:
    buffer_load_dwordx2 v[122:123], v120, s[88:91], 0 offen offset:8 sc1
    s_waitcnt vmcnt(0)
    v_readfirstlane_b32 s96, v122
    v_readfirstlane_b32 s97, v123
    s_add_u32 s50, s50, 1
    s_cmp_lg_u32 s97, 0
    s_cbranch_scc1 L_nrd_12
    s_cmp_ge_u32 s50, 20000
    s_cbranch_scc1 L_nrd_12
    s_sleep 4
    s_branch L_nrl_11
L_nrd_12:
    s_nop 3
L_ng_10:
    s_nop 3
    s_cmp_lt_u32 s2, 36
    s_cselect_b32 s50, s96, 0
    v_and_b32 v116, 1, v7
    v_lshlrev_b32 v116, 4, v116
    v_lshrrev_b32 v116, v116, s50
    v_and_b32 v116, 0xffff, v116
    v_or_b32 v128, v128, v116
    v_lshlrev_b32 v117, 2, v112
    s_lshl_b32 s50, s2, 7
    s_add_u32 s50, s50, 0
    buffer_store_dword v128, v117, s[76:79], s50 offen sc1
    v_mov_b32 v120, 0
    s_mov_b32 s50, 0
L_nrl_13:
    buffer_load_dwordx2 v[122:123], v120, s[88:91], 0 offen offset:8 sc1
    s_waitcnt vmcnt(0)
    v_readfirstlane_b32 s96, v122
    v_readfirstlane_b32 s97, v123
    s_add_u32 s50, s50, 1
    s_cmp_lg_u32 s97, 0
    s_cbranch_scc1 L_nrd_14
    s_cmp_ge_u32 s50, 20000
    s_cbranch_scc1 L_nrd_14
    s_sleep 4
    s_branch L_nrl_13
L_nrd_14:
    s_nop 3
    v_lshlrev_b32 v116, 10, v7
    v_mov_b32 v122, s96
    v_mov_b32 v123, s97
    s_lshl_b32 s50, s2, 3
    s_add_u32 s50, s50, 49152
    v_cmp_gt_u32 vcc, 8, v7
    s_nop 0
    s_and_saveexec_b64 s[4:5], vcc
    buffer_store_dwordx2 v[122:123], v116, s[76:79], s50 offen sc1
    s_mov_b64 exec, s[4:5]
L_modw_9:
    s_waitcnt lgkmcnt(0)
L_modskip_8:
    s_nop 1
    v_and_b32 v255, 7, v7
    v_lshlrev_b32 v255, 5, v255
    v_add_u32 v255, 155648, v255
    s_lshl_b32 s50, s32, 2
    v_add_u32 v254, s50, v255
    s_waitcnt vmcnt(1)
    v_lshlrev_b32 v76, 16, v20
    v_and_b32 v77, 0xffff0000, v20
    v_lshlrev_b32 v78, 16, v21
    v_and_b32 v79, 0xffff0000, v21
    s_waitcnt vmcnt(0)
    v_lshlrev_b32 v80, 16, v22
    v_and_b32 v81, 0xffff0000, v22
    v_lshlrev_b32 v82, 16, v23
    v_and_b32 v83, 0xffff0000, v23
    v_add_f32 v252, v76, v77
    v_add_f32 v252, v252, v78
    v_add_f32 v252, v252, v79
    v_add_f32 v252, v252, v80
    v_add_f32 v252, v252, v81
    v_add_f32 v252, v252, v82
    v_add_f32 v252, v252, v83
    s_cmp_lg_u32 s32, 0
    s_cbranch_scc1 L_itb_15
    v_lshlrev_b32 v84, 16, v24
    v_and_b32 v85, 0xffff0000, v24
    v_lshlrev_b32 v86, 16, v25
    v_and_b32 v87, 0xffff0000, v25
    v_lshlrev_b32 v88, 16, v26
    v_and_b32 v89, 0xffff0000, v26
    v_lshlrev_b32 v90, 16, v27
    v_and_b32 v91, 0xffff0000, v27
    v_add_f32 v252, v252, v84
    v_add_f32 v252, v252, v85
    v_add_f32 v252, v252, v86
    v_add_f32 v252, v252, v87
    v_add_f32 v252, v252, v88
    v_add_f32 v252, v252, v89
    v_add_f32 v252, v252, v90
    v_add_f32 v252, v252, v91
L_itb_15:
    s_nop 1
    v_add_f32_dpp v246, v252, v252 row_ror:8 row_mask:0xf bank_mask:0xf
    v_mov_b32 v252, v246
    s_nop 1
    v_permlane16_swap_b32 v252, v246
    v_add_f32 v252, v252, v246
    v_mov_b32 v246, v252
    s_nop 0
    s_nop 0
    v_permlane32_swap_b32 v252, v246
    v_add_f32 v252, v252, v246
    v_cmp_gt_u32 vcc, 8, v7
    s_nop 0
    s_and_saveexec_b64 s[50:51], vcc
    ds_write_b32 v254, v252 offset:0
    s_mov_b64 exec, s[50:51]
    s_waitcnt lgkmcnt(0)
    s_barrier
    ds_read_b128 v[92:95], v255 offset:0
    ds_read_b128 v[96:99], v255 offset:16
    s_waitcnt lgkmcnt(1)
    v_add_f32 v252, v92, v93
    v_add_f32 v252, v252, v94
    v_add_f32 v252, v252, v95
    s_waitcnt lgkmcnt(0)
    v_add_f32 v252, v252, v96
    v_add_f32 v252, v252, v97
    v_add_f32 v252, v252, v98
    v_add_f32 v252, v252, v99
    v_mul_f32 v253, 0x3ae38e39, v252
    v_sub_f32 v248, v76, v253
    v_mul_f32 v252, v248, v248
    v_sub_f32 v248, v77, v253
    v_fmac_f32 v252, v248, v248
    v_sub_f32 v248, v78, v253
    v_fmac_f32 v252, v248, v248
    v_sub_f32 v248, v79, v253
    v_fmac_f32 v252, v248, v248
    v_sub_f32 v248, v80, v253
    v_fmac_f32 v252, v248, v248
    v_sub_f32 v248, v81, v253
    v_fmac_f32 v252, v248, v248
    v_sub_f32 v248, v82, v253
    v_fmac_f32 v252, v248, v248
    v_sub_f32 v248, v83, v253
    v_fmac_f32 v252, v248, v248
    s_cmp_lg_u32 s32, 0
    s_cbranch_scc1 L_itb_16
    v_sub_f32 v248, v84, v253
    v_fmac_f32 v252, v248, v248
    v_sub_f32 v248, v85, v253
    v_fmac_f32 v252, v248, v248
    v_sub_f32 v248, v86, v253
    v_fmac_f32 v252, v248, v248
    v_sub_f32 v248, v87, v253
    v_fmac_f32 v252, v248, v248
    v_sub_f32 v248, v88, v253
    v_fmac_f32 v252, v248, v248
    v_sub_f32 v248, v89, v253
    v_fmac_f32 v252, v248, v248
    v_sub_f32 v248, v90, v253
    v_fmac_f32 v252, v248, v248
    v_sub_f32 v248, v91, v253
    v_fmac_f32 v252, v248, v248
L_itb_16:
    s_nop 1
    v_add_f32_dpp v246, v252, v252 row_ror:8 row_mask:0xf bank_mask:0xf
    v_mov_b32 v252, v246
    s_nop 1
    v_permlane16_swap_b32 v252, v246
    v_add_f32 v252, v252, v246
    v_mov_b32 v246, v252
    s_nop 0
    s_nop 0
    v_permlane32_swap_b32 v252, v246
    v_add_f32 v252, v252, v246
    v_cmp_gt_u32 vcc, 8, v7
    s_nop 0
    s_and_saveexec_b64 s[50:51], vcc
    ds_write_b32 v254, v252 offset:256
    s_mov_b64 exec, s[50:51]
    s_waitcnt lgkmcnt(0)
    s_barrier
    ds_read_b128 v[92:95], v255 offset:256
    ds_read_b128 v[96:99], v255 offset:272
    s_waitcnt lgkmcnt(1)
    v_add_f32 v252, v92, v93
    v_add_f32 v252, v252, v94
    v_add_f32 v252, v252, v95
    s_waitcnt lgkmcnt(0)
    v_add_f32 v252, v252, v96
    v_add_f32 v252, v252, v97
    v_add_f32 v252, v252, v98
    v_add_f32 v252, v252, v99
    v_mul_f32 v252, 0x3ae38e39, v252
    v_cvt_pk_bf16_f32 v246, v252, v253
    v_lshlrev_b32 v252, 16, v246
    v_and_b32 v253, 0xffff0000, v246
    v_add_f32 v252, 0x3727c5ac, v252
    v_cvt_pk_bf16_f32 v246, v252, v252
    v_and_b32 v252, 0xffff0000, v246
    v_sqrt_f32 v252, v252
    s_nop 0
    v_cvt_pk_bf16_f32 v246, v252, v252
    v_and_b32 v252, 0xffff0000, v246
    v_rcp_f32 v252, v252
    v_sub_f32 v76, v76, v253
    v_sub_f32 v77, v77, v253
    v_sub_f32 v78, v78, v253
    v_sub_f32 v79, v79, v253
    v_sub_f32 v80, v80, v253
    v_sub_f32 v81, v81, v253
    v_sub_f32 v82, v82, v253
    v_sub_f32 v83, v83, v253
    v_cvt_pk_bf16_f32 v246, v76, v77
    v_lshlrev_b32 v76, 16, v246
    v_and_b32 v77, 0xffff0000, v246
    v_cvt_pk_bf16_f32 v246, v78, v79
    v_lshlrev_b32 v78, 16, v246
    v_and_b32 v79, 0xffff0000, v246
    v_cvt_pk_bf16_f32 v246, v80, v81
    v_lshlrev_b32 v80, 16, v246
    v_and_b32 v81, 0xffff0000, v246
    v_cvt_pk_bf16_f32 v246, v82, v83
    v_lshlrev_b32 v82, 16, v246
    v_and_b32 v83, 0xffff0000, v246
    v_mul_f32 v76, v76, v252
    v_mul_f32 v77, v77, v252
    v_mul_f32 v78, v78, v252
    v_mul_f32 v79, v79, v252
    v_mul_f32 v80, v80, v252
    v_mul_f32 v81, v81, v252
    v_mul_f32 v82, v82, v252
    v_mul_f32 v83, v83, v252
    v_cvt_pk_bf16_f32 v246, v76, v77
    v_lshlrev_b32 v76, 16, v246
    v_and_b32 v77, 0xffff0000, v246
    v_cvt_pk_bf16_f32 v246, v78, v79
    v_lshlrev_b32 v78, 16, v246
    v_and_b32 v79, 0xffff0000, v246
    v_cvt_pk_bf16_f32 v246, v80, v81
    v_lshlrev_b32 v80, 16, v246
    v_and_b32 v81, 0xffff0000, v246
    v_cvt_pk_bf16_f32 v246, v82, v83
    v_lshlrev_b32 v82, 16, v246
    v_and_b32 v83, 0xffff0000, v246
    s_cmp_lg_u32 s32, 0
    s_cbranch_scc1 L_itb_17
    v_sub_f32 v84, v84, v253
    v_sub_f32 v85, v85, v253
    v_sub_f32 v86, v86, v253
    v_sub_f32 v87, v87, v253
    v_sub_f32 v88, v88, v253
    v_sub_f32 v89, v89, v253
    v_sub_f32 v90, v90, v253
    v_sub_f32 v91, v91, v253
    v_cvt_pk_bf16_f32 v246, v84, v85
    v_lshlrev_b32 v84, 16, v246
    v_and_b32 v85, 0xffff0000, v246
    v_cvt_pk_bf16_f32 v246, v86, v87
    v_lshlrev_b32 v86, 16, v246
    v_and_b32 v87, 0xffff0000, v246
    v_cvt_pk_bf16_f32 v246, v88, v89
    v_lshlrev_b32 v88, 16, v246
    v_and_b32 v89, 0xffff0000, v246
    v_cvt_pk_bf16_f32 v246, v90, v91
    v_lshlrev_b32 v90, 16, v246
    v_and_b32 v91, 0xffff0000, v246
    v_mul_f32 v84, v84, v252
    v_mul_f32 v85, v85, v252
    v_mul_f32 v86, v86, v252
    v_mul_f32 v87, v87, v252
    v_mul_f32 v88, v88, v252
    v_mul_f32 v89, v89, v252
    v_mul_f32 v90, v90, v252
    v_mul_f32 v91, v91, v252
    v_cvt_pk_bf16_f32 v246, v84, v85
    v_lshlrev_b32 v84, 16, v246
    v_and_b32 v85, 0xffff0000, v246
    v_cvt_pk_bf16_f32 v246, v86, v87
    v_lshlrev_b32 v86, 16, v246
    v_and_b32 v87, 0xffff0000, v246
    v_cvt_pk_bf16_f32 v246, v88, v89
    v_lshlrev_b32 v88, 16, v246
    v_and_b32 v89, 0xffff0000, v246
    v_cvt_pk_bf16_f32 v246, v90, v91
    v_lshlrev_b32 v90, 16, v246
    v_and_b32 v91, 0xffff0000, v246
L_itb_17:
    s_load_dwordx2 s[40:41], s[0:1], 48
    s_load_dwordx2 s[42:43], s[0:1], 56
    s_load_dwordx2 s[44:45], s[0:1], 64
    s_waitcnt lgkmcnt(0)
    v_readfirstlane_b32 s96, v156
    v_readfirstlane_b32 s97, v157
    s_nop 0
    s_cmp_lg_u32 s97, 0
    s_cbranch_scc1 L_ng_18
    v_mov_b32 v246, 0
    s_mov_b32 s50, 0
L_nrl_19:
    buffer_load_dwordx2 v[248:249], v246, s[88:91], 0 offen offset:8 sc1
    s_waitcnt vmcnt(0)
    v_readfirstlane_b32 s96, v248
    v_readfirstlane_b32 s97, v249
    s_add_u32 s50, s50, 1
    s_cmp_lg_u32 s97, 0
    s_cbranch_scc1 L_nrd_20
    s_cmp_ge_u32 s50, 20000
    s_cbranch_scc1 L_nrd_20
    s_sleep 4
    s_branch L_nrl_19
L_nrd_20:
    s_nop 3
L_ng_18:
    s_nop 3
    s_and_b32 s4, s96, 0xffff
    s_lshr_b32 s5, s96, 16
    s_mov_b32 s6, 0
L_tml_21:
    s_cmp_lg_u32 s32, 0
    s_cbranch_scc1 L_itb_24
    s_mov_b32 s50, 2304
    buffer_load_dwordx4 v[52:55], v18, s[76:79], s50 offen offset:2048 sc1
    buffer_load_dwordx4 v[56:59], v18, s[76:79], s50 offen offset:2112 sc1
    s_mov_b32 s50, 0
    buffer_load_dwordx4 v[68:71], v18, s[76:79], s50 offen offset:2048 sc1
    buffer_load_dwordx4 v[72:75], v18, s[76:79], s50 offen offset:2112 sc1
L_itb_24:
    s_mov_b32 s50, 2304
    buffer_load_dwordx4 v[44:47], v18, s[76:79], s50 offen offset:0 sc1
    buffer_load_dwordx4 v[48:51], v18, s[76:79], s50 offen offset:64 sc1
    s_mov_b32 s50, 0
    buffer_load_dwordx4 v[60:63], v18, s[76:79], s50 offen offset:0 sc1
    buffer_load_dwordx4 v[64:67], v18, s[76:79], s50 offen offset:64 sc1
    s_waitcnt vmcnt(0)
L_tmc_23:
    v_mov_b32 v252, 0
    v_xor_b32 v253, s4, v44
    v_xor_b32 v254, s5, v45
    v_or3_b32 v252, v252, v253, v254
    v_xor_b32 v253, s4, v46
    v_xor_b32 v254, s5, v47
    v_or3_b32 v252, v252, v253, v254
    v_xor_b32 v253, s4, v48
    v_xor_b32 v254, s5, v49
    v_or3_b32 v252, v252, v253, v254
    v_xor_b32 v253, s4, v50
    v_xor_b32 v254, s5, v51
    v_or3_b32 v252, v252, v253, v254
    v_xor_b32 v253, s4, v60
    v_xor_b32 v254, s5, v61
    v_or3_b32 v252, v252, v253, v254
    v_xor_b32 v253, s4, v62
    v_xor_b32 v254, s5, v63
    v_or3_b32 v252, v252, v253, v254
    v_xor_b32 v253, s4, v64
    v_xor_b32 v254, s5, v65
    v_or3_b32 v252, v252, v253, v254
    v_xor_b32 v253, s4, v66
    v_xor_b32 v254, s5, v67
    v_or3_b32 v252, v252, v253, v254
    s_cmp_lg_u32 s32, 0
    s_cbranch_scc1 L_itb_25
    v_xor_b32 v253, s4, v52
    v_xor_b32 v254, s5, v53
    v_or3_b32 v252, v252, v253, v254
    v_xor_b32 v253, s4, v54
    v_xor_b32 v254, s5, v55
    v_or3_b32 v252, v252, v253, v254
    v_xor_b32 v253, s4, v56
    v_xor_b32 v254, s5, v57
    v_or3_b32 v252, v252, v253, v254
    v_xor_b32 v253, s4, v58
    v_xor_b32 v254, s5, v59
    v_or3_b32 v252, v252, v253, v254
    v_xor_b32 v253, s4, v68
    v_xor_b32 v254, s5, v69
    v_or3_b32 v252, v252, v253, v254
    v_xor_b32 v253, s4, v70
    v_xor_b32 v254, s5, v71
    v_or3_b32 v252, v252, v253, v254
    v_xor_b32 v253, s4, v72
    v_xor_b32 v254, s5, v73
    v_or3_b32 v252, v252, v253, v254
    v_xor_b32 v253, s4, v74
    v_xor_b32 v254, s5, v75
    v_or3_b32 v252, v252, v253, v254
L_itb_25:
    v_and_b32 v252, 0xffff, v252
    v_cmp_ne_u32 vcc, 0, v252
    s_add_u32 s6, s6, 1
    s_cbranch_vccz L_tmd_22
    s_cmp_ge_u32 s6, 20000
    s_cbranch_scc1 L_tmd_22
    s_sleep 3
    s_branch L_tml_21
L_tmd_22:
    v_and_b32 v44, 0xffff0000, v44
    v_and_b32 v45, 0xffff0000, v45
    v_and_b32 v46, 0xffff0000, v46
    v_and_b32 v47, 0xffff0000, v47
    v_and_b32 v48, 0xffff0000, v48
    v_and_b32 v49, 0xffff0000, v49
    v_and_b32 v50, 0xffff0000, v50
    v_and_b32 v51, 0xffff0000, v51
    v_and_b32 v60, 0xffff0000, v60
    v_and_b32 v61, 0xffff0000, v61
    v_and_b32 v62, 0xffff0000, v62
    v_and_b32 v63, 0xffff0000, v63
    v_and_b32 v64, 0xffff0000, v64
    v_and_b32 v65, 0xffff0000, v65
    v_and_b32 v66, 0xffff0000, v66
    v_and_b32 v67, 0xffff0000, v67
    s_cmp_lg_u32 s32, 0
    s_cbranch_scc1 L_itb_26
    v_and_b32 v52, 0xffff0000, v52
    v_and_b32 v53, 0xffff0000, v53
    v_and_b32 v54, 0xffff0000, v54
    v_and_b32 v55, 0xffff0000, v55
    v_and_b32 v56, 0xffff0000, v56
    v_and_b32 v57, 0xffff0000, v57
    v_and_b32 v58, 0xffff0000, v58
    v_and_b32 v59, 0xffff0000, v59
    v_and_b32 v68, 0xffff0000, v68
    v_and_b32 v69, 0xffff0000, v69
    v_and_b32 v70, 0xffff0000, v70
    v_and_b32 v71, 0xffff0000, v71
    v_and_b32 v72, 0xffff0000, v72
    v_and_b32 v73, 0xffff0000, v73
    v_and_b32 v74, 0xffff0000, v74
    v_and_b32 v75, 0xffff0000, v75
L_itb_26:
    v_add_f32 v44, 1.0, v44
    v_add_f32 v45, 1.0, v45
    v_add_f32 v46, 1.0, v46
    v_add_f32 v47, 1.0, v47
    v_add_f32 v48, 1.0, v48
    v_add_f32 v49, 1.0, v49
    v_add_f32 v50, 1.0, v50
    v_add_f32 v51, 1.0, v51
    v_cvt_pk_bf16_f32 v246, v44, v45
    v_lshlrev_b32 v44, 16, v246
    v_and_b32 v45, 0xffff0000, v246
    v_cvt_pk_bf16_f32 v246, v46, v47
    v_lshlrev_b32 v46, 16, v246
    v_and_b32 v47, 0xffff0000, v246
    v_cvt_pk_bf16_f32 v246, v48, v49
    v_lshlrev_b32 v48, 16, v246
    v_and_b32 v49, 0xffff0000, v246
    v_cvt_pk_bf16_f32 v246, v50, v51
    v_lshlrev_b32 v50, 16, v246
    v_and_b32 v51, 0xffff0000, v246
    v_mul_f32 v76, v76, v44
    v_mul_f32 v77, v77, v45
    v_mul_f32 v78, v78, v46
    v_mul_f32 v79, v79, v47
    v_mul_f32 v80, v80, v48
    v_mul_f32 v81, v81, v49
    v_mul_f32 v82, v82, v50
    v_mul_f32 v83, v83, v51
    v_cvt_pk_bf16_f32 v246, v76, v77
    v_lshlrev_b32 v76, 16, v246
    v_and_b32 v77, 0xffff0000, v246
    v_cvt_pk_bf16_f32 v246, v78, v79
    v_lshlrev_b32 v78, 16, v246
    v_and_b32 v79, 0xffff0000, v246
    v_cvt_pk_bf16_f32 v246, v80, v81
    v_lshlrev_b32 v80, 16, v246
    v_and_b32 v81, 0xffff0000, v246
    v_cvt_pk_bf16_f32 v246, v82, v83
    v_lshlrev_b32 v82, 16, v246
    v_and_b32 v83, 0xffff0000, v246
    v_add_f32 v76, v76, v60
    v_add_f32 v77, v77, v61
    v_add_f32 v78, v78, v62
    v_add_f32 v79, v79, v63
    v_add_f32 v80, v80, v64
    v_add_f32 v81, v81, v65
    v_add_f32 v82, v82, v66
    v_add_f32 v83, v83, v67
    v_cvt_pk_bf16_f32 v44, v76, v77
    v_cvt_pk_bf16_f32 v45, v78, v79
    v_cvt_pk_bf16_f32 v46, v80, v81
    v_cvt_pk_bf16_f32 v47, v82, v83
    s_mov_b32 s50, 0x10000
    buffer_store_dwordx4 v[44:47], v16, s[76:79], s50 offen sc1
    s_cmp_lg_u32 s32, 0
    s_cbranch_scc1 L_itb_27
    v_add_f32 v52, 1.0, v52
    v_add_f32 v53, 1.0, v53
    v_add_f32 v54, 1.0, v54
    v_add_f32 v55, 1.0, v55
    v_add_f32 v56, 1.0, v56
    v_add_f32 v57, 1.0, v57
    v_add_f32 v58, 1.0, v58
    v_add_f32 v59, 1.0, v59
    v_cvt_pk_bf16_f32 v246, v52, v53
    v_lshlrev_b32 v52, 16, v246
    v_and_b32 v53, 0xffff0000, v246
    v_cvt_pk_bf16_f32 v246, v54, v55
    v_lshlrev_b32 v54, 16, v246
    v_and_b32 v55, 0xffff0000, v246
    v_cvt_pk_bf16_f32 v246, v56, v57
    v_lshlrev_b32 v56, 16, v246
    v_and_b32 v57, 0xffff0000, v246
    v_cvt_pk_bf16_f32 v246, v58, v59
    v_lshlrev_b32 v58, 16, v246
    v_and_b32 v59, 0xffff0000, v246
    v_mul_f32 v84, v84, v52
    v_mul_f32 v85, v85, v53
    v_mul_f32 v86, v86, v54
    v_mul_f32 v87, v87, v55
    v_mul_f32 v88, v88, v56
    v_mul_f32 v89, v89, v57
    v_mul_f32 v90, v90, v58
    v_mul_f32 v91, v91, v59
    v_cvt_pk_bf16_f32 v246, v84, v85
    v_lshlrev_b32 v84, 16, v246
    v_and_b32 v85, 0xffff0000, v246
    v_cvt_pk_bf16_f32 v246, v86, v87
    v_lshlrev_b32 v86, 16, v246
    v_and_b32 v87, 0xffff0000, v246
    v_cvt_pk_bf16_f32 v246, v88, v89
    v_lshlrev_b32 v88, 16, v246
    v_and_b32 v89, 0xffff0000, v246
    v_cvt_pk_bf16_f32 v246, v90, v91
    v_lshlrev_b32 v90, 16, v246
    v_and_b32 v91, 0xffff0000, v246
    v_add_f32 v84, v84, v68
    v_add_f32 v85, v85, v69
    v_add_f32 v86, v86, v70
    v_add_f32 v87, v87, v71
    v_add_f32 v88, v88, v72
    v_add_f32 v89, v89, v73
    v_add_f32 v90, v90, v74
    v_add_f32 v91, v91, v75
    v_cvt_pk_bf16_f32 v52, v84, v85
    v_cvt_pk_bf16_f32 v53, v86, v87
    v_cvt_pk_bf16_f32 v54, v88, v89
    v_cvt_pk_bf16_f32 v55, v90, v91
    s_mov_b32 s50, 0x18000
    buffer_store_dwordx4 v[52:55], v16, s[76:79], s50 offen sc1
L_itb_27:
    s_cmp_lg_u32 s32, 0
    s_cbranch_scc1 L_ci_28
    s_lshl_b32 s50, s38, 5
    s_add_u32 s50, s50, 57344
    v_mov_b32 v246, 0
    buffer_store_dword v246, v246, s[76:79], s50 offen sc1
L_ci_28:
    s_nop 1
    s_waitcnt vmcnt(0)
    s_barrier
    s_cmp_lg_u32 s32, 0
    s_cbranch_scc1 L_pub_29
    s_lshl_b32 s50, s98, 3
    s_add_u32 s50, s50, 32768
    v_mov_b32 v248, s96
    v_mov_b32 v249, s97
    v_mov_b32 v246, 0
    v_cmp_eq_u32 vcc, 0, v7
    s_nop 0
    s_and_saveexec_b64 s[4:5], vcc
    buffer_store_dwordx2 v[248:249], v246, s[76:79], s50 offen sc1
    s_mov_b64 exec, s[4:5]
L_pub_29:
    s_nop 1
    s_cmp_ge_u32 s2, 108
    s_cbranch_scc1 L_cd_30
    s_add_u32 m0, s39, 0x4000
    s_mov_b32 s61, 0x0
    buffer_load_dwordx4 v2, s[8:11], s61 offen lds
    s_add_u32 m0, s39, 0x6000
    s_mov_b32 s62, 0x100
    buffer_load_dwordx4 v2, s[8:11], s62 offen lds
    s_add_u32 m0, s39, 0x8000
    s_mov_b32 s63, 0x40000
    buffer_load_dwordx4 v2, s[8:11], s63 offen lds
    s_add_u32 m0, s39, 0xa000
    s_mov_b32 s56, 0x40100
    buffer_load_dwordx4 v2, s[8:11], s56 offen lds
    s_add_u32 m0, s39, 0x10000
    s_mov_b32 s57, 0x80000
    buffer_load_dwordx4 v2, s[8:11], s57 offen lds
    s_add_u32 m0, s39, 0x12000
    s_mov_b32 s58, 0x80100
    buffer_load_dwordx4 v2, s[8:11], s58 offen lds
    s_add_u32 m0, s39, 0x14000
    s_mov_b32 s59, 0xc0000
    buffer_load_dwordx4 v2, s[8:11], s59 offen lds
    s_add_u32 m0, s39, 0x16000
    s_mov_b32 s60, 0xc0100
    buffer_load_dwordx4 v2, s[8:11], s60 offen lds
    s_add_u32 m0, s39, 0x1c000
    s_mov_b32 s61, 0x100000
    buffer_load_dwordx4 v2, s[8:11], s61 offen lds
    s_add_u32 m0, s39, 0x1e000
    s_mov_b32 s62, 0x100100
    buffer_load_dwordx4 v2, s[8:11], s62 offen lds
    s_add_u32 m0, s39, 0x20000
    s_mov_b32 s63, 0x140000
    buffer_load_dwordx4 v2, s[8:11], s63 offen lds
    s_add_u32 m0, s39, 0x22000
    s_mov_b32 s56, 0x140100
    buffer_load_dwordx4 v2, s[8:11], s56 offen lds
L_cd_30:
    s_nop 1
    s_cmp_lg_u32 s32, 4
    s_cbranch_scc1 L_pm_31
    v_min_u32 v246, 63, v7
    v_lshlrev_b32 v246, 3, v246
    s_and_b32 s51, s2, 7
    s_lshl_b32 s51, s51, 10
    s_add_u32 s51, s51, 49440
    s_mov_b32 s50, 0
L_pml_32:
    buffer_load_dwordx2 v[248:249], v246, s[76:79], s51 offen sc1
    s_waitcnt vmcnt(0)
    v_cmp_ne_u64 vcc, s[96:97], v[248:249]
    s_add_u32 s50, s50, 1
    s_cbranch_vccz L_pmd_33
    s_cmp_ge_u32 s50, 20000
    s_cbranch_scc1 L_pmd_33
    s_sleep 2
    s_branch L_pml_32
L_pmd_33:
    v_min_u32 v246, 7, v7
    v_lshlrev_b32 v246, 3, v246
    s_and_b32 s51, s2, 7
    s_lshl_b32 s51, s51, 10
    s_add_u32 s51, s51, 49952
    s_mov_b32 s50, 0
L_pml_34:
    buffer_load_dwordx2 v[248:249], v246, s[76:79], s51 offen sc1
    s_waitcnt vmcnt(0)
    v_cmp_ne_u64 vcc, s[96:97], v[248:249]
    s_add_u32 s50, s50, 1
    s_cbranch_vccz L_pmd_35
    s_cmp_ge_u32 s50, 20000
    s_cbranch_scc1 L_pmd_35
    s_sleep 2
    s_branch L_pml_34
L_pmd_35:
L_pm_31:
    s_nop 1
    s_cmp_lg_u32 s32, 0
    s_cbranch_scc1 L_pt_36
    v_and_b32 v246, 15, v7
    v_lshlrev_b32 v246, 3, v246
    s_lshl_b32 s51, s34, 7
    s_add_u32 s51, s51, 32768
    s_mov_b32 s50, 0
L_ptl_37:
    buffer_load_dwordx2 v[248:249], v246, s[76:79], s51 offen sc1
    s_waitcnt vmcnt(0)
    v_cmp_ne_u64 vcc, s[96:97], v[248:249]
    s_add_u32 s50, s50, 1
    s_cbranch_vccz L_ptd_38
    s_cmp_ge_u32 s50, 20000
    s_cbranch_scc1 L_ptd_38
    s_sleep 1
    s_branch L_ptl_37
L_ptd_38:
L_pt_36:
    s_nop 1
    s_barrier
    s_add_u32 m0, s39, 0x0
    s_mov_b32 s57, 0x0
    buffer_load_dwordx4 v230, s[24:27], s57 offen sc1 lds
    s_add_u32 m0, s39, 0x2000
    s_mov_b32 s58, 0x800
    buffer_load_dwordx4 v230, s[24:27], s58 offen sc1 lds
    s_setprio 3
    s_waitcnt vmcnt(0)
    s_barrier
    ds_read_b128 v[48:51], v231 offset:0
    ds_read_b128 v[52:55], v231 offset:1024
    ds_read_b64_tr_b16 v[16:17], v8 offset:16384
    ds_read_b64_tr_b16 v[18:19], v8 offset:20480
    ds_read_b64_tr_b16 v[20:21], v9 offset:16384
    ds_read_b64_tr_b16 v[22:23], v9 offset:20480
    ds_read_b64_tr_b16 v[24:25], v10 offset:16384
    ds_read_b64_tr_b16 v[26:27], v10 offset:20480
    s_waitcnt lgkmcnt(4)
    v_mfma_f32_16x16x32_bf16 v[144:147], v[16:19], v[48:51], 0
    ds_read_b64_tr_b16 v[28:29], v11 offset:16384
    v_mfma_f32_16x16x32_bf16 v[148:151], v[16:19], v[52:55], 0
    ds_read_b64_tr_b16 v[30:31], v11 offset:20480
    s_add_u32 m0, s39, 0xc000
    s_mov_b32 s59, 0x1000
    buffer_load_dwordx4 v230, s[24:27], s59 offen sc1 lds
    s_waitcnt lgkmcnt(4)
    v_mfma_f32_16x16x32_bf16 v[152:155], v[20:23], v[48:51], 0
    ds_read_b64_tr_b16 v[16:17], v12 offset:16384
    v_mfma_f32_16x16x32_bf16 v[156:159], v[20:23], v[52:55], 0
    ds_read_b64_tr_b16 v[18:19], v12 offset:20480
    s_add_u32 m0, s39, 0xe000
    s_mov_b32 s60, 0x1800
    buffer_load_dwordx4 v230, s[24:27], s60 offen sc1 lds
    s_waitcnt lgkmcnt(4)
    v_mfma_f32_16x16x32_bf16 v[160:163], v[24:27], v[48:51], 0
    ds_read_b64_tr_b16 v[20:21], v13 offset:16384
    v_mfma_f32_16x16x32_bf16 v[164:167], v[24:27], v[52:55], 0
    ds_read_b64_tr_b16 v[22:23], v13 offset:20480
    s_add_u32 m0, s39, 0x18000
    s_mov_b32 s61, 0x2000
    buffer_load_dwordx4 v230, s[24:27], s61 offen sc1 lds
    s_waitcnt lgkmcnt(4)
    v_mfma_f32_16x16x32_bf16 v[168:171], v[28:31], v[48:51], 0
    ds_read_b64_tr_b16 v[24:25], v14 offset:16384
    v_mfma_f32_16x16x32_bf16 v[172:175], v[28:31], v[52:55], 0
    ds_read_b64_tr_b16 v[26:27], v14 offset:20480
    s_add_u32 m0, s39, 0x1a000
    s_mov_b32 s62, 0x2800
    buffer_load_dwordx4 v230, s[24:27], s62 offen sc1 lds
    s_setprio 2
    s_waitcnt lgkmcnt(4)
    v_mfma_f32_16x16x32_bf16 v[176:179], v[16:19], v[48:51], 0
    ds_read_b64_tr_b16 v[28:29], v15 offset:16384
    v_mfma_f32_16x16x32_bf16 v[180:183], v[16:19], v[52:55], 0
    ds_read_b64_tr_b16 v[30:31], v15 offset:20480
    s_add_u32 m0, s39, 0x24000
    s_mov_b32 s63, 0x3000
    buffer_load_dwordx4 v230, s[24:27], s63 offen sc1 lds
    s_waitcnt lgkmcnt(4)
    v_mfma_f32_16x16x32_bf16 v[184:187], v[20:23], v[48:51], 0
    ds_read_b128 v[56:59], v231 offset:8192
    ds_read_b128 v[60:63], v231 offset:9216
    ds_read_b64_tr_b16 v[16:17], v8 offset:32768
    v_mfma_f32_16x16x32_bf16 v[188:191], v[20:23], v[52:55], 0
    ds_read_b64_tr_b16 v[18:19], v8 offset:36864
    s_add_u32 m0, s39, 0x26000
    s_mov_b32 s56, 0x3800
    buffer_load_dwordx4 v230, s[24:27], s56 offen sc1 lds
    s_waitcnt lgkmcnt(6)
    v_mfma_f32_16x16x32_bf16 v[192:195], v[24:27], v[48:51], 0
    ds_read_b64_tr_b16 v[20:21], v9 offset:32768
    v_mfma_f32_16x16x32_bf16 v[196:199], v[24:27], v[52:55], 0
    ds_read_b64_tr_b16 v[22:23], v9 offset:36864
    s_waitcnt lgkmcnt(6)
    v_mfma_f32_16x16x32_bf16 v[200:203], v[28:31], v[48:51], 0
    ds_read_b64_tr_b16 v[24:25], v10 offset:32768
    v_mfma_f32_16x16x32_bf16 v[204:207], v[28:31], v[52:55], 0
    ds_read_b64_tr_b16 v[26:27], v10 offset:36864
    s_setprio 1
    s_waitcnt lgkmcnt(4)
    v_mfma_f32_16x16x32_bf16 v[144:147], v[16:19], v[56:59], v[144:147]
    ds_read_b64_tr_b16 v[28:29], v11 offset:32768
    v_mfma_f32_16x16x32_bf16 v[148:151], v[16:19], v[60:63], v[148:151]
    ds_read_b64_tr_b16 v[30:31], v11 offset:36864
    s_waitcnt lgkmcnt(4)
    v_mfma_f32_16x16x32_bf16 v[152:155], v[20:23], v[56:59], v[152:155]
    ds_read_b64_tr_b16 v[16:17], v12 offset:32768
    v_mfma_f32_16x16x32_bf16 v[156:159], v[20:23], v[60:63], v[156:159]
    ds_read_b64_tr_b16 v[18:19], v12 offset:36864
    s_waitcnt lgkmcnt(4)
    v_mfma_f32_16x16x32_bf16 v[160:163], v[24:27], v[56:59], v[160:163]
    ds_read_b64_tr_b16 v[20:21], v13 offset:32768
    v_mfma_f32_16x16x32_bf16 v[164:167], v[24:27], v[60:63], v[164:167]
    ds_read_b64_tr_b16 v[22:23], v13 offset:36864
    s_waitcnt lgkmcnt(4)
    v_mfma_f32_16x16x32_bf16 v[168:171], v[28:31], v[56:59], v[168:171]
    ds_read_b64_tr_b16 v[24:25], v14 offset:32768
    v_mfma_f32_16x16x32_bf16 v[172:175], v[28:31], v[60:63], v[172:175]
    ds_read_b64_tr_b16 v[26:27], v14 offset:36864
    s_setprio 0
    s_waitcnt lgkmcnt(4)
    v_mfma_f32_16x16x32_bf16 v[176:179], v[16:19], v[56:59], v[176:179]
    ds_read_b64_tr_b16 v[28:29], v15 offset:32768
    v_mfma_f32_16x16x32_bf16 v[180:183], v[16:19], v[60:63], v[180:183]
    ds_read_b64_tr_b16 v[30:31], v15 offset:36864
    s_waitcnt lgkmcnt(4)
    v_mfma_f32_16x16x32_bf16 v[184:187], v[20:23], v[56:59], v[184:187]
    v_mfma_f32_16x16x32_bf16 v[188:191], v[20:23], v[60:63], v[188:191]
    s_waitcnt lgkmcnt(2)
    v_mfma_f32_16x16x32_bf16 v[192:195], v[24:27], v[56:59], v[192:195]
    v_mfma_f32_16x16x32_bf16 v[196:199], v[24:27], v[60:63], v[196:199]
    s_waitcnt lgkmcnt(0)
    v_mfma_f32_16x16x32_bf16 v[200:203], v[28:31], v[56:59], v[200:203]
    v_mfma_f32_16x16x32_bf16 v[204:207], v[28:31], v[60:63], v[204:207]
    s_setprio 3
    s_waitcnt vmcnt(3)
    s_barrier
    ds_read_b128 v[48:51], v231 offset:49152
    ds_read_b128 v[52:55], v231 offset:50176
    v_add_u32 v8, 0x10000, v8
    ds_read_b64_tr_b16 v[16:17], v8 offset:0
    ds_read_b64_tr_b16 v[18:19], v8 offset:4096
    v_add_u32 v9, 0x10000, v9
    ds_read_b64_tr_b16 v[20:21], v9 offset:0
    ds_read_b64_tr_b16 v[22:23], v9 offset:4096
    v_add_u32 v10, 0x10000, v10
    ds_read_b64_tr_b16 v[24:25], v10 offset:0
    ds_read_b64_tr_b16 v[26:27], v10 offset:4096
    s_waitcnt lgkmcnt(4)
    v_mfma_f32_16x16x32_bf16 v[144:147], v[16:19], v[48:51], v[144:147]
    v_add_u32 v11, 0x10000, v11
    ds_read_b64_tr_b16 v[28:29], v11 offset:0
    v_mfma_f32_16x16x32_bf16 v[148:151], v[16:19], v[52:55], v[148:151]
    ds_read_b64_tr_b16 v[30:31], v11 offset:4096
    s_add_u32 m0, s39, 0x0
    s_mov_b32 s57, 0x180000
    buffer_load_dwordx4 v2, s[8:11], s57 offen lds
    s_waitcnt lgkmcnt(4)
    v_mfma_f32_16x16x32_bf16 v[152:155], v[20:23], v[48:51], v[152:155]
    v_add_u32 v12, 0x10000, v12
    ds_read_b64_tr_b16 v[16:17], v12 offset:0
    v_mfma_f32_16x16x32_bf16 v[156:159], v[20:23], v[52:55], v[156:159]
    ds_read_b64_tr_b16 v[18:19], v12 offset:4096
    s_waitcnt lgkmcnt(4)
    v_mfma_f32_16x16x32_bf16 v[160:163], v[24:27], v[48:51], v[160:163]
    v_add_u32 v13, 0x10000, v13
    ds_read_b64_tr_b16 v[20:21], v13 offset:0
    v_mfma_f32_16x16x32_bf16 v[164:167], v[24:27], v[52:55], v[164:167]
    ds_read_b64_tr_b16 v[22:23], v13 offset:4096
    s_add_u32 m0, s39, 0x2000
    s_mov_b32 s58, 0x180100
    buffer_load_dwordx4 v2, s[8:11], s58 offen lds
    s_waitcnt lgkmcnt(4)
    v_mfma_f32_16x16x32_bf16 v[168:171], v[28:31], v[48:51], v[168:171]
    v_add_u32 v14, 0x10000, v14
    ds_read_b64_tr_b16 v[24:25], v14 offset:0
    v_mfma_f32_16x16x32_bf16 v[172:175], v[28:31], v[52:55], v[172:175]
    ds_read_b64_tr_b16 v[26:27], v14 offset:4096
    s_setprio 2
    s_waitcnt lgkmcnt(4)
    v_mfma_f32_16x16x32_bf16 v[176:179], v[16:19], v[48:51], v[176:179]
    v_add_u32 v15, 0x10000, v15
    ds_read_b64_tr_b16 v[28:29], v15 offset:0
    v_mfma_f32_16x16x32_bf16 v[180:183], v[16:19], v[52:55], v[180:183]
    ds_read_b64_tr_b16 v[30:31], v15 offset:4096
    s_add_u32 m0, s39, 0x4000
    s_mov_b32 s59, 0x1c0000
    buffer_load_dwordx4 v2, s[8:11], s59 offen lds
    s_waitcnt lgkmcnt(4)
    v_mfma_f32_16x16x32_bf16 v[184:187], v[20:23], v[48:51], v[184:187]
    ds_read_b128 v[56:59], v231 offset:57344
    ds_read_b128 v[60:63], v231 offset:58368
    ds_read_b64_tr_b16 v[16:17], v8 offset:16384
    v_mfma_f32_16x16x32_bf16 v[188:191], v[20:23], v[52:55], v[188:191]
    ds_read_b64_tr_b16 v[18:19], v8 offset:20480
    s_waitcnt lgkmcnt(6)
    v_mfma_f32_16x16x32_bf16 v[192:195], v[24:27], v[48:51], v[192:195]
    ds_read_b64_tr_b16 v[20:21], v9 offset:16384
    v_mfma_f32_16x16x32_bf16 v[196:199], v[24:27], v[52:55], v[196:199]
    ds_read_b64_tr_b16 v[22:23], v9 offset:20480
    s_add_u32 m0, s39, 0x6000
    s_mov_b32 s60, 0x1c0100
    buffer_load_dwordx4 v2, s[8:11], s60 offen lds
    s_waitcnt lgkmcnt(6)
    v_mfma_f32_16x16x32_bf16 v[200:203], v[28:31], v[48:51], v[200:203]
    ds_read_b64_tr_b16 v[24:25], v10 offset:16384
    v_mfma_f32_16x16x32_bf16 v[204:207], v[28:31], v[52:55], v[204:207]
    ds_read_b64_tr_b16 v[26:27], v10 offset:20480
    s_setprio 1
    s_waitcnt lgkmcnt(4)
    v_mfma_f32_16x16x32_bf16 v[144:147], v[16:19], v[56:59], v[144:147]
    ds_read_b64_tr_b16 v[28:29], v11 offset:16384
    v_mfma_f32_16x16x32_bf16 v[148:151], v[16:19], v[60:63], v[148:151]
    ds_read_b64_tr_b16 v[30:31], v11 offset:20480
    s_add_u32 m0, s39, 0x8000
    s_mov_b32 s61, 0x4000
    buffer_load_dwordx4 v230, s[24:27], s61 offen sc1 lds
    s_waitcnt lgkmcnt(4)
    v_mfma_f32_16x16x32_bf16 v[152:155], v[20:23], v[56:59], v[152:155]
    ds_read_b64_tr_b16 v[16:17], v12 offset:16384
    v_mfma_f32_16x16x32_bf16 v[156:159], v[20:23], v[60:63], v[156:159]
    ds_read_b64_tr_b16 v[18:19], v12 offset:20480
    s_waitcnt lgkmcnt(4)
    v_mfma_f32_16x16x32_bf16 v[160:163], v[24:27], v[56:59], v[160:163]
    ds_read_b64_tr_b16 v[20:21], v13 offset:16384
    v_mfma_f32_16x16x32_bf16 v[164:167], v[24:27], v[60:63], v[164:167]
    ds_read_b64_tr_b16 v[22:23], v13 offset:20480
    s_add_u32 m0, s39, 0xa000
    s_mov_b32 s62, 0x4800
    buffer_load_dwordx4 v230, s[24:27], s62 offen sc1 lds
    s_waitcnt lgkmcnt(4)
    v_mfma_f32_16x16x32_bf16 v[168:171], v[28:31], v[56:59], v[168:171]
    ds_read_b64_tr_b16 v[24:25], v14 offset:16384
    v_mfma_f32_16x16x32_bf16 v[172:175], v[28:31], v[60:63], v[172:175]
    ds_read_b64_tr_b16 v[26:27], v14 offset:20480
    s_setprio 0
    s_waitcnt lgkmcnt(4)
    v_mfma_f32_16x16x32_bf16 v[176:179], v[16:19], v[56:59], v[176:179]
    ds_read_b64_tr_b16 v[28:29], v15 offset:16384
    v_mfma_f32_16x16x32_bf16 v[180:183], v[16:19], v[60:63], v[180:183]
    ds_read_b64_tr_b16 v[30:31], v15 offset:20480
    s_waitcnt lgkmcnt(4)
    v_mfma_f32_16x16x32_bf16 v[184:187], v[20:23], v[56:59], v[184:187]
    v_add_u32 v231, 0x10000, v231
    ds_read_b128 v[48:51], v231 offset:32768
    ds_read_b128 v[52:55], v231 offset:33792
    ds_read_b64_tr_b16 v[16:17], v8 offset:49152
    v_mfma_f32_16x16x32_bf16 v[188:191], v[20:23], v[60:63], v[188:191]
    ds_read_b64_tr_b16 v[18:19], v8 offset:53248
    s_waitcnt lgkmcnt(6)
    v_mfma_f32_16x16x32_bf16 v[192:195], v[24:27], v[56:59], v[192:195]
    ds_read_b64_tr_b16 v[20:21], v9 offset:49152
    v_mfma_f32_16x16x32_bf16 v[196:199], v[24:27], v[60:63], v[196:199]
    ds_read_b64_tr_b16 v[22:23], v9 offset:53248
    s_waitcnt lgkmcnt(6)
    v_mfma_f32_16x16x32_bf16 v[200:203], v[28:31], v[56:59], v[200:203]
    ds_read_b64_tr_b16 v[24:25], v10 offset:49152
    v_mfma_f32_16x16x32_bf16 v[204:207], v[28:31], v[60:63], v[204:207]
    ds_read_b64_tr_b16 v[26:27], v10 offset:53248
    s_setprio 3
    s_waitcnt vmcnt(4)
    s_barrier
    s_waitcnt lgkmcnt(4)
    v_mfma_f32_16x16x32_bf16 v[144:147], v[16:19], v[48:51], v[144:147]
    ds_read_b64_tr_b16 v[28:29], v11 offset:49152
    v_mfma_f32_16x16x32_bf16 v[148:151], v[16:19], v[52:55], v[148:151]
    ds_read_b64_tr_b16 v[30:31], v11 offset:53248
    s_add_u32 m0, s39, 0xc000
    s_mov_b32 s63, 0x200000
    buffer_load_dwordx4 v2, s[8:11], s63 offen lds
    s_waitcnt lgkmcnt(4)
    v_mfma_f32_16x16x32_bf16 v[152:155], v[20:23], v[48:51], v[152:155]
    ds_read_b64_tr_b16 v[16:17], v12 offset:49152
    v_mfma_f32_16x16x32_bf16 v[156:159], v[20:23], v[52:55], v[156:159]
    ds_read_b64_tr_b16 v[18:19], v12 offset:53248
    s_waitcnt lgkmcnt(4)
    v_mfma_f32_16x16x32_bf16 v[160:163], v[24:27], v[48:51], v[160:163]
    ds_read_b64_tr_b16 v[20:21], v13 offset:49152
    v_mfma_f32_16x16x32_bf16 v[164:167], v[24:27], v[52:55], v[164:167]
    ds_read_b64_tr_b16 v[22:23], v13 offset:53248
    s_add_u32 m0, s39, 0xe000
    s_mov_b32 s56, 0x200100
    buffer_load_dwordx4 v2, s[8:11], s56 offen lds
    s_waitcnt lgkmcnt(4)
    v_mfma_f32_16x16x32_bf16 v[168:171], v[28:31], v[48:51], v[168:171]
    ds_read_b64_tr_b16 v[24:25], v14 offset:49152
    v_mfma_f32_16x16x32_bf16 v[172:175], v[28:31], v[52:55], v[172:175]
    ds_read_b64_tr_b16 v[26:27], v14 offset:53248
    s_setprio 2
    s_waitcnt lgkmcnt(4)
    v_mfma_f32_16x16x32_bf16 v[176:179], v[16:19], v[48:51], v[176:179]
    ds_read_b64_tr_b16 v[28:29], v15 offset:49152
    v_mfma_f32_16x16x32_bf16 v[180:183], v[16:19], v[52:55], v[180:183]
    ds_read_b64_tr_b16 v[30:31], v15 offset:53248
    s_add_u32 m0, s39, 0x10000
    s_mov_b32 s57, 0x240000
    buffer_load_dwordx4 v2, s[8:11], s57 offen lds
    s_waitcnt lgkmcnt(4)
    v_mfma_f32_16x16x32_bf16 v[184:187], v[20:23], v[48:51], v[184:187]
    ds_read_b128 v[56:59], v231 offset:40960
    ds_read_b128 v[60:63], v231 offset:41984
    v_add_u32 v8, 0x10000, v8
    ds_read_b64_tr_b16 v[16:17], v8 offset:0
    v_mfma_f32_16x16x32_bf16 v[188:191], v[20:23], v[52:55], v[188:191]
    ds_read_b64_tr_b16 v[18:19], v8 offset:4096
    s_waitcnt lgkmcnt(6)
    v_mfma_f32_16x16x32_bf16 v[192:195], v[24:27], v[48:51], v[192:195]
    v_add_u32 v9, 0x10000, v9
    ds_read_b64_tr_b16 v[20:21], v9 offset:0
    v_mfma_f32_16x16x32_bf16 v[196:199], v[24:27], v[52:55], v[196:199]
    ds_read_b64_tr_b16 v[22:23], v9 offset:4096
    s_add_u32 m0, s39, 0x12000
    s_mov_b32 s58, 0x240100
    buffer_load_dwordx4 v2, s[8:11], s58 offen lds
    s_waitcnt lgkmcnt(6)
    v_mfma_f32_16x16x32_bf16 v[200:203], v[28:31], v[48:51], v[200:203]
    v_add_u32 v10, 0x10000, v10
    ds_read_b64_tr_b16 v[24:25], v10 offset:0
    v_mfma_f32_16x16x32_bf16 v[204:207], v[28:31], v[52:55], v[204:207]
    ds_read_b64_tr_b16 v[26:27], v10 offset:4096
    s_setprio 1
    s_waitcnt lgkmcnt(4)
    v_mfma_f32_16x16x32_bf16 v[144:147], v[16:19], v[56:59], v[144:147]
    v_add_u32 v11, 0x10000, v11
    ds_read_b64_tr_b16 v[28:29], v11 offset:0
    v_mfma_f32_16x16x32_bf16 v[148:151], v[16:19], v[60:63], v[148:151]
    ds_read_b64_tr_b16 v[30:31], v11 offset:4096
    s_add_u32 m0, s39, 0x14000
    s_mov_b32 s59, 0x5000
    buffer_load_dwordx4 v230, s[24:27], s59 offen sc1 lds
    s_waitcnt lgkmcnt(4)
    v_mfma_f32_16x16x32_bf16 v[152:155], v[20:23], v[56:59], v[152:155]
    v_add_u32 v12, 0x10000, v12
    ds_read_b64_tr_b16 v[16:17], v12 offset:0
    v_mfma_f32_16x16x32_bf16 v[156:159], v[20:23], v[60:63], v[156:159]
    ds_read_b64_tr_b16 v[18:19], v12 offset:4096
    s_waitcnt lgkmcnt(4)
    v_mfma_f32_16x16x32_bf16 v[160:163], v[24:27], v[56:59], v[160:163]
    v_add_u32 v13, 0x10000, v13
    ds_read_b64_tr_b16 v[20:21], v13 offset:0
    v_mfma_f32_16x16x32_bf16 v[164:167], v[24:27], v[60:63], v[164:167]
    ds_read_b64_tr_b16 v[22:23], v13 offset:4096
    s_add_u32 m0, s39, 0x16000
    s_mov_b32 s60, 0x5800
    buffer_load_dwordx4 v230, s[24:27], s60 offen sc1 lds
    s_waitcnt lgkmcnt(4)
    v_mfma_f32_16x16x32_bf16 v[168:171], v[28:31], v[56:59], v[168:171]
    v_add_u32 v14, 0x10000, v14
    ds_read_b64_tr_b16 v[24:25], v14 offset:0
    v_mfma_f32_16x16x32_bf16 v[172:175], v[28:31], v[60:63], v[172:175]
    ds_read_b64_tr_b16 v[26:27], v14 offset:4096
    s_setprio 0
    s_waitcnt lgkmcnt(4)
    v_mfma_f32_16x16x32_bf16 v[176:179], v[16:19], v[56:59], v[176:179]
    v_add_u32 v15, 0x10000, v15
    ds_read_b64_tr_b16 v[28:29], v15 offset:0
    v_mfma_f32_16x16x32_bf16 v[180:183], v[16:19], v[60:63], v[180:183]
    ds_read_b64_tr_b16 v[30:31], v15 offset:4096
    s_waitcnt lgkmcnt(4)
    v_mfma_f32_16x16x32_bf16 v[184:187], v[20:23], v[56:59], v[184:187]
    v_add_u32 v231, 0x10000, v231
    ds_read_b128 v[48:51], v231 offset:16384
    ds_read_b128 v[52:55], v231 offset:17408
    v_subrev_u32 v8, 0x20000, v8
    ds_read_b64_tr_b16 v[16:17], v8 offset:0
    v_mfma_f32_16x16x32_bf16 v[188:191], v[20:23], v[60:63], v[188:191]
    ds_read_b64_tr_b16 v[18:19], v8 offset:4096
    s_waitcnt lgkmcnt(6)
    v_mfma_f32_16x16x32_bf16 v[192:195], v[24:27], v[56:59], v[192:195]
    v_subrev_u32 v9, 0x20000, v9
    ds_read_b64_tr_b16 v[20:21], v9 offset:0
    v_mfma_f32_16x16x32_bf16 v[196:199], v[24:27], v[60:63], v[196:199]
    ds_read_b64_tr_b16 v[22:23], v9 offset:4096
    s_waitcnt lgkmcnt(6)
    v_mfma_f32_16x16x32_bf16 v[200:203], v[28:31], v[56:59], v[200:203]
    v_subrev_u32 v10, 0x20000, v10
    ds_read_b64_tr_b16 v[24:25], v10 offset:0
    v_mfma_f32_16x16x32_bf16 v[204:207], v[28:31], v[60:63], v[204:207]
    ds_read_b64_tr_b16 v[26:27], v10 offset:4096
    s_setprio 3
    s_waitcnt vmcnt(4)
    s_barrier
    s_waitcnt lgkmcnt(4)
    v_mfma_f32_16x16x32_bf16 v[144:147], v[16:19], v[48:51], v[144:147]
    v_subrev_u32 v11, 0x20000, v11
    ds_read_b64_tr_b16 v[28:29], v11 offset:0
    v_mfma_f32_16x16x32_bf16 v[148:151], v[16:19], v[52:55], v[148:151]
    ds_read_b64_tr_b16 v[30:31], v11 offset:4096
    s_add_u32 m0, s39, 0x18000
    s_mov_b32 s61, 0x280000
    buffer_load_dwordx4 v2, s[8:11], s61 offen lds
    s_waitcnt lgkmcnt(4)
    v_mfma_f32_16x16x32_bf16 v[152:155], v[20:23], v[48:51], v[152:155]
    v_subrev_u32 v12, 0x20000, v12
    ds_read_b64_tr_b16 v[16:17], v12 offset:0
    v_mfma_f32_16x16x32_bf16 v[156:159], v[20:23], v[52:55], v[156:159]
    ds_read_b64_tr_b16 v[18:19], v12 offset:4096
    s_waitcnt lgkmcnt(4)
    v_mfma_f32_16x16x32_bf16 v[160:163], v[24:27], v[48:51], v[160:163]
    v_subrev_u32 v13, 0x20000, v13
    ds_read_b64_tr_b16 v[20:21], v13 offset:0
    v_mfma_f32_16x16x32_bf16 v[164:167], v[24:27], v[52:55], v[164:167]
    ds_read_b64_tr_b16 v[22:23], v13 offset:4096
    s_add_u32 m0, s39, 0x1a000
    s_mov_b32 s62, 0x280100
    buffer_load_dwordx4 v2, s[8:11], s62 offen lds
    s_waitcnt lgkmcnt(4)
    v_mfma_f32_16x16x32_bf16 v[168:171], v[28:31], v[48:51], v[168:171]
    v_subrev_u32 v14, 0x20000, v14
    ds_read_b64_tr_b16 v[24:25], v14 offset:0
    v_mfma_f32_16x16x32_bf16 v[172:175], v[28:31], v[52:55], v[172:175]
    ds_read_b64_tr_b16 v[26:27], v14 offset:4096
    s_setprio 2
    s_waitcnt lgkmcnt(4)
    v_mfma_f32_16x16x32_bf16 v[176:179], v[16:19], v[48:51], v[176:179]
    v_subrev_u32 v15, 0x20000, v15
    ds_read_b64_tr_b16 v[28:29], v15 offset:0
    v_mfma_f32_16x16x32_bf16 v[180:183], v[16:19], v[52:55], v[180:183]
    ds_read_b64_tr_b16 v[30:31], v15 offset:4096
    s_add_u32 m0, s39, 0x1c000
    s_mov_b32 s63, 0x2c0000
    buffer_load_dwordx4 v2, s[8:11], s63 offen lds
    s_waitcnt lgkmcnt(4)
    v_mfma_f32_16x16x32_bf16 v[184:187], v[20:23], v[48:51], v[184:187]
    ds_read_b128 v[56:59], v231 offset:24576
    ds_read_b128 v[60:63], v231 offset:25600
    ds_read_b64_tr_b16 v[16:17], v8 offset:16384
    v_mfma_f32_16x16x32_bf16 v[188:191], v[20:23], v[52:55], v[188:191]
    ds_read_b64_tr_b16 v[18:19], v8 offset:20480
    s_waitcnt lgkmcnt(6)
    v_mfma_f32_16x16x32_bf16 v[192:195], v[24:27], v[48:51], v[192:195]
    ds_read_b64_tr_b16 v[20:21], v9 offset:16384
    v_mfma_f32_16x16x32_bf16 v[196:199], v[24:27], v[52:55], v[196:199]
    ds_read_b64_tr_b16 v[22:23], v9 offset:20480
    s_add_u32 m0, s39, 0x1e000
    s_mov_b32 s56, 0x2c0100
    buffer_load_dwordx4 v2, s[8:11], s56 offen lds
    s_waitcnt lgkmcnt(6)
    v_mfma_f32_16x16x32_bf16 v[200:203], v[28:31], v[48:51], v[200:203]
    ds_read_b64_tr_b16 v[24:25], v10 offset:16384
    v_mfma_f32_16x16x32_bf16 v[204:207], v[28:31], v[52:55], v[204:207]
    ds_read_b64_tr_b16 v[26:27], v10 offset:20480
    s_setprio 1
    s_waitcnt lgkmcnt(4)
    v_mfma_f32_16x16x32_bf16 v[144:147], v[16:19], v[56:59], v[144:147]
    ds_read_b64_tr_b16 v[28:29], v11 offset:16384
    v_mfma_f32_16x16x32_bf16 v[148:151], v[16:19], v[60:63], v[148:151]
    ds_read_b64_tr_b16 v[30:31], v11 offset:20480
    s_add_u32 m0, s39, 0x20000
    s_mov_b32 s57, 0x6000
    buffer_load_dwordx4 v230, s[24:27], s57 offen sc1 lds
    s_waitcnt lgkmcnt(4)
    v_mfma_f32_16x16x32_bf16 v[152:155], v[20:23], v[56:59], v[152:155]
    ds_read_b64_tr_b16 v[16:17], v12 offset:16384
    v_mfma_f32_16x16x32_bf16 v[156:159], v[20:23], v[60:63], v[156:159]
    ds_read_b64_tr_b16 v[18:19], v12 offset:20480
    s_waitcnt lgkmcnt(4)
    v_mfma_f32_16x16x32_bf16 v[160:163], v[24:27], v[56:59], v[160:163]
    ds_read_b64_tr_b16 v[20:21], v13 offset:16384
    v_mfma_f32_16x16x32_bf16 v[164:167], v[24:27], v[60:63], v[164:167]
    ds_read_b64_tr_b16 v[22:23], v13 offset:20480
    s_add_u32 m0, s39, 0x22000
    s_mov_b32 s58, 0x6800
    buffer_load_dwordx4 v230, s[24:27], s58 offen sc1 lds
    s_waitcnt lgkmcnt(4)
    v_mfma_f32_16x16x32_bf16 v[168:171], v[28:31], v[56:59], v[168:171]
    ds_read_b64_tr_b16 v[24:25], v14 offset:16384
    v_mfma_f32_16x16x32_bf16 v[172:175], v[28:31], v[60:63], v[172:175]
    ds_read_b64_tr_b16 v[26:27], v14 offset:20480
    s_setprio 0
    s_waitcnt lgkmcnt(4)
    v_mfma_f32_16x16x32_bf16 v[176:179], v[16:19], v[56:59], v[176:179]
    ds_read_b64_tr_b16 v[28:29], v15 offset:16384
    v_mfma_f32_16x16x32_bf16 v[180:183], v[16:19], v[60:63], v[180:183]
    ds_read_b64_tr_b16 v[30:31], v15 offset:20480
    s_waitcnt lgkmcnt(4)
    v_mfma_f32_16x16x32_bf16 v[184:187], v[20:23], v[56:59], v[184:187]
    v_subrev_u32 v231, 0x20000, v231
    ds_read_b128 v[48:51], v231 offset:32768
    ds_read_b128 v[52:55], v231 offset:33792
    ds_read_b64_tr_b16 v[16:17], v8 offset:49152
    v_mfma_f32_16x16x32_bf16 v[188:191], v[20:23], v[60:63], v[188:191]
    ds_read_b64_tr_b16 v[18:19], v8 offset:53248
    s_waitcnt lgkmcnt(6)
    v_mfma_f32_16x16x32_bf16 v[192:195], v[24:27], v[56:59], v[192:195]
    ds_read_b64_tr_b16 v[20:21], v9 offset:49152
    v_mfma_f32_16x16x32_bf16 v[196:199], v[24:27], v[60:63], v[196:199]
    ds_read_b64_tr_b16 v[22:23], v9 offset:53248
    s_waitcnt lgkmcnt(6)
    v_mfma_f32_16x16x32_bf16 v[200:203], v[28:31], v[56:59], v[200:203]
    ds_read_b64_tr_b16 v[24:25], v10 offset:49152
    v_mfma_f32_16x16x32_bf16 v[204:207], v[28:31], v[60:63], v[204:207]
    ds_read_b64_tr_b16 v[26:27], v10 offset:53248
    s_setprio 3
    s_waitcnt vmcnt(4)
    s_barrier
    s_waitcnt lgkmcnt(4)
    v_mfma_f32_16x16x32_bf16 v[144:147], v[16:19], v[48:51], v[144:147]
    ds_read_b64_tr_b16 v[28:29], v11 offset:49152
    v_mfma_f32_16x16x32_bf16 v[148:151], v[16:19], v[52:55], v[148:151]
    ds_read_b64_tr_b16 v[30:31], v11 offset:53248
    s_add_u32 m0, s39, 0x24000
    s_mov_b32 s59, 0x300000
    buffer_load_dwordx4 v2, s[8:11], s59 offen lds
    s_waitcnt lgkmcnt(4)
    v_mfma_f32_16x16x32_bf16 v[152:155], v[20:23], v[48:51], v[152:155]
    ds_read_b64_tr_b16 v[16:17], v12 offset:49152
    v_mfma_f32_16x16x32_bf16 v[156:159], v[20:23], v[52:55], v[156:159]
    ds_read_b64_tr_b16 v[18:19], v12 offset:53248
    s_waitcnt lgkmcnt(4)
    v_mfma_f32_16x16x32_bf16 v[160:163], v[24:27], v[48:51], v[160:163]
    ds_read_b64_tr_b16 v[20:21], v13 offset:49152
    v_mfma_f32_16x16x32_bf16 v[164:167], v[24:27], v[52:55], v[164:167]
    ds_read_b64_tr_b16 v[22:23], v13 offset:53248
    s_add_u32 m0, s39, 0x26000
    s_mov_b32 s60, 0x300100
    buffer_load_dwordx4 v2, s[8:11], s60 offen lds
    s_waitcnt lgkmcnt(4)
    v_mfma_f32_16x16x32_bf16 v[168:171], v[28:31], v[48:51], v[168:171]
    ds_read_b64_tr_b16 v[24:25], v14 offset:49152
    v_mfma_f32_16x16x32_bf16 v[172:175], v[28:31], v[52:55], v[172:175]
    ds_read_b64_tr_b16 v[26:27], v14 offset:53248
    s_setprio 2
    s_waitcnt lgkmcnt(4)
    v_mfma_f32_16x16x32_bf16 v[176:179], v[16:19], v[48:51], v[176:179]
    ds_read_b64_tr_b16 v[28:29], v15 offset:49152
    v_mfma_f32_16x16x32_bf16 v[180:183], v[16:19], v[52:55], v[180:183]
    ds_read_b64_tr_b16 v[30:31], v15 offset:53248
    s_add_u32 m0, s39, 0x0
    s_mov_b32 s61, 0x340000
    buffer_load_dwordx4 v2, s[8:11], s61 offen lds
    s_waitcnt lgkmcnt(4)
    v_mfma_f32_16x16x32_bf16 v[184:187], v[20:23], v[48:51], v[184:187]
    ds_read_b128 v[56:59], v231 offset:40960
    ds_read_b128 v[60:63], v231 offset:41984
    v_add_u32 v8, 0x10000, v8
    ds_read_b64_tr_b16 v[16:17], v8 offset:0
    v_mfma_f32_16x16x32_bf16 v[188:191], v[20:23], v[52:55], v[188:191]
    ds_read_b64_tr_b16 v[18:19], v8 offset:4096
    s_waitcnt lgkmcnt(6)
    v_mfma_f32_16x16x32_bf16 v[192:195], v[24:27], v[48:51], v[192:195]
    v_add_u32 v9, 0x10000, v9
    ds_read_b64_tr_b16 v[20:21], v9 offset:0
    v_mfma_f32_16x16x32_bf16 v[196:199], v[24:27], v[52:55], v[196:199]
    ds_read_b64_tr_b16 v[22:23], v9 offset:4096
    s_add_u32 m0, s39, 0x2000
    s_mov_b32 s62, 0x340100
    buffer_load_dwordx4 v2, s[8:11], s62 offen lds
    s_waitcnt lgkmcnt(6)
    v_mfma_f32_16x16x32_bf16 v[200:203], v[28:31], v[48:51], v[200:203]
    v_add_u32 v10, 0x10000, v10
    ds_read_b64_tr_b16 v[24:25], v10 offset:0
    v_mfma_f32_16x16x32_bf16 v[204:207], v[28:31], v[52:55], v[204:207]
    ds_read_b64_tr_b16 v[26:27], v10 offset:4096
    s_setprio 1
    s_waitcnt lgkmcnt(4)
    v_mfma_f32_16x16x32_bf16 v[144:147], v[16:19], v[56:59], v[144:147]
    v_add_u32 v11, 0x10000, v11
    ds_read_b64_tr_b16 v[28:29], v11 offset:0
    v_mfma_f32_16x16x32_bf16 v[148:151], v[16:19], v[60:63], v[148:151]
    ds_read_b64_tr_b16 v[30:31], v11 offset:4096
    s_add_u32 m0, s39, 0x4000
    s_mov_b32 s63, 0x7000
    buffer_load_dwordx4 v230, s[24:27], s63 offen sc1 lds
    s_waitcnt lgkmcnt(4)
    v_mfma_f32_16x16x32_bf16 v[152:155], v[20:23], v[56:59], v[152:155]
    v_add_u32 v12, 0x10000, v12
    ds_read_b64_tr_b16 v[16:17], v12 offset:0
    v_mfma_f32_16x16x32_bf16 v[156:159], v[20:23], v[60:63], v[156:159]
    ds_read_b64_tr_b16 v[18:19], v12 offset:4096
    s_waitcnt lgkmcnt(4)
    v_mfma_f32_16x16x32_bf16 v[160:163], v[24:27], v[56:59], v[160:163]
    v_add_u32 v13, 0x10000, v13
    ds_read_b64_tr_b16 v[20:21], v13 offset:0
    v_mfma_f32_16x16x32_bf16 v[164:167], v[24:27], v[60:63], v[164:167]
    ds_read_b64_tr_b16 v[22:23], v13 offset:4096
    s_add_u32 m0, s39, 0x6000
    s_mov_b32 s56, 0x7800
    buffer_load_dwordx4 v230, s[24:27], s56 offen sc1 lds
    s_waitcnt lgkmcnt(4)
    v_mfma_f32_16x16x32_bf16 v[168:171], v[28:31], v[56:59], v[168:171]
    v_add_u32 v14, 0x10000, v14
    ds_read_b64_tr_b16 v[24:25], v14 offset:0
    v_mfma_f32_16x16x32_bf16 v[172:175], v[28:31], v[60:63], v[172:175]
    ds_read_b64_tr_b16 v[26:27], v14 offset:4096
    s_setprio 0
    s_waitcnt lgkmcnt(4)
    v_mfma_f32_16x16x32_bf16 v[176:179], v[16:19], v[56:59], v[176:179]
    v_add_u32 v15, 0x10000, v15
    ds_read_b64_tr_b16 v[28:29], v15 offset:0
    v_mfma_f32_16x16x32_bf16 v[180:183], v[16:19], v[60:63], v[180:183]
    ds_read_b64_tr_b16 v[30:31], v15 offset:4096
    s_waitcnt lgkmcnt(4)
    v_mfma_f32_16x16x32_bf16 v[184:187], v[20:23], v[56:59], v[184:187]
    v_add_u32 v231, 0x10000, v231
    ds_read_b128 v[48:51], v231 offset:16384
    ds_read_b128 v[52:55], v231 offset:17408
    ds_read_b64_tr_b16 v[16:17], v8 offset:32768
    v_mfma_f32_16x16x32_bf16 v[188:191], v[20:23], v[60:63], v[188:191]
    ds_read_b64_tr_b16 v[18:19], v8 offset:36864
    s_waitcnt lgkmcnt(6)
    v_mfma_f32_16x16x32_bf16 v[192:195], v[24:27], v[56:59], v[192:195]
    ds_read_b64_tr_b16 v[20:21], v9 offset:32768
    v_mfma_f32_16x16x32_bf16 v[196:199], v[24:27], v[60:63], v[196:199]
    ds_read_b64_tr_b16 v[22:23], v9 offset:36864
    s_waitcnt lgkmcnt(6)
    v_mfma_f32_16x16x32_bf16 v[200:203], v[28:31], v[56:59], v[200:203]
    ds_read_b64_tr_b16 v[24:25], v10 offset:32768
    v_mfma_f32_16x16x32_bf16 v[204:207], v[28:31], v[60:63], v[204:207]
    ds_read_b64_tr_b16 v[26:27], v10 offset:36864
    s_setprio 3
    s_waitcnt vmcnt(4)
    s_barrier
    s_waitcnt lgkmcnt(4)
    v_mfma_f32_16x16x32_bf16 v[144:147], v[16:19], v[48:51], v[144:147]
    ds_read_b64_tr_b16 v[28:29], v11 offset:32768
    v_mfma_f32_16x16x32_bf16 v[148:151], v[16:19], v[52:55], v[148:151]
    ds_read_b64_tr_b16 v[30:31], v11 offset:36864
    s_add_u32 m0, s39, 0x8000
    s_mov_b32 s57, 0x380000
    buffer_load_dwordx4 v2, s[8:11], s57 offen lds
    s_waitcnt lgkmcnt(4)
    v_mfma_f32_16x16x32_bf16 v[152:155], v[20:23], v[48:51], v[152:155]
    ds_read_b64_tr_b16 v[16:17], v12 offset:32768
    v_mfma_f32_16x16x32_bf16 v[156:159], v[20:23], v[52:55], v[156:159]
    ds_read_b64_tr_b16 v[18:19], v12 offset:36864
    s_waitcnt lgkmcnt(4)
    v_mfma_f32_16x16x32_bf16 v[160:163], v[24:27], v[48:51], v[160:163]
    ds_read_b64_tr_b16 v[20:21], v13 offset:32768
    v_mfma_f32_16x16x32_bf16 v[164:167], v[24:27], v[52:55], v[164:167]
    ds_read_b64_tr_b16 v[22:23], v13 offset:36864
    s_add_u32 m0, s39, 0xa000
    s_mov_b32 s58, 0x380100
    buffer_load_dwordx4 v2, s[8:11], s58 offen lds
    s_waitcnt lgkmcnt(4)
    v_mfma_f32_16x16x32_bf16 v[168:171], v[28:31], v[48:51], v[168:171]
    ds_read_b64_tr_b16 v[24:25], v14 offset:32768
    v_mfma_f32_16x16x32_bf16 v[172:175], v[28:31], v[52:55], v[172:175]
    ds_read_b64_tr_b16 v[26:27], v14 offset:36864
    s_setprio 2
    s_waitcnt lgkmcnt(4)
    v_mfma_f32_16x16x32_bf16 v[176:179], v[16:19], v[48:51], v[176:179]
    ds_read_b64_tr_b16 v[28:29], v15 offset:32768
    v_mfma_f32_16x16x32_bf16 v[180:183], v[16:19], v[52:55], v[180:183]
    ds_read_b64_tr_b16 v[30:31], v15 offset:36864
    s_add_u32 m0, s39, 0xc000
    s_mov_b32 s59, 0x3c0000
    buffer_load_dwordx4 v2, s[8:11], s59 offen lds
    s_waitcnt lgkmcnt(4)
    v_mfma_f32_16x16x32_bf16 v[184:187], v[20:23], v[48:51], v[184:187]
    ds_read_b128 v[56:59], v231 offset:24576
    ds_read_b128 v[60:63], v231 offset:25600
    ds_read_b64_tr_b16 v[16:17], v8 offset:49152
    v_mfma_f32_16x16x32_bf16 v[188:191], v[20:23], v[52:55], v[188:191]
    ds_read_b64_tr_b16 v[18:19], v8 offset:53248
    s_waitcnt lgkmcnt(6)
    v_mfma_f32_16x16x32_bf16 v[192:195], v[24:27], v[48:51], v[192:195]
    ds_read_b64_tr_b16 v[20:21], v9 offset:49152
    v_mfma_f32_16x16x32_bf16 v[196:199], v[24:27], v[52:55], v[196:199]
    ds_read_b64_tr_b16 v[22:23], v9 offset:53248
    s_add_u32 m0, s39, 0xe000
    s_mov_b32 s60, 0x3c0100
    buffer_load_dwordx4 v2, s[8:11], s60 offen lds
    s_waitcnt lgkmcnt(6)
    v_mfma_f32_16x16x32_bf16 v[200:203], v[28:31], v[48:51], v[200:203]
    ds_read_b64_tr_b16 v[24:25], v10 offset:49152
    v_mfma_f32_16x16x32_bf16 v[204:207], v[28:31], v[52:55], v[204:207]
    ds_read_b64_tr_b16 v[26:27], v10 offset:53248
    s_setprio 1
    s_waitcnt lgkmcnt(4)
    v_mfma_f32_16x16x32_bf16 v[144:147], v[16:19], v[56:59], v[144:147]
    ds_read_b64_tr_b16 v[28:29], v11 offset:49152
    v_mfma_f32_16x16x32_bf16 v[148:151], v[16:19], v[60:63], v[148:151]
    ds_read_b64_tr_b16 v[30:31], v11 offset:53248
    s_add_u32 m0, s39, 0x10000
    s_mov_b32 s61, 0x8000
    buffer_load_dwordx4 v230, s[24:27], s61 offen sc1 lds
    s_waitcnt lgkmcnt(4)
    v_mfma_f32_16x16x32_bf16 v[152:155], v[20:23], v[56:59], v[152:155]
    ds_read_b64_tr_b16 v[16:17], v12 offset:49152
    v_mfma_f32_16x16x32_bf16 v[156:159], v[20:23], v[60:63], v[156:159]
    ds_read_b64_tr_b16 v[18:19], v12 offset:53248
    s_waitcnt lgkmcnt(4)
    v_mfma_f32_16x16x32_bf16 v[160:163], v[24:27], v[56:59], v[160:163]
    ds_read_b64_tr_b16 v[20:21], v13 offset:49152
    v_mfma_f32_16x16x32_bf16 v[164:167], v[24:27], v[60:63], v[164:167]
    ds_read_b64_tr_b16 v[22:23], v13 offset:53248
    s_add_u32 m0, s39, 0x12000
    s_mov_b32 s62, 0x8800
    buffer_load_dwordx4 v230, s[24:27], s62 offen sc1 lds
    s_waitcnt lgkmcnt(4)
    v_mfma_f32_16x16x32_bf16 v[168:171], v[28:31], v[56:59], v[168:171]
    ds_read_b64_tr_b16 v[24:25], v14 offset:49152
    v_mfma_f32_16x16x32_bf16 v[172:175], v[28:31], v[60:63], v[172:175]
    ds_read_b64_tr_b16 v[26:27], v14 offset:53248
    s_setprio 0
    s_waitcnt lgkmcnt(4)
    v_mfma_f32_16x16x32_bf16 v[176:179], v[16:19], v[56:59], v[176:179]
    ds_read_b64_tr_b16 v[28:29], v15 offset:49152
    v_mfma_f32_16x16x32_bf16 v[180:183], v[16:19], v[60:63], v[180:183]
    ds_read_b64_tr_b16 v[30:31], v15 offset:53248
    s_waitcnt lgkmcnt(4)
    v_mfma_f32_16x16x32_bf16 v[184:187], v[20:23], v[56:59], v[184:187]
    v_add_u32 v231, 0x10000, v231
    ds_read_b128 v[48:51], v231 offset:0
    ds_read_b128 v[52:55], v231 offset:1024
    v_add_u32 v8, 0x10000, v8
    ds_read_b64_tr_b16 v[16:17], v8 offset:16384
    v_mfma_f32_16x16x32_bf16 v[188:191], v[20:23], v[60:63], v[188:191]
    ds_read_b64_tr_b16 v[18:19], v8 offset:20480
    s_waitcnt lgkmcnt(6)
    v_mfma_f32_16x16x32_bf16 v[192:195], v[24:27], v[56:59], v[192:195]
    v_add_u32 v9, 0x10000, v9
    ds_read_b64_tr_b16 v[20:21], v9 offset:16384
    v_mfma_f32_16x16x32_bf16 v[196:199], v[24:27], v[60:63], v[196:199]
    ds_read_b64_tr_b16 v[22:23], v9 offset:20480
    s_waitcnt lgkmcnt(6)
    v_mfma_f32_16x16x32_bf16 v[200:203], v[28:31], v[56:59], v[200:203]
    v_add_u32 v10, 0x10000, v10
    ds_read_b64_tr_b16 v[24:25], v10 offset:16384
    v_mfma_f32_16x16x32_bf16 v[204:207], v[28:31], v[60:63], v[204:207]
    ds_read_b64_tr_b16 v[26:27], v10 offset:20480
    s_setprio 3
    s_waitcnt vmcnt(4)
    s_barrier
    s_waitcnt lgkmcnt(4)
    v_mfma_f32_16x16x32_bf16 v[144:147], v[16:19], v[48:51], v[144:147]
    v_add_u32 v11, 0x10000, v11
    ds_read_b64_tr_b16 v[28:29], v11 offset:16384
    v_mfma_f32_16x16x32_bf16 v[148:151], v[16:19], v[52:55], v[148:151]
    ds_read_b64_tr_b16 v[30:31], v11 offset:20480
    s_add_u32 m0, s39, 0x14000
    s_mov_b32 s63, 0x400000
    buffer_load_dwordx4 v2, s[8:11], s63 offen lds
    s_waitcnt lgkmcnt(4)
    v_mfma_f32_16x16x32_bf16 v[152:155], v[20:23], v[48:51], v[152:155]
    v_add_u32 v12, 0x10000, v12
    ds_read_b64_tr_b16 v[16:17], v12 offset:16384
    v_mfma_f32_16x16x32_bf16 v[156:159], v[20:23], v[52:55], v[156:159]
    ds_read_b64_tr_b16 v[18:19], v12 offset:20480
    s_waitcnt lgkmcnt(4)
    v_mfma_f32_16x16x32_bf16 v[160:163], v[24:27], v[48:51], v[160:163]
    v_add_u32 v13, 0x10000, v13
    ds_read_b64_tr_b16 v[20:21], v13 offset:16384
    v_mfma_f32_16x16x32_bf16 v[164:167], v[24:27], v[52:55], v[164:167]
    ds_read_b64_tr_b16 v[22:23], v13 offset:20480
    s_add_u32 m0, s39, 0x16000
    s_mov_b32 s56, 0x400100
    buffer_load_dwordx4 v2, s[8:11], s56 offen lds
    s_waitcnt lgkmcnt(4)
    v_mfma_f32_16x16x32_bf16 v[168:171], v[28:31], v[48:51], v[168:171]
    v_add_u32 v14, 0x10000, v14
    ds_read_b64_tr_b16 v[24:25], v14 offset:16384
    v_mfma_f32_16x16x32_bf16 v[172:175], v[28:31], v[52:55], v[172:175]
    ds_read_b64_tr_b16 v[26:27], v14 offset:20480
    s_setprio 2
    s_waitcnt lgkmcnt(4)
    v_mfma_f32_16x16x32_bf16 v[176:179], v[16:19], v[48:51], v[176:179]
    v_add_u32 v15, 0x10000, v15
    ds_read_b64_tr_b16 v[28:29], v15 offset:16384
    v_mfma_f32_16x16x32_bf16 v[180:183], v[16:19], v[52:55], v[180:183]
    ds_read_b64_tr_b16 v[30:31], v15 offset:20480
    s_add_u32 m0, s39, 0x18000
    s_mov_b32 s57, 0x440000
    buffer_load_dwordx4 v2, s[8:11], s57 offen lds
    s_waitcnt lgkmcnt(4)
    v_mfma_f32_16x16x32_bf16 v[184:187], v[20:23], v[48:51], v[184:187]
    ds_read_b128 v[56:59], v231 offset:8192
    ds_read_b128 v[60:63], v231 offset:9216
    v_subrev_u32 v8, 0x20000, v8
    ds_read_b64_tr_b16 v[16:17], v8 offset:0
    v_mfma_f32_16x16x32_bf16 v[188:191], v[20:23], v[52:55], v[188:191]
    ds_read_b64_tr_b16 v[18:19], v8 offset:4096
    s_waitcnt lgkmcnt(6)
    v_mfma_f32_16x16x32_bf16 v[192:195], v[24:27], v[48:51], v[192:195]
    v_subrev_u32 v9, 0x20000, v9
    ds_read_b64_tr_b16 v[20:21], v9 offset:0
    v_mfma_f32_16x16x32_bf16 v[196:199], v[24:27], v[52:55], v[196:199]
    ds_read_b64_tr_b16 v[22:23], v9 offset:4096
    s_add_u32 m0, s39, 0x1a000
    s_mov_b32 s58, 0x440100
    buffer_load_dwordx4 v2, s[8:11], s58 offen lds
    s_waitcnt lgkmcnt(6)
    v_mfma_f32_16x16x32_bf16 v[200:203], v[28:31], v[48:51], v[200:203]
    v_subrev_u32 v10, 0x20000, v10
    ds_read_b64_tr_b16 v[24:25], v10 offset:0
    v_mfma_f32_16x16x32_bf16 v[204:207], v[28:31], v[52:55], v[204:207]
    ds_read_b64_tr_b16 v[26:27], v10 offset:4096
    s_setprio 1
    s_waitcnt lgkmcnt(4)
    v_mfma_f32_16x16x32_bf16 v[144:147], v[16:19], v[56:59], v[144:147]
    v_subrev_u32 v11, 0x20000, v11
    ds_read_b64_tr_b16 v[28:29], v11 offset:0
    v_mfma_f32_16x16x32_bf16 v[148:151], v[16:19], v[60:63], v[148:151]
    ds_read_b64_tr_b16 v[30:31], v11 offset:4096
    s_add_u32 m0, s39, 0x1c000
    s_mov_b32 s59, 0x0
    buffer_load_dwordx4 v3, s[12:15], s59 offen lds
    s_waitcnt lgkmcnt(4)
    v_mfma_f32_16x16x32_bf16 v[152:155], v[20:23], v[56:59], v[152:155]
    v_subrev_u32 v12, 0x20000, v12
    ds_read_b64_tr_b16 v[16:17], v12 offset:0
    v_mfma_f32_16x16x32_bf16 v[156:159], v[20:23], v[60:63], v[156:159]
    ds_read_b64_tr_b16 v[18:19], v12 offset:4096
    s_waitcnt lgkmcnt(4)
    v_mfma_f32_16x16x32_bf16 v[160:163], v[24:27], v[56:59], v[160:163]
    v_subrev_u32 v13, 0x20000, v13
    ds_read_b64_tr_b16 v[20:21], v13 offset:0
    v_mfma_f32_16x16x32_bf16 v[164:167], v[24:27], v[60:63], v[164:167]
    ds_read_b64_tr_b16 v[22:23], v13 offset:4096
    s_add_u32 m0, s39, 0x1e000
    s_mov_b32 s60, 0x2000
    buffer_load_dwordx4 v3, s[12:15], s60 offen lds
    s_waitcnt lgkmcnt(4)
    v_mfma_f32_16x16x32_bf16 v[168:171], v[28:31], v[56:59], v[168:171]
    v_subrev_u32 v14, 0x20000, v14
    ds_read_b64_tr_b16 v[24:25], v14 offset:0
    v_mfma_f32_16x16x32_bf16 v[172:175], v[28:31], v[60:63], v[172:175]
    ds_read_b64_tr_b16 v[26:27], v14 offset:4096
    s_setprio 0
    s_waitcnt lgkmcnt(4)
    v_mfma_f32_16x16x32_bf16 v[176:179], v[16:19], v[56:59], v[176:179]
    v_subrev_u32 v15, 0x20000, v15
    ds_read_b64_tr_b16 v[28:29], v15 offset:0
    v_mfma_f32_16x16x32_bf16 v[180:183], v[16:19], v[60:63], v[180:183]
    ds_read_b64_tr_b16 v[30:31], v15 offset:4096
    s_waitcnt lgkmcnt(4)
    v_mfma_f32_16x16x32_bf16 v[184:187], v[20:23], v[56:59], v[184:187]
    v_subrev_u32 v231, 0x20000, v231
    ds_read_b128 v[48:51], v231 offset:16384
    ds_read_b128 v[52:55], v231 offset:17408
    ds_read_b64_tr_b16 v[16:17], v8 offset:32768
    v_mfma_f32_16x16x32_bf16 v[188:191], v[20:23], v[60:63], v[188:191]
    ds_read_b64_tr_b16 v[18:19], v8 offset:36864
    s_waitcnt lgkmcnt(6)
    v_mfma_f32_16x16x32_bf16 v[192:195], v[24:27], v[56:59], v[192:195]
    ds_read_b64_tr_b16 v[20:21], v9 offset:32768
    v_mfma_f32_16x16x32_bf16 v[196:199], v[24:27], v[60:63], v[196:199]
    ds_read_b64_tr_b16 v[22:23], v9 offset:36864
    s_waitcnt lgkmcnt(6)
    v_mfma_f32_16x16x32_bf16 v[200:203], v[28:31], v[56:59], v[200:203]
    ds_read_b64_tr_b16 v[24:25], v10 offset:32768
    v_mfma_f32_16x16x32_bf16 v[204:207], v[28:31], v[60:63], v[204:207]
    ds_read_b64_tr_b16 v[26:27], v10 offset:36864
    s_setprio 3
    s_waitcnt vmcnt(4)
    s_barrier
    s_waitcnt lgkmcnt(4)
    v_mfma_f32_16x16x32_bf16 v[144:147], v[16:19], v[48:51], v[144:147]
    ds_read_b64_tr_b16 v[28:29], v11 offset:32768
    v_mfma_f32_16x16x32_bf16 v[148:151], v[16:19], v[52:55], v[148:151]
    ds_read_b64_tr_b16 v[30:31], v11 offset:36864
    s_add_u32 m0, s39, 0x20000
    s_mov_b32 s61, 0x4000
    buffer_load_dwordx4 v3, s[12:15], s61 offen lds
    s_waitcnt lgkmcnt(4)
    v_mfma_f32_16x16x32_bf16 v[152:155], v[20:23], v[48:51], v[152:155]
    ds_read_b64_tr_b16 v[16:17], v12 offset:32768
    v_mfma_f32_16x16x32_bf16 v[156:159], v[20:23], v[52:55], v[156:159]
    ds_read_b64_tr_b16 v[18:19], v12 offset:36864
    s_waitcnt lgkmcnt(4)
    v_mfma_f32_16x16x32_bf16 v[160:163], v[24:27], v[48:51], v[160:163]
    ds_read_b64_tr_b16 v[20:21], v13 offset:32768
    v_mfma_f32_16x16x32_bf16 v[164:167], v[24:27], v[52:55], v[164:167]
    ds_read_b64_tr_b16 v[22:23], v13 offset:36864
    s_add_u32 m0, s39, 0x22000
    s_mov_b32 s62, 0x0
    buffer_load_dwordx4 v4, s[16:19], s62 offen lds
    s_waitcnt lgkmcnt(4)
    v_mfma_f32_16x16x32_bf16 v[168:171], v[28:31], v[48:51], v[168:171]
    ds_read_b64_tr_b16 v[24:25], v14 offset:32768
    v_mfma_f32_16x16x32_bf16 v[172:175], v[28:31], v[52:55], v[172:175]
    ds_read_b64_tr_b16 v[26:27], v14 offset:36864
    s_setprio 2
    s_waitcnt lgkmcnt(4)
    v_mfma_f32_16x16x32_bf16 v[176:179], v[16:19], v[48:51], v[176:179]
    ds_read_b64_tr_b16 v[28:29], v15 offset:32768
    v_mfma_f32_16x16x32_bf16 v[180:183], v[16:19], v[52:55], v[180:183]
    ds_read_b64_tr_b16 v[30:31], v15 offset:36864
    s_add_u32 m0, s39, 0x24000
    s_mov_b32 s63, 0x6000
    buffer_load_dwordx4 v3, s[12:15], s63 offen lds
    s_waitcnt lgkmcnt(4)
    v_mfma_f32_16x16x32_bf16 v[184:187], v[20:23], v[48:51], v[184:187]
    ds_read_b128 v[56:59], v231 offset:24576
    ds_read_b128 v[60:63], v231 offset:25600
    ds_read_b64_tr_b16 v[16:17], v8 offset:49152
    v_mfma_f32_16x16x32_bf16 v[188:191], v[20:23], v[52:55], v[188:191]
    ds_read_b64_tr_b16 v[18:19], v8 offset:53248
    s_waitcnt lgkmcnt(6)
    v_mfma_f32_16x16x32_bf16 v[192:195], v[24:27], v[48:51], v[192:195]
    ds_read_b64_tr_b16 v[20:21], v9 offset:49152
    v_mfma_f32_16x16x32_bf16 v[196:199], v[24:27], v[52:55], v[196:199]
    ds_read_b64_tr_b16 v[22:23], v9 offset:53248
    s_add_u32 m0, s39, 0x26000
    s_mov_b32 s56, 0x2000
    buffer_load_dwordx4 v4, s[16:19], s56 offen lds
    s_waitcnt lgkmcnt(6)
    v_mfma_f32_16x16x32_bf16 v[200:203], v[28:31], v[48:51], v[200:203]
    ds_read_b64_tr_b16 v[24:25], v10 offset:49152
    v_mfma_f32_16x16x32_bf16 v[204:207], v[28:31], v[52:55], v[204:207]
    ds_read_b64_tr_b16 v[26:27], v10 offset:53248
    s_setprio 1
    s_waitcnt lgkmcnt(4)
    v_mfma_f32_16x16x32_bf16 v[144:147], v[16:19], v[56:59], v[144:147]
    ds_read_b64_tr_b16 v[28:29], v11 offset:49152
    v_mfma_f32_16x16x32_bf16 v[148:151], v[16:19], v[60:63], v[148:151]
    ds_read_b64_tr_b16 v[30:31], v11 offset:53248
    s_add_u32 m0, s39, 0x0
    s_mov_b32 s57, 0x8000
    buffer_load_dwordx4 v3, s[12:15], s57 offen lds
    s_waitcnt lgkmcnt(4)
    v_mfma_f32_16x16x32_bf16 v[152:155], v[20:23], v[56:59], v[152:155]
    ds_read_b64_tr_b16 v[16:17], v12 offset:49152
    v_mfma_f32_16x16x32_bf16 v[156:159], v[20:23], v[60:63], v[156:159]
    ds_read_b64_tr_b16 v[18:19], v12 offset:53248
    s_waitcnt lgkmcnt(4)
    v_mfma_f32_16x16x32_bf16 v[160:163], v[24:27], v[56:59], v[160:163]
    ds_read_b64_tr_b16 v[20:21], v13 offset:49152
    v_mfma_f32_16x16x32_bf16 v[164:167], v[24:27], v[60:63], v[164:167]
    ds_read_b64_tr_b16 v[22:23], v13 offset:53248
    s_add_u32 m0, s39, 0x2000
    s_mov_b32 s58, 0x4000
    buffer_load_dwordx4 v4, s[16:19], s58 offen lds
    s_waitcnt lgkmcnt(4)
    v_mfma_f32_16x16x32_bf16 v[168:171], v[28:31], v[56:59], v[168:171]
    ds_read_b64_tr_b16 v[24:25], v14 offset:49152
    v_mfma_f32_16x16x32_bf16 v[172:175], v[28:31], v[60:63], v[172:175]
    ds_read_b64_tr_b16 v[26:27], v14 offset:53248
    s_setprio 0
    s_waitcnt lgkmcnt(4)
    v_mfma_f32_16x16x32_bf16 v[176:179], v[16:19], v[56:59], v[176:179]
    ds_read_b64_tr_b16 v[28:29], v15 offset:49152
    v_mfma_f32_16x16x32_bf16 v[180:183], v[16:19], v[60:63], v[180:183]
    ds_read_b64_tr_b16 v[30:31], v15 offset:53248
    s_waitcnt lgkmcnt(4)
    v_mfma_f32_16x16x32_bf16 v[184:187], v[20:23], v[56:59], v[184:187]
    v_add_u32 v231, 0x10000, v231
    ds_read_b128 v[48:51], v231 offset:0
    ds_read_b128 v[52:55], v231 offset:1024
    v_add_u32 v8, 0x10000, v8
    ds_read_b64_tr_b16 v[16:17], v8 offset:16384
    v_mfma_f32_16x16x32_bf16 v[188:191], v[20:23], v[60:63], v[188:191]
    ds_read_b64_tr_b16 v[18:19], v8 offset:20480
    s_waitcnt lgkmcnt(6)
    v_mfma_f32_16x16x32_bf16 v[192:195], v[24:27], v[56:59], v[192:195]
    v_add_u32 v9, 0x10000, v9
    ds_read_b64_tr_b16 v[20:21], v9 offset:16384
    v_mfma_f32_16x16x32_bf16 v[196:199], v[24:27], v[60:63], v[196:199]
    ds_read_b64_tr_b16 v[22:23], v9 offset:20480
    s_waitcnt lgkmcnt(6)
    v_mfma_f32_16x16x32_bf16 v[200:203], v[28:31], v[56:59], v[200:203]
    v_add_u32 v10, 0x10000, v10
    ds_read_b64_tr_b16 v[24:25], v10 offset:16384
    v_mfma_f32_16x16x32_bf16 v[204:207], v[28:31], v[60:63], v[204:207]
    ds_read_b64_tr_b16 v[26:27], v10 offset:20480
    s_setprio 3
    s_waitcnt vmcnt(7)
    s_barrier
    s_waitcnt lgkmcnt(4)
    v_mfma_f32_16x16x32_bf16 v[144:147], v[16:19], v[48:51], v[144:147]
    v_add_u32 v11, 0x10000, v11
    ds_read_b64_tr_b16 v[28:29], v11 offset:16384
    v_mfma_f32_16x16x32_bf16 v[148:151], v[16:19], v[52:55], v[148:151]
    ds_read_b64_tr_b16 v[30:31], v11 offset:20480
    s_add_u32 m0, s39, 0x4000
    s_mov_b32 s59, 0xa000
    buffer_load_dwordx4 v3, s[12:15], s59 offen lds
    s_waitcnt lgkmcnt(4)
    v_mfma_f32_16x16x32_bf16 v[152:155], v[20:23], v[48:51], v[152:155]
    v_add_u32 v12, 0x10000, v12
    ds_read_b64_tr_b16 v[16:17], v12 offset:16384
    v_mfma_f32_16x16x32_bf16 v[156:159], v[20:23], v[52:55], v[156:159]
    ds_read_b64_tr_b16 v[18:19], v12 offset:20480
    s_waitcnt lgkmcnt(4)
    v_mfma_f32_16x16x32_bf16 v[160:163], v[24:27], v[48:51], v[160:163]
    v_add_u32 v13, 0x10000, v13
    ds_read_b64_tr_b16 v[20:21], v13 offset:16384
    v_mfma_f32_16x16x32_bf16 v[164:167], v[24:27], v[52:55], v[164:167]
    ds_read_b64_tr_b16 v[22:23], v13 offset:20480
    s_add_u32 m0, s39, 0x6000
    s_mov_b32 s60, 0x6000
    buffer_load_dwordx4 v4, s[16:19], s60 offen lds
    s_waitcnt lgkmcnt(4)
    v_mfma_f32_16x16x32_bf16 v[168:171], v[28:31], v[48:51], v[168:171]
    v_add_u32 v14, 0x10000, v14
    ds_read_b64_tr_b16 v[24:25], v14 offset:16384
    v_mfma_f32_16x16x32_bf16 v[172:175], v[28:31], v[52:55], v[172:175]
    ds_read_b64_tr_b16 v[26:27], v14 offset:20480
    s_setprio 2
    s_waitcnt lgkmcnt(4)
    v_mfma_f32_16x16x32_bf16 v[176:179], v[16:19], v[48:51], v[176:179]
    v_add_u32 v15, 0x10000, v15
    ds_read_b64_tr_b16 v[28:29], v15 offset:16384
    v_mfma_f32_16x16x32_bf16 v[180:183], v[16:19], v[52:55], v[180:183]
    ds_read_b64_tr_b16 v[30:31], v15 offset:20480
    s_add_u32 m0, s39, 0x8000
    s_mov_b32 s61, 0xc000
    buffer_load_dwordx4 v3, s[12:15], s61 offen lds
    s_waitcnt lgkmcnt(4)
    v_mfma_f32_16x16x32_bf16 v[184:187], v[20:23], v[48:51], v[184:187]
    ds_read_b128 v[56:59], v231 offset:8192
    ds_read_b128 v[60:63], v231 offset:9216
    ds_read_b64_tr_b16 v[16:17], v8 offset:32768
    v_mfma_f32_16x16x32_bf16 v[188:191], v[20:23], v[52:55], v[188:191]
    ds_read_b64_tr_b16 v[18:19], v8 offset:36864
    s_waitcnt lgkmcnt(6)
    v_mfma_f32_16x16x32_bf16 v[192:195], v[24:27], v[48:51], v[192:195]
    ds_read_b64_tr_b16 v[20:21], v9 offset:32768
    v_mfma_f32_16x16x32_bf16 v[196:199], v[24:27], v[52:55], v[196:199]
    ds_read_b64_tr_b16 v[22:23], v9 offset:36864
    s_add_u32 m0, s39, 0xa000
    s_mov_b32 s62, 0x8000
    buffer_load_dwordx4 v4, s[16:19], s62 offen lds
    s_waitcnt lgkmcnt(6)
    v_mfma_f32_16x16x32_bf16 v[200:203], v[28:31], v[48:51], v[200:203]
    ds_read_b64_tr_b16 v[24:25], v10 offset:32768
    v_mfma_f32_16x16x32_bf16 v[204:207], v[28:31], v[52:55], v[204:207]
    ds_read_b64_tr_b16 v[26:27], v10 offset:36864
    s_setprio 1
    s_waitcnt lgkmcnt(4)
    v_mfma_f32_16x16x32_bf16 v[144:147], v[16:19], v[56:59], v[144:147]
    ds_read_b64_tr_b16 v[28:29], v11 offset:32768
    v_mfma_f32_16x16x32_bf16 v[148:151], v[16:19], v[60:63], v[148:151]
    ds_read_b64_tr_b16 v[30:31], v11 offset:36864
    s_add_u32 m0, s39, 0xc000
    s_mov_b32 s63, 0xe000
    buffer_load_dwordx4 v3, s[12:15], s63 offen lds
    s_waitcnt lgkmcnt(4)
    v_mfma_f32_16x16x32_bf16 v[152:155], v[20:23], v[56:59], v[152:155]
    ds_read_b64_tr_b16 v[16:17], v12 offset:32768
    v_mfma_f32_16x16x32_bf16 v[156:159], v[20:23], v[60:63], v[156:159]
    ds_read_b64_tr_b16 v[18:19], v12 offset:36864
    s_waitcnt lgkmcnt(4)
    v_mfma_f32_16x16x32_bf16 v[160:163], v[24:27], v[56:59], v[160:163]
    ds_read_b64_tr_b16 v[20:21], v13 offset:32768
    v_mul_f32 v144, s53, v144
    v_mul_f32 v145, s53, v145
    v_mfma_f32_16x16x32_bf16 v[164:167], v[24:27], v[60:63], v[164:167]
    ds_read_b64_tr_b16 v[22:23], v13 offset:36864
    v_mul_f32 v146, s53, v146
    v_mul_f32 v147, s53, v147
    s_add_u32 m0, s39, 0xe000
    s_mov_b32 s56, 0xa000
    buffer_load_dwordx4 v4, s[16:19], s56 offen lds
    s_waitcnt lgkmcnt(4)
    v_mfma_f32_16x16x32_bf16 v[168:171], v[28:31], v[56:59], v[168:171]
    ds_read_b64_tr_b16 v[24:25], v14 offset:32768
    v_cvt_pk_bf16_f32 v112, v144, v145
    v_cvt_pk_bf16_f32 v113, v146, v147
    v_mfma_f32_16x16x32_bf16 v[172:175], v[28:31], v[60:63], v[172:175]
    ds_read_b64_tr_b16 v[26:27], v14 offset:36864
    v_mul_f32 v148, s53, v148
    v_mul_f32 v149, s53, v149
    s_setprio 0
    s_waitcnt lgkmcnt(4)
    v_mfma_f32_16x16x32_bf16 v[176:179], v[16:19], v[56:59], v[176:179]
    ds_read_b64_tr_b16 v[28:29], v15 offset:32768
    v_mul_f32 v150, s53, v150
    v_mul_f32 v151, s53, v151
    v_mfma_f32_16x16x32_bf16 v[180:183], v[16:19], v[60:63], v[180:183]
    ds_read_b64_tr_b16 v[30:31], v15 offset:36864
    v_cvt_pk_bf16_f32 v116, v148, v149
    v_cvt_pk_bf16_f32 v117, v150, v151
    s_waitcnt lgkmcnt(4)
    v_mfma_f32_16x16x32_bf16 v[184:187], v[20:23], v[56:59], v[184:187]
    v_add_u32 v208, 0x10000, v208
    ds_read_b64 v[16:17], v208 offset:49152
    v_mul_f32 v152, s53, v152
    v_mul_f32 v153, s53, v153
    v_mfma_f32_16x16x32_bf16 v[188:191], v[20:23], v[60:63], v[188:191]
    v_add_u32 v209, 0x10000, v209
    ds_read_b64 v[18:19], v209 offset:49152
    v_mul_f32 v154, s53, v154
    v_mul_f32 v155, s53, v155
    s_waitcnt lgkmcnt(4)
    v_mfma_f32_16x16x32_bf16 v[192:195], v[24:27], v[56:59], v[192:195]
    ds_read_b64 v[20:21], v208 offset:53248
    v_cvt_pk_bf16_f32 v114, v152, v153
    v_cvt_pk_bf16_f32 v115, v154, v155
    v_mfma_f32_16x16x32_bf16 v[196:199], v[24:27], v[60:63], v[196:199]
    ds_read_b64 v[22:23], v209 offset:53248
    v_mul_f32 v156, s53, v156
    v_mul_f32 v157, s53, v157
    s_waitcnt lgkmcnt(4)
    v_mfma_f32_16x16x32_bf16 v[200:203], v[28:31], v[56:59], v[200:203]
    v_add_u32 v210, 0x10000, v210
    ds_read_b64 v[24:25], v210 offset:49152
    v_mul_f32 v158, s53, v158
    v_mul_f32 v159, s53, v159
    v_mfma_f32_16x16x32_bf16 v[204:207], v[28:31], v[60:63], v[204:207]
    v_add_u32 v211, 0x10000, v211
    ds_read_b64 v[26:27], v211 offset:49152
    v_cvt_pk_bf16_f32 v118, v156, v157
    v_cvt_pk_bf16_f32 v119, v158, v159
    s_setprio 3
    s_waitcnt vmcnt(9)
    s_barrier
    s_waitcnt lgkmcnt(4)
    v_mfma_f32_16x16x32_bf16 v[48:51], v[16:19], v[112:115], 0
    ds_read_b64 v[28:29], v210 offset:53248
    v_mul_f32 v160, s53, v160
    v_mul_f32 v161, s53, v161
    v_mul_f32 v162, s53, v162
    v_mfma_f32_16x16x32_bf16 v[52:55], v[16:19], v[116:119], 0
    ds_read_b64 v[30:31], v211 offset:53248
    v_mul_f32 v163, s53, v163
    v_cvt_pk_bf16_f32 v120, v160, v161
    v_cvt_pk_bf16_f32 v121, v162, v163
    s_add_u32 m0, s39, 0x10000
    s_mov_b32 s57, 0x10000
    buffer_load_dwordx4 v3, s[12:15], s57 offen lds
    s_waitcnt lgkmcnt(4)
    v_mfma_f32_16x16x32_bf16 v[56:59], v[20:23], v[112:115], 0
    v_add_u32 v212, 0x10000, v212
    ds_read_b64 v[16:17], v212 offset:49152
    v_mul_f32 v164, s53, v164
    v_mul_f32 v165, s53, v165
    v_mul_f32 v166, s53, v166
    v_mfma_f32_16x16x32_bf16 v[60:63], v[20:23], v[116:119], 0
    v_add_u32 v213, 0x10000, v213
    ds_read_b64 v[18:19], v213 offset:49152
    v_mul_f32 v167, s53, v167
    v_cvt_pk_bf16_f32 v124, v164, v165
    v_cvt_pk_bf16_f32 v125, v166, v167
    v_mul_f32 v168, s53, v168
    v_mul_f32 v169, s53, v169
    v_mul_f32 v170, s53, v170
    v_mul_f32 v171, s53, v171
    v_cvt_pk_bf16_f32 v122, v168, v169
    v_cvt_pk_bf16_f32 v123, v170, v171
    v_mul_f32 v172, s53, v172
    v_mul_f32 v173, s53, v173
    v_mul_f32 v174, s53, v174
    v_mul_f32 v175, s53, v175
    v_cvt_pk_bf16_f32 v126, v172, v173
    v_cvt_pk_bf16_f32 v127, v174, v175
    s_waitcnt lgkmcnt(4)
    v_mfma_f32_16x16x32_bf16 v[48:51], v[24:27], v[120:123], v[48:51]
    ds_read_b64 v[20:21], v212 offset:53248
    v_mul_f32 v176, s53, v176
    v_mul_f32 v177, s53, v177
    v_mul_f32 v178, s53, v178
    v_mfma_f32_16x16x32_bf16 v[52:55], v[24:27], v[124:127], v[52:55]
    ds_read_b64 v[22:23], v213 offset:53248
    v_mul_f32 v179, s53, v179
    v_cvt_pk_bf16_f32 v128, v176, v177
    v_cvt_pk_bf16_f32 v129, v178, v179
    s_add_u32 m0, s39, 0x12000
    s_mov_b32 s58, 0xc000
    buffer_load_dwordx4 v4, s[16:19], s58 offen lds
    s_waitcnt lgkmcnt(4)
    v_mfma_f32_16x16x32_bf16 v[56:59], v[28:31], v[120:123], v[56:59]
    v_add_u32 v214, 0x10000, v214
    ds_read_b64 v[24:25], v214 offset:49152
    v_mul_f32 v180, s53, v180
    v_mul_f32 v181, s53, v181
    v_mul_f32 v182, s53, v182
    v_mfma_f32_16x16x32_bf16 v[60:63], v[28:31], v[124:127], v[60:63]
    v_add_u32 v215, 0x10000, v215
    ds_read_b64 v[26:27], v215 offset:49152
    v_mul_f32 v183, s53, v183
    v_cvt_pk_bf16_f32 v132, v180, v181
    v_cvt_pk_bf16_f32 v133, v182, v183
    v_mul_f32 v184, s53, v184
    v_mul_f32 v185, s53, v185
    v_mul_f32 v186, s53, v186
    v_mul_f32 v187, s53, v187
    v_cvt_pk_bf16_f32 v130, v184, v185
    v_cvt_pk_bf16_f32 v131, v186, v187
    v_mul_f32 v188, s53, v188
    v_mul_f32 v189, s53, v189
    v_mul_f32 v190, s53, v190
    v_mul_f32 v191, s53, v191
    v_cvt_pk_bf16_f32 v134, v188, v189
    v_cvt_pk_bf16_f32 v135, v190, v191
    s_waitcnt lgkmcnt(4)
    v_mfma_f32_16x16x32_bf16 v[48:51], v[16:19], v[128:131], v[48:51]
    ds_read_b64 v[28:29], v214 offset:53248
    v_mul_f32 v192, s53, v192
    v_mul_f32 v193, s53, v193
    v_mul_f32 v194, s53, v194
    v_mfma_f32_16x16x32_bf16 v[52:55], v[16:19], v[132:135], v[52:55]
    ds_read_b64 v[30:31], v215 offset:53248
    v_mul_f32 v195, s53, v195
    v_cvt_pk_bf16_f32 v136, v192, v193
    v_cvt_pk_bf16_f32 v137, v194, v195
    s_add_u32 m0, s39, 0x14000
    s_mov_b32 s59, 0x12000
    buffer_load_dwordx4 v3, s[12:15], s59 offen lds
    s_waitcnt lgkmcnt(4)
    v_mfma_f32_16x16x32_bf16 v[56:59], v[20:23], v[128:131], v[56:59]
    ds_read_b64 v[16:17], v208 offset:57344
    v_mul_f32 v196, s53, v196
    v_mul_f32 v197, s53, v197
    v_mul_f32 v198, s53, v198
    v_mfma_f32_16x16x32_bf16 v[60:63], v[20:23], v[132:135], v[60:63]
    ds_read_b64 v[18:19], v209 offset:57344
    v_mul_f32 v199, s53, v199
    v_cvt_pk_bf16_f32 v140, v196, v197
    v_cvt_pk_bf16_f32 v141, v198, v199
    v_mul_f32 v200, s53, v200
    v_mul_f32 v201, s53, v201
    v_mul_f32 v202, s53, v202
    v_mul_f32 v203, s53, v203
    v_cvt_pk_bf16_f32 v138, v200, v201
    v_cvt_pk_bf16_f32 v139, v202, v203
    v_mul_f32 v204, s53, v204
    v_mul_f32 v205, s53, v205
    v_mul_f32 v206, s53, v206
    v_mul_f32 v207, s53, v207
    v_cvt_pk_bf16_f32 v142, v204, v205
    v_cvt_pk_bf16_f32 v143, v206, v207
    s_waitcnt lgkmcnt(4)
    v_mfma_f32_16x16x32_bf16 v[48:51], v[24:27], v[136:139], v[48:51]
    ds_read_b64 v[20:21], v210 offset:57344
    v_mfma_f32_16x16x32_bf16 v[52:55], v[24:27], v[140:143], v[52:55]
    ds_read_b64 v[22:23], v211 offset:57344
    s_add_u32 m0, s39, 0x16000
    s_mov_b32 s60, 0xe000
    buffer_load_dwordx4 v4, s[16:19], s60 offen lds
    s_waitcnt lgkmcnt(4)
    v_mfma_f32_16x16x32_bf16 v[56:59], v[28:31], v[136:139], v[56:59]
    ds_read_b64 v[24:25], v212 offset:57344
    v_mfma_f32_16x16x32_bf16 v[60:63], v[28:31], v[140:143], v[60:63]
    ds_read_b64 v[26:27], v213 offset:57344
    s_setprio 2
    s_waitcnt lgkmcnt(4)
    v_mfma_f32_16x16x32_bf16 v[64:67], v[16:19], v[112:115], 0
    ds_read_b64 v[28:29], v214 offset:57344
    v_mfma_f32_16x16x32_bf16 v[68:71], v[16:19], v[116:119], 0
    ds_read_b64 v[30:31], v215 offset:57344
    s_add_u32 m0, s39, 0x18000
    s_mov_b32 s61, 0x14000
    buffer_load_dwordx4 v3, s[12:15], s61 offen lds
    s_sub_u32 s50, s34, 0
    s_lshl_b32 s50, s50, 3
    s_add_u32 s50, s50, s32
    s_mul_i32 s50, s50, 9
    v_add_u32 v250, s50, v7
    v_lshlrev_b32 v251, 7, v250
    v_cmp_gt_u32 vcc, 9, v7
    s_nop 1
    v_cndmask_b32 v251, -16, v251, vcc
    buffer_load_dword v240, v251, s[20:23], 0 offen
    s_waitcnt lgkmcnt(4)
    v_mfma_f32_16x16x32_bf16 v[64:67], v[20:23], v[120:123], v[64:67]
    ds_read_b64 v[16:17], v208 offset:61440
    v_max3_f32 v36, v48, v49, v50
    v_max3_f32 v36, v36, v51, v56
    v_max3_f32 v36, v36, v57, v58
    v_max_f32 v36, v36, v59
    v_mfma_f32_16x16x32_bf16 v[68:71], v[20:23], v[124:127], v[68:71]
    ds_read_b64 v[18:19], v209 offset:61440
    v_mov_b32 v38, v36
    s_nop 1
    v_permlane16_swap_b32 v36, v38
    v_max_f32 v36, v36, v38
    v_mov_b32 v38, v36
    s_waitcnt lgkmcnt(4)
    v_mfma_f32_16x16x32_bf16 v[64:67], v[24:27], v[128:131], v[64:67]
    ds_read_b64 v[20:21], v210 offset:61440
    v_permlane32_swap_b32 v36, v38
    v_max_f32 v36, v36, v38
    v_ceil_f32 v36, v36
    v_sub_f32 v96, 0, v36
    v_mfma_f32_16x16x32_bf16 v[68:71], v[24:27], v[132:135], v[68:71]
    ds_read_b64 v[22:23], v211 offset:61440
    v_sub_f32 v97, 0, v36
    v_sub_f32 v98, 0, v36
    v_sub_f32 v99, 0, v36
    v_sub_f32 v48, v48, v36
    s_add_u32 m0, s39, 0x1a000
    s_mov_b32 s62, 0x10000
    buffer_load_dwordx4 v4, s[16:19], s62 offen lds
    s_waitcnt lgkmcnt(4)
    v_mfma_f32_16x16x32_bf16 v[64:67], v[28:31], v[136:139], v[64:67]
    ds_read_b64 v[24:25], v212 offset:61440
    v_sub_f32 v49, v49, v36
    v_sub_f32 v50, v50, v36
    v_sub_f32 v51, v51, v36
    v_sub_f32 v56, v56, v36
    v_mfma_f32_16x16x32_bf16 v[68:71], v[28:31], v[140:143], v[68:71]
    ds_read_b64 v[26:27], v213 offset:61440
    v_sub_f32 v57, v57, v36
    v_sub_f32 v58, v58, v36
    v_sub_f32 v59, v59, v36
    v_max3_f32 v37, v52, v53, v54
    s_waitcnt lgkmcnt(4)
    v_mfma_f32_16x16x32_bf16 v[72:75], v[16:19], v[112:115], 0
    ds_read_b64 v[28:29], v214 offset:61440
    v_max3_f32 v37, v37, v55, v60
    v_max3_f32 v37, v37, v61, v62
    v_max_f32 v37, v37, v63
    v_mov_b32 v38, v37
    v_mfma_f32_16x16x32_bf16 v[76:79], v[16:19], v[116:119], 0
    ds_read_b64 v[30:31], v215 offset:61440
    v_permlane16_swap_b32 v37, v38
    v_max_f32 v37, v37, v38
    v_mov_b32 v38, v37
    s_nop 0
    s_nop 0
    v_permlane32_swap_b32 v37, v38
    s_waitcnt lgkmcnt(4)
    v_mfma_f32_16x16x32_bf16 v[72:75], v[20:23], v[120:123], v[72:75]
    v_add_u32 v208, 0x10000, v208
    ds_read_b64 v[16:17], v208 offset:0
    v_max_f32 v37, v37, v38
    v_ceil_f32 v37, v37
    v_sub_f32 v100, 0, v37
    v_sub_f32 v101, 0, v37
    v_mfma_f32_16x16x32_bf16 v[76:79], v[20:23], v[124:127], v[76:79]
    v_add_u32 v209, 0x10000, v209
    ds_read_b64 v[18:19], v209 offset:0
    v_sub_f32 v102, 0, v37
    v_sub_f32 v103, 0, v37
    v_sub_f32 v52, v52, v37
    v_sub_f32 v53, v53, v37
    s_waitcnt lgkmcnt(4)
    v_mfma_f32_16x16x32_bf16 v[72:75], v[24:27], v[128:131], v[72:75]
    v_add_u32 v210, 0x10000, v210
    ds_read_b64 v[20:21], v210 offset:0
    v_sub_f32 v54, v54, v37
    v_sub_f32 v55, v55, v37
    v_sub_f32 v60, v60, v37
    v_sub_f32 v61, v61, v37
    v_mfma_f32_16x16x32_bf16 v[76:79], v[24:27], v[132:135], v[76:79]
    v_add_u32 v211, 0x10000, v211
    ds_read_b64 v[22:23], v211 offset:0
    v_sub_f32 v62, v62, v37
    v_sub_f32 v63, v63, v37
    v_exp_f32 v40, v48
    s_waitcnt lgkmcnt(4)
    v_mfma_f32_16x16x32_bf16 v[72:75], v[28:31], v[136:139], v[72:75]
    v_add_u32 v212, 0x10000, v212
    ds_read_b64 v[24:25], v212 offset:0
    v_exp_f32 v41, v49
    v_exp_f32 v42, v50
    v_mfma_f32_16x16x32_bf16 v[76:79], v[28:31], v[140:143], v[76:79]
    v_add_u32 v213, 0x10000, v213
    ds_read_b64 v[26:27], v213 offset:0
    v_exp_f32 v43, v51
    v_add_f32 v34, v40, v41
    v_cvt_pk_bf16_f32 v80, v40, v41
    v_add_f32 v34, v34, v42
    v_cvt_pk_bf16_f32 v81, v42, v43
    v_add_f32 v34, v34, v43
    v_exp_f32 v44, v56
    v_exp_f32 v45, v57
    v_exp_f32 v46, v58
    v_exp_f32 v47, v59
    v_add_f32 v34, v34, v44
    v_cvt_pk_bf16_f32 v82, v44, v45
    v_add_f32 v34, v34, v45
    v_cvt_pk_bf16_f32 v83, v46, v47
    v_add_f32 v34, v34, v46
    v_add_f32 v34, v34, v47
    v_exp_f32 v40, v52
    v_exp_f32 v41, v53
    v_exp_f32 v42, v54
    v_exp_f32 v43, v55
    v_add_f32 v35, v40, v41
    v_cvt_pk_bf16_f32 v84, v40, v41
    v_add_f32 v35, v35, v42
    v_cvt_pk_bf16_f32 v85, v42, v43
    v_add_f32 v35, v35, v43
    v_exp_f32 v44, v60
    v_exp_f32 v45, v61
    v_exp_f32 v46, v62
    v_exp_f32 v47, v63
    v_add_f32 v35, v35, v44
    v_cvt_pk_bf16_f32 v86, v44, v45
    v_add_f32 v35, v35, v45
    v_cvt_pk_bf16_f32 v87, v46, v47
    v_add_f32 v35, v35, v46
    v_add_f32 v35, v35, v47
    v_sub_f32 v64, v64, v36
    v_sub_f32 v65, v65, v36
    v_sub_f32 v66, v66, v36
    v_sub_f32 v67, v67, v36
    v_sub_f32 v72, v72, v36
    v_sub_f32 v73, v73, v36
    v_sub_f32 v74, v74, v36
    v_sub_f32 v75, v75, v36
    v_sub_f32 v68, v68, v37
    v_sub_f32 v69, v69, v37
    v_sub_f32 v70, v70, v37
    v_sub_f32 v71, v71, v37
    v_sub_f32 v76, v76, v37
    v_sub_f32 v77, v77, v37
    v_sub_f32 v78, v78, v37
    v_sub_f32 v79, v79, v37
    v_mov_b32 v32, v34
    v_mov_b32 v33, v35
    s_setprio 1
    s_waitcnt lgkmcnt(4)
    v_mfma_f32_16x16x32_bf16 v[48:51], v[16:19], v[112:115], v[96:99]
    v_add_u32 v214, 0x10000, v214
    ds_read_b64 v[28:29], v214 offset:0
    v_exp_f32 v40, v64
    v_mfma_f32_16x16x32_bf16 v[52:55], v[16:19], v[116:119], v[100:103]
    v_add_u32 v215, 0x10000, v215
    ds_read_b64 v[30:31], v215 offset:0
    v_exp_f32 v41, v65
    s_waitcnt lgkmcnt(4)
    v_mfma_f32_16x16x32_bf16 v[48:51], v[20:23], v[120:123], v[48:51]
    ds_read_b64 v[16:17], v208 offset:4096
    v_exp_f32 v42, v66
    v_mfma_f32_16x16x32_bf16 v[52:55], v[20:23], v[124:127], v[52:55]
    ds_read_b64 v[18:19], v209 offset:4096
    v_exp_f32 v43, v67
    s_waitcnt lgkmcnt(4)
    v_mfma_f32_16x16x32_bf16 v[48:51], v[24:27], v[128:131], v[48:51]
    ds_read_b64 v[20:21], v210 offset:4096
    v_add_f32 v34, v40, v41
    v_cvt_pk_bf16_f32 v88, v40, v41
    v_mfma_f32_16x16x32_bf16 v[52:55], v[24:27], v[132:135], v[52:55]
    ds_read_b64 v[22:23], v211 offset:4096
    v_add_f32 v34, v34, v42
    v_cvt_pk_bf16_f32 v89, v42, v43
    s_waitcnt lgkmcnt(4)
    v_mfma_f32_16x16x32_bf16 v[48:51], v[28:31], v[136:139], v[48:51]
    ds_read_b64 v[24:25], v212 offset:4096
    v_add_f32 v34, v34, v43
    v_mfma_f32_16x16x32_bf16 v[52:55], v[28:31], v[140:143], v[52:55]
    ds_read_b64 v[26:27], v213 offset:4096
    v_exp_f32 v44, v72
    s_sub_u32 s50, s34, 0
    s_lshl_b32 s50, s50, 3
    s_add_u32 s50, s50, s32
    s_mul_i32 s50, s50, 9
    s_add_u32 s50, s50, 1152
    v_add_u32 v250, s50, v7
    v_lshlrev_b32 v251, 7, v250
    v_cmp_gt_u32 vcc, 9, v7
    s_nop 1
    v_cndmask_b32 v251, -16, v251, vcc
    buffer_load_dword v241, v251, s[20:23], 0 offen
    s_waitcnt lgkmcnt(4)
    v_mfma_f32_16x16x32_bf16 v[56:59], v[16:19], v[112:115], v[96:99]
    ds_read_b64 v[28:29], v214 offset:4096
    v_exp_f32 v45, v73
    v_mfma_f32_16x16x32_bf16 v[60:63], v[16:19], v[116:119], v[100:103]
    ds_read_b64 v[30:31], v215 offset:4096
    v_exp_f32 v46, v74
    s_waitcnt lgkmcnt(4)
    v_mfma_f32_16x16x32_bf16 v[56:59], v[20:23], v[120:123], v[56:59]
    v_add_u32 v232, 0x20000, v232
    ds_read_b64_tr_b16 v[16:17], v232 offset:8192
    v_exp_f32 v47, v75
    v_mfma_f32_16x16x32_bf16 v[60:63], v[20:23], v[124:127], v[60:63]
    ds_read_b64_tr_b16 v[18:19], v232 offset:12288
    v_add_f32 v34, v34, v44
    v_cvt_pk_bf16_f32 v90, v44, v45
    s_waitcnt lgkmcnt(4)
    v_mfma_f32_16x16x32_bf16 v[56:59], v[24:27], v[128:131], v[56:59]
    v_add_u32 v233, 0x20000, v233
    ds_read_b64_tr_b16 v[20:21], v233 offset:8192
    v_add_f32 v34, v34, v45
    v_cvt_pk_bf16_f32 v91, v46, v47
    v_mfma_f32_16x16x32_bf16 v[60:63], v[24:27], v[132:135], v[60:63]
    ds_read_b64_tr_b16 v[22:23], v233 offset:12288
    v_add_f32 v34, v34, v46
    v_add_f32 v34, v34, v47
    s_waitcnt lgkmcnt(4)
    v_mfma_f32_16x16x32_bf16 v[56:59], v[28:31], v[136:139], v[56:59]
    v_add_u32 v234, 0x20000, v234
    ds_read_b64_tr_b16 v[24:25], v234 offset:8192
    v_exp_f32 v40, v68
    v_mfma_f32_16x16x32_bf16 v[60:63], v[28:31], v[140:143], v[60:63]
    ds_read_b64_tr_b16 v[26:27], v234 offset:12288
    v_exp_f32 v41, v69
    s_setprio 0
    s_waitcnt lgkmcnt(4)
    v_mfma_f32_16x16x32_bf16 v[144:147], v[16:19], v[80:83], 0
    v_add_u32 v235, 0x20000, v235
    ds_read_b64_tr_b16 v[28:29], v235 offset:8192
    v_exp_f32 v42, v70
    v_mfma_f32_16x16x32_bf16 v[148:151], v[16:19], v[84:87], 0
    ds_read_b64_tr_b16 v[30:31], v235 offset:12288
    v_exp_f32 v43, v71
    s_waitcnt lgkmcnt(4)
    v_mfma_f32_16x16x32_bf16 v[152:155], v[20:23], v[80:83], 0
    v_add_u32 v236, 0x20000, v236
    ds_read_b64_tr_b16 v[16:17], v236 offset:8192
    v_add_f32 v35, v40, v41
    v_cvt_pk_bf16_f32 v92, v40, v41
    v_mfma_f32_16x16x32_bf16 v[156:159], v[20:23], v[84:87], 0
    ds_read_b64_tr_b16 v[18:19], v236 offset:12288
    v_add_f32 v35, v35, v42
    v_cvt_pk_bf16_f32 v93, v42, v43
    s_waitcnt lgkmcnt(4)
    v_mfma_f32_16x16x32_bf16 v[160:163], v[24:27], v[80:83], 0
    v_add_u32 v237, 0x20000, v237
    ds_read_b64_tr_b16 v[20:21], v237 offset:8192
    v_add_f32 v35, v35, v43
    v_mfma_f32_16x16x32_bf16 v[164:167], v[24:27], v[84:87], 0
    ds_read_b64_tr_b16 v[22:23], v237 offset:12288
    v_exp_f32 v44, v76
    s_waitcnt lgkmcnt(4)
    v_mfma_f32_16x16x32_bf16 v[168:171], v[28:31], v[80:83], 0
    v_add_u32 v238, 0x20000, v238
    ds_read_b64_tr_b16 v[24:25], v238 offset:8192
    v_exp_f32 v45, v77
    v_mfma_f32_16x16x32_bf16 v[172:175], v[28:31], v[84:87], 0
    ds_read_b64_tr_b16 v[26:27], v238 offset:12288
    v_exp_f32 v46, v78
    s_waitcnt lgkmcnt(4)
    v_mfma_f32_16x16x32_bf16 v[176:179], v[16:19], v[80:83], 0
    v_add_u32 v239, 0x20000, v239
    ds_read_b64_tr_b16 v[28:29], v239 offset:8192
    v_exp_f32 v47, v79
    v_mfma_f32_16x16x32_bf16 v[180:183], v[16:19], v[84:87], 0
    ds_read_b64_tr_b16 v[30:31], v239 offset:12288
    v_add_f32 v35, v35, v44
    v_cvt_pk_bf16_f32 v94, v44, v45
    s_waitcnt lgkmcnt(4)
    v_mfma_f32_16x16x32_bf16 v[184:187], v[20:23], v[80:83], 0
    ds_read_b64 v[16:17], v208 offset:16384
    v_add_f32 v35, v35, v45
    v_cvt_pk_bf16_f32 v95, v46, v47
    v_mfma_f32_16x16x32_bf16 v[188:191], v[20:23], v[84:87], 0
    ds_read_b64 v[18:19], v209 offset:16384
    v_add_f32 v35, v35, v46
    v_add_f32 v35, v35, v47
    s_waitcnt lgkmcnt(4)
    v_mfma_f32_16x16x32_bf16 v[192:195], v[24:27], v[80:83], 0
    ds_read_b64 v[20:21], v210 offset:16384
    v_mfma_f32_16x16x32_bf16 v[196:199], v[24:27], v[84:87], 0
    ds_read_b64 v[22:23], v211 offset:16384
    s_waitcnt lgkmcnt(4)
    v_mfma_f32_16x16x32_bf16 v[200:203], v[28:31], v[80:83], 0
    ds_read_b64 v[24:25], v212 offset:16384
    v_mfma_f32_16x16x32_bf16 v[204:207], v[28:31], v[84:87], 0
    ds_read_b64 v[26:27], v213 offset:16384
    v_add_f32 v36, v34, v35
    v_cmp_ngt_f32 vcc, s52, v36
    s_cbranch_vccnz L_slow_1
L_back_1:
    v_add_f32 v32, v32, v34
    v_add_f32 v33, v33, v35
    s_setprio 3
    s_waitcnt vmcnt(13)
    s_barrier
    s_waitcnt lgkmcnt(4)
    v_mfma_f32_16x16x32_bf16 v[64:67], v[16:19], v[112:115], v[96:99]
    ds_read_b64 v[28:29], v214 offset:16384
    v_exp_f32 v40, v48
    v_mfma_f32_16x16x32_bf16 v[68:71], v[16:19], v[116:119], v[100:103]
    ds_read_b64 v[30:31], v215 offset:16384
    v_exp_f32 v41, v49
    s_add_u32 m0, s39, 0x1c000
    s_mov_b32 s63, 0x16000
    buffer_load_dwordx4 v3, s[12:15], s63 offen lds
    s_waitcnt lgkmcnt(4)
    v_mfma_f32_16x16x32_bf16 v[64:67], v[20:23], v[120:123], v[64:67]
    ds_read_b64 v[16:17], v208 offset:20480
    v_exp_f32 v42, v50
    v_mfma_f32_16x16x32_bf16 v[68:71], v[20:23], v[124:127], v[68:71]
    ds_read_b64 v[18:19], v209 offset:20480
    v_exp_f32 v43, v51
    s_waitcnt lgkmcnt(4)
    v_mfma_f32_16x16x32_bf16 v[64:67], v[24:27], v[128:131], v[64:67]
    ds_read_b64 v[20:21], v210 offset:20480
    v_add_f32 v34, v40, v41
    v_cvt_pk_bf16_f32 v80, v40, v41
    v_mfma_f32_16x16x32_bf16 v[68:71], v[24:27], v[132:135], v[68:71]
    ds_read_b64 v[22:23], v211 offset:20480
    v_add_f32 v34, v34, v42
    v_cvt_pk_bf16_f32 v81, v42, v43
    s_add_u32 m0, s39, 0x1e000
    s_mov_b32 s56, 0x12000
    buffer_load_dwordx4 v4, s[16:19], s56 offen lds
    s_waitcnt lgkmcnt(4)
    v_mfma_f32_16x16x32_bf16 v[64:67], v[28:31], v[136:139], v[64:67]
    ds_read_b64 v[24:25], v212 offset:20480
    v_add_f32 v34, v34, v43
    v_mfma_f32_16x16x32_bf16 v[68:71], v[28:31], v[140:143], v[68:71]
    ds_read_b64 v[26:27], v213 offset:20480
    v_exp_f32 v44, v56
    s_waitcnt lgkmcnt(4)
    v_mfma_f32_16x16x32_bf16 v[72:75], v[16:19], v[112:115], v[96:99]
    ds_read_b64 v[28:29], v214 offset:20480
    v_exp_f32 v45, v57
    v_mfma_f32_16x16x32_bf16 v[76:79], v[16:19], v[116:119], v[100:103]
    ds_read_b64 v[30:31], v215 offset:20480
    v_exp_f32 v46, v58
    s_add_u32 m0, s39, 0x20000
    s_mov_b32 s57, 0x18000
    buffer_load_dwordx4 v3, s[12:15], s57 offen lds
    s_waitcnt lgkmcnt(4)
    v_mfma_f32_16x16x32_bf16 v[72:75], v[20:23], v[120:123], v[72:75]
    ds_read_b64_tr_b16 v[16:17], v232 offset:24576
    v_exp_f32 v47, v59
    v_mfma_f32_16x16x32_bf16 v[76:79], v[20:23], v[124:127], v[76:79]
    ds_read_b64_tr_b16 v[18:19], v232 offset:28672
    v_add_f32 v34, v34, v44
    v_cvt_pk_bf16_f32 v82, v44, v45
    s_waitcnt lgkmcnt(4)
    v_mfma_f32_16x16x32_bf16 v[72:75], v[24:27], v[128:131], v[72:75]
    ds_read_b64_tr_b16 v[20:21], v233 offset:24576
    v_add_f32 v34, v34, v45
    v_cvt_pk_bf16_f32 v83, v46, v47
    v_mfma_f32_16x16x32_bf16 v[76:79], v[24:27], v[132:135], v[76:79]
    ds_read_b64_tr_b16 v[22:23], v233 offset:28672
    v_add_f32 v34, v34, v46
    v_add_f32 v34, v34, v47
    s_add_u32 m0, s39, 0x22000
    s_mov_b32 s58, 0x14000
    buffer_load_dwordx4 v4, s[16:19], s58 offen lds
    s_waitcnt lgkmcnt(4)
    v_mfma_f32_16x16x32_bf16 v[72:75], v[28:31], v[136:139], v[72:75]
    ds_read_b64_tr_b16 v[24:25], v234 offset:24576
    v_exp_f32 v40, v52
    v_mfma_f32_16x16x32_bf16 v[76:79], v[28:31], v[140:143], v[76:79]
    ds_read_b64_tr_b16 v[26:27], v234 offset:28672
    v_exp_f32 v41, v53
    s_setprio 2
    s_waitcnt lgkmcnt(4)
    v_mfma_f32_16x16x32_bf16 v[144:147], v[16:19], v[88:91], v[144:147]
    ds_read_b64_tr_b16 v[28:29], v235 offset:24576
    v_exp_f32 v42, v54
    v_mfma_f32_16x16x32_bf16 v[148:151], v[16:19], v[92:95], v[148:151]
    ds_read_b64_tr_b16 v[30:31], v235 offset:28672
    v_exp_f32 v43, v55
    s_mul_i32 s51, s33, 576
    s_mov_b32 s92, s40
    s_mov_b32 s93, s41
    s_mov_b32 s94, 0x510000
    s_add_u32 s92, s92, s51
    s_addc_u32 s93, s93, 0
    s_sub_u32 s94, s94, s51
    s_mov_b32 s95, 0x00020000
    s_sub_u32 s50, s34, 0
    s_lshl_b32 s50, s50, 3
    s_add_u32 s50, s50, s32
    s_mul_i32 s50, s50, 9
    v_add_u32 v246, s50, v7
    v_lshrrev_b32 v247, 3, v246
    s_mov_b32 s50, 9216
    v_mul_lo_u32 v247, v247, s50
    v_and_b32 v246, 7, v246
    v_lshl_add_u32 v247, v246, 7, v247
    v_cmp_gt_u32 vcc, 9, v7
    v_cmp_gt_u32 s[50:51], 5, v246
    s_nop 0
    s_and_b64 vcc, vcc, s[50:51]
    v_cndmask_b32 v247, -16, v247, vcc
    s_waitcnt vmcnt(6)
    buffer_load_dword v240, v247, s[92:95], 0 offen
    s_waitcnt lgkmcnt(4)
    v_mfma_f32_16x16x32_bf16 v[152:155], v[20:23], v[88:91], v[152:155]
    ds_read_b64_tr_b16 v[16:17], v236 offset:24576
    v_add_f32 v35, v40, v41
    v_cvt_pk_bf16_f32 v84, v40, v41
    v_mfma_f32_16x16x32_bf16 v[156:159], v[20:23], v[92:95], v[156:159]
    ds_read_b64_tr_b16 v[18:19], v236 offset:28672
    v_add_f32 v35, v35, v42
    v_cvt_pk_bf16_f32 v85, v42, v43
    s_waitcnt lgkmcnt(4)
    v_mfma_f32_16x16x32_bf16 v[160:163], v[24:27], v[88:91], v[160:163]
    ds_read_b64_tr_b16 v[20:21], v237 offset:24576
    v_add_f32 v35, v35, v43
    v_mfma_f32_16x16x32_bf16 v[164:167], v[24:27], v[92:95], v[164:167]
    ds_read_b64_tr_b16 v[22:23], v237 offset:28672
    v_exp_f32 v44, v60
    s_waitcnt lgkmcnt(4)
    v_mfma_f32_16x16x32_bf16 v[168:171], v[28:31], v[88:91], v[168:171]
    ds_read_b64_tr_b16 v[24:25], v238 offset:24576
    v_exp_f32 v45, v61
    v_mfma_f32_16x16x32_bf16 v[172:175], v[28:31], v[92:95], v[172:175]
    ds_read_b64_tr_b16 v[26:27], v238 offset:28672
    v_exp_f32 v46, v62
    s_waitcnt lgkmcnt(4)
    v_mfma_f32_16x16x32_bf16 v[176:179], v[16:19], v[88:91], v[176:179]
    ds_read_b64_tr_b16 v[28:29], v239 offset:24576
    v_exp_f32 v47, v63
    v_mfma_f32_16x16x32_bf16 v[180:183], v[16:19], v[92:95], v[180:183]
    ds_read_b64_tr_b16 v[30:31], v239 offset:28672
    v_add_f32 v35, v35, v44
    v_cvt_pk_bf16_f32 v86, v44, v45
    s_waitcnt lgkmcnt(4)
    v_mfma_f32_16x16x32_bf16 v[184:187], v[20:23], v[88:91], v[184:187]
    v_subrev_u32 v208, 0x20000, v208
    ds_read_b64 v[16:17], v208 offset:0
    v_add_f32 v35, v35, v45
    v_cvt_pk_bf16_f32 v87, v46, v47
    v_mfma_f32_16x16x32_bf16 v[188:191], v[20:23], v[92:95], v[188:191]
    v_subrev_u32 v209, 0x20000, v209
    ds_read_b64 v[18:19], v209 offset:0
    v_add_f32 v35, v35, v46
    v_add_f32 v35, v35, v47
    s_waitcnt lgkmcnt(4)
    v_mfma_f32_16x16x32_bf16 v[192:195], v[24:27], v[88:91], v[192:195]
    v_subrev_u32 v210, 0x20000, v210
    ds_read_b64 v[20:21], v210 offset:0
    v_mfma_f32_16x16x32_bf16 v[196:199], v[24:27], v[92:95], v[196:199]
    v_subrev_u32 v211, 0x20000, v211
    ds_read_b64 v[22:23], v211 offset:0
    s_waitcnt lgkmcnt(4)
    v_mfma_f32_16x16x32_bf16 v[200:203], v[28:31], v[88:91], v[200:203]
    v_subrev_u32 v212, 0x20000, v212
    ds_read_b64 v[24:25], v212 offset:0
    v_mfma_f32_16x16x32_bf16 v[204:207], v[28:31], v[92:95], v[204:207]
    v_subrev_u32 v213, 0x20000, v213
    ds_read_b64 v[26:27], v213 offset:0
    v_add_f32 v36, v34, v35
    v_cmp_ngt_f32 vcc, s52, v36
    s_cbranch_vccnz L_slow_2
L_back_2:
    v_add_f32 v32, v32, v34
    v_add_f32 v33, v33, v35
    s_setprio 1
    s_waitcnt lgkmcnt(4)
    v_mfma_f32_16x16x32_bf16 v[48:51], v[16:19], v[112:115], v[96:99]
    v_subrev_u32 v214, 0x20000, v214
    ds_read_b64 v[28:29], v214 offset:0
    v_exp_f32 v40, v64
    v_mfma_f32_16x16x32_bf16 v[52:55], v[16:19], v[116:119], v[100:103]
    v_subrev_u32 v215, 0x20000, v215
    ds_read_b64 v[30:31], v215 offset:0
    v_exp_f32 v41, v65
    s_waitcnt lgkmcnt(4)
    v_mfma_f32_16x16x32_bf16 v[48:51], v[20:23], v[120:123], v[48:51]
    ds_read_b64 v[16:17], v208 offset:4096
    v_exp_f32 v42, v66
    v_mfma_f32_16x16x32_bf16 v[52:55], v[20:23], v[124:127], v[52:55]
    ds_read_b64 v[18:19], v209 offset:4096
    v_exp_f32 v43, v67
    s_waitcnt lgkmcnt(4)
    v_mfma_f32_16x16x32_bf16 v[48:51], v[24:27], v[128:131], v[48:51]
    ds_read_b64 v[20:21], v210 offset:4096
    v_add_f32 v34, v40, v41
    v_cvt_pk_bf16_f32 v88, v40, v41
    v_mfma_f32_16x16x32_bf16 v[52:55], v[24:27], v[132:135], v[52:55]
    ds_read_b64 v[22:23], v211 offset:4096
    v_add_f32 v34, v34, v42
    v_cvt_pk_bf16_f32 v89, v42, v43
    s_waitcnt lgkmcnt(4)
    v_mfma_f32_16x16x32_bf16 v[48:51], v[28:31], v[136:139], v[48:51]
    ds_read_b64 v[24:25], v212 offset:4096
    v_add_f32 v34, v34, v43
    v_mfma_f32_16x16x32_bf16 v[52:55], v[28:31], v[140:143], v[52:55]
    ds_read_b64 v[26:27], v213 offset:4096
    v_exp_f32 v44, v72
    s_mul_i32 s51, s33, 576
    s_mov_b32 s92, s42
    s_mov_b32 s93, s43
    s_mov_b32 s94, 0x510000
    s_add_u32 s92, s92, s51
    s_addc_u32 s93, s93, 0
    s_sub_u32 s94, s94, s51
    s_mov_b32 s95, 0x00020000
    s_sub_u32 s50, s34, 0
    s_lshl_b32 s50, s50, 3
    s_add_u32 s50, s50, s32
    s_mul_i32 s50, s50, 9
    v_add_u32 v246, s50, v7
    v_lshrrev_b32 v247, 3, v246
    s_mov_b32 s50, 9216
    v_mul_lo_u32 v247, v247, s50
    v_and_b32 v246, 7, v246
    v_lshl_add_u32 v247, v246, 7, v247
    v_cmp_gt_u32 vcc, 9, v7
    v_cmp_gt_u32 s[50:51], 5, v246
    s_nop 0
    s_and_b64 vcc, vcc, s[50:51]
    v_cndmask_b32 v247, -16, v247, vcc
    s_waitcnt vmcnt(5)
    buffer_load_dword v241, v247, s[92:95], 0 offen
    s_waitcnt lgkmcnt(4)
    v_mfma_f32_16x16x32_bf16 v[56:59], v[16:19], v[112:115], v[96:99]
    ds_read_b64 v[28:29], v214 offset:4096
    v_exp_f32 v45, v73
    v_mfma_f32_16x16x32_bf16 v[60:63], v[16:19], v[116:119], v[100:103]
    ds_read_b64 v[30:31], v215 offset:4096
    v_exp_f32 v46, v74
    s_waitcnt lgkmcnt(4)
    v_mfma_f32_16x16x32_bf16 v[56:59], v[20:23], v[120:123], v[56:59]
    v_subrev_u32 v232, 0x20000, v232
    ds_read_b64_tr_b16 v[16:17], v232 offset:8192
    v_exp_f32 v47, v75
    v_mfma_f32_16x16x32_bf16 v[60:63], v[20:23], v[124:127], v[60:63]
    ds_read_b64_tr_b16 v[18:19], v232 offset:12288
    v_add_f32 v34, v34, v44
    v_cvt_pk_bf16_f32 v90, v44, v45
    s_waitcnt lgkmcnt(4)
    v_mfma_f32_16x16x32_bf16 v[56:59], v[24:27], v[128:131], v[56:59]
    v_subrev_u32 v233, 0x20000, v233
    ds_read_b64_tr_b16 v[20:21], v233 offset:8192
    v_add_f32 v34, v34, v45
    v_cvt_pk_bf16_f32 v91, v46, v47
    v_mfma_f32_16x16x32_bf16 v[60:63], v[24:27], v[132:135], v[60:63]
    ds_read_b64_tr_b16 v[22:23], v233 offset:12288
    v_add_f32 v34, v34, v46
    v_add_f32 v34, v34, v47
    s_waitcnt lgkmcnt(4)
    v_mfma_f32_16x16x32_bf16 v[56:59], v[28:31], v[136:139], v[56:59]
    v_subrev_u32 v234, 0x20000, v234
    ds_read_b64_tr_b16 v[24:25], v234 offset:8192
    v_exp_f32 v40, v68
    v_mfma_f32_16x16x32_bf16 v[60:63], v[28:31], v[140:143], v[60:63]
    ds_read_b64_tr_b16 v[26:27], v234 offset:12288
    v_exp_f32 v41, v69
    s_setprio 0
    s_waitcnt lgkmcnt(4)
    v_mfma_f32_16x16x32_bf16 v[144:147], v[16:19], v[80:83], v[144:147]
    v_subrev_u32 v235, 0x20000, v235
    ds_read_b64_tr_b16 v[28:29], v235 offset:8192
    v_exp_f32 v42, v70
    v_mfma_f32_16x16x32_bf16 v[148:151], v[16:19], v[84:87], v[148:151]
    ds_read_b64_tr_b16 v[30:31], v235 offset:12288
    v_exp_f32 v43, v71
    s_waitcnt lgkmcnt(4)
    v_mfma_f32_16x16x32_bf16 v[152:155], v[20:23], v[80:83], v[152:155]
    v_subrev_u32 v236, 0x20000, v236
    ds_read_b64_tr_b16 v[16:17], v236 offset:8192
    v_add_f32 v35, v40, v41
    v_cvt_pk_bf16_f32 v92, v40, v41
    v_mfma_f32_16x16x32_bf16 v[156:159], v[20:23], v[84:87], v[156:159]
    ds_read_b64_tr_b16 v[18:19], v236 offset:12288
    v_add_f32 v35, v35, v42
    v_cvt_pk_bf16_f32 v93, v42, v43
    s_waitcnt lgkmcnt(4)
    v_mfma_f32_16x16x32_bf16 v[160:163], v[24:27], v[80:83], v[160:163]
    v_subrev_u32 v237, 0x20000, v237
    ds_read_b64_tr_b16 v[20:21], v237 offset:8192
    v_add_f32 v35, v35, v43
    v_mfma_f32_16x16x32_bf16 v[164:167], v[24:27], v[84:87], v[164:167]
    ds_read_b64_tr_b16 v[22:23], v237 offset:12288
    v_exp_f32 v44, v76
    s_waitcnt lgkmcnt(4)
    v_mfma_f32_16x16x32_bf16 v[168:171], v[28:31], v[80:83], v[168:171]
    v_subrev_u32 v238, 0x20000, v238
    ds_read_b64_tr_b16 v[24:25], v238 offset:8192
    v_exp_f32 v45, v77
    v_mfma_f32_16x16x32_bf16 v[172:175], v[28:31], v[84:87], v[172:175]
    ds_read_b64_tr_b16 v[26:27], v238 offset:12288
    v_exp_f32 v46, v78
    s_waitcnt lgkmcnt(4)
    v_mfma_f32_16x16x32_bf16 v[176:179], v[16:19], v[80:83], v[176:179]
    v_subrev_u32 v239, 0x20000, v239
    ds_read_b64_tr_b16 v[28:29], v239 offset:8192
    v_exp_f32 v47, v79
    v_mfma_f32_16x16x32_bf16 v[180:183], v[16:19], v[84:87], v[180:183]
    ds_read_b64_tr_b16 v[30:31], v239 offset:12288
    v_add_f32 v35, v35, v44
    v_cvt_pk_bf16_f32 v94, v44, v45
    s_waitcnt lgkmcnt(4)
    v_mfma_f32_16x16x32_bf16 v[184:187], v[20:23], v[80:83], v[184:187]
    ds_read_b64 v[16:17], v208 offset:16384
    v_add_f32 v35, v35, v45
    v_cvt_pk_bf16_f32 v95, v46, v47
    v_mfma_f32_16x16x32_bf16 v[188:191], v[20:23], v[84:87], v[188:191]
    ds_read_b64 v[18:19], v209 offset:16384
    v_add_f32 v35, v35, v46
    v_add_f32 v35, v35, v47
    s_waitcnt lgkmcnt(4)
    v_mfma_f32_16x16x32_bf16 v[192:195], v[24:27], v[80:83], v[192:195]
    ds_read_b64 v[20:21], v210 offset:16384
    v_mfma_f32_16x16x32_bf16 v[196:199], v[24:27], v[84:87], v[196:199]
    ds_read_b64 v[22:23], v211 offset:16384
    s_waitcnt lgkmcnt(4)
    v_mfma_f32_16x16x32_bf16 v[200:203], v[28:31], v[80:83], v[200:203]
    ds_read_b64 v[24:25], v212 offset:16384
    v_mfma_f32_16x16x32_bf16 v[204:207], v[28:31], v[84:87], v[204:207]
    ds_read_b64 v[26:27], v213 offset:16384
    v_add_f32 v36, v34, v35
    v_cmp_ngt_f32 vcc, s52, v36
    s_cbranch_vccnz L_slow_3
L_back_3:
    v_add_f32 v32, v32, v34
    v_add_f32 v33, v33, v35
    s_setprio 3
    s_barrier
    s_waitcnt lgkmcnt(4)
    v_mfma_f32_16x16x32_bf16 v[64:67], v[16:19], v[112:115], v[96:99]
    ds_read_b64 v[28:29], v214 offset:16384
    v_exp_f32 v40, v48
    v_mfma_f32_16x16x32_bf16 v[68:71], v[16:19], v[116:119], v[100:103]
    ds_read_b64 v[30:31], v215 offset:16384
    v_exp_f32 v41, v49
    s_add_u32 m0, s39, 0x24000
    s_mov_b32 s59, 0x1a000
    buffer_load_dwordx4 v3, s[12:15], s59 offen lds
    s_waitcnt lgkmcnt(4)
    v_mfma_f32_16x16x32_bf16 v[64:67], v[20:23], v[120:123], v[64:67]
    ds_read_b64 v[16:17], v208 offset:20480
    v_exp_f32 v42, v50
    v_mfma_f32_16x16x32_bf16 v[68:71], v[20:23], v[124:127], v[68:71]
    ds_read_b64 v[18:19], v209 offset:20480
    v_exp_f32 v43, v51
    s_waitcnt lgkmcnt(4)
    v_mfma_f32_16x16x32_bf16 v[64:67], v[24:27], v[128:131], v[64:67]
    ds_read_b64 v[20:21], v210 offset:20480
    v_add_f32 v34, v40, v41
    v_cvt_pk_bf16_f32 v80, v40, v41
    v_mfma_f32_16x16x32_bf16 v[68:71], v[24:27], v[132:135], v[68:71]
    ds_read_b64 v[22:23], v211 offset:20480
    v_add_f32 v34, v34, v42
    v_cvt_pk_bf16_f32 v81, v42, v43
    s_add_u32 m0, s39, 0x26000
    s_mov_b32 s60, 0x16000
    buffer_load_dwordx4 v4, s[16:19], s60 offen lds
    s_waitcnt lgkmcnt(4)
    v_mfma_f32_16x16x32_bf16 v[64:67], v[28:31], v[136:139], v[64:67]
    ds_read_b64 v[24:25], v212 offset:20480
    v_add_f32 v34, v34, v43
    v_mfma_f32_16x16x32_bf16 v[68:71], v[28:31], v[140:143], v[68:71]
    ds_read_b64 v[26:27], v213 offset:20480
    v_exp_f32 v44, v56
    s_waitcnt lgkmcnt(4)
    v_mfma_f32_16x16x32_bf16 v[72:75], v[16:19], v[112:115], v[96:99]
    ds_read_b64 v[28:29], v214 offset:20480
    v_exp_f32 v45, v57
    v_mfma_f32_16x16x32_bf16 v[76:79], v[16:19], v[116:119], v[100:103]
    ds_read_b64 v[30:31], v215 offset:20480
    v_exp_f32 v46, v58
    s_add_u32 m0, s39, 0x0
    s_mov_b32 s61, 0x1c000
    buffer_load_dwordx4 v3, s[12:15], s61 offen lds
    s_waitcnt lgkmcnt(4)
    v_mfma_f32_16x16x32_bf16 v[72:75], v[20:23], v[120:123], v[72:75]
    ds_read_b64_tr_b16 v[16:17], v232 offset:24576
    v_exp_f32 v47, v59
    v_mfma_f32_16x16x32_bf16 v[76:79], v[20:23], v[124:127], v[76:79]
    ds_read_b64_tr_b16 v[18:19], v232 offset:28672
    v_add_f32 v34, v34, v44
    v_cvt_pk_bf16_f32 v82, v44, v45
    s_waitcnt lgkmcnt(4)
    v_mfma_f32_16x16x32_bf16 v[72:75], v[24:27], v[128:131], v[72:75]
    ds_read_b64_tr_b16 v[20:21], v233 offset:24576
    v_add_f32 v34, v34, v45
    v_cvt_pk_bf16_f32 v83, v46, v47
    v_mfma_f32_16x16x32_bf16 v[76:79], v[24:27], v[132:135], v[76:79]
    ds_read_b64_tr_b16 v[22:23], v233 offset:28672
    v_add_f32 v34, v34, v46
    v_add_f32 v34, v34, v47
    s_add_u32 m0, s39, 0x2000
    s_mov_b32 s62, 0x18000
    buffer_load_dwordx4 v4, s[16:19], s62 offen lds
    s_waitcnt lgkmcnt(4)
    v_mfma_f32_16x16x32_bf16 v[72:75], v[28:31], v[136:139], v[72:75]
    ds_read_b64_tr_b16 v[24:25], v234 offset:24576
    v_exp_f32 v40, v52
    v_mfma_f32_16x16x32_bf16 v[76:79], v[28:31], v[140:143], v[76:79]
    ds_read_b64_tr_b16 v[26:27], v234 offset:28672
    v_exp_f32 v41, v53
    s_setprio 2
    s_waitcnt lgkmcnt(4)
    v_mfma_f32_16x16x32_bf16 v[144:147], v[16:19], v[88:91], v[144:147]
    ds_read_b64_tr_b16 v[28:29], v235 offset:24576
    v_exp_f32 v42, v54
    v_mfma_f32_16x16x32_bf16 v[148:151], v[16:19], v[92:95], v[148:151]
    ds_read_b64_tr_b16 v[30:31], v235 offset:28672
    v_exp_f32 v43, v55
    s_mul_i32 s51, s33, 576
    s_mov_b32 s92, s40
    s_mov_b32 s93, s41
    s_mov_b32 s94, 0x510000
    s_add_u32 s92, s92, s51
    s_addc_u32 s93, s93, 0
    s_sub_u32 s94, s94, s51
    s_mov_b32 s95, 0x00020000
    s_sub_u32 s50, s34, 0
    s_lshl_b32 s50, s50, 3
    s_add_u32 s50, s50, s32
    s_mul_i32 s50, s50, 9
    s_add_u32 s50, s50, 1152
    v_add_u32 v246, s50, v7
    v_lshrrev_b32 v247, 3, v246
    s_mov_b32 s50, 9216
    v_mul_lo_u32 v247, v247, s50
    v_and_b32 v246, 7, v246
    v_lshl_add_u32 v247, v246, 7, v247
    v_cmp_gt_u32 vcc, 9, v7
    v_cmp_gt_u32 s[50:51], 5, v246
    s_nop 0
    s_and_b64 vcc, vcc, s[50:51]
    v_cndmask_b32 v247, -16, v247, vcc
    buffer_load_dword v242, v247, s[92:95], 0 offen
    s_waitcnt lgkmcnt(4)
    v_mfma_f32_16x16x32_bf16 v[152:155], v[20:23], v[88:91], v[152:155]
    ds_read_b64_tr_b16 v[16:17], v236 offset:24576
    v_add_f32 v35, v40, v41
    v_cvt_pk_bf16_f32 v84, v40, v41
    v_mfma_f32_16x16x32_bf16 v[156:159], v[20:23], v[92:95], v[156:159]
    ds_read_b64_tr_b16 v[18:19], v236 offset:28672
    v_add_f32 v35, v35, v42
    v_cvt_pk_bf16_f32 v85, v42, v43
    s_waitcnt lgkmcnt(4)
    v_mfma_f32_16x16x32_bf16 v[160:163], v[24:27], v[88:91], v[160:163]
    ds_read_b64_tr_b16 v[20:21], v237 offset:24576
    v_add_f32 v35, v35, v43
    v_mfma_f32_16x16x32_bf16 v[164:167], v[24:27], v[92:95], v[164:167]
    ds_read_b64_tr_b16 v[22:23], v237 offset:28672
    v_exp_f32 v44, v60
    s_waitcnt lgkmcnt(4)
    v_mfma_f32_16x16x32_bf16 v[168:171], v[28:31], v[88:91], v[168:171]
    ds_read_b64_tr_b16 v[24:25], v238 offset:24576
    v_exp_f32 v45, v61
    v_mfma_f32_16x16x32_bf16 v[172:175], v[28:31], v[92:95], v[172:175]
    ds_read_b64_tr_b16 v[26:27], v238 offset:28672
    v_exp_f32 v46, v62
    s_waitcnt lgkmcnt(4)
    v_mfma_f32_16x16x32_bf16 v[176:179], v[16:19], v[88:91], v[176:179]
    ds_read_b64_tr_b16 v[28:29], v239 offset:24576
    v_exp_f32 v47, v63
    v_mfma_f32_16x16x32_bf16 v[180:183], v[16:19], v[92:95], v[180:183]
    ds_read_b64_tr_b16 v[30:31], v239 offset:28672
    v_add_f32 v35, v35, v44
    v_cvt_pk_bf16_f32 v86, v44, v45
    s_waitcnt lgkmcnt(4)
    v_mfma_f32_16x16x32_bf16 v[184:187], v[20:23], v[88:91], v[184:187]
    ds_read_b64 v[16:17], v208 offset:32768
    v_add_f32 v35, v35, v45
    v_cvt_pk_bf16_f32 v87, v46, v47
    v_mfma_f32_16x16x32_bf16 v[188:191], v[20:23], v[92:95], v[188:191]
    ds_read_b64 v[18:19], v209 offset:32768
    v_add_f32 v35, v35, v46
    v_add_f32 v35, v35, v47
    s_waitcnt lgkmcnt(4)
    v_mfma_f32_16x16x32_bf16 v[192:195], v[24:27], v[88:91], v[192:195]
    ds_read_b64 v[20:21], v210 offset:32768
    v_mfma_f32_16x16x32_bf16 v[196:199], v[24:27], v[92:95], v[196:199]
    ds_read_b64 v[22:23], v211 offset:32768
    s_waitcnt lgkmcnt(4)
    v_mfma_f32_16x16x32_bf16 v[200:203], v[28:31], v[88:91], v[200:203]
    ds_read_b64 v[24:25], v212 offset:32768
    v_mfma_f32_16x16x32_bf16 v[204:207], v[28:31], v[92:95], v[204:207]
    ds_read_b64 v[26:27], v213 offset:32768
    v_add_f32 v36, v34, v35
    v_cmp_ngt_f32 vcc, s52, v36
    s_cbranch_vccnz L_slow_4
L_back_4:
    v_add_f32 v32, v32, v34
    v_add_f32 v33, v33, v35
    s_setprio 1
    s_waitcnt lgkmcnt(4)
    v_mfma_f32_16x16x32_bf16 v[48:51], v[16:19], v[112:115], v[96:99]
    ds_read_b64 v[28:29], v214 offset:32768
    v_exp_f32 v40, v64
    v_mfma_f32_16x16x32_bf16 v[52:55], v[16:19], v[116:119], v[100:103]
    ds_read_b64 v[30:31], v215 offset:32768
    v_exp_f32 v41, v65
    s_waitcnt lgkmcnt(4)
    v_mfma_f32_16x16x32_bf16 v[48:51], v[20:23], v[120:123], v[48:51]
    ds_read_b64 v[16:17], v208 offset:36864
    v_exp_f32 v42, v66
    v_mfma_f32_16x16x32_bf16 v[52:55], v[20:23], v[124:127], v[52:55]
    ds_read_b64 v[18:19], v209 offset:36864
    v_exp_f32 v43, v67
    s_waitcnt lgkmcnt(4)
    v_mfma_f32_16x16x32_bf16 v[48:51], v[24:27], v[128:131], v[48:51]
    ds_read_b64 v[20:21], v210 offset:36864
    v_add_f32 v34, v40, v41
    v_cvt_pk_bf16_f32 v88, v40, v41
    v_mfma_f32_16x16x32_bf16 v[52:55], v[24:27], v[132:135], v[52:55]
    ds_read_b64 v[22:23], v211 offset:36864
    v_add_f32 v34, v34, v42
    v_cvt_pk_bf16_f32 v89, v42, v43
    s_waitcnt lgkmcnt(4)
    v_mfma_f32_16x16x32_bf16 v[48:51], v[28:31], v[136:139], v[48:51]
    ds_read_b64 v[24:25], v212 offset:36864
    v_add_f32 v34, v34, v43
    v_mfma_f32_16x16x32_bf16 v[52:55], v[28:31], v[140:143], v[52:55]
    ds_read_b64 v[26:27], v213 offset:36864
    v_exp_f32 v44, v72
    s_mul_i32 s51, s33, 576
    s_mov_b32 s92, s42
    s_mov_b32 s93, s43
    s_mov_b32 s94, 0x510000
    s_add_u32 s92, s92, s51
    s_addc_u32 s93, s93, 0
    s_sub_u32 s94, s94, s51
    s_mov_b32 s95, 0x00020000
    s_sub_u32 s50, s34, 0
    s_lshl_b32 s50, s50, 3
    s_add_u32 s50, s50, s32
    s_mul_i32 s50, s50, 9
    s_add_u32 s50, s50, 1152
    v_add_u32 v246, s50, v7
    v_lshrrev_b32 v247, 3, v246
    s_mov_b32 s50, 9216
    v_mul_lo_u32 v247, v247, s50
    v_and_b32 v246, 7, v246
    v_lshl_add_u32 v247, v246, 7, v247
    v_cmp_gt_u32 vcc, 9, v7
    v_cmp_gt_u32 s[50:51], 5, v246
    s_nop 0
    s_and_b64 vcc, vcc, s[50:51]
    v_cndmask_b32 v247, -16, v247, vcc
    buffer_load_dword v243, v247, s[92:95], 0 offen
    s_waitcnt lgkmcnt(4)
    v_mfma_f32_16x16x32_bf16 v[56:59], v[16:19], v[112:115], v[96:99]
    ds_read_b64 v[28:29], v214 offset:36864
    v_exp_f32 v45, v73
    v_mfma_f32_16x16x32_bf16 v[60:63], v[16:19], v[116:119], v[100:103]
    ds_read_b64 v[30:31], v215 offset:36864
    v_exp_f32 v46, v74
    s_waitcnt lgkmcnt(4)
    v_mfma_f32_16x16x32_bf16 v[56:59], v[20:23], v[120:123], v[56:59]
    ds_read_b64_tr_b16 v[16:17], v232 offset:40960
    v_exp_f32 v47, v75
    v_mfma_f32_16x16x32_bf16 v[60:63], v[20:23], v[124:127], v[60:63]
    ds_read_b64_tr_b16 v[18:19], v232 offset:45056
    v_add_f32 v34, v34, v44
    v_cvt_pk_bf16_f32 v90, v44, v45
    s_waitcnt lgkmcnt(4)
    v_mfma_f32_16x16x32_bf16 v[56:59], v[24:27], v[128:131], v[56:59]
    ds_read_b64_tr_b16 v[20:21], v233 offset:40960
    v_add_f32 v34, v34, v45
    v_cvt_pk_bf16_f32 v91, v46, v47
    v_mfma_f32_16x16x32_bf16 v[60:63], v[24:27], v[132:135], v[60:63]
    ds_read_b64_tr_b16 v[22:23], v233 offset:45056
    v_add_f32 v34, v34, v46
    v_add_f32 v34, v34, v47
    s_waitcnt lgkmcnt(4)
    v_mfma_f32_16x16x32_bf16 v[56:59], v[28:31], v[136:139], v[56:59]
    ds_read_b64_tr_b16 v[24:25], v234 offset:40960
    v_exp_f32 v40, v68
    v_mfma_f32_16x16x32_bf16 v[60:63], v[28:31], v[140:143], v[60:63]
    ds_read_b64_tr_b16 v[26:27], v234 offset:45056
    v_exp_f32 v41, v69
    s_setprio 0
    s_waitcnt lgkmcnt(4)
    v_mfma_f32_16x16x32_bf16 v[144:147], v[16:19], v[80:83], v[144:147]
    ds_read_b64_tr_b16 v[28:29], v235 offset:40960
    v_exp_f32 v42, v70
    v_mfma_f32_16x16x32_bf16 v[148:151], v[16:19], v[84:87], v[148:151]
    ds_read_b64_tr_b16 v[30:31], v235 offset:45056
    v_exp_f32 v43, v71
    s_waitcnt lgkmcnt(4)
    v_mfma_f32_16x16x32_bf16 v[152:155], v[20:23], v[80:83], v[152:155]
    ds_read_b64_tr_b16 v[16:17], v236 offset:40960
    v_add_f32 v35, v40, v41
    v_cvt_pk_bf16_f32 v92, v40, v41
    v_mfma_f32_16x16x32_bf16 v[156:159], v[20:23], v[84:87], v[156:159]
    ds_read_b64_tr_b16 v[18:19], v236 offset:45056
    v_add_f32 v35, v35, v42
    v_cvt_pk_bf16_f32 v93, v42, v43
    s_waitcnt lgkmcnt(4)
    v_mfma_f32_16x16x32_bf16 v[160:163], v[24:27], v[80:83], v[160:163]
    ds_read_b64_tr_b16 v[20:21], v237 offset:40960
    v_add_f32 v35, v35, v43
    v_mfma_f32_16x16x32_bf16 v[164:167], v[24:27], v[84:87], v[164:167]
    ds_read_b64_tr_b16 v[22:23], v237 offset:45056
    v_exp_f32 v44, v76
    s_waitcnt lgkmcnt(4)
    v_mfma_f32_16x16x32_bf16 v[168:171], v[28:31], v[80:83], v[168:171]
    ds_read_b64_tr_b16 v[24:25], v238 offset:40960
    v_exp_f32 v45, v77
    v_mfma_f32_16x16x32_bf16 v[172:175], v[28:31], v[84:87], v[172:175]
    ds_read_b64_tr_b16 v[26:27], v238 offset:45056
    v_exp_f32 v46, v78
    s_waitcnt lgkmcnt(4)
    v_mfma_f32_16x16x32_bf16 v[176:179], v[16:19], v[80:83], v[176:179]
    ds_read_b64_tr_b16 v[28:29], v239 offset:40960
    v_exp_f32 v47, v79
    v_mfma_f32_16x16x32_bf16 v[180:183], v[16:19], v[84:87], v[180:183]
    ds_read_b64_tr_b16 v[30:31], v239 offset:45056
    v_add_f32 v35, v35, v44
    v_cvt_pk_bf16_f32 v94, v44, v45
    s_waitcnt lgkmcnt(4)
    v_mfma_f32_16x16x32_bf16 v[184:187], v[20:23], v[80:83], v[184:187]
    ds_read_b64 v[16:17], v208 offset:49152
    v_add_f32 v35, v35, v45
    v_cvt_pk_bf16_f32 v95, v46, v47
    v_mfma_f32_16x16x32_bf16 v[188:191], v[20:23], v[84:87], v[188:191]
    ds_read_b64 v[18:19], v209 offset:49152
    v_add_f32 v35, v35, v46
    v_add_f32 v35, v35, v47
    s_waitcnt lgkmcnt(4)
    v_mfma_f32_16x16x32_bf16 v[192:195], v[24:27], v[80:83], v[192:195]
    ds_read_b64 v[20:21], v210 offset:49152
    v_mfma_f32_16x16x32_bf16 v[196:199], v[24:27], v[84:87], v[196:199]
    ds_read_b64 v[22:23], v211 offset:49152
    s_waitcnt lgkmcnt(4)
    v_mfma_f32_16x16x32_bf16 v[200:203], v[28:31], v[80:83], v[200:203]
    ds_read_b64 v[24:25], v212 offset:49152
    v_mfma_f32_16x16x32_bf16 v[204:207], v[28:31], v[84:87], v[204:207]
    ds_read_b64 v[26:27], v213 offset:49152
    v_add_f32 v36, v34, v35
    v_cmp_ngt_f32 vcc, s52, v36
    s_cbranch_vccnz L_slow_5
L_back_5:
    v_add_f32 v32, v32, v34
    v_add_f32 v33, v33, v35
    s_setprio 3
    s_barrier
    s_waitcnt lgkmcnt(4)
    v_mfma_f32_16x16x32_bf16 v[64:67], v[16:19], v[112:115], v[96:99]
    ds_read_b64 v[28:29], v214 offset:49152
    v_exp_f32 v40, v48
    v_mfma_f32_16x16x32_bf16 v[68:71], v[16:19], v[116:119], v[100:103]
    ds_read_b64 v[30:31], v215 offset:49152
    v_exp_f32 v41, v49
    s_add_u32 m0, s39, 0x4000
    s_mov_b32 s63, 0x1e000
    buffer_load_dwordx4 v3, s[12:15], s63 offen lds
    s_waitcnt lgkmcnt(4)
    v_mfma_f32_16x16x32_bf16 v[64:67], v[20:23], v[120:123], v[64:67]
    ds_read_b64 v[16:17], v208 offset:53248
    v_exp_f32 v42, v50
    v_mfma_f32_16x16x32_bf16 v[68:71], v[20:23], v[124:127], v[68:71]
    ds_read_b64 v[18:19], v209 offset:53248
    v_exp_f32 v43, v51
    s_waitcnt lgkmcnt(4)
    v_mfma_f32_16x16x32_bf16 v[64:67], v[24:27], v[128:131], v[64:67]
    ds_read_b64 v[20:21], v210 offset:53248
    v_add_f32 v34, v40, v41
    v_cvt_pk_bf16_f32 v80, v40, v41
    v_mfma_f32_16x16x32_bf16 v[68:71], v[24:27], v[132:135], v[68:71]
    ds_read_b64 v[22:23], v211 offset:53248
    v_add_f32 v34, v34, v42
    v_cvt_pk_bf16_f32 v81, v42, v43
    s_add_u32 m0, s39, 0x6000
    s_mov_b32 s56, 0x1a000
    buffer_load_dwordx4 v4, s[16:19], s56 offen lds
    s_waitcnt lgkmcnt(4)
    v_mfma_f32_16x16x32_bf16 v[64:67], v[28:31], v[136:139], v[64:67]
    ds_read_b64 v[24:25], v212 offset:53248
    v_add_f32 v34, v34, v43
    v_mfma_f32_16x16x32_bf16 v[68:71], v[28:31], v[140:143], v[68:71]
    ds_read_b64 v[26:27], v213 offset:53248
    v_exp_f32 v44, v56
    s_waitcnt lgkmcnt(4)
    v_mfma_f32_16x16x32_bf16 v[72:75], v[16:19], v[112:115], v[96:99]
    ds_read_b64 v[28:29], v214 offset:53248
    v_exp_f32 v45, v57
    v_mfma_f32_16x16x32_bf16 v[76:79], v[16:19], v[116:119], v[100:103]
    ds_read_b64 v[30:31], v215 offset:53248
    v_exp_f32 v46, v58
    s_add_u32 m0, s39, 0x8000
    s_mov_b32 s57, 0x1c000
    buffer_load_dwordx4 v4, s[16:19], s57 offen lds
    s_waitcnt lgkmcnt(4)
    v_mfma_f32_16x16x32_bf16 v[72:75], v[20:23], v[120:123], v[72:75]
    ds_read_b64_tr_b16 v[16:17], v232 offset:57344
    v_exp_f32 v47, v59
    v_mfma_f32_16x16x32_bf16 v[76:79], v[20:23], v[124:127], v[76:79]
    ds_read_b64_tr_b16 v[18:19], v232 offset:61440
    v_add_f32 v34, v34, v44
    v_cvt_pk_bf16_f32 v82, v44, v45
    s_waitcnt lgkmcnt(4)
    v_mfma_f32_16x16x32_bf16 v[72:75], v[24:27], v[128:131], v[72:75]
    ds_read_b64_tr_b16 v[20:21], v233 offset:57344
    v_add_f32 v34, v34, v45
    v_cvt_pk_bf16_f32 v83, v46, v47
    v_mfma_f32_16x16x32_bf16 v[76:79], v[24:27], v[132:135], v[76:79]
    ds_read_b64_tr_b16 v[22:23], v233 offset:61440
    v_add_f32 v34, v34, v46
    v_add_f32 v34, v34, v47
    s_add_u32 m0, s39, 0xa000
    s_mov_b32 s58, 0x1e000
    buffer_load_dwordx4 v4, s[16:19], s58 offen lds
    s_waitcnt lgkmcnt(4)
    v_mfma_f32_16x16x32_bf16 v[72:75], v[28:31], v[136:139], v[72:75]
    ds_read_b64_tr_b16 v[24:25], v234 offset:57344
    v_exp_f32 v40, v52
    v_mfma_f32_16x16x32_bf16 v[76:79], v[28:31], v[140:143], v[76:79]
    ds_read_b64_tr_b16 v[26:27], v234 offset:61440
    v_exp_f32 v41, v53
    s_setprio 2
    s_waitcnt lgkmcnt(4)
    v_mfma_f32_16x16x32_bf16 v[144:147], v[16:19], v[88:91], v[144:147]
    ds_read_b64_tr_b16 v[28:29], v235 offset:57344
    v_exp_f32 v42, v54
    v_mfma_f32_16x16x32_bf16 v[148:151], v[16:19], v[92:95], v[148:151]
    ds_read_b64_tr_b16 v[30:31], v235 offset:61440
    v_exp_f32 v43, v55
    s_mul_i32 s51, s33, 576
    s_mov_b32 s92, s40
    s_mov_b32 s93, s41
    s_mov_b32 s94, 0x510000
    s_add_u32 s92, s92, s51
    s_addc_u32 s93, s93, 0
    s_sub_u32 s94, s94, s51
    s_mov_b32 s95, 0x00020000
    s_sub_u32 s50, s34, 0
    s_lshl_b32 s50, s50, 3
    s_add_u32 s50, s50, s32
    s_mul_i32 s50, s50, 9
    s_add_u32 s50, s50, 2304
    v_add_u32 v246, s50, v7
    v_lshrrev_b32 v247, 3, v246
    s_mov_b32 s50, 9216
    v_mul_lo_u32 v247, v247, s50
    v_and_b32 v246, 7, v246
    v_lshl_add_u32 v247, v246, 7, v247
    v_cmp_gt_u32 vcc, 9, v7
    v_cmp_gt_u32 s[50:51], 5, v246
    s_nop 0
    s_and_b64 vcc, vcc, s[50:51]
    v_cndmask_b32 v247, -16, v247, vcc
    buffer_load_dword v244, v247, s[92:95], 0 offen
    s_waitcnt lgkmcnt(4)
    v_mfma_f32_16x16x32_bf16 v[152:155], v[20:23], v[88:91], v[152:155]
    ds_read_b64_tr_b16 v[16:17], v236 offset:57344
    v_add_f32 v35, v40, v41
    v_cvt_pk_bf16_f32 v84, v40, v41
    v_mfma_f32_16x16x32_bf16 v[156:159], v[20:23], v[92:95], v[156:159]
    ds_read_b64_tr_b16 v[18:19], v236 offset:61440
    v_add_f32 v35, v35, v42
    v_cvt_pk_bf16_f32 v85, v42, v43
    s_waitcnt lgkmcnt(4)
    v_mfma_f32_16x16x32_bf16 v[160:163], v[24:27], v[88:91], v[160:163]
    ds_read_b64_tr_b16 v[20:21], v237 offset:57344
    v_add_f32 v35, v35, v43
    v_mfma_f32_16x16x32_bf16 v[164:167], v[24:27], v[92:95], v[164:167]
    ds_read_b64_tr_b16 v[22:23], v237 offset:61440
    v_exp_f32 v44, v60
    s_waitcnt lgkmcnt(4)
    v_mfma_f32_16x16x32_bf16 v[168:171], v[28:31], v[88:91], v[168:171]
    ds_read_b64_tr_b16 v[24:25], v238 offset:57344
    v_exp_f32 v45, v61
    v_mfma_f32_16x16x32_bf16 v[172:175], v[28:31], v[92:95], v[172:175]
    ds_read_b64_tr_b16 v[26:27], v238 offset:61440
    v_exp_f32 v46, v62
    s_waitcnt lgkmcnt(4)
    v_mfma_f32_16x16x32_bf16 v[176:179], v[16:19], v[88:91], v[176:179]
    ds_read_b64_tr_b16 v[28:29], v239 offset:57344
    v_exp_f32 v47, v63
    v_mfma_f32_16x16x32_bf16 v[180:183], v[16:19], v[92:95], v[180:183]
    ds_read_b64_tr_b16 v[30:31], v239 offset:61440
    v_add_f32 v35, v35, v44
    v_cvt_pk_bf16_f32 v86, v44, v45
    s_waitcnt lgkmcnt(4)
    v_mfma_f32_16x16x32_bf16 v[184:187], v[20:23], v[88:91], v[184:187]
    v_add_u32 v208, 0x10000, v208
    ds_read_b64 v[16:17], v208 offset:0
    v_add_f32 v35, v35, v45
    v_cvt_pk_bf16_f32 v87, v46, v47
    v_mfma_f32_16x16x32_bf16 v[188:191], v[20:23], v[92:95], v[188:191]
    v_add_u32 v209, 0x10000, v209
    ds_read_b64 v[18:19], v209 offset:0
    v_add_f32 v35, v35, v46
    v_add_f32 v35, v35, v47
    s_waitcnt lgkmcnt(4)
    v_mfma_f32_16x16x32_bf16 v[192:195], v[24:27], v[88:91], v[192:195]
    v_add_u32 v210, 0x10000, v210
    ds_read_b64 v[20:21], v210 offset:0
    v_mfma_f32_16x16x32_bf16 v[196:199], v[24:27], v[92:95], v[196:199]
    v_add_u32 v211, 0x10000, v211
    ds_read_b64 v[22:23], v211 offset:0
    s_waitcnt lgkmcnt(4)
    v_mfma_f32_16x16x32_bf16 v[200:203], v[28:31], v[88:91], v[200:203]
    v_add_u32 v212, 0x10000, v212
    ds_read_b64 v[24:25], v212 offset:0
    v_mfma_f32_16x16x32_bf16 v[204:207], v[28:31], v[92:95], v[204:207]
    v_add_u32 v213, 0x10000, v213
    ds_read_b64 v[26:27], v213 offset:0
    v_add_f32 v36, v34, v35
    v_cmp_ngt_f32 vcc, s52, v36
    s_cbranch_vccnz L_slow_6
L_back_6:
    v_add_f32 v32, v32, v34
    v_add_f32 v33, v33, v35
    s_setprio 1
    s_waitcnt lgkmcnt(4)
    v_mfma_f32_16x16x32_bf16 v[48:51], v[16:19], v[112:115], v[96:99]
    v_add_u32 v214, 0x10000, v214
    ds_read_b64 v[28:29], v214 offset:0
    v_exp_f32 v40, v64
    v_mfma_f32_16x16x32_bf16 v[52:55], v[16:19], v[116:119], v[100:103]
    v_add_u32 v215, 0x10000, v215
    ds_read_b64 v[30:31], v215 offset:0
    v_exp_f32 v41, v65
    s_waitcnt lgkmcnt(4)
    v_mfma_f32_16x16x32_bf16 v[48:51], v[20:23], v[120:123], v[48:51]
    ds_read_b64 v[16:17], v208 offset:4096
    v_exp_f32 v42, v66
    v_mfma_f32_16x16x32_bf16 v[52:55], v[20:23], v[124:127], v[52:55]
    ds_read_b64 v[18:19], v209 offset:4096
    v_exp_f32 v43, v67
    s_waitcnt lgkmcnt(4)
    v_mfma_f32_16x16x32_bf16 v[48:51], v[24:27], v[128:131], v[48:51]
    ds_read_b64 v[20:21], v210 offset:4096
    v_add_f32 v34, v40, v41
    v_cvt_pk_bf16_f32 v88, v40, v41
    v_mfma_f32_16x16x32_bf16 v[52:55], v[24:27], v[132:135], v[52:55]
    ds_read_b64 v[22:23], v211 offset:4096
    v_add_f32 v34, v34, v42
    v_cvt_pk_bf16_f32 v89, v42, v43
    s_waitcnt lgkmcnt(4)
    v_mfma_f32_16x16x32_bf16 v[48:51], v[28:31], v[136:139], v[48:51]
    ds_read_b64 v[24:25], v212 offset:4096
    v_add_f32 v34, v34, v43
    v_mfma_f32_16x16x32_bf16 v[52:55], v[28:31], v[140:143], v[52:55]
    ds_read_b64 v[26:27], v213 offset:4096
    v_exp_f32 v44, v72
    s_mul_i32 s51, s33, 576
    s_mov_b32 s92, s42
    s_mov_b32 s93, s43
    s_mov_b32 s94, 0x510000
    s_add_u32 s92, s92, s51
    s_addc_u32 s93, s93, 0
    s_sub_u32 s94, s94, s51
    s_mov_b32 s95, 0x00020000
    s_sub_u32 s50, s34, 0
    s_lshl_b32 s50, s50, 3
    s_add_u32 s50, s50, s32
    s_mul_i32 s50, s50, 9
    s_add_u32 s50, s50, 2304
    v_add_u32 v246, s50, v7
    v_lshrrev_b32 v247, 3, v246
    s_mov_b32 s50, 9216
    v_mul_lo_u32 v247, v247, s50
    v_and_b32 v246, 7, v246
    v_lshl_add_u32 v247, v246, 7, v247
    v_cmp_gt_u32 vcc, 9, v7
    v_cmp_gt_u32 s[50:51], 5, v246
    s_nop 0
    s_and_b64 vcc, vcc, s[50:51]
    v_cndmask_b32 v247, -16, v247, vcc
    s_waitcnt vmcnt(12)
    buffer_load_dword v240, v247, s[92:95], 0 offen
    s_waitcnt lgkmcnt(4)
    v_mfma_f32_16x16x32_bf16 v[56:59], v[16:19], v[112:115], v[96:99]
    ds_read_b64 v[28:29], v214 offset:4096
    v_exp_f32 v45, v73
    v_mfma_f32_16x16x32_bf16 v[60:63], v[16:19], v[116:119], v[100:103]
    ds_read_b64 v[30:31], v215 offset:4096
    v_exp_f32 v46, v74
    s_waitcnt lgkmcnt(4)
    v_mfma_f32_16x16x32_bf16 v[56:59], v[20:23], v[120:123], v[56:59]
    v_add_u32 v232, 0x10000, v232
    ds_read_b64_tr_b16 v[16:17], v232 offset:8192
    v_exp_f32 v47, v75
    v_mfma_f32_16x16x32_bf16 v[60:63], v[20:23], v[124:127], v[60:63]
    ds_read_b64_tr_b16 v[18:19], v232 offset:12288
    v_add_f32 v34, v34, v44
    v_cvt_pk_bf16_f32 v90, v44, v45
    s_waitcnt lgkmcnt(4)
    v_mfma_f32_16x16x32_bf16 v[56:59], v[24:27], v[128:131], v[56:59]
    v_add_u32 v233, 0x10000, v233
    ds_read_b64_tr_b16 v[20:21], v233 offset:8192
    v_add_f32 v34, v34, v45
    v_cvt_pk_bf16_f32 v91, v46, v47
    v_mfma_f32_16x16x32_bf16 v[60:63], v[24:27], v[132:135], v[60:63]
    ds_read_b64_tr_b16 v[22:23], v233 offset:12288
    v_add_f32 v34, v34, v46
    v_add_f32 v34, v34, v47
    s_waitcnt lgkmcnt(4)
    v_mfma_f32_16x16x32_bf16 v[56:59], v[28:31], v[136:139], v[56:59]
    v_add_u32 v234, 0x10000, v234
    ds_read_b64_tr_b16 v[24:25], v234 offset:8192
    v_exp_f32 v40, v68
    v_mfma_f32_16x16x32_bf16 v[60:63], v[28:31], v[140:143], v[60:63]
    ds_read_b64_tr_b16 v[26:27], v234 offset:12288
    v_exp_f32 v41, v69
    s_setprio 0
    s_waitcnt lgkmcnt(4)
    v_mfma_f32_16x16x32_bf16 v[144:147], v[16:19], v[80:83], v[144:147]
    v_add_u32 v235, 0x10000, v235
    ds_read_b64_tr_b16 v[28:29], v235 offset:8192
    v_exp_f32 v42, v70
    v_mfma_f32_16x16x32_bf16 v[148:151], v[16:19], v[84:87], v[148:151]
    ds_read_b64_tr_b16 v[30:31], v235 offset:12288
    v_exp_f32 v43, v71
    s_waitcnt lgkmcnt(4)
    v_mfma_f32_16x16x32_bf16 v[152:155], v[20:23], v[80:83], v[152:155]
    v_add_u32 v236, 0x10000, v236
    ds_read_b64_tr_b16 v[16:17], v236 offset:8192
    v_add_f32 v35, v40, v41
    v_cvt_pk_bf16_f32 v92, v40, v41
    v_mfma_f32_16x16x32_bf16 v[156:159], v[20:23], v[84:87], v[156:159]
    ds_read_b64_tr_b16 v[18:19], v236 offset:12288
    v_add_f32 v35, v35, v42
    v_cvt_pk_bf16_f32 v93, v42, v43
    s_waitcnt lgkmcnt(4)
    v_mfma_f32_16x16x32_bf16 v[160:163], v[24:27], v[80:83], v[160:163]
    v_add_u32 v237, 0x10000, v237
    ds_read_b64_tr_b16 v[20:21], v237 offset:8192
    v_add_f32 v35, v35, v43
    v_mfma_f32_16x16x32_bf16 v[164:167], v[24:27], v[84:87], v[164:167]
    ds_read_b64_tr_b16 v[22:23], v237 offset:12288
    v_exp_f32 v44, v76
    s_waitcnt lgkmcnt(4)
    v_mfma_f32_16x16x32_bf16 v[168:171], v[28:31], v[80:83], v[168:171]
    v_add_u32 v238, 0x10000, v238
    ds_read_b64_tr_b16 v[24:25], v238 offset:8192
    v_exp_f32 v45, v77
    v_mfma_f32_16x16x32_bf16 v[172:175], v[28:31], v[84:87], v[172:175]
    ds_read_b64_tr_b16 v[26:27], v238 offset:12288
    v_exp_f32 v46, v78
    s_waitcnt lgkmcnt(4)
    v_mfma_f32_16x16x32_bf16 v[176:179], v[16:19], v[80:83], v[176:179]
    v_add_u32 v239, 0x10000, v239
    ds_read_b64_tr_b16 v[28:29], v239 offset:8192
    v_exp_f32 v47, v79
    v_mfma_f32_16x16x32_bf16 v[180:183], v[16:19], v[84:87], v[180:183]
    ds_read_b64_tr_b16 v[30:31], v239 offset:12288
    v_add_f32 v35, v35, v44
    v_cvt_pk_bf16_f32 v94, v44, v45
    s_waitcnt lgkmcnt(4)
    v_mfma_f32_16x16x32_bf16 v[184:187], v[20:23], v[80:83], v[184:187]
    ds_read_b64 v[16:17], v208 offset:16384
    v_add_f32 v35, v35, v45
    v_cvt_pk_bf16_f32 v95, v46, v47
    v_mfma_f32_16x16x32_bf16 v[188:191], v[20:23], v[84:87], v[188:191]
    ds_read_b64 v[18:19], v209 offset:16384
    v_add_f32 v35, v35, v46
    v_add_f32 v35, v35, v47
    s_waitcnt lgkmcnt(4)
    v_mfma_f32_16x16x32_bf16 v[192:195], v[24:27], v[80:83], v[192:195]
    ds_read_b64 v[20:21], v210 offset:16384
    v_mfma_f32_16x16x32_bf16 v[196:199], v[24:27], v[84:87], v[196:199]
    ds_read_b64 v[22:23], v211 offset:16384
    s_waitcnt lgkmcnt(4)
    v_mfma_f32_16x16x32_bf16 v[200:203], v[28:31], v[80:83], v[200:203]
    ds_read_b64 v[24:25], v212 offset:16384
    v_mfma_f32_16x16x32_bf16 v[204:207], v[28:31], v[84:87], v[204:207]
    ds_read_b64 v[26:27], v213 offset:16384
    v_add_f32 v36, v34, v35
    v_cmp_ngt_f32 vcc, s52, v36
    s_cbranch_vccnz L_slow_7
L_back_7:
    v_add_f32 v32, v32, v34
    v_add_f32 v33, v33, v35
    s_setprio 3
    s_barrier
    s_waitcnt lgkmcnt(4)
    v_mfma_f32_16x16x32_bf16 v[64:67], v[16:19], v[112:115], v[96:99]
    ds_read_b64 v[28:29], v214 offset:16384
    v_exp_f32 v40, v48
    v_mfma_f32_16x16x32_bf16 v[68:71], v[16:19], v[116:119], v[100:103]
    ds_read_b64 v[30:31], v215 offset:16384
    v_exp_f32 v41, v49
    s_waitcnt lgkmcnt(4)
    v_mfma_f32_16x16x32_bf16 v[64:67], v[20:23], v[120:123], v[64:67]
    ds_read_b64 v[16:17], v208 offset:20480
    v_exp_f32 v42, v50
    v_mfma_f32_16x16x32_bf16 v[68:71], v[20:23], v[124:127], v[68:71]
    ds_read_b64 v[18:19], v209 offset:20480
    v_exp_f32 v43, v51
    s_waitcnt lgkmcnt(4)
    v_mfma_f32_16x16x32_bf16 v[64:67], v[24:27], v[128:131], v[64:67]
    ds_read_b64 v[20:21], v210 offset:20480
    v_add_f32 v34, v40, v41
    v_cvt_pk_bf16_f32 v80, v40, v41
    v_mfma_f32_16x16x32_bf16 v[68:71], v[24:27], v[132:135], v[68:71]
    ds_read_b64 v[22:23], v211 offset:20480
    v_add_f32 v34, v34, v42
    v_cvt_pk_bf16_f32 v81, v42, v43
    s_waitcnt lgkmcnt(4)
    v_mfma_f32_16x16x32_bf16 v[64:67], v[28:31], v[136:139], v[64:67]
    ds_read_b64 v[24:25], v212 offset:20480
    v_add_f32 v34, v34, v43
    v_mfma_f32_16x16x32_bf16 v[68:71], v[28:31], v[140:143], v[68:71]
    ds_read_b64 v[26:27], v213 offset:20480
    v_exp_f32 v44, v56
    s_waitcnt lgkmcnt(4)
    v_mfma_f32_16x16x32_bf16 v[72:75], v[16:19], v[112:115], v[96:99]
    ds_read_b64 v[28:29], v214 offset:20480
    v_exp_f32 v45, v57
    v_mfma_f32_16x16x32_bf16 v[76:79], v[16:19], v[116:119], v[100:103]
    ds_read_b64 v[30:31], v215 offset:20480
    v_exp_f32 v46, v58
    s_waitcnt lgkmcnt(4)
    v_mfma_f32_16x16x32_bf16 v[72:75], v[20:23], v[120:123], v[72:75]
    ds_read_b64_tr_b16 v[16:17], v232 offset:24576
    v_exp_f32 v47, v59
    v_mfma_f32_16x16x32_bf16 v[76:79], v[20:23], v[124:127], v[76:79]
    ds_read_b64_tr_b16 v[18:19], v232 offset:28672
    v_add_f32 v34, v34, v44
    v_cvt_pk_bf16_f32 v82, v44, v45
    s_waitcnt lgkmcnt(4)
    v_mfma_f32_16x16x32_bf16 v[72:75], v[24:27], v[128:131], v[72:75]
    ds_read_b64_tr_b16 v[20:21], v233 offset:24576
    v_add_f32 v34, v34, v45
    v_cvt_pk_bf16_f32 v83, v46, v47
    v_mfma_f32_16x16x32_bf16 v[76:79], v[24:27], v[132:135], v[76:79]
    ds_read_b64_tr_b16 v[22:23], v233 offset:28672
    v_add_f32 v34, v34, v46
    v_add_f32 v34, v34, v47
    s_waitcnt lgkmcnt(4)
    v_mfma_f32_16x16x32_bf16 v[72:75], v[28:31], v[136:139], v[72:75]
    ds_read_b64_tr_b16 v[24:25], v234 offset:24576
    v_exp_f32 v40, v52
    v_mfma_f32_16x16x32_bf16 v[76:79], v[28:31], v[140:143], v[76:79]
    ds_read_b64_tr_b16 v[26:27], v234 offset:28672
    v_exp_f32 v41, v53
    s_setprio 2
    s_waitcnt lgkmcnt(4)
    v_mfma_f32_16x16x32_bf16 v[144:147], v[16:19], v[88:91], v[144:147]
    ds_read_b64_tr_b16 v[28:29], v235 offset:24576
    v_exp_f32 v42, v54
    v_mfma_f32_16x16x32_bf16 v[148:151], v[16:19], v[92:95], v[148:151]
    ds_read_b64_tr_b16 v[30:31], v235 offset:28672
    v_exp_f32 v43, v55
    s_mul_i32 s51, s33, 576
    s_mov_b32 s92, s40
    s_mov_b32 s93, s41
    s_mov_b32 s94, 0x510000
    s_add_u32 s92, s92, s51
    s_addc_u32 s93, s93, 0
    s_sub_u32 s94, s94, s51
    s_mov_b32 s95, 0x00020000
    s_sub_u32 s50, s34, 0
    s_lshl_b32 s50, s50, 3
    s_add_u32 s50, s50, s32
    s_mul_i32 s50, s50, 9
    s_add_u32 s50, s50, 3456
    v_add_u32 v246, s50, v7
    v_lshrrev_b32 v247, 3, v246
    s_mov_b32 s50, 9216
    v_mul_lo_u32 v247, v247, s50
    v_and_b32 v246, 7, v246
    v_lshl_add_u32 v247, v246, 7, v247
    v_cmp_gt_u32 vcc, 9, v7
    v_cmp_gt_u32 s[50:51], 5, v246
    s_nop 0
    s_and_b64 vcc, vcc, s[50:51]
    v_cndmask_b32 v247, -16, v247, vcc
    s_waitcnt vmcnt(12)
    buffer_load_dword v241, v247, s[92:95], 0 offen
    s_waitcnt lgkmcnt(4)
    v_mfma_f32_16x16x32_bf16 v[152:155], v[20:23], v[88:91], v[152:155]
    ds_read_b64_tr_b16 v[16:17], v236 offset:24576
    v_add_f32 v35, v40, v41
    v_cvt_pk_bf16_f32 v84, v40, v41
    v_mfma_f32_16x16x32_bf16 v[156:159], v[20:23], v[92:95], v[156:159]
    ds_read_b64_tr_b16 v[18:19], v236 offset:28672
    v_add_f32 v35, v35, v42
    v_cvt_pk_bf16_f32 v85, v42, v43
    s_waitcnt lgkmcnt(4)
    v_mfma_f32_16x16x32_bf16 v[160:163], v[24:27], v[88:91], v[160:163]
    ds_read_b64_tr_b16 v[20:21], v237 offset:24576
    v_add_f32 v35, v35, v43
    v_mfma_f32_16x16x32_bf16 v[164:167], v[24:27], v[92:95], v[164:167]
    ds_read_b64_tr_b16 v[22:23], v237 offset:28672
    v_exp_f32 v44, v60
    s_waitcnt lgkmcnt(4)
    v_mfma_f32_16x16x32_bf16 v[168:171], v[28:31], v[88:91], v[168:171]
    ds_read_b64_tr_b16 v[24:25], v238 offset:24576
    v_exp_f32 v45, v61
    v_mfma_f32_16x16x32_bf16 v[172:175], v[28:31], v[92:95], v[172:175]
    ds_read_b64_tr_b16 v[26:27], v238 offset:28672
    v_exp_f32 v46, v62
    s_waitcnt lgkmcnt(4)
    v_mfma_f32_16x16x32_bf16 v[176:179], v[16:19], v[88:91], v[176:179]
    ds_read_b64_tr_b16 v[28:29], v239 offset:24576
    v_exp_f32 v47, v63
    v_mfma_f32_16x16x32_bf16 v[180:183], v[16:19], v[92:95], v[180:183]
    ds_read_b64_tr_b16 v[30:31], v239 offset:28672
    v_add_f32 v35, v35, v44
    v_cvt_pk_bf16_f32 v86, v44, v45
    s_waitcnt lgkmcnt(4)
    v_mfma_f32_16x16x32_bf16 v[184:187], v[20:23], v[88:91], v[184:187]
    ds_read_b64 v[16:17], v208 offset:32768
    v_add_f32 v35, v35, v45
    v_cvt_pk_bf16_f32 v87, v46, v47
    v_mfma_f32_16x16x32_bf16 v[188:191], v[20:23], v[92:95], v[188:191]
    ds_read_b64 v[18:19], v209 offset:32768
    v_add_f32 v35, v35, v46
    v_add_f32 v35, v35, v47
    s_waitcnt lgkmcnt(4)
    v_mfma_f32_16x16x32_bf16 v[192:195], v[24:27], v[88:91], v[192:195]
    ds_read_b64 v[20:21], v210 offset:32768
    v_mfma_f32_16x16x32_bf16 v[196:199], v[24:27], v[92:95], v[196:199]
    ds_read_b64 v[22:23], v211 offset:32768
    s_waitcnt lgkmcnt(4)
    v_mfma_f32_16x16x32_bf16 v[200:203], v[28:31], v[88:91], v[200:203]
    ds_read_b64 v[24:25], v212 offset:32768
    v_mfma_f32_16x16x32_bf16 v[204:207], v[28:31], v[92:95], v[204:207]
    ds_read_b64 v[26:27], v213 offset:32768
    v_add_f32 v36, v34, v35
    v_cmp_ngt_f32 vcc, s52, v36
    s_cbranch_vccnz L_slow_8
L_back_8:
    v_add_f32 v32, v32, v34
    v_add_f32 v33, v33, v35
    s_setprio 1
    s_waitcnt lgkmcnt(4)
    v_mfma_f32_16x16x32_bf16 v[48:51], v[16:19], v[112:115], v[96:99]
    ds_read_b64 v[28:29], v214 offset:32768
    v_exp_f32 v40, v64
    v_mfma_f32_16x16x32_bf16 v[52:55], v[16:19], v[116:119], v[100:103]
    ds_read_b64 v[30:31], v215 offset:32768
    v_exp_f32 v41, v65
    s_waitcnt lgkmcnt(4)
    v_mfma_f32_16x16x32_bf16 v[48:51], v[20:23], v[120:123], v[48:51]
    ds_read_b64 v[16:17], v208 offset:36864
    v_exp_f32 v42, v66
    v_mfma_f32_16x16x32_bf16 v[52:55], v[20:23], v[124:127], v[52:55]
    ds_read_b64 v[18:19], v209 offset:36864
    v_exp_f32 v43, v67
    s_waitcnt lgkmcnt(4)
    v_mfma_f32_16x16x32_bf16 v[48:51], v[24:27], v[128:131], v[48:51]
    ds_read_b64 v[20:21], v210 offset:36864
    v_add_f32 v34, v40, v41
    v_cvt_pk_bf16_f32 v88, v40, v41
    v_mfma_f32_16x16x32_bf16 v[52:55], v[24:27], v[132:135], v[52:55]
    ds_read_b64 v[22:23], v211 offset:36864
    v_add_f32 v34, v34, v42
    v_cvt_pk_bf16_f32 v89, v42, v43
    s_waitcnt lgkmcnt(4)
    v_mfma_f32_16x16x32_bf16 v[48:51], v[28:31], v[136:139], v[48:51]
    ds_read_b64 v[24:25], v212 offset:36864
    v_add_f32 v34, v34, v43
    v_mfma_f32_16x16x32_bf16 v[52:55], v[28:31], v[140:143], v[52:55]
    ds_read_b64 v[26:27], v213 offset:36864
    v_exp_f32 v44, v72
    s_mul_i32 s51, s33, 576
    s_mov_b32 s92, s42
    s_mov_b32 s93, s43
    s_mov_b32 s94, 0x510000
    s_add_u32 s92, s92, s51
    s_addc_u32 s93, s93, 0
    s_sub_u32 s94, s94, s51
    s_mov_b32 s95, 0x00020000
    s_sub_u32 s50, s34, 0
    s_lshl_b32 s50, s50, 3
    s_add_u32 s50, s50, s32
    s_mul_i32 s50, s50, 9
    s_add_u32 s50, s50, 3456
    v_add_u32 v246, s50, v7
    v_lshrrev_b32 v247, 3, v246
    s_mov_b32 s50, 9216
    v_mul_lo_u32 v247, v247, s50
    v_and_b32 v246, 7, v246
    v_lshl_add_u32 v247, v246, 7, v247
    v_cmp_gt_u32 vcc, 9, v7
    v_cmp_gt_u32 s[50:51], 5, v246
    s_nop 0
    s_and_b64 vcc, vcc, s[50:51]
    v_cndmask_b32 v247, -16, v247, vcc
    s_waitcnt vmcnt(8)
    buffer_load_dword v242, v247, s[92:95], 0 offen
    s_waitcnt lgkmcnt(4)
    v_mfma_f32_16x16x32_bf16 v[56:59], v[16:19], v[112:115], v[96:99]
    ds_read_b64 v[28:29], v214 offset:36864
    v_exp_f32 v45, v73
    v_mfma_f32_16x16x32_bf16 v[60:63], v[16:19], v[116:119], v[100:103]
    ds_read_b64 v[30:31], v215 offset:36864
    v_exp_f32 v46, v74
    s_waitcnt lgkmcnt(4)
    v_mfma_f32_16x16x32_bf16 v[56:59], v[20:23], v[120:123], v[56:59]
    ds_read_b64_tr_b16 v[16:17], v232 offset:40960
    v_exp_f32 v47, v75
    v_mfma_f32_16x16x32_bf16 v[60:63], v[20:23], v[124:127], v[60:63]
    ds_read_b64_tr_b16 v[18:19], v232 offset:45056
    v_add_f32 v34, v34, v44
    v_cvt_pk_bf16_f32 v90, v44, v45
    s_waitcnt lgkmcnt(4)
    v_mfma_f32_16x16x32_bf16 v[56:59], v[24:27], v[128:131], v[56:59]
    ds_read_b64_tr_b16 v[20:21], v233 offset:40960
    v_add_f32 v34, v34, v45
    v_cvt_pk_bf16_f32 v91, v46, v47
    v_mfma_f32_16x16x32_bf16 v[60:63], v[24:27], v[132:135], v[60:63]
    ds_read_b64_tr_b16 v[22:23], v233 offset:45056
    v_add_f32 v34, v34, v46
    v_add_f32 v34, v34, v47
    s_waitcnt lgkmcnt(4)
    v_mfma_f32_16x16x32_bf16 v[56:59], v[28:31], v[136:139], v[56:59]
    ds_read_b64_tr_b16 v[24:25], v234 offset:40960
    v_exp_f32 v40, v68
    v_mfma_f32_16x16x32_bf16 v[60:63], v[28:31], v[140:143], v[60:63]
    ds_read_b64_tr_b16 v[26:27], v234 offset:45056
    v_exp_f32 v41, v69
    s_setprio 0
    s_waitcnt lgkmcnt(4)
    v_mfma_f32_16x16x32_bf16 v[144:147], v[16:19], v[80:83], v[144:147]
    ds_read_b64_tr_b16 v[28:29], v235 offset:40960
    v_exp_f32 v42, v70
    v_mfma_f32_16x16x32_bf16 v[148:151], v[16:19], v[84:87], v[148:151]
    ds_read_b64_tr_b16 v[30:31], v235 offset:45056
    v_exp_f32 v43, v71
    s_waitcnt lgkmcnt(4)
    v_mfma_f32_16x16x32_bf16 v[152:155], v[20:23], v[80:83], v[152:155]
    ds_read_b64_tr_b16 v[16:17], v236 offset:40960
    v_add_f32 v35, v40, v41
    v_cvt_pk_bf16_f32 v92, v40, v41
    v_mfma_f32_16x16x32_bf16 v[156:159], v[20:23], v[84:87], v[156:159]
    ds_read_b64_tr_b16 v[18:19], v236 offset:45056
    v_add_f32 v35, v35, v42
    v_cvt_pk_bf16_f32 v93, v42, v43
    s_waitcnt lgkmcnt(4)
    v_mfma_f32_16x16x32_bf16 v[160:163], v[24:27], v[80:83], v[160:163]
    ds_read_b64_tr_b16 v[20:21], v237 offset:40960
    v_add_f32 v35, v35, v43
    v_mfma_f32_16x16x32_bf16 v[164:167], v[24:27], v[84:87], v[164:167]
    ds_read_b64_tr_b16 v[22:23], v237 offset:45056
    v_exp_f32 v44, v76
    s_waitcnt lgkmcnt(4)
    v_mfma_f32_16x16x32_bf16 v[168:171], v[28:31], v[80:83], v[168:171]
    ds_read_b64_tr_b16 v[24:25], v238 offset:40960
    v_exp_f32 v45, v77
    v_mfma_f32_16x16x32_bf16 v[172:175], v[28:31], v[84:87], v[172:175]
    ds_read_b64_tr_b16 v[26:27], v238 offset:45056
    v_exp_f32 v46, v78
    s_waitcnt lgkmcnt(4)
    v_mfma_f32_16x16x32_bf16 v[176:179], v[16:19], v[80:83], v[176:179]
    ds_read_b64_tr_b16 v[28:29], v239 offset:40960
    v_exp_f32 v47, v79
    v_mfma_f32_16x16x32_bf16 v[180:183], v[16:19], v[84:87], v[180:183]
    ds_read_b64_tr_b16 v[30:31], v239 offset:45056
    v_add_f32 v35, v35, v44
    v_cvt_pk_bf16_f32 v94, v44, v45
    s_waitcnt lgkmcnt(4)
    v_mfma_f32_16x16x32_bf16 v[184:187], v[20:23], v[80:83], v[184:187]
    ds_read_b64 v[16:17], v208 offset:49152
    v_add_f32 v35, v35, v45
    v_cvt_pk_bf16_f32 v95, v46, v47
    v_mfma_f32_16x16x32_bf16 v[188:191], v[20:23], v[84:87], v[188:191]
    ds_read_b64 v[18:19], v209 offset:49152
    v_add_f32 v35, v35, v46
    v_add_f32 v35, v35, v47
    s_waitcnt lgkmcnt(4)
    v_mfma_f32_16x16x32_bf16 v[192:195], v[24:27], v[80:83], v[192:195]
    ds_read_b64 v[20:21], v210 offset:49152
    v_mfma_f32_16x16x32_bf16 v[196:199], v[24:27], v[84:87], v[196:199]
    ds_read_b64 v[22:23], v211 offset:49152
    s_waitcnt lgkmcnt(4)
    v_mfma_f32_16x16x32_bf16 v[200:203], v[28:31], v[80:83], v[200:203]
    ds_read_b64 v[24:25], v212 offset:49152
    v_mfma_f32_16x16x32_bf16 v[204:207], v[28:31], v[84:87], v[204:207]
    ds_read_b64 v[26:27], v213 offset:49152
    v_add_f32 v36, v34, v35
    v_cmp_ngt_f32 vcc, s52, v36
    s_cbranch_vccnz L_slow_9
L_back_9:
    v_add_f32 v32, v32, v34
    v_add_f32 v33, v33, v35
    s_setprio 3
    s_barrier
    s_waitcnt lgkmcnt(4)
    v_mfma_f32_16x16x32_bf16 v[64:67], v[16:19], v[112:115], v[96:99]
    ds_read_b64 v[28:29], v214 offset:49152
    v_exp_f32 v40, v48
    v_mfma_f32_16x16x32_bf16 v[68:71], v[16:19], v[116:119], v[100:103]
    ds_read_b64 v[30:31], v215 offset:49152
    v_exp_f32 v41, v49
    s_waitcnt lgkmcnt(4)
    v_mfma_f32_16x16x32_bf16 v[64:67], v[20:23], v[120:123], v[64:67]
    ds_read_b64 v[16:17], v208 offset:53248
    v_exp_f32 v42, v50
    v_mfma_f32_16x16x32_bf16 v[68:71], v[20:23], v[124:127], v[68:71]
    ds_read_b64 v[18:19], v209 offset:53248
    v_exp_f32 v43, v51
    s_waitcnt lgkmcnt(4)
    v_mfma_f32_16x16x32_bf16 v[64:67], v[24:27], v[128:131], v[64:67]
    ds_read_b64 v[20:21], v210 offset:53248
    v_add_f32 v34, v40, v41
    v_cvt_pk_bf16_f32 v80, v40, v41
    v_mfma_f32_16x16x32_bf16 v[68:71], v[24:27], v[132:135], v[68:71]
    ds_read_b64 v[22:23], v211 offset:53248
    v_add_f32 v34, v34, v42
    v_cvt_pk_bf16_f32 v81, v42, v43
    s_waitcnt lgkmcnt(4)
    v_mfma_f32_16x16x32_bf16 v[64:67], v[28:31], v[136:139], v[64:67]
    ds_read_b64 v[24:25], v212 offset:53248
    v_add_f32 v34, v34, v43
    v_mfma_f32_16x16x32_bf16 v[68:71], v[28:31], v[140:143], v[68:71]
    ds_read_b64 v[26:27], v213 offset:53248
    v_exp_f32 v44, v56
    s_waitcnt lgkmcnt(4)
    v_mfma_f32_16x16x32_bf16 v[72:75], v[16:19], v[112:115], v[96:99]
    ds_read_b64 v[28:29], v214 offset:53248
    v_exp_f32 v45, v57
    v_mfma_f32_16x16x32_bf16 v[76:79], v[16:19], v[116:119], v[100:103]
    ds_read_b64 v[30:31], v215 offset:53248
    v_exp_f32 v46, v58
    s_waitcnt lgkmcnt(4)
    v_mfma_f32_16x16x32_bf16 v[72:75], v[20:23], v[120:123], v[72:75]
    ds_read_b64_tr_b16 v[16:17], v232 offset:57344
    v_exp_f32 v47, v59
    v_mfma_f32_16x16x32_bf16 v[76:79], v[20:23], v[124:127], v[76:79]
    ds_read_b64_tr_b16 v[18:19], v232 offset:61440
    v_add_f32 v34, v34, v44
    v_cvt_pk_bf16_f32 v82, v44, v45
    s_waitcnt lgkmcnt(4)
    v_mfma_f32_16x16x32_bf16 v[72:75], v[24:27], v[128:131], v[72:75]
    ds_read_b64_tr_b16 v[20:21], v233 offset:57344
    v_add_f32 v34, v34, v45
    v_cvt_pk_bf16_f32 v83, v46, v47
    v_mfma_f32_16x16x32_bf16 v[76:79], v[24:27], v[132:135], v[76:79]
    ds_read_b64_tr_b16 v[22:23], v233 offset:61440
    v_add_f32 v34, v34, v46
    v_add_f32 v34, v34, v47
    s_waitcnt lgkmcnt(4)
    v_mfma_f32_16x16x32_bf16 v[72:75], v[28:31], v[136:139], v[72:75]
    ds_read_b64_tr_b16 v[24:25], v234 offset:57344
    v_exp_f32 v40, v52
    v_mfma_f32_16x16x32_bf16 v[76:79], v[28:31], v[140:143], v[76:79]
    ds_read_b64_tr_b16 v[26:27], v234 offset:61440
    v_exp_f32 v41, v53
    s_setprio 2
    s_waitcnt lgkmcnt(4)
    v_mfma_f32_16x16x32_bf16 v[144:147], v[16:19], v[88:91], v[144:147]
    ds_read_b64_tr_b16 v[28:29], v235 offset:57344
    v_exp_f32 v42, v54
    v_mfma_f32_16x16x32_bf16 v[148:151], v[16:19], v[92:95], v[148:151]
    ds_read_b64_tr_b16 v[30:31], v235 offset:61440
    v_exp_f32 v43, v55
    s_mul_i32 s51, s33, 331776
    s_mov_b32 s92, s44
    s_mov_b32 s93, s45
    s_mov_b32 s94, 0x510000
    s_add_u32 s92, s92, s51
    s_addc_u32 s93, s93, 0
    s_sub_u32 s94, s94, s51
    s_mov_b32 s95, 0x00020000
    s_sub_u32 s50, s34, 0
    s_lshl_b32 s50, s50, 3
    s_add_u32 s50, s50, s32
    s_mul_i32 s50, s50, 11
    v_add_u32 v246, s50, v7
    v_lshlrev_b32 v247, 7, v246
    v_cmp_gt_u32 vcc, 11, v7
    s_nop 1
    v_cndmask_b32 v247, -16, v247, vcc
    s_waitcnt vmcnt(8)
    buffer_load_dword v243, v247, s[92:95], 0 offen
    s_waitcnt lgkmcnt(4)
    v_mfma_f32_16x16x32_bf16 v[152:155], v[20:23], v[88:91], v[152:155]
    ds_read_b64_tr_b16 v[16:17], v236 offset:57344
    v_add_f32 v35, v40, v41
    v_cvt_pk_bf16_f32 v84, v40, v41
    v_mfma_f32_16x16x32_bf16 v[156:159], v[20:23], v[92:95], v[156:159]
    ds_read_b64_tr_b16 v[18:19], v236 offset:61440
    v_add_f32 v35, v35, v42
    v_cvt_pk_bf16_f32 v85, v42, v43
    s_waitcnt lgkmcnt(4)
    v_mfma_f32_16x16x32_bf16 v[160:163], v[24:27], v[88:91], v[160:163]
    ds_read_b64_tr_b16 v[20:21], v237 offset:57344
    v_add_f32 v35, v35, v43
    v_mfma_f32_16x16x32_bf16 v[164:167], v[24:27], v[92:95], v[164:167]
    ds_read_b64_tr_b16 v[22:23], v237 offset:61440
    v_exp_f32 v44, v60
    s_waitcnt lgkmcnt(4)
    v_mfma_f32_16x16x32_bf16 v[168:171], v[28:31], v[88:91], v[168:171]
    ds_read_b64_tr_b16 v[24:25], v238 offset:57344
    v_exp_f32 v45, v61
    v_mfma_f32_16x16x32_bf16 v[172:175], v[28:31], v[92:95], v[172:175]
    ds_read_b64_tr_b16 v[26:27], v238 offset:61440
    v_exp_f32 v46, v62
    s_waitcnt lgkmcnt(4)
    v_mfma_f32_16x16x32_bf16 v[176:179], v[16:19], v[88:91], v[176:179]
    ds_read_b64_tr_b16 v[28:29], v239 offset:57344
    v_exp_f32 v47, v63
    v_mfma_f32_16x16x32_bf16 v[180:183], v[16:19], v[92:95], v[180:183]
    ds_read_b64_tr_b16 v[30:31], v239 offset:61440
    v_add_f32 v35, v35, v44
    v_cvt_pk_bf16_f32 v86, v44, v45
    s_waitcnt lgkmcnt(4)
    v_mfma_f32_16x16x32_bf16 v[184:187], v[20:23], v[88:91], v[184:187]
    v_add_u32 v208, 0x10000, v208
    ds_read_b64 v[16:17], v208 offset:0
    v_add_f32 v35, v35, v45
    v_cvt_pk_bf16_f32 v87, v46, v47
    v_mfma_f32_16x16x32_bf16 v[188:191], v[20:23], v[92:95], v[188:191]
    v_add_u32 v209, 0x10000, v209
    ds_read_b64 v[18:19], v209 offset:0
    v_add_f32 v35, v35, v46
    v_add_f32 v35, v35, v47
    s_waitcnt lgkmcnt(4)
    v_mfma_f32_16x16x32_bf16 v[192:195], v[24:27], v[88:91], v[192:195]
    v_add_u32 v210, 0x10000, v210
    ds_read_b64 v[20:21], v210 offset:0
    v_mfma_f32_16x16x32_bf16 v[196:199], v[24:27], v[92:95], v[196:199]
    v_add_u32 v211, 0x10000, v211
    ds_read_b64 v[22:23], v211 offset:0
    s_waitcnt lgkmcnt(4)
    v_mfma_f32_16x16x32_bf16 v[200:203], v[28:31], v[88:91], v[200:203]
    v_add_u32 v212, 0x10000, v212
    ds_read_b64 v[24:25], v212 offset:0
    v_mfma_f32_16x16x32_bf16 v[204:207], v[28:31], v[92:95], v[204:207]
    v_add_u32 v213, 0x10000, v213
    ds_read_b64 v[26:27], v213 offset:0
    v_add_f32 v36, v34, v35
    v_cmp_ngt_f32 vcc, s52, v36
    s_cbranch_vccnz L_slow_10
L_back_10:
    v_add_f32 v32, v32, v34
    v_add_f32 v33, v33, v35
    s_setprio 1
    s_waitcnt lgkmcnt(4)
    v_mfma_f32_16x16x32_bf16 v[48:51], v[16:19], v[112:115], v[96:99]
    v_add_u32 v214, 0x10000, v214
    ds_read_b64 v[28:29], v214 offset:0
    v_exp_f32 v40, v64
    v_mfma_f32_16x16x32_bf16 v[52:55], v[16:19], v[116:119], v[100:103]
    v_add_u32 v215, 0x10000, v215
    ds_read_b64 v[30:31], v215 offset:0
    v_exp_f32 v41, v65
    s_waitcnt lgkmcnt(4)
    v_mfma_f32_16x16x32_bf16 v[48:51], v[20:23], v[120:123], v[48:51]
    ds_read_b64 v[16:17], v208 offset:4096
    v_exp_f32 v42, v66
    v_mfma_f32_16x16x32_bf16 v[52:55], v[20:23], v[124:127], v[52:55]
    ds_read_b64 v[18:19], v209 offset:4096
    v_exp_f32 v43, v67
    s_waitcnt lgkmcnt(4)
    v_mfma_f32_16x16x32_bf16 v[48:51], v[24:27], v[128:131], v[48:51]
    ds_read_b64 v[20:21], v210 offset:4096
    v_add_f32 v34, v40, v41
    v_cvt_pk_bf16_f32 v88, v40, v41
    v_mfma_f32_16x16x32_bf16 v[52:55], v[24:27], v[132:135], v[52:55]
    ds_read_b64 v[22:23], v211 offset:4096
    v_add_f32 v34, v34, v42
    v_cvt_pk_bf16_f32 v89, v42, v43
    s_waitcnt lgkmcnt(4)
    v_mfma_f32_16x16x32_bf16 v[48:51], v[28:31], v[136:139], v[48:51]
    ds_read_b64 v[24:25], v212 offset:4096
    v_add_f32 v34, v34, v43
    v_mfma_f32_16x16x32_bf16 v[52:55], v[28:31], v[140:143], v[52:55]
    ds_read_b64 v[26:27], v213 offset:4096
    v_exp_f32 v44, v72
    s_mul_i32 s51, s33, 331776
    s_mov_b32 s92, s44
    s_mov_b32 s93, s45
    s_mov_b32 s94, 0x510000
    s_add_u32 s92, s92, s51
    s_addc_u32 s93, s93, 0
    s_sub_u32 s94, s94, s51
    s_mov_b32 s95, 0x00020000
    s_sub_u32 s50, s34, 0
    s_lshl_b32 s50, s50, 3
    s_add_u32 s50, s50, s32
    s_mul_i32 s50, s50, 11
    s_add_u32 s50, s50, 1408
    v_add_u32 v246, s50, v7
    v_lshlrev_b32 v247, 7, v246
    v_cmp_gt_u32 vcc, 11, v7
    s_nop 1
    v_cndmask_b32 v247, -16, v247, vcc
    s_waitcnt vmcnt(4)
    buffer_load_dword v244, v247, s[92:95], 0 offen
    s_waitcnt lgkmcnt(4)
    v_mfma_f32_16x16x32_bf16 v[56:59], v[16:19], v[112:115], v[96:99]
    ds_read_b64 v[28:29], v214 offset:4096
    v_exp_f32 v45, v73
    v_mfma_f32_16x16x32_bf16 v[60:63], v[16:19], v[116:119], v[100:103]
    ds_read_b64 v[30:31], v215 offset:4096
    v_exp_f32 v46, v74
    s_waitcnt lgkmcnt(4)
    v_mfma_f32_16x16x32_bf16 v[56:59], v[20:23], v[120:123], v[56:59]
    v_add_u32 v232, 0x10000, v232
    ds_read_b64_tr_b16 v[16:17], v232 offset:8192
    v_exp_f32 v47, v75
    v_mfma_f32_16x16x32_bf16 v[60:63], v[20:23], v[124:127], v[60:63]
    ds_read_b64_tr_b16 v[18:19], v232 offset:12288
    v_add_f32 v34, v34, v44
    v_cvt_pk_bf16_f32 v90, v44, v45
    s_waitcnt lgkmcnt(4)
    v_mfma_f32_16x16x32_bf16 v[56:59], v[24:27], v[128:131], v[56:59]
    v_add_u32 v233, 0x10000, v233
    ds_read_b64_tr_b16 v[20:21], v233 offset:8192
    v_add_f32 v34, v34, v45
    v_cvt_pk_bf16_f32 v91, v46, v47
    v_mfma_f32_16x16x32_bf16 v[60:63], v[24:27], v[132:135], v[60:63]
    ds_read_b64_tr_b16 v[22:23], v233 offset:12288
    v_add_f32 v34, v34, v46
    v_add_f32 v34, v34, v47
    s_waitcnt lgkmcnt(4)
    v_mfma_f32_16x16x32_bf16 v[56:59], v[28:31], v[136:139], v[56:59]
    v_add_u32 v234, 0x10000, v234
    ds_read_b64_tr_b16 v[24:25], v234 offset:8192
    v_exp_f32 v40, v68
    v_mfma_f32_16x16x32_bf16 v[60:63], v[28:31], v[140:143], v[60:63]
    ds_read_b64_tr_b16 v[26:27], v234 offset:12288
    v_exp_f32 v41, v69
    s_setprio 0
    s_waitcnt lgkmcnt(4)
    v_mfma_f32_16x16x32_bf16 v[144:147], v[16:19], v[80:83], v[144:147]
    v_add_u32 v235, 0x10000, v235
    ds_read_b64_tr_b16 v[28:29], v235 offset:8192
    v_exp_f32 v42, v70
    v_mfma_f32_16x16x32_bf16 v[148:151], v[16:19], v[84:87], v[148:151]
    ds_read_b64_tr_b16 v[30:31], v235 offset:12288
    v_exp_f32 v43, v71
    s_waitcnt lgkmcnt(4)
    v_mfma_f32_16x16x32_bf16 v[152:155], v[20:23], v[80:83], v[152:155]
    v_add_u32 v236, 0x10000, v236
    ds_read_b64_tr_b16 v[16:17], v236 offset:8192
    v_add_f32 v35, v40, v41
    v_cvt_pk_bf16_f32 v92, v40, v41
    v_mfma_f32_16x16x32_bf16 v[156:159], v[20:23], v[84:87], v[156:159]
    ds_read_b64_tr_b16 v[18:19], v236 offset:12288
    v_add_f32 v35, v35, v42
    v_cvt_pk_bf16_f32 v93, v42, v43
    s_waitcnt lgkmcnt(4)
    v_mfma_f32_16x16x32_bf16 v[160:163], v[24:27], v[80:83], v[160:163]
    v_add_u32 v237, 0x10000, v237
    ds_read_b64_tr_b16 v[20:21], v237 offset:8192
    v_add_f32 v35, v35, v43
    v_mfma_f32_16x16x32_bf16 v[164:167], v[24:27], v[84:87], v[164:167]
    ds_read_b64_tr_b16 v[22:23], v237 offset:12288
    v_exp_f32 v44, v76
    s_waitcnt lgkmcnt(4)
    v_mfma_f32_16x16x32_bf16 v[168:171], v[28:31], v[80:83], v[168:171]
    v_add_u32 v238, 0x10000, v238
    ds_read_b64_tr_b16 v[24:25], v238 offset:8192
    v_exp_f32 v45, v77
    v_mfma_f32_16x16x32_bf16 v[172:175], v[28:31], v[84:87], v[172:175]
    ds_read_b64_tr_b16 v[26:27], v238 offset:12288
    v_exp_f32 v46, v78
    s_waitcnt lgkmcnt(4)
    v_mfma_f32_16x16x32_bf16 v[176:179], v[16:19], v[80:83], v[176:179]
    v_add_u32 v239, 0x10000, v239
    ds_read_b64_tr_b16 v[28:29], v239 offset:8192
    v_exp_f32 v47, v79
    v_mfma_f32_16x16x32_bf16 v[180:183], v[16:19], v[84:87], v[180:183]
    ds_read_b64_tr_b16 v[30:31], v239 offset:12288
    v_add_f32 v35, v35, v44
    v_cvt_pk_bf16_f32 v94, v44, v45
    s_waitcnt lgkmcnt(4)
    v_mfma_f32_16x16x32_bf16 v[184:187], v[20:23], v[80:83], v[184:187]
    ds_read_b64 v[16:17], v208 offset:16384
    v_add_f32 v35, v35, v45
    v_cvt_pk_bf16_f32 v95, v46, v47
    v_mfma_f32_16x16x32_bf16 v[188:191], v[20:23], v[84:87], v[188:191]
    ds_read_b64 v[18:19], v209 offset:16384
    v_add_f32 v35, v35, v46
    v_add_f32 v35, v35, v47
    s_waitcnt lgkmcnt(4)
    v_mfma_f32_16x16x32_bf16 v[192:195], v[24:27], v[80:83], v[192:195]
    ds_read_b64 v[20:21], v210 offset:16384
    v_mfma_f32_16x16x32_bf16 v[196:199], v[24:27], v[84:87], v[196:199]
    ds_read_b64 v[22:23], v211 offset:16384
    s_waitcnt lgkmcnt(4)
    v_mfma_f32_16x16x32_bf16 v[200:203], v[28:31], v[80:83], v[200:203]
    ds_read_b64 v[24:25], v212 offset:16384
    v_mfma_f32_16x16x32_bf16 v[204:207], v[28:31], v[84:87], v[204:207]
    ds_read_b64 v[26:27], v213 offset:16384
    v_add_f32 v36, v34, v35
    v_cmp_ngt_f32 vcc, s52, v36
    s_cbranch_vccnz L_slow_11
L_back_11:
    v_add_f32 v32, v32, v34
    v_add_f32 v33, v33, v35
    s_setprio 3
    s_barrier
    s_waitcnt lgkmcnt(4)
    v_mfma_f32_16x16x32_bf16 v[64:67], v[16:19], v[112:115], v[96:99]
    ds_read_b64 v[28:29], v214 offset:16384
    v_exp_f32 v40, v48
    v_mfma_f32_16x16x32_bf16 v[68:71], v[16:19], v[116:119], v[100:103]
    ds_read_b64 v[30:31], v215 offset:16384
    v_exp_f32 v41, v49
    s_add_u32 m0, s39, 0x20000
    s_mov_b32 s59, 0x0
    buffer_load_dwordx4 v5, s[20:23], s59 offen lds
    s_waitcnt lgkmcnt(4)
    v_mfma_f32_16x16x32_bf16 v[64:67], v[20:23], v[120:123], v[64:67]
    ds_read_b64 v[16:17], v208 offset:20480
    v_exp_f32 v42, v50
    v_mfma_f32_16x16x32_bf16 v[68:71], v[20:23], v[124:127], v[68:71]
    ds_read_b64 v[18:19], v209 offset:20480
    v_exp_f32 v43, v51
    s_waitcnt lgkmcnt(4)
    v_mfma_f32_16x16x32_bf16 v[64:67], v[24:27], v[128:131], v[64:67]
    ds_read_b64 v[20:21], v210 offset:20480
    v_add_f32 v34, v40, v41
    v_cvt_pk_bf16_f32 v80, v40, v41
    v_mfma_f32_16x16x32_bf16 v[68:71], v[24:27], v[132:135], v[68:71]
    ds_read_b64 v[22:23], v211 offset:20480
    v_add_f32 v34, v34, v42
    v_cvt_pk_bf16_f32 v81, v42, v43
    s_add_u32 m0, s39, 0x22000
    s_mov_b32 s60, 0x9000
    buffer_load_dwordx4 v5, s[20:23], s60 offen lds
    s_waitcnt lgkmcnt(4)
    v_mfma_f32_16x16x32_bf16 v[64:67], v[28:31], v[136:139], v[64:67]
    ds_read_b64 v[24:25], v212 offset:20480
    v_add_f32 v34, v34, v43
    v_mfma_f32_16x16x32_bf16 v[68:71], v[28:31], v[140:143], v[68:71]
    ds_read_b64 v[26:27], v213 offset:20480
    v_exp_f32 v44, v56
    s_waitcnt lgkmcnt(4)
    v_mfma_f32_16x16x32_bf16 v[72:75], v[16:19], v[112:115], v[96:99]
    ds_read_b64 v[28:29], v214 offset:20480
    v_exp_f32 v45, v57
    v_mfma_f32_16x16x32_bf16 v[76:79], v[16:19], v[116:119], v[100:103]
    ds_read_b64 v[30:31], v215 offset:20480
    v_exp_f32 v46, v58
    s_add_u32 m0, s39, 0x1c000
    s_mov_b32 s61, 0x24200
    buffer_load_dwordx4 v5, s[20:23], s61 offen lds
    s_waitcnt lgkmcnt(4)
    v_mfma_f32_16x16x32_bf16 v[72:75], v[20:23], v[120:123], v[72:75]
    ds_read_b64_tr_b16 v[16:17], v232 offset:24576
    v_exp_f32 v47, v59
    v_mfma_f32_16x16x32_bf16 v[76:79], v[20:23], v[124:127], v[76:79]
    ds_read_b64_tr_b16 v[18:19], v232 offset:28672
    v_add_f32 v34, v34, v44
    v_cvt_pk_bf16_f32 v82, v44, v45
    s_waitcnt lgkmcnt(4)
    v_mfma_f32_16x16x32_bf16 v[72:75], v[24:27], v[128:131], v[72:75]
    ds_read_b64_tr_b16 v[20:21], v233 offset:24576
    v_add_f32 v34, v34, v45
    v_cvt_pk_bf16_f32 v83, v46, v47
    v_mfma_f32_16x16x32_bf16 v[76:79], v[24:27], v[132:135], v[76:79]
    ds_read_b64_tr_b16 v[22:23], v233 offset:28672
    v_add_f32 v34, v34, v46
    v_add_f32 v34, v34, v47
    s_add_u32 m0, s39, 0x1e000
    s_mov_b32 s62, 0x2d200
    buffer_load_dwordx4 v5, s[20:23], s62 offen lds
    s_waitcnt lgkmcnt(4)
    v_mfma_f32_16x16x32_bf16 v[72:75], v[28:31], v[136:139], v[72:75]
    ds_read_b64_tr_b16 v[24:25], v234 offset:24576
    v_exp_f32 v40, v52
    v_mfma_f32_16x16x32_bf16 v[76:79], v[28:31], v[140:143], v[76:79]
    ds_read_b64_tr_b16 v[26:27], v234 offset:28672
    v_exp_f32 v41, v53
    s_setprio 2
    s_waitcnt lgkmcnt(4)
    v_mfma_f32_16x16x32_bf16 v[144:147], v[16:19], v[88:91], v[144:147]
    ds_read_b64_tr_b16 v[28:29], v235 offset:24576
    v_exp_f32 v42, v54
    v_mfma_f32_16x16x32_bf16 v[148:151], v[16:19], v[92:95], v[148:151]
    ds_read_b64_tr_b16 v[30:31], v235 offset:28672
    v_exp_f32 v43, v55
    s_waitcnt lgkmcnt(4)
    v_mfma_f32_16x16x32_bf16 v[152:155], v[20:23], v[88:91], v[152:155]
    ds_read_b64_tr_b16 v[16:17], v236 offset:24576
    v_add_f32 v35, v40, v41
    v_cvt_pk_bf16_f32 v84, v40, v41
    v_mfma_f32_16x16x32_bf16 v[156:159], v[20:23], v[92:95], v[156:159]
    ds_read_b64_tr_b16 v[18:19], v236 offset:28672
    v_add_f32 v35, v35, v42
    v_cvt_pk_bf16_f32 v85, v42, v43
    s_waitcnt lgkmcnt(4)
    v_mfma_f32_16x16x32_bf16 v[160:163], v[24:27], v[88:91], v[160:163]
    ds_read_b64_tr_b16 v[20:21], v237 offset:24576
    v_add_f32 v35, v35, v43
    v_mfma_f32_16x16x32_bf16 v[164:167], v[24:27], v[92:95], v[164:167]
    ds_read_b64_tr_b16 v[22:23], v237 offset:28672
    v_exp_f32 v44, v60
    s_waitcnt lgkmcnt(4)
    v_mfma_f32_16x16x32_bf16 v[168:171], v[28:31], v[88:91], v[168:171]
    ds_read_b64_tr_b16 v[24:25], v238 offset:24576
    v_exp_f32 v45, v61
    v_mfma_f32_16x16x32_bf16 v[172:175], v[28:31], v[92:95], v[172:175]
    ds_read_b64_tr_b16 v[26:27], v238 offset:28672
    v_exp_f32 v46, v62
    s_waitcnt lgkmcnt(4)
    v_mfma_f32_16x16x32_bf16 v[176:179], v[16:19], v[88:91], v[176:179]
    ds_read_b64_tr_b16 v[28:29], v239 offset:24576
    v_exp_f32 v47, v63
    v_mfma_f32_16x16x32_bf16 v[180:183], v[16:19], v[92:95], v[180:183]
    ds_read_b64_tr_b16 v[30:31], v239 offset:28672
    v_add_f32 v35, v35, v44
    v_cvt_pk_bf16_f32 v86, v44, v45
    s_waitcnt lgkmcnt(4)
    v_mfma_f32_16x16x32_bf16 v[184:187], v[20:23], v[88:91], v[184:187]
    v_subrev_u32 v208, 0x20000, v208
    ds_read_b64 v[16:17], v208 offset:0
    v_add_f32 v35, v35, v45
    v_cvt_pk_bf16_f32 v87, v46, v47
    v_mfma_f32_16x16x32_bf16 v[188:191], v[20:23], v[92:95], v[188:191]
    v_subrev_u32 v209, 0x20000, v209
    ds_read_b64 v[18:19], v209 offset:0
    v_add_f32 v35, v35, v46
    v_add_f32 v35, v35, v47
    s_waitcnt lgkmcnt(4)
    v_mfma_f32_16x16x32_bf16 v[192:195], v[24:27], v[88:91], v[192:195]
    v_subrev_u32 v210, 0x20000, v210
    ds_read_b64 v[20:21], v210 offset:0
    v_mfma_f32_16x16x32_bf16 v[196:199], v[24:27], v[92:95], v[196:199]
    v_subrev_u32 v211, 0x20000, v211
    ds_read_b64 v[22:23], v211 offset:0
    s_waitcnt lgkmcnt(4)
    v_mfma_f32_16x16x32_bf16 v[200:203], v[28:31], v[88:91], v[200:203]
    v_subrev_u32 v212, 0x20000, v212
    ds_read_b64 v[24:25], v212 offset:0
    v_mfma_f32_16x16x32_bf16 v[204:207], v[28:31], v[92:95], v[204:207]
    v_subrev_u32 v213, 0x20000, v213
    ds_read_b64 v[26:27], v213 offset:0
    v_add_f32 v36, v34, v35
    v_cmp_ngt_f32 vcc, s52, v36
    s_cbranch_vccnz L_slow_12
L_back_12:
    v_add_f32 v32, v32, v34
    v_add_f32 v33, v33, v35
    s_setprio 1
    s_waitcnt lgkmcnt(4)
    v_mfma_f32_16x16x32_bf16 v[48:51], v[16:19], v[112:115], v[96:99]
    v_subrev_u32 v214, 0x20000, v214
    ds_read_b64 v[28:29], v214 offset:0
    v_exp_f32 v40, v64
    v_mfma_f32_16x16x32_bf16 v[52:55], v[16:19], v[116:119], v[100:103]
    v_subrev_u32 v215, 0x20000, v215
    ds_read_b64 v[30:31], v215 offset:0
    v_exp_f32 v41, v65
    s_waitcnt lgkmcnt(4)
    v_mfma_f32_16x16x32_bf16 v[48:51], v[20:23], v[120:123], v[48:51]
    ds_read_b64 v[16:17], v208 offset:4096
    v_exp_f32 v42, v66
    v_mfma_f32_16x16x32_bf16 v[52:55], v[20:23], v[124:127], v[52:55]
    ds_read_b64 v[18:19], v209 offset:4096
    v_exp_f32 v43, v67
    s_waitcnt lgkmcnt(4)
    v_mfma_f32_16x16x32_bf16 v[48:51], v[24:27], v[128:131], v[48:51]
    ds_read_b64 v[20:21], v210 offset:4096
    v_add_f32 v34, v40, v41
    v_cvt_pk_bf16_f32 v88, v40, v41
    v_mfma_f32_16x16x32_bf16 v[52:55], v[24:27], v[132:135], v[52:55]
    ds_read_b64 v[22:23], v211 offset:4096
    v_add_f32 v34, v34, v42
    v_cvt_pk_bf16_f32 v89, v42, v43
    s_waitcnt lgkmcnt(4)
    v_mfma_f32_16x16x32_bf16 v[48:51], v[28:31], v[136:139], v[48:51]
    ds_read_b64 v[24:25], v212 offset:4096
    v_add_f32 v34, v34, v43
    v_mfma_f32_16x16x32_bf16 v[52:55], v[28:31], v[140:143], v[52:55]
    ds_read_b64 v[26:27], v213 offset:4096
    v_exp_f32 v44, v72
    s_waitcnt lgkmcnt(4)
    v_mfma_f32_16x16x32_bf16 v[56:59], v[16:19], v[112:115], v[96:99]
    ds_read_b64 v[28:29], v214 offset:4096
    v_exp_f32 v45, v73
    v_mfma_f32_16x16x32_bf16 v[60:63], v[16:19], v[116:119], v[100:103]
    ds_read_b64 v[30:31], v215 offset:4096
    v_exp_f32 v46, v74
    s_waitcnt lgkmcnt(4)
    v_mfma_f32_16x16x32_bf16 v[56:59], v[20:23], v[120:123], v[56:59]
    v_subrev_u32 v232, 0x20000, v232
    ds_read_b64_tr_b16 v[16:17], v232 offset:8192
    v_exp_f32 v47, v75
    v_mfma_f32_16x16x32_bf16 v[60:63], v[20:23], v[124:127], v[60:63]
    ds_read_b64_tr_b16 v[18:19], v232 offset:12288
    v_add_f32 v34, v34, v44
    v_cvt_pk_bf16_f32 v90, v44, v45
    s_waitcnt lgkmcnt(4)
    v_mfma_f32_16x16x32_bf16 v[56:59], v[24:27], v[128:131], v[56:59]
    v_subrev_u32 v233, 0x20000, v233
    ds_read_b64_tr_b16 v[20:21], v233 offset:8192
    v_add_f32 v34, v34, v45
    v_cvt_pk_bf16_f32 v91, v46, v47
    v_mfma_f32_16x16x32_bf16 v[60:63], v[24:27], v[132:135], v[60:63]
    ds_read_b64_tr_b16 v[22:23], v233 offset:12288
    v_add_f32 v34, v34, v46
    v_add_f32 v34, v34, v47
    s_waitcnt lgkmcnt(4)
    v_mfma_f32_16x16x32_bf16 v[56:59], v[28:31], v[136:139], v[56:59]
    v_subrev_u32 v234, 0x20000, v234
    ds_read_b64_tr_b16 v[24:25], v234 offset:8192
    v_exp_f32 v40, v68
    v_mfma_f32_16x16x32_bf16 v[60:63], v[28:31], v[140:143], v[60:63]
    ds_read_b64_tr_b16 v[26:27], v234 offset:12288
    v_exp_f32 v41, v69
    s_setprio 0
    s_waitcnt lgkmcnt(4)
    v_mfma_f32_16x16x32_bf16 v[144:147], v[16:19], v[80:83], v[144:147]
    v_subrev_u32 v235, 0x20000, v235
    ds_read_b64_tr_b16 v[28:29], v235 offset:8192
    v_exp_f32 v42, v70
    v_mfma_f32_16x16x32_bf16 v[148:151], v[16:19], v[84:87], v[148:151]
    ds_read_b64_tr_b16 v[30:31], v235 offset:12288
    v_exp_f32 v43, v71
    s_waitcnt lgkmcnt(4)
    v_mfma_f32_16x16x32_bf16 v[152:155], v[20:23], v[80:83], v[152:155]
    v_subrev_u32 v236, 0x20000, v236
    ds_read_b64_tr_b16 v[16:17], v236 offset:8192
    v_add_f32 v35, v40, v41
    v_cvt_pk_bf16_f32 v92, v40, v41
    v_mfma_f32_16x16x32_bf16 v[156:159], v[20:23], v[84:87], v[156:159]
    ds_read_b64_tr_b16 v[18:19], v236 offset:12288
    v_add_f32 v35, v35, v42
    v_cvt_pk_bf16_f32 v93, v42, v43
    s_waitcnt lgkmcnt(4)
    v_mfma_f32_16x16x32_bf16 v[160:163], v[24:27], v[80:83], v[160:163]
    v_subrev_u32 v237, 0x20000, v237
    ds_read_b64_tr_b16 v[20:21], v237 offset:8192
    v_add_f32 v35, v35, v43
    v_mfma_f32_16x16x32_bf16 v[164:167], v[24:27], v[84:87], v[164:167]
    ds_read_b64_tr_b16 v[22:23], v237 offset:12288
    v_exp_f32 v44, v76
    s_waitcnt lgkmcnt(4)
    v_mfma_f32_16x16x32_bf16 v[168:171], v[28:31], v[80:83], v[168:171]
    v_subrev_u32 v238, 0x20000, v238
    ds_read_b64_tr_b16 v[24:25], v238 offset:8192
    v_exp_f32 v45, v77
    v_mfma_f32_16x16x32_bf16 v[172:175], v[28:31], v[84:87], v[172:175]
    ds_read_b64_tr_b16 v[26:27], v238 offset:12288
    v_exp_f32 v46, v78
    s_waitcnt lgkmcnt(4)
    v_mfma_f32_16x16x32_bf16 v[176:179], v[16:19], v[80:83], v[176:179]
    v_subrev_u32 v239, 0x20000, v239
    ds_read_b64_tr_b16 v[28:29], v239 offset:8192
    v_exp_f32 v47, v79
    v_mfma_f32_16x16x32_bf16 v[180:183], v[16:19], v[84:87], v[180:183]
    ds_read_b64_tr_b16 v[30:31], v239 offset:12288
    v_add_f32 v35, v35, v44
    v_cvt_pk_bf16_f32 v94, v44, v45
    s_waitcnt lgkmcnt(4)
    v_mfma_f32_16x16x32_bf16 v[184:187], v[20:23], v[80:83], v[184:187]
    ds_read_b64 v[16:17], v208 offset:16384
    v_add_f32 v35, v35, v45
    v_cvt_pk_bf16_f32 v95, v46, v47
    v_mfma_f32_16x16x32_bf16 v[188:191], v[20:23], v[84:87], v[188:191]
    ds_read_b64 v[18:19], v209 offset:16384
    v_add_f32 v35, v35, v46
    v_add_f32 v35, v35, v47
    s_waitcnt lgkmcnt(4)
    v_mfma_f32_16x16x32_bf16 v[192:195], v[24:27], v[80:83], v[192:195]
    ds_read_b64 v[20:21], v210 offset:16384
    v_mfma_f32_16x16x32_bf16 v[196:199], v[24:27], v[84:87], v[196:199]
    ds_read_b64 v[22:23], v211 offset:16384
    s_waitcnt lgkmcnt(4)
    v_mfma_f32_16x16x32_bf16 v[200:203], v[28:31], v[80:83], v[200:203]
    ds_read_b64 v[24:25], v212 offset:16384
    v_mfma_f32_16x16x32_bf16 v[204:207], v[28:31], v[84:87], v[204:207]
    ds_read_b64 v[26:27], v213 offset:16384
    v_add_f32 v36, v34, v35
    v_cmp_ngt_f32 vcc, s52, v36
    s_cbranch_vccnz L_slow_13
L_back_13:
    v_add_f32 v32, v32, v34
    v_add_f32 v33, v33, v35
    s_setprio 3
    s_waitcnt vmcnt(3)
    s_barrier
    s_waitcnt lgkmcnt(4)
    v_mfma_f32_16x16x32_bf16 v[64:67], v[16:19], v[112:115], v[96:99]
    ds_read_b64 v[28:29], v214 offset:16384
    v_exp_f32 v40, v48
    v_mfma_f32_16x16x32_bf16 v[68:71], v[16:19], v[116:119], v[100:103]
    ds_read_b64 v[30:31], v215 offset:16384
    v_exp_f32 v41, v49
    s_add_u32 m0, s39, 0x24000
    s_mov_b32 s63, 0x24000
    buffer_load_dwordx4 v5, s[20:23], s63 offen lds
    s_waitcnt lgkmcnt(4)
    v_mfma_f32_16x16x32_bf16 v[64:67], v[20:23], v[120:123], v[64:67]
    ds_read_b64 v[16:17], v208 offset:20480
    v_exp_f32 v42, v50
    v_mfma_f32_16x16x32_bf16 v[68:71], v[20:23], v[124:127], v[68:71]
    ds_read_b64 v[18:19], v209 offset:20480
    v_exp_f32 v43, v51
    s_waitcnt lgkmcnt(4)
    v_mfma_f32_16x16x32_bf16 v[64:67], v[24:27], v[128:131], v[64:67]
    ds_read_b64 v[20:21], v210 offset:20480
    v_add_f32 v34, v40, v41
    v_cvt_pk_bf16_f32 v80, v40, v41
    v_mfma_f32_16x16x32_bf16 v[68:71], v[24:27], v[132:135], v[68:71]
    ds_read_b64 v[22:23], v211 offset:20480
    v_add_f32 v34, v34, v42
    v_cvt_pk_bf16_f32 v81, v42, v43
    s_add_u32 m0, s39, 0x26000
    s_mov_b32 s56, 0x2d000
    buffer_load_dwordx4 v5, s[20:23], s56 offen lds
    s_waitcnt lgkmcnt(4)
    v_mfma_f32_16x16x32_bf16 v[64:67], v[28:31], v[136:139], v[64:67]
    ds_read_b64 v[24:25], v212 offset:20480
    v_add_f32 v34, v34, v43
    v_mfma_f32_16x16x32_bf16 v[68:71], v[28:31], v[140:143], v[68:71]
    ds_read_b64 v[26:27], v213 offset:20480
    v_exp_f32 v44, v56
    s_waitcnt lgkmcnt(4)
    v_mfma_f32_16x16x32_bf16 v[72:75], v[16:19], v[112:115], v[96:99]
    ds_read_b64 v[28:29], v214 offset:20480
    v_exp_f32 v45, v57
    v_mfma_f32_16x16x32_bf16 v[76:79], v[16:19], v[116:119], v[100:103]
    ds_read_b64 v[30:31], v215 offset:20480
    v_exp_f32 v46, v58
    s_add_u32 m0, s39, 0x0
    s_mov_b32 s57, 0x12000
    buffer_load_dwordx4 v5, s[20:23], s57 offen lds
    s_waitcnt lgkmcnt(4)
    v_mfma_f32_16x16x32_bf16 v[72:75], v[20:23], v[120:123], v[72:75]
    ds_read_b64_tr_b16 v[16:17], v232 offset:24576
    v_exp_f32 v47, v59
    v_mfma_f32_16x16x32_bf16 v[76:79], v[20:23], v[124:127], v[76:79]
    ds_read_b64_tr_b16 v[18:19], v232 offset:28672
    v_add_f32 v34, v34, v44
    v_cvt_pk_bf16_f32 v82, v44, v45
    s_waitcnt lgkmcnt(4)
    v_mfma_f32_16x16x32_bf16 v[72:75], v[24:27], v[128:131], v[72:75]
    ds_read_b64_tr_b16 v[20:21], v233 offset:24576
    v_add_f32 v34, v34, v45
    v_cvt_pk_bf16_f32 v83, v46, v47
    v_mfma_f32_16x16x32_bf16 v[76:79], v[24:27], v[132:135], v[76:79]
    ds_read_b64_tr_b16 v[22:23], v233 offset:28672
    v_add_f32 v34, v34, v46
    v_add_f32 v34, v34, v47
    s_add_u32 m0, s39, 0x2000
    s_mov_b32 s58, 0x1b000
    buffer_load_dwordx4 v5, s[20:23], s58 offen lds
    s_waitcnt lgkmcnt(4)
    v_mfma_f32_16x16x32_bf16 v[72:75], v[28:31], v[136:139], v[72:75]
    ds_read_b64_tr_b16 v[24:25], v234 offset:24576
    v_exp_f32 v40, v52
    v_mfma_f32_16x16x32_bf16 v[76:79], v[28:31], v[140:143], v[76:79]
    ds_read_b64_tr_b16 v[26:27], v234 offset:28672
    v_exp_f32 v41, v53
    s_setprio 2
    s_waitcnt lgkmcnt(4)
    v_mfma_f32_16x16x32_bf16 v[144:147], v[16:19], v[88:91], v[144:147]
    ds_read_b64_tr_b16 v[28:29], v235 offset:24576
    v_exp_f32 v42, v54
    v_mfma_f32_16x16x32_bf16 v[148:151], v[16:19], v[92:95], v[148:151]
    ds_read_b64_tr_b16 v[30:31], v235 offset:28672
    v_exp_f32 v43, v55
    s_waitcnt lgkmcnt(4)
    v_mfma_f32_16x16x32_bf16 v[152:155], v[20:23], v[88:91], v[152:155]
    ds_read_b64_tr_b16 v[16:17], v236 offset:24576
    v_add_f32 v35, v40, v41
    v_cvt_pk_bf16_f32 v84, v40, v41
    v_mfma_f32_16x16x32_bf16 v[156:159], v[20:23], v[92:95], v[156:159]
    ds_read_b64_tr_b16 v[18:19], v236 offset:28672
    v_add_f32 v35, v35, v42
    v_cvt_pk_bf16_f32 v85, v42, v43
    s_waitcnt lgkmcnt(4)
    v_mfma_f32_16x16x32_bf16 v[160:163], v[24:27], v[88:91], v[160:163]
    ds_read_b64_tr_b16 v[20:21], v237 offset:24576
    v_add_f32 v35, v35, v43
    v_mfma_f32_16x16x32_bf16 v[164:167], v[24:27], v[92:95], v[164:167]
    ds_read_b64_tr_b16 v[22:23], v237 offset:28672
    v_exp_f32 v44, v60
    s_waitcnt lgkmcnt(4)
    v_mfma_f32_16x16x32_bf16 v[168:171], v[28:31], v[88:91], v[168:171]
    ds_read_b64_tr_b16 v[24:25], v238 offset:24576
    v_exp_f32 v45, v61
    v_mfma_f32_16x16x32_bf16 v[172:175], v[28:31], v[92:95], v[172:175]
    ds_read_b64_tr_b16 v[26:27], v238 offset:28672
    v_exp_f32 v46, v62
    s_waitcnt lgkmcnt(4)
    v_mfma_f32_16x16x32_bf16 v[176:179], v[16:19], v[88:91], v[176:179]
    ds_read_b64_tr_b16 v[28:29], v239 offset:24576
    v_exp_f32 v47, v63
    v_mfma_f32_16x16x32_bf16 v[180:183], v[16:19], v[92:95], v[180:183]
    ds_read_b64_tr_b16 v[30:31], v239 offset:28672
    v_add_f32 v35, v35, v44
    v_cvt_pk_bf16_f32 v86, v44, v45
    s_waitcnt lgkmcnt(4)
    v_mfma_f32_16x16x32_bf16 v[184:187], v[20:23], v[88:91], v[184:187]
    ds_read_b64_tr_b16 v[16:17], v232 offset:32768
    v_add_f32 v35, v35, v45
    v_cvt_pk_bf16_f32 v87, v46, v47
    v_mfma_f32_16x16x32_bf16 v[188:191], v[20:23], v[92:95], v[188:191]
    ds_read_b64_tr_b16 v[18:19], v232 offset:36864
    v_add_f32 v35, v35, v46
    v_add_f32 v35, v35, v47
    s_waitcnt lgkmcnt(4)
    v_mfma_f32_16x16x32_bf16 v[192:195], v[24:27], v[88:91], v[192:195]
    ds_read_b64_tr_b16 v[20:21], v233 offset:32768
    v_mfma_f32_16x16x32_bf16 v[196:199], v[24:27], v[92:95], v[196:199]
    ds_read_b64_tr_b16 v[22:23], v233 offset:36864
    s_waitcnt lgkmcnt(4)
    v_mfma_f32_16x16x32_bf16 v[200:203], v[28:31], v[88:91], v[200:203]
    ds_read_b64_tr_b16 v[24:25], v234 offset:32768
    v_mfma_f32_16x16x32_bf16 v[204:207], v[28:31], v[92:95], v[204:207]
    ds_read_b64_tr_b16 v[26:27], v234 offset:36864
    v_add_f32 v36, v34, v35
    v_cmp_ngt_f32 vcc, s52, v36
    s_cbranch_vccnz L_slow_14
L_back_14:
    v_add_f32 v32, v32, v34
    v_add_f32 v33, v33, v35
    s_setprio 1
    s_waitcnt lgkmcnt(4)
    v_mfma_f32_16x16x32_bf16 v[144:147], v[16:19], v[80:83], v[144:147]
    ds_read_b64_tr_b16 v[28:29], v235 offset:32768
    v_exp_f32 v40, v64
    v_exp_f32 v41, v65
    v_mfma_f32_16x16x32_bf16 v[148:151], v[16:19], v[84:87], v[148:151]
    ds_read_b64_tr_b16 v[30:31], v235 offset:36864
    v_exp_f32 v42, v66
    v_exp_f32 v43, v67
    s_waitcnt lgkmcnt(4)
    v_mfma_f32_16x16x32_bf16 v[152:155], v[20:23], v[80:83], v[152:155]
    ds_read_b64_tr_b16 v[16:17], v236 offset:32768
    v_add_f32 v34, v40, v41
    v_cvt_pk_bf16_f32 v88, v40, v41
    v_add_f32 v34, v34, v42
    v_cvt_pk_bf16_f32 v89, v42, v43
    v_mfma_f32_16x16x32_bf16 v[156:159], v[20:23], v[84:87], v[156:159]
    ds_read_b64_tr_b16 v[18:19], v236 offset:36864
    v_add_f32 v34, v34, v43
    v_exp_f32 v44, v72
    s_waitcnt lgkmcnt(4)
    v_mfma_f32_16x16x32_bf16 v[160:163], v[24:27], v[80:83], v[160:163]
    ds_read_b64_tr_b16 v[20:21], v237 offset:32768
    v_exp_f32 v45, v73
    v_exp_f32 v46, v74
    v_mfma_f32_16x16x32_bf16 v[164:167], v[24:27], v[84:87], v[164:167]
    ds_read_b64_tr_b16 v[22:23], v237 offset:36864
    v_exp_f32 v47, v75
    v_add_f32 v34, v34, v44
    v_cvt_pk_bf16_f32 v90, v44, v45
    s_waitcnt lgkmcnt(4)
    v_mfma_f32_16x16x32_bf16 v[168:171], v[28:31], v[80:83], v[168:171]
    ds_read_b64_tr_b16 v[24:25], v238 offset:32768
    v_add_f32 v34, v34, v45
    v_cvt_pk_bf16_f32 v91, v46, v47
    v_add_f32 v34, v34, v46
    v_add_f32 v34, v34, v47
    v_mfma_f32_16x16x32_bf16 v[172:175], v[28:31], v[84:87], v[172:175]
    ds_read_b64_tr_b16 v[26:27], v238 offset:36864
    v_exp_f32 v40, v68
    v_exp_f32 v41, v69
    s_waitcnt lgkmcnt(4)
    v_mfma_f32_16x16x32_bf16 v[176:179], v[16:19], v[80:83], v[176:179]
    ds_read_b64_tr_b16 v[28:29], v239 offset:32768
    v_exp_f32 v42, v70
    v_exp_f32 v43, v71
    v_mfma_f32_16x16x32_bf16 v[180:183], v[16:19], v[84:87], v[180:183]
    ds_read_b64_tr_b16 v[30:31], v239 offset:36864
    v_add_f32 v35, v40, v41
    v_cvt_pk_bf16_f32 v92, v40, v41
    v_add_f32 v35, v35, v42
    v_cvt_pk_bf16_f32 v93, v42, v43
    s_waitcnt lgkmcnt(4)
    v_mfma_f32_16x16x32_bf16 v[184:187], v[20:23], v[80:83], v[184:187]
    ds_read_b64_tr_b16 v[16:17], v232 offset:40960
    v_add_f32 v35, v35, v43
    v_exp_f32 v44, v76
    v_mfma_f32_16x16x32_bf16 v[188:191], v[20:23], v[84:87], v[188:191]
    ds_read_b64_tr_b16 v[18:19], v232 offset:45056
    v_exp_f32 v45, v77
    v_exp_f32 v46, v78
    s_waitcnt lgkmcnt(4)
    v_mfma_f32_16x16x32_bf16 v[192:195], v[24:27], v[80:83], v[192:195]
    ds_read_b64_tr_b16 v[20:21], v233 offset:40960
    v_exp_f32 v47, v79
    v_add_f32 v35, v35, v44
    v_cvt_pk_bf16_f32 v94, v44, v45
    v_mfma_f32_16x16x32_bf16 v[196:199], v[24:27], v[84:87], v[196:199]
    ds_read_b64_tr_b16 v[22:23], v233 offset:45056
    v_add_f32 v35, v35, v45
    v_cvt_pk_bf16_f32 v95, v46, v47
    v_add_f32 v35, v35, v46
    v_add_f32 v35, v35, v47
    s_waitcnt lgkmcnt(4)
    v_mfma_f32_16x16x32_bf16 v[200:203], v[28:31], v[80:83], v[200:203]
    ds_read_b64_tr_b16 v[24:25], v234 offset:40960
    v_mfma_f32_16x16x32_bf16 v[204:207], v[28:31], v[84:87], v[204:207]
    ds_read_b64_tr_b16 v[26:27], v234 offset:45056
    v_add_f32 v36, v34, v35
    v_cmp_ngt_f32 vcc, s52, v36
    s_cbranch_vccnz L_slow_15
L_back_15:
    v_add_f32 v32, v32, v34
    v_add_f32 v33, v33, v35
    s_setprio 0
    s_waitcnt lgkmcnt(4)
    v_mfma_f32_16x16x32_bf16 v[144:147], v[16:19], v[88:91], v[144:147]
    ds_read_b64_tr_b16 v[28:29], v235 offset:40960
    v_mfma_f32_16x16x32_bf16 v[148:151], v[16:19], v[92:95], v[148:151]
    ds_read_b64_tr_b16 v[30:31], v235 offset:45056
    v_mov_b32 v36, v32
    s_nop 1
    v_permlane16_swap_b32 v32, v36
    v_add_f32 v32, v32, v36
    v_mov_b32 v36, v32
    s_nop 0
    s_nop 0
    v_permlane32_swap_b32 v32, v36
    v_add_f32 v32, v32, v36
    v_rcp_f32 v38, v32
    v_mov_b32 v36, v33
    s_nop 1
    v_permlane16_swap_b32 v33, v36
    v_add_f32 v33, v33, v36
    v_mov_b32 v36, v33
    s_nop 0
    s_nop 0
    v_permlane32_swap_b32 v33, v36
    v_add_f32 v33, v33, v36
    v_rcp_f32 v39, v33
    s_waitcnt lgkmcnt(4)
    v_mfma_f32_16x16x32_bf16 v[152:155], v[20:23], v[88:91], v[152:155]
    ds_read_b64_tr_b16 v[16:17], v236 offset:40960
    v_mfma_f32_16x16x32_bf16 v[156:159], v[20:23], v[92:95], v[156:159]
    ds_read_b64_tr_b16 v[18:19], v236 offset:45056
    s_waitcnt lgkmcnt(4)
    v_mfma_f32_16x16x32_bf16 v[160:163], v[24:27], v[88:91], v[160:163]
    ds_read_b64_tr_b16 v[20:21], v237 offset:40960
    v_mul_f32 v144, v144, v38
    v_mul_f32 v145, v145, v38
    v_mul_f32 v146, v146, v38
    v_mul_f32 v147, v147, v38
    v_mfma_f32_16x16x32_bf16 v[164:167], v[24:27], v[92:95], v[164:167]
    ds_read_b64_tr_b16 v[22:23], v237 offset:45056
    v_cvt_pk_bf16_f32 v48, v144, v145
    v_cvt_pk_bf16_f32 v49, v146, v147
    v_mul_f32 v148, v148, v39
    v_mul_f32 v149, v149, v39
    s_waitcnt lgkmcnt(4)
    v_mfma_f32_16x16x32_bf16 v[168:171], v[28:31], v[88:91], v[168:171]
    ds_read_b64_tr_b16 v[24:25], v238 offset:40960
    v_mul_f32 v150, v150, v39
    v_mul_f32 v151, v151, v39
    v_cvt_pk_bf16_f32 v52, v148, v149
    v_cvt_pk_bf16_f32 v53, v150, v151
    v_mfma_f32_16x16x32_bf16 v[172:175], v[28:31], v[92:95], v[172:175]
    ds_read_b64_tr_b16 v[26:27], v238 offset:45056
    v_mul_f32 v152, v152, v38
    v_mul_f32 v153, v153, v38
    v_mul_f32 v154, v154, v38
    v_mul_f32 v155, v155, v38
    s_waitcnt lgkmcnt(4)
    v_mfma_f32_16x16x32_bf16 v[176:179], v[16:19], v[88:91], v[176:179]
    ds_read_b64_tr_b16 v[28:29], v239 offset:40960
    v_cvt_pk_bf16_f32 v50, v152, v153
    v_cvt_pk_bf16_f32 v51, v154, v155
    v_mul_f32 v156, v156, v39
    v_mul_f32 v157, v157, v39
    v_mfma_f32_16x16x32_bf16 v[180:183], v[16:19], v[92:95], v[180:183]
    ds_read_b64_tr_b16 v[30:31], v239 offset:45056
    v_mul_f32 v158, v158, v39
    v_mul_f32 v159, v159, v39
    v_cvt_pk_bf16_f32 v54, v156, v157
    v_cvt_pk_bf16_f32 v55, v158, v159
    s_waitcnt lgkmcnt(4)
    v_mfma_f32_16x16x32_bf16 v[184:187], v[20:23], v[88:91], v[184:187]
    ds_write_b128 v228, v[48:51] offset:0
    ds_write_b128 v228, v[52:55] offset:1024
    v_mul_f32 v160, v160, v38
    v_mul_f32 v161, v161, v38
    v_mfma_f32_16x16x32_bf16 v[188:191], v[20:23], v[92:95], v[188:191]
    v_mul_f32 v162, v162, v38
    v_mul_f32 v163, v163, v38
    v_cvt_pk_bf16_f32 v56, v160, v161
    v_cvt_pk_bf16_f32 v57, v162, v163
    s_waitcnt lgkmcnt(4)
    v_mfma_f32_16x16x32_bf16 v[192:195], v[24:27], v[88:91], v[192:195]
    v_mul_f32 v164, v164, v39
    v_mul_f32 v165, v165, v39
    v_mul_f32 v166, v166, v39
    v_mul_f32 v167, v167, v39
    v_mfma_f32_16x16x32_bf16 v[196:199], v[24:27], v[92:95], v[196:199]
    v_cvt_pk_bf16_f32 v60, v164, v165
    v_cvt_pk_bf16_f32 v61, v166, v167
    v_mul_f32 v168, v168, v38
    v_mul_f32 v169, v169, v38
    s_waitcnt lgkmcnt(2)
    v_mfma_f32_16x16x32_bf16 v[200:203], v[28:31], v[88:91], v[200:203]
    v_mul_f32 v170, v170, v38
    v_mul_f32 v171, v171, v38
    v_cvt_pk_bf16_f32 v58, v168, v169
    v_cvt_pk_bf16_f32 v59, v170, v171
    v_mfma_f32_16x16x32_bf16 v[204:207], v[28:31], v[92:95], v[204:207]
    v_mul_f32 v172, v172, v39
    v_mul_f32 v173, v173, v39
    v_mul_f32 v174, v174, v39
    v_mul_f32 v175, v175, v39
    v_cvt_pk_bf16_f32 v62, v172, v173
    v_cvt_pk_bf16_f32 v63, v174, v175
    ds_write_b128 v228, v[56:59] offset:2048
    ds_write_b128 v228, v[60:63] offset:3072
    v_mul_f32 v176, v176, v38
    v_mul_f32 v177, v177, v38
    v_mul_f32 v178, v178, v38
    v_mul_f32 v179, v179, v38
    v_cvt_pk_bf16_f32 v64, v176, v177
    v_cvt_pk_bf16_f32 v65, v178, v179
    v_mul_f32 v180, v180, v39
    v_mul_f32 v181, v181, v39
    v_mul_f32 v182, v182, v39
    v_mul_f32 v183, v183, v39
    v_cvt_pk_bf16_f32 v68, v180, v181
    v_cvt_pk_bf16_f32 v69, v182, v183
    v_mul_f32 v184, v184, v38
    v_mul_f32 v185, v185, v38
    v_mul_f32 v186, v186, v38
    v_mul_f32 v187, v187, v38
    v_cvt_pk_bf16_f32 v66, v184, v185
    v_cvt_pk_bf16_f32 v67, v186, v187
    v_mul_f32 v188, v188, v39
    v_mul_f32 v189, v189, v39
    v_mul_f32 v190, v190, v39
    v_mul_f32 v191, v191, v39
    v_cvt_pk_bf16_f32 v70, v188, v189
    v_cvt_pk_bf16_f32 v71, v190, v191
    ds_write_b128 v228, v[64:67] offset:4096
    ds_write_b128 v228, v[68:71] offset:5120
    v_mul_f32 v192, v192, v38
    v_mul_f32 v193, v193, v38
    v_mul_f32 v194, v194, v38
    v_mul_f32 v195, v195, v38
    v_cvt_pk_bf16_f32 v72, v192, v193
    v_cvt_pk_bf16_f32 v73, v194, v195
    v_mul_f32 v196, v196, v39
    v_mul_f32 v197, v197, v39
    v_mul_f32 v198, v198, v39
    v_mul_f32 v199, v199, v39
    v_cvt_pk_bf16_f32 v76, v196, v197
    v_cvt_pk_bf16_f32 v77, v198, v199
    v_mul_f32 v200, v200, v38
    v_mul_f32 v201, v201, v38
    v_mul_f32 v202, v202, v38
    v_mul_f32 v203, v203, v38
    v_cvt_pk_bf16_f32 v74, v200, v201
    v_cvt_pk_bf16_f32 v75, v202, v203
    v_mul_f32 v204, v204, v39
    v_mul_f32 v205, v205, v39
    v_mul_f32 v206, v206, v39
    v_mul_f32 v207, v207, v39
    v_cvt_pk_bf16_f32 v78, v204, v205
    v_cvt_pk_bf16_f32 v79, v206, v207
    ds_write_b128 v228, v[72:75] offset:6144
    ds_write_b128 v228, v[76:79] offset:7168
    s_setprio 3
    s_waitcnt lgkmcnt(0)
    s_waitcnt vmcnt(1)
    s_barrier
    ds_read_b128 v[80:83], v229 offset:0
    ds_read_b128 v[84:87], v229 offset:1024
    ds_read_b128 v[88:91], v229 offset:2048
    ds_read_b128 v[92:95], v229 offset:3072
    ds_read_b128 v[96:99], v229 offset:4096
    ds_read_b128 v[100:103], v229 offset:5120
    ds_read_b128 v[104:107], v229 offset:6144
    ds_read_b128 v[108:111], v229 offset:7168
    v_add_u32 v216, 0x20000, v216
    ds_read_b64_tr_b16 v[16:17], v216 offset:0
    ds_read_b64_tr_b16 v[18:19], v216 offset:4096
    v_add_u32 v217, 0x20000, v217
    ds_read_b64_tr_b16 v[20:21], v217 offset:0
    ds_read_b64_tr_b16 v[22:23], v217 offset:4096
    v_add_u32 v218, 0x20000, v218
    ds_read_b64_tr_b16 v[24:25], v218 offset:0
    ds_read_b64_tr_b16 v[26:27], v218 offset:4096
    s_waitcnt lgkmcnt(4)
    v_mfma_f32_16x16x32_bf16 v[112:115], v[16:19], v[48:51], 0
    v_add_u32 v219, 0x20000, v219
    ds_read_b64_tr_b16 v[28:29], v219 offset:0
    v_mfma_f32_16x16x32_bf16 v[116:119], v[16:19], v[52:55], 0
    ds_read_b64_tr_b16 v[30:31], v219 offset:4096
    s_add_u32 m0, s39, 0x4000
    s_mov_b32 s59, 0x36000
    buffer_load_dwordx4 v5, s[20:23], s59 offen lds
    s_waitcnt lgkmcnt(4)
    v_mfma_f32_16x16x32_bf16 v[120:123], v[20:23], v[48:51], 0
    ds_read_b64_tr_b16 v[16:17], v216 offset:8192
    v_mfma_f32_16x16x32_bf16 v[124:127], v[20:23], v[52:55], 0
    ds_read_b64_tr_b16 v[18:19], v216 offset:12288
    s_add_u32 m0, s39, 0x6000
    s_mov_b32 s60, 0x3f000
    buffer_load_dwordx4 v5, s[20:23], s60 offen lds
    s_waitcnt lgkmcnt(4)
    v_mfma_f32_16x16x32_bf16 v[128:131], v[24:27], v[48:51], 0
    ds_read_b64_tr_b16 v[20:21], v217 offset:8192
    v_mfma_f32_16x16x32_bf16 v[132:135], v[24:27], v[52:55], 0
    ds_read_b64_tr_b16 v[22:23], v217 offset:12288
    s_add_u32 m0, s39, 0x8000
    s_mov_b32 s61, 0x100
    buffer_load_dwordx4 v5, s[20:23], s61 offen lds
    s_waitcnt lgkmcnt(4)
    v_mfma_f32_16x16x32_bf16 v[136:139], v[28:31], v[48:51], 0
    ds_read_b64_tr_b16 v[24:25], v218 offset:8192
    v_mfma_f32_16x16x32_bf16 v[140:143], v[28:31], v[52:55], 0
    ds_read_b64_tr_b16 v[26:27], v218 offset:12288
    s_add_u32 m0, s39, 0xa000
    s_mov_b32 s62, 0x9100
    buffer_load_dwordx4 v5, s[20:23], s62 offen lds
    s_setprio 2
    s_waitcnt lgkmcnt(4)
    v_mfma_f32_16x16x32_bf16 v[112:115], v[16:19], v[56:59], v[112:115]
    ds_read_b64_tr_b16 v[28:29], v219 offset:8192
    v_mfma_f32_16x16x32_bf16 v[116:119], v[16:19], v[60:63], v[116:119]
    ds_read_b64_tr_b16 v[30:31], v219 offset:12288
    s_waitcnt lgkmcnt(4)
    v_mfma_f32_16x16x32_bf16 v[120:123], v[20:23], v[56:59], v[120:123]
    v_add_u32 v220, 0x20000, v220
    ds_read_b64_tr_b16 v[16:17], v220 offset:0
    v_mfma_f32_16x16x32_bf16 v[124:127], v[20:23], v[60:63], v[124:127]
    ds_read_b64_tr_b16 v[18:19], v220 offset:4096
    s_waitcnt lgkmcnt(4)
    v_mfma_f32_16x16x32_bf16 v[128:131], v[24:27], v[56:59], v[128:131]
    v_add_u32 v221, 0x20000, v221
    ds_read_b64_tr_b16 v[20:21], v221 offset:0
    v_mfma_f32_16x16x32_bf16 v[132:135], v[24:27], v[60:63], v[132:135]
    ds_read_b64_tr_b16 v[22:23], v221 offset:4096
    s_waitcnt lgkmcnt(4)
    v_mfma_f32_16x16x32_bf16 v[136:139], v[28:31], v[56:59], v[136:139]
    v_add_u32 v222, 0x20000, v222
    ds_read_b64_tr_b16 v[24:25], v222 offset:0
    v_mfma_f32_16x16x32_bf16 v[140:143], v[28:31], v[60:63], v[140:143]
    ds_read_b64_tr_b16 v[26:27], v222 offset:4096
    s_setprio 1
    s_waitcnt lgkmcnt(4)
    v_mfma_f32_16x16x32_bf16 v[112:115], v[16:19], v[80:83], v[112:115]
    v_add_u32 v223, 0x20000, v223
    ds_read_b64_tr_b16 v[28:29], v223 offset:0
    v_mfma_f32_16x16x32_bf16 v[116:119], v[16:19], v[84:87], v[116:119]
    ds_read_b64_tr_b16 v[30:31], v223 offset:4096
    s_waitcnt lgkmcnt(4)
    v_mfma_f32_16x16x32_bf16 v[120:123], v[20:23], v[80:83], v[120:123]
    ds_read_b64_tr_b16 v[16:17], v220 offset:8192
    v_mfma_f32_16x16x32_bf16 v[124:127], v[20:23], v[84:87], v[124:127]
    ds_read_b64_tr_b16 v[18:19], v220 offset:12288
    s_waitcnt lgkmcnt(4)
    v_mfma_f32_16x16x32_bf16 v[128:131], v[24:27], v[80:83], v[128:131]
    ds_read_b64_tr_b16 v[20:21], v221 offset:8192
    v_mfma_f32_16x16x32_bf16 v[132:135], v[24:27], v[84:87], v[132:135]
    ds_read_b64_tr_b16 v[22:23], v221 offset:12288
    s_waitcnt lgkmcnt(4)
    v_mfma_f32_16x16x32_bf16 v[136:139], v[28:31], v[80:83], v[136:139]
    ds_read_b64_tr_b16 v[24:25], v222 offset:8192
    v_mfma_f32_16x16x32_bf16 v[140:143], v[28:31], v[84:87], v[140:143]
    ds_read_b64_tr_b16 v[26:27], v222 offset:12288
    s_setprio 0
    s_waitcnt lgkmcnt(4)
    v_mfma_f32_16x16x32_bf16 v[112:115], v[16:19], v[88:91], v[112:115]
    ds_read_b64_tr_b16 v[28:29], v223 offset:8192
    v_mfma_f32_16x16x32_bf16 v[116:119], v[16:19], v[92:95], v[116:119]
    ds_read_b64_tr_b16 v[30:31], v223 offset:12288
    s_waitcnt lgkmcnt(4)
    v_mfma_f32_16x16x32_bf16 v[120:123], v[20:23], v[88:91], v[120:123]
    v_mfma_f32_16x16x32_bf16 v[124:127], v[20:23], v[92:95], v[124:127]
    s_waitcnt lgkmcnt(2)
    v_mfma_f32_16x16x32_bf16 v[128:131], v[24:27], v[88:91], v[128:131]
    v_mfma_f32_16x16x32_bf16 v[132:135], v[24:27], v[92:95], v[132:135]
    s_waitcnt lgkmcnt(0)
    v_mfma_f32_16x16x32_bf16 v[136:139], v[28:31], v[88:91], v[136:139]
    v_mfma_f32_16x16x32_bf16 v[140:143], v[28:31], v[92:95], v[140:143]
    s_setprio 3
    s_waitcnt vmcnt(1)
    s_barrier
    v_subrev_u32 v216, 0x20000, v216
    ds_read_b64_tr_b16 v[16:17], v216 offset:0
    ds_read_b64_tr_b16 v[18:19], v216 offset:4096
    v_subrev_u32 v217, 0x20000, v217
    ds_read_b64_tr_b16 v[20:21], v217 offset:0
    ds_read_b64_tr_b16 v[22:23], v217 offset:4096
    v_subrev_u32 v218, 0x20000, v218
    ds_read_b64_tr_b16 v[24:25], v218 offset:0
    ds_read_b64_tr_b16 v[26:27], v218 offset:4096
    s_waitcnt lgkmcnt(4)
    v_mfma_f32_16x16x32_bf16 v[112:115], v[16:19], v[64:67], v[112:115]
    v_subrev_u32 v219, 0x20000, v219
    ds_read_b64_tr_b16 v[28:29], v219 offset:0
    v_mfma_f32_16x16x32_bf16 v[116:119], v[16:19], v[68:71], v[116:119]
    ds_read_b64_tr_b16 v[30:31], v219 offset:4096
    s_add_u32 m0, s39, 0xc000
    s_mov_b32 s63, 0x24100
    buffer_load_dwordx4 v5, s[20:23], s63 offen lds
    s_waitcnt lgkmcnt(4)
    v_mfma_f32_16x16x32_bf16 v[120:123], v[20:23], v[64:67], v[120:123]
    ds_read_b64_tr_b16 v[16:17], v216 offset:8192
    v_mfma_f32_16x16x32_bf16 v[124:127], v[20:23], v[68:71], v[124:127]
    ds_read_b64_tr_b16 v[18:19], v216 offset:12288
    s_add_u32 m0, s39, 0xe000
    s_mov_b32 s56, 0x2d100
    buffer_load_dwordx4 v5, s[20:23], s56 offen lds
    s_waitcnt lgkmcnt(4)
    v_mfma_f32_16x16x32_bf16 v[128:131], v[24:27], v[64:67], v[128:131]
    ds_read_b64_tr_b16 v[20:21], v217 offset:8192
    v_mfma_f32_16x16x32_bf16 v[132:135], v[24:27], v[68:71], v[132:135]
    ds_read_b64_tr_b16 v[22:23], v217 offset:12288
    s_add_u32 m0, s39, 0x10000
    s_mov_b32 s57, 0x12100
    buffer_load_dwordx4 v5, s[20:23], s57 offen lds
    s_waitcnt lgkmcnt(4)
    v_mfma_f32_16x16x32_bf16 v[136:139], v[28:31], v[64:67], v[136:139]
    ds_read_b64_tr_b16 v[24:25], v218 offset:8192
    v_mfma_f32_16x16x32_bf16 v[140:143], v[28:31], v[68:71], v[140:143]
    ds_read_b64_tr_b16 v[26:27], v218 offset:12288
    s_add_u32 m0, s39, 0x12000
    s_mov_b32 s58, 0x1b100
    buffer_load_dwordx4 v5, s[20:23], s58 offen lds
    s_setprio 2
    s_waitcnt lgkmcnt(4)
    v_mfma_f32_16x16x32_bf16 v[112:115], v[16:19], v[72:75], v[112:115]
    ds_read_b64_tr_b16 v[28:29], v219 offset:8192
    v_mfma_f32_16x16x32_bf16 v[116:119], v[16:19], v[76:79], v[116:119]
    ds_read_b64_tr_b16 v[30:31], v219 offset:12288
    s_add_u32 m0, s39, 0x14000
    s_mov_b32 s59, 0x36100
    buffer_load_dwordx4 v5, s[20:23], s59 offen lds
    s_waitcnt lgkmcnt(4)
    v_mfma_f32_16x16x32_bf16 v[120:123], v[20:23], v[72:75], v[120:123]
    v_subrev_u32 v220, 0x20000, v220
    ds_read_b64_tr_b16 v[16:17], v220 offset:0
    v_mfma_f32_16x16x32_bf16 v[124:127], v[20:23], v[76:79], v[124:127]
    ds_read_b64_tr_b16 v[18:19], v220 offset:4096
    s_add_u32 m0, s39, 0x16000
    s_mov_b32 s60, 0x3f100
    buffer_load_dwordx4 v5, s[20:23], s60 offen lds
    s_waitcnt lgkmcnt(4)
    v_mfma_f32_16x16x32_bf16 v[128:131], v[24:27], v[72:75], v[128:131]
    v_subrev_u32 v221, 0x20000, v221
    ds_read_b64_tr_b16 v[20:21], v221 offset:0
    v_mfma_f32_16x16x32_bf16 v[132:135], v[24:27], v[76:79], v[132:135]
    ds_read_b64_tr_b16 v[22:23], v221 offset:4096
    s_add_u32 m0, s39, 0x18000
    s_mov_b32 s61, 0x200
    buffer_load_dwordx4 v5, s[20:23], s61 offen lds
    s_waitcnt lgkmcnt(4)
    v_mfma_f32_16x16x32_bf16 v[136:139], v[28:31], v[72:75], v[136:139]
    v_subrev_u32 v222, 0x20000, v222
    ds_read_b64_tr_b16 v[24:25], v222 offset:0
    v_mfma_f32_16x16x32_bf16 v[140:143], v[28:31], v[76:79], v[140:143]
    ds_read_b64_tr_b16 v[26:27], v222 offset:4096
    s_add_u32 m0, s39, 0x1a000
    s_mov_b32 s62, 0x9200
    buffer_load_dwordx4 v5, s[20:23], s62 offen lds
    s_setprio 1
    s_waitcnt lgkmcnt(4)
    v_mfma_f32_16x16x32_bf16 v[112:115], v[16:19], v[96:99], v[112:115]
    v_subrev_u32 v223, 0x20000, v223
    ds_read_b64_tr_b16 v[28:29], v223 offset:0
    v_mfma_f32_16x16x32_bf16 v[116:119], v[16:19], v[100:103], v[116:119]
    ds_read_b64_tr_b16 v[30:31], v223 offset:4096
    s_add_u32 m0, s39, 0x20000
    s_mov_b32 s63, 0x12200
    buffer_load_dwordx4 v5, s[20:23], s63 offen lds
    s_waitcnt lgkmcnt(4)
    v_mfma_f32_16x16x32_bf16 v[120:123], v[20:23], v[96:99], v[120:123]
    ds_read_b64_tr_b16 v[16:17], v220 offset:8192
    v_mfma_f32_16x16x32_bf16 v[124:127], v[20:23], v[100:103], v[124:127]
    ds_read_b64_tr_b16 v[18:19], v220 offset:12288
    s_add_u32 m0, s39, 0x22000
    s_mov_b32 s56, 0x1b200
    buffer_load_dwordx4 v5, s[20:23], s56 offen lds
    s_waitcnt lgkmcnt(4)
    v_mfma_f32_16x16x32_bf16 v[128:131], v[24:27], v[96:99], v[128:131]
    ds_read_b64_tr_b16 v[20:21], v221 offset:8192
    v_mfma_f32_16x16x32_bf16 v[132:135], v[24:27], v[100:103], v[132:135]
    ds_read_b64_tr_b16 v[22:23], v221 offset:12288
    s_add_u32 m0, s39, 0x24000
    s_mov_b32 s57, 0x36200
    buffer_load_dwordx4 v5, s[20:23], s57 offen lds
    s_waitcnt lgkmcnt(4)
    v_mfma_f32_16x16x32_bf16 v[136:139], v[28:31], v[96:99], v[136:139]
    ds_read_b64_tr_b16 v[24:25], v222 offset:8192
    v_mfma_f32_16x16x32_bf16 v[140:143], v[28:31], v[100:103], v[140:143]
    ds_read_b64_tr_b16 v[26:27], v222 offset:12288
    s_add_u32 m0, s39, 0x26000
    s_mov_b32 s58, 0x3f200
    buffer_load_dwordx4 v5, s[20:23], s58 offen lds
    s_setprio 0
    s_waitcnt lgkmcnt(4)
    v_mfma_f32_16x16x32_bf16 v[112:115], v[16:19], v[104:107], v[112:115]
    ds_read_b64_tr_b16 v[28:29], v223 offset:8192
    v_mfma_f32_16x16x32_bf16 v[116:119], v[16:19], v[108:111], v[116:119]
    ds_read_b64_tr_b16 v[30:31], v223 offset:12288
    s_waitcnt lgkmcnt(4)
    v_mfma_f32_16x16x32_bf16 v[120:123], v[20:23], v[104:107], v[120:123]
    v_mfma_f32_16x16x32_bf16 v[124:127], v[20:23], v[108:111], v[124:127]
    s_waitcnt lgkmcnt(2)
    v_mfma_f32_16x16x32_bf16 v[128:131], v[24:27], v[104:107], v[128:131]
    v_mfma_f32_16x16x32_bf16 v[132:135], v[24:27], v[108:111], v[132:135]
    s_waitcnt lgkmcnt(0)
    v_mfma_f32_16x16x32_bf16 v[136:139], v[28:31], v[104:107], v[136:139]
    v_mfma_f32_16x16x32_bf16 v[140:143], v[28:31], v[108:111], v[140:143]
    s_setprio 3
    s_waitcnt vmcnt(7)
    s_barrier
    ds_read_b64_tr_b16 v[16:17], v216 offset:32768
    ds_read_b64_tr_b16 v[18:19], v216 offset:36864
    ds_read_b64_tr_b16 v[20:21], v217 offset:32768
    ds_read_b64_tr_b16 v[22:23], v217 offset:36864
    ds_read_b64_tr_b16 v[24:25], v218 offset:32768
    ds_read_b64_tr_b16 v[26:27], v218 offset:36864
    s_waitcnt lgkmcnt(4)
    v_mfma_f32_16x16x32_bf16 v[144:147], v[16:19], v[48:51], 0
    ds_read_b64_tr_b16 v[28:29], v219 offset:32768
    v_mfma_f32_16x16x32_bf16 v[148:151], v[16:19], v[52:55], 0
    ds_read_b64_tr_b16 v[30:31], v219 offset:36864
    s_add_u32 m0, s39, 0x0
    s_mov_b32 s59, 0x300
    buffer_load_dwordx4 v5, s[20:23], s59 offen lds
    s_waitcnt lgkmcnt(4)
    v_mfma_f32_16x16x32_bf16 v[152:155], v[20:23], v[48:51], 0
    ds_read_b64_tr_b16 v[16:17], v216 offset:40960
    v_mfma_f32_16x16x32_bf16 v[156:159], v[20:23], v[52:55], 0
    ds_read_b64_tr_b16 v[18:19], v216 offset:45056
    s_add_u32 m0, s39, 0x2000
    s_mov_b32 s60, 0x9300
    buffer_load_dwordx4 v5, s[20:23], s60 offen lds
    s_waitcnt lgkmcnt(4)
    v_mfma_f32_16x16x32_bf16 v[160:163], v[24:27], v[48:51], 0
    ds_read_b64_tr_b16 v[20:21], v217 offset:40960
    v_mfma_f32_16x16x32_bf16 v[164:167], v[24:27], v[52:55], 0
    ds_read_b64_tr_b16 v[22:23], v217 offset:45056
    v_cvt_pk_bf16_f32 v176, v112, v113
    s_add_u32 m0, s39, 0x4000
    s_mov_b32 s61, 0x24300
    buffer_load_dwordx4 v5, s[20:23], s61 offen lds
    s_waitcnt lgkmcnt(4)
    v_mfma_f32_16x16x32_bf16 v[168:171], v[28:31], v[48:51], 0
    ds_read_b64_tr_b16 v[24:25], v218 offset:40960
    v_cvt_pk_bf16_f32 v177, v114, v115
    v_mfma_f32_16x16x32_bf16 v[172:175], v[28:31], v[52:55], 0
    ds_read_b64_tr_b16 v[26:27], v218 offset:45056
    v_cvt_pk_bf16_f32 v178, v120, v121
    s_add_u32 m0, s39, 0x6000
    s_mov_b32 s62, 0x2d300
    buffer_load_dwordx4 v5, s[20:23], s62 offen lds
    s_setprio 2
    s_waitcnt lgkmcnt(4)
    v_mfma_f32_16x16x32_bf16 v[144:147], v[16:19], v[56:59], v[144:147]
    ds_read_b64_tr_b16 v[28:29], v219 offset:40960
    v_cvt_pk_bf16_f32 v179, v122, v123
    v_mfma_f32_16x16x32_bf16 v[148:151], v[16:19], v[60:63], v[148:151]
    ds_read_b64_tr_b16 v[30:31], v219 offset:45056
    v_cvt_pk_bf16_f32 v180, v116, v117
    s_waitcnt lgkmcnt(4)
    v_mfma_f32_16x16x32_bf16 v[152:155], v[20:23], v[56:59], v[152:155]
    ds_read_b64_tr_b16 v[16:17], v220 offset:32768
    v_cvt_pk_bf16_f32 v181, v118, v119
    v_mfma_f32_16x16x32_bf16 v[156:159], v[20:23], v[60:63], v[156:159]
    ds_read_b64_tr_b16 v[18:19], v220 offset:36864
    v_cvt_pk_bf16_f32 v182, v124, v125
    s_waitcnt lgkmcnt(4)
    v_mfma_f32_16x16x32_bf16 v[160:163], v[24:27], v[56:59], v[160:163]
    ds_read_b64_tr_b16 v[20:21], v221 offset:32768
    v_cvt_pk_bf16_f32 v183, v126, v127
    v_mfma_f32_16x16x32_bf16 v[164:167], v[24:27], v[60:63], v[164:167]
    ds_read_b64_tr_b16 v[22:23], v221 offset:36864
    s_lshl_b32 s63, s36, 10
    s_add_u32 s63, s63, 0
    buffer_store_dwordx4 v[176:179], v245, s[28:31], s63 offen sc1
    s_lshl_b32 s56, s36, 10
    s_add_u32 s56, s56, 294912
    buffer_store_dwordx4 v[180:183], v245, s[28:31], s56 offen sc1
    s_waitcnt lgkmcnt(4)
    v_mfma_f32_16x16x32_bf16 v[168:171], v[28:31], v[56:59], v[168:171]
    ds_read_b64_tr_b16 v[24:25], v222 offset:32768
    v_cvt_pk_bf16_f32 v184, v128, v129
    v_mfma_f32_16x16x32_bf16 v[172:175], v[28:31], v[60:63], v[172:175]
    ds_read_b64_tr_b16 v[26:27], v222 offset:36864
    v_cvt_pk_bf16_f32 v185, v130, v131
    s_setprio 1
    s_waitcnt lgkmcnt(4)
    v_mfma_f32_16x16x32_bf16 v[144:147], v[16:19], v[80:83], v[144:147]
    ds_read_b64_tr_b16 v[28:29], v223 offset:32768
    v_cvt_pk_bf16_f32 v186, v136, v137
    v_mfma_f32_16x16x32_bf16 v[148:151], v[16:19], v[84:87], v[148:151]
    ds_read_b64_tr_b16 v[30:31], v223 offset:36864
    v_cvt_pk_bf16_f32 v187, v138, v139
    s_waitcnt lgkmcnt(4)
    v_mfma_f32_16x16x32_bf16 v[152:155], v[20:23], v[80:83], v[152:155]
    ds_read_b64_tr_b16 v[16:17], v220 offset:40960
    v_cvt_pk_bf16_f32 v188, v132, v133
    v_mfma_f32_16x16x32_bf16 v[156:159], v[20:23], v[84:87], v[156:159]
    ds_read_b64_tr_b16 v[18:19], v220 offset:45056
    v_cvt_pk_bf16_f32 v189, v134, v135
    s_waitcnt lgkmcnt(4)
    v_mfma_f32_16x16x32_bf16 v[160:163], v[24:27], v[80:83], v[160:163]
    ds_read_b64_tr_b16 v[20:21], v221 offset:40960
    v_cvt_pk_bf16_f32 v190, v140, v141
    v_mfma_f32_16x16x32_bf16 v[164:167], v[24:27], v[84:87], v[164:167]
    ds_read_b64_tr_b16 v[22:23], v221 offset:45056
    v_cvt_pk_bf16_f32 v191, v142, v143
    s_waitcnt lgkmcnt(4)
    v_mfma_f32_16x16x32_bf16 v[168:171], v[28:31], v[80:83], v[168:171]
    ds_read_b64_tr_b16 v[24:25], v222 offset:40960
    v_mfma_f32_16x16x32_bf16 v[172:175], v[28:31], v[84:87], v[172:175]
    ds_read_b64_tr_b16 v[26:27], v222 offset:45056
    s_lshl_b32 s57, s36, 10
    s_add_u32 s57, s57, 512
    buffer_store_dwordx4 v[184:187], v245, s[28:31], s57 offen sc1
    s_lshl_b32 s58, s36, 10
    s_add_u32 s58, s58, 295424
    buffer_store_dwordx4 v[188:191], v245, s[28:31], s58 offen sc1
    s_setprio 0
    s_waitcnt lgkmcnt(4)
    v_mfma_f32_16x16x32_bf16 v[144:147], v[16:19], v[88:91], v[144:147]
    ds_read_b64_tr_b16 v[28:29], v223 offset:40960
    v_mfma_f32_16x16x32_bf16 v[148:151], v[16:19], v[92:95], v[148:151]
    ds_read_b64_tr_b16 v[30:31], v223 offset:45056
    s_waitcnt lgkmcnt(4)
    v_mfma_f32_16x16x32_bf16 v[152:155], v[20:23], v[88:91], v[152:155]
    v_add_u32 v216, 0x10000, v216
    ds_read_b64_tr_b16 v[16:17], v216 offset:0
    v_mfma_f32_16x16x32_bf16 v[156:159], v[20:23], v[92:95], v[156:159]
    ds_read_b64_tr_b16 v[18:19], v216 offset:4096
    s_waitcnt lgkmcnt(4)
    v_mfma_f32_16x16x32_bf16 v[160:163], v[24:27], v[88:91], v[160:163]
    v_add_u32 v217, 0x10000, v217
    ds_read_b64_tr_b16 v[20:21], v217 offset:0
    v_mfma_f32_16x16x32_bf16 v[164:167], v[24:27], v[92:95], v[164:167]
    ds_read_b64_tr_b16 v[22:23], v217 offset:4096
    s_waitcnt lgkmcnt(4)
    v_mfma_f32_16x16x32_bf16 v[168:171], v[28:31], v[88:91], v[168:171]
    v_add_u32 v218, 0x10000, v218
    ds_read_b64_tr_b16 v[24:25], v218 offset:0
    v_mfma_f32_16x16x32_bf16 v[172:175], v[28:31], v[92:95], v[172:175]
    ds_read_b64_tr_b16 v[26:27], v218 offset:4096
    s_setprio 3
    s_waitcnt vmcnt(13)
    s_barrier
    s_waitcnt lgkmcnt(4)
    v_mfma_f32_16x16x32_bf16 v[144:147], v[16:19], v[64:67], v[144:147]
    v_add_u32 v219, 0x10000, v219
    ds_read_b64_tr_b16 v[28:29], v219 offset:0
    v_mfma_f32_16x16x32_bf16 v[148:151], v[16:19], v[68:71], v[148:151]
    ds_read_b64_tr_b16 v[30:31], v219 offset:4096
    s_add_u32 m0, s39, 0x8000
    s_mov_b32 s59, 0x12300
    buffer_load_dwordx4 v5, s[20:23], s59 offen lds
    s_waitcnt lgkmcnt(4)
    v_mfma_f32_16x16x32_bf16 v[152:155], v[20:23], v[64:67], v[152:155]
    ds_read_b64_tr_b16 v[16:17], v216 offset:8192
    v_mfma_f32_16x16x32_bf16 v[156:159], v[20:23], v[68:71], v[156:159]
    ds_read_b64_tr_b16 v[18:19], v216 offset:12288
    s_waitcnt lgkmcnt(4)
    v_mfma_f32_16x16x32_bf16 v[160:163], v[24:27], v[64:67], v[160:163]
    ds_read_b64_tr_b16 v[20:21], v217 offset:8192
    v_mfma_f32_16x16x32_bf16 v[164:167], v[24:27], v[68:71], v[164:167]
    ds_read_b64_tr_b16 v[22:23], v217 offset:12288
    s_add_u32 m0, s39, 0xa000
    s_mov_b32 s60, 0x1b300
    buffer_load_dwordx4 v5, s[20:23], s60 offen lds
    s_waitcnt lgkmcnt(4)
    v_mfma_f32_16x16x32_bf16 v[168:171], v[28:31], v[64:67], v[168:171]
    ds_read_b64_tr_b16 v[24:25], v218 offset:8192
    v_mfma_f32_16x16x32_bf16 v[172:175], v[28:31], v[68:71], v[172:175]
    ds_read_b64_tr_b16 v[26:27], v218 offset:12288
    s_setprio 2
    s_waitcnt lgkmcnt(4)
    v_mfma_f32_16x16x32_bf16 v[144:147], v[16:19], v[72:75], v[144:147]
    ds_read_b64_tr_b16 v[28:29], v219 offset:8192
    v_mfma_f32_16x16x32_bf16 v[148:151], v[16:19], v[76:79], v[148:151]
    ds_read_b64_tr_b16 v[30:31], v219 offset:12288
    s_add_u32 m0, s39, 0xc000
    s_mov_b32 s61, 0x36300
    buffer_load_dwordx4 v5, s[20:23], s61 offen lds
    s_waitcnt lgkmcnt(4)
    v_mfma_f32_16x16x32_bf16 v[152:155], v[20:23], v[72:75], v[152:155]
    v_add_u32 v220, 0x10000, v220
    ds_read_b64_tr_b16 v[16:17], v220 offset:0
    v_mfma_f32_16x16x32_bf16 v[156:159], v[20:23], v[76:79], v[156:159]
    ds_read_b64_tr_b16 v[18:19], v220 offset:4096
    s_waitcnt lgkmcnt(4)
    v_mfma_f32_16x16x32_bf16 v[160:163], v[24:27], v[72:75], v[160:163]
    v_add_u32 v221, 0x10000, v221
    ds_read_b64_tr_b16 v[20:21], v221 offset:0
    v_mfma_f32_16x16x32_bf16 v[164:167], v[24:27], v[76:79], v[164:167]
    ds_read_b64_tr_b16 v[22:23], v221 offset:4096
    s_add_u32 m0, s39, 0xe000
    s_mov_b32 s62, 0x3f300
    buffer_load_dwordx4 v5, s[20:23], s62 offen lds
    s_waitcnt lgkmcnt(4)
    v_mfma_f32_16x16x32_bf16 v[168:171], v[28:31], v[72:75], v[168:171]
    v_add_u32 v222, 0x10000, v222
    ds_read_b64_tr_b16 v[24:25], v222 offset:0
    v_mfma_f32_16x16x32_bf16 v[172:175], v[28:31], v[76:79], v[172:175]
    ds_read_b64_tr_b16 v[26:27], v222 offset:4096
    s_setprio 1
    s_waitcnt lgkmcnt(4)
    v_mfma_f32_16x16x32_bf16 v[144:147], v[16:19], v[96:99], v[144:147]
    v_add_u32 v223, 0x10000, v223
    ds_read_b64_tr_b16 v[28:29], v223 offset:0
    v_mfma_f32_16x16x32_bf16 v[148:151], v[16:19], v[100:103], v[148:151]
    ds_read_b64_tr_b16 v[30:31], v223 offset:4096
    s_waitcnt lgkmcnt(4)
    v_mfma_f32_16x16x32_bf16 v[152:155], v[20:23], v[96:99], v[152:155]
    ds_read_b64_tr_b16 v[16:17], v220 offset:8192
    v_mfma_f32_16x16x32_bf16 v[156:159], v[20:23], v[100:103], v[156:159]
    ds_read_b64_tr_b16 v[18:19], v220 offset:12288
    s_waitcnt lgkmcnt(4)
    v_mfma_f32_16x16x32_bf16 v[160:163], v[24:27], v[96:99], v[160:163]
    ds_read_b64_tr_b16 v[20:21], v221 offset:8192
    v_mfma_f32_16x16x32_bf16 v[164:167], v[24:27], v[100:103], v[164:167]
    ds_read_b64_tr_b16 v[22:23], v221 offset:12288
    s_waitcnt lgkmcnt(4)
    v_mfma_f32_16x16x32_bf16 v[168:171], v[28:31], v[96:99], v[168:171]
    ds_read_b64_tr_b16 v[24:25], v222 offset:8192
    v_mfma_f32_16x16x32_bf16 v[172:175], v[28:31], v[100:103], v[172:175]
    ds_read_b64_tr_b16 v[26:27], v222 offset:12288
    s_setprio 0
    s_waitcnt lgkmcnt(4)
    v_mfma_f32_16x16x32_bf16 v[144:147], v[16:19], v[104:107], v[144:147]
    ds_read_b64_tr_b16 v[28:29], v223 offset:8192
    v_mfma_f32_16x16x32_bf16 v[148:151], v[16:19], v[108:111], v[148:151]
    ds_read_b64_tr_b16 v[30:31], v223 offset:12288
    s_waitcnt lgkmcnt(4)
    v_mfma_f32_16x16x32_bf16 v[152:155], v[20:23], v[104:107], v[152:155]
    ds_read_b64_tr_b16 v[16:17], v216 offset:32768
    v_mfma_f32_16x16x32_bf16 v[156:159], v[20:23], v[108:111], v[156:159]
    ds_read_b64_tr_b16 v[18:19], v216 offset:36864
    s_waitcnt lgkmcnt(4)
    v_mfma_f32_16x16x32_bf16 v[160:163], v[24:27], v[104:107], v[160:163]
    ds_read_b64_tr_b16 v[20:21], v217 offset:32768
    v_mfma_f32_16x16x32_bf16 v[164:167], v[24:27], v[108:111], v[164:167]
    ds_read_b64_tr_b16 v[22:23], v217 offset:36864
    s_waitcnt lgkmcnt(4)
    v_mfma_f32_16x16x32_bf16 v[168:171], v[28:31], v[104:107], v[168:171]
    ds_read_b64_tr_b16 v[24:25], v218 offset:32768
    v_mfma_f32_16x16x32_bf16 v[172:175], v[28:31], v[108:111], v[172:175]
    ds_read_b64_tr_b16 v[26:27], v218 offset:36864
    s_setprio 3
    s_waitcnt vmcnt(13)
    s_barrier
    s_waitcnt lgkmcnt(4)
    v_mfma_f32_16x16x32_bf16 v[112:115], v[16:19], v[48:51], 0
    ds_read_b64_tr_b16 v[28:29], v219 offset:32768
    v_mfma_f32_16x16x32_bf16 v[116:119], v[16:19], v[52:55], 0
    ds_read_b64_tr_b16 v[30:31], v219 offset:36864
    s_add_u32 m0, s39, 0x10000
    s_mov_b32 s63, 0x400
    buffer_load_dwordx4 v6, s[20:23], s63 offen lds
    s_waitcnt lgkmcnt(4)
    v_mfma_f32_16x16x32_bf16 v[120:123], v[20:23], v[48:51], 0
    ds_read_b64_tr_b16 v[16:17], v216 offset:40960
    v_mfma_f32_16x16x32_bf16 v[124:127], v[20:23], v[52:55], 0
    ds_read_b64_tr_b16 v[18:19], v216 offset:45056
    s_waitcnt lgkmcnt(4)
    v_mfma_f32_16x16x32_bf16 v[128:131], v[24:27], v[48:51], 0
    ds_read_b64_tr_b16 v[20:21], v217 offset:40960
    v_mfma_f32_16x16x32_bf16 v[132:135], v[24:27], v[52:55], 0
    ds_read_b64_tr_b16 v[22:23], v217 offset:45056
    v_cvt_pk_bf16_f32 v192, v144, v145
    s_add_u32 m0, s39, 0x12000
    s_mov_b32 s56, 0x12400
    buffer_load_dwordx4 v6, s[20:23], s56 offen lds
    s_waitcnt lgkmcnt(4)
    v_mfma_f32_16x16x32_bf16 v[136:139], v[28:31], v[48:51], 0
    ds_read_b64_tr_b16 v[24:25], v218 offset:40960
    v_cvt_pk_bf16_f32 v193, v146, v147
    v_mfma_f32_16x16x32_bf16 v[140:143], v[28:31], v[52:55], 0
    ds_read_b64_tr_b16 v[26:27], v218 offset:45056
    v_cvt_pk_bf16_f32 v194, v152, v153
    s_setprio 2
    s_waitcnt lgkmcnt(4)
    v_mfma_f32_16x16x32_bf16 v[112:115], v[16:19], v[56:59], v[112:115]
    ds_read_b64_tr_b16 v[28:29], v219 offset:40960
    v_cvt_pk_bf16_f32 v195, v154, v155
    v_mfma_f32_16x16x32_bf16 v[116:119], v[16:19], v[60:63], v[116:119]
    ds_read_b64_tr_b16 v[30:31], v219 offset:45056
    v_cvt_pk_bf16_f32 v196, v148, v149
    s_add_u32 m0, s39, 0x14000
    s_mov_b32 s57, 0x24400
    buffer_load_dwordx4 v6, s[20:23], s57 offen lds
    s_waitcnt lgkmcnt(4)
    v_mfma_f32_16x16x32_bf16 v[120:123], v[20:23], v[56:59], v[120:123]
    ds_read_b64_tr_b16 v[16:17], v220 offset:32768
    v_cvt_pk_bf16_f32 v197, v150, v151
    v_mfma_f32_16x16x32_bf16 v[124:127], v[20:23], v[60:63], v[124:127]
    ds_read_b64_tr_b16 v[18:19], v220 offset:36864
    v_cvt_pk_bf16_f32 v198, v156, v157
    s_waitcnt lgkmcnt(4)
    v_mfma_f32_16x16x32_bf16 v[128:131], v[24:27], v[56:59], v[128:131]
    ds_read_b64_tr_b16 v[20:21], v221 offset:32768
    v_cvt_pk_bf16_f32 v199, v158, v159
    v_mfma_f32_16x16x32_bf16 v[132:135], v[24:27], v[60:63], v[132:135]
    ds_read_b64_tr_b16 v[22:23], v221 offset:36864
    s_add_u32 m0, s39, 0x16000
    s_mov_b32 s58, 0x36400
    buffer_load_dwordx4 v6, s[20:23], s58 offen lds
    s_waitcnt lgkmcnt(4)
    v_mfma_f32_16x16x32_bf16 v[136:139], v[28:31], v[56:59], v[136:139]
    ds_read_b64_tr_b16 v[24:25], v222 offset:32768
    v_cvt_pk_bf16_f32 v200, v160, v161
    v_mfma_f32_16x16x32_bf16 v[140:143], v[28:31], v[60:63], v[140:143]
    ds_read_b64_tr_b16 v[26:27], v222 offset:36864
    v_cvt_pk_bf16_f32 v201, v162, v163
    s_setprio 1
    s_waitcnt lgkmcnt(4)
    v_mfma_f32_16x16x32_bf16 v[112:115], v[16:19], v[80:83], v[112:115]
    ds_read_b64_tr_b16 v[28:29], v223 offset:32768
    v_cvt_pk_bf16_f32 v202, v168, v169
    v_mfma_f32_16x16x32_bf16 v[116:119], v[16:19], v[84:87], v[116:119]
    ds_read_b64_tr_b16 v[30:31], v223 offset:36864
    v_cvt_pk_bf16_f32 v203, v170, v171
    s_lshl_b32 s59, s36, 10
    s_add_u32 s59, s59, 2048
    buffer_store_dwordx4 v[192:195], v245, s[28:31], s59 offen sc1
    s_lshl_b32 s60, s36, 10
    s_add_u32 s60, s60, 296960
    buffer_store_dwordx4 v[196:199], v245, s[28:31], s60 offen sc1
    s_waitcnt lgkmcnt(4)
    v_mfma_f32_16x16x32_bf16 v[120:123], v[20:23], v[80:83], v[120:123]
    ds_read_b64_tr_b16 v[16:17], v220 offset:40960
    v_cvt_pk_bf16_f32 v204, v164, v165
    v_mfma_f32_16x16x32_bf16 v[124:127], v[20:23], v[84:87], v[124:127]
    ds_read_b64_tr_b16 v[18:19], v220 offset:45056
    v_cvt_pk_bf16_f32 v205, v166, v167
    s_waitcnt lgkmcnt(4)
    v_mfma_f32_16x16x32_bf16 v[128:131], v[24:27], v[80:83], v[128:131]
    ds_read_b64_tr_b16 v[20:21], v221 offset:40960
    v_cvt_pk_bf16_f32 v206, v172, v173
    v_mfma_f32_16x16x32_bf16 v[132:135], v[24:27], v[84:87], v[132:135]
    ds_read_b64_tr_b16 v[22:23], v221 offset:45056
    v_cvt_pk_bf16_f32 v207, v174, v175
    s_waitcnt lgkmcnt(4)
    v_mfma_f32_16x16x32_bf16 v[136:139], v[28:31], v[80:83], v[136:139]
    ds_read_b64_tr_b16 v[24:25], v222 offset:40960
    v_mfma_f32_16x16x32_bf16 v[140:143], v[28:31], v[84:87], v[140:143]
    ds_read_b64_tr_b16 v[26:27], v222 offset:45056
    s_setprio 0
    s_waitcnt lgkmcnt(4)
    v_mfma_f32_16x16x32_bf16 v[112:115], v[16:19], v[88:91], v[112:115]
    ds_read_b64_tr_b16 v[28:29], v223 offset:40960
    v_mfma_f32_16x16x32_bf16 v[116:119], v[16:19], v[92:95], v[116:119]
    ds_read_b64_tr_b16 v[30:31], v223 offset:45056
    s_lshl_b32 s61, s36, 10
    s_add_u32 s61, s61, 2560
    buffer_store_dwordx4 v[200:203], v245, s[28:31], s61 offen sc1
    s_lshl_b32 s62, s36, 10
    s_add_u32 s62, s62, 297472
    buffer_store_dwordx4 v[204:207], v245, s[28:31], s62 offen sc1
    s_waitcnt lgkmcnt(4)
    v_mfma_f32_16x16x32_bf16 v[120:123], v[20:23], v[88:91], v[120:123]
    v_add_u32 v216, 0x10000, v216
    ds_read_b64_tr_b16 v[16:17], v216 offset:0
    v_mfma_f32_16x16x32_bf16 v[124:127], v[20:23], v[92:95], v[124:127]
    ds_read_b64_tr_b16 v[18:19], v216 offset:4096
    s_waitcnt lgkmcnt(4)
    v_mfma_f32_16x16x32_bf16 v[128:131], v[24:27], v[88:91], v[128:131]
    v_add_u32 v217, 0x10000, v217
    ds_read_b64_tr_b16 v[20:21], v217 offset:0
    v_mfma_f32_16x16x32_bf16 v[132:135], v[24:27], v[92:95], v[132:135]
    ds_read_b64_tr_b16 v[22:23], v217 offset:4096
    s_waitcnt lgkmcnt(4)
    v_mfma_f32_16x16x32_bf16 v[136:139], v[28:31], v[88:91], v[136:139]
    v_add_u32 v218, 0x10000, v218
    ds_read_b64_tr_b16 v[24:25], v218 offset:0
    v_mfma_f32_16x16x32_bf16 v[140:143], v[28:31], v[92:95], v[140:143]
    ds_read_b64_tr_b16 v[26:27], v218 offset:4096
    s_setprio 3
    s_waitcnt vmcnt(17)
    s_barrier
    s_waitcnt lgkmcnt(4)
    v_mfma_f32_16x16x32_bf16 v[112:115], v[16:19], v[64:67], v[112:115]
    v_add_u32 v219, 0x10000, v219
    ds_read_b64_tr_b16 v[28:29], v219 offset:0
    v_mfma_f32_16x16x32_bf16 v[116:119], v[16:19], v[68:71], v[116:119]
    ds_read_b64_tr_b16 v[30:31], v219 offset:4096
    s_waitcnt lgkmcnt(4)
    v_mfma_f32_16x16x32_bf16 v[120:123], v[20:23], v[64:67], v[120:123]
    ds_read_b64_tr_b16 v[16:17], v216 offset:8192
    v_mfma_f32_16x16x32_bf16 v[124:127], v[20:23], v[68:71], v[124:127]
    ds_read_b64_tr_b16 v[18:19], v216 offset:12288
    s_waitcnt lgkmcnt(4)
    v_mfma_f32_16x16x32_bf16 v[128:131], v[24:27], v[64:67], v[128:131]
    ds_read_b64_tr_b16 v[20:21], v217 offset:8192
    v_mfma_f32_16x16x32_bf16 v[132:135], v[24:27], v[68:71], v[132:135]
    ds_read_b64_tr_b16 v[22:23], v217 offset:12288
    s_waitcnt lgkmcnt(4)
    v_mfma_f32_16x16x32_bf16 v[136:139], v[28:31], v[64:67], v[136:139]
    ds_read_b64_tr_b16 v[24:25], v218 offset:8192
    v_mfma_f32_16x16x32_bf16 v[140:143], v[28:31], v[68:71], v[140:143]
    ds_read_b64_tr_b16 v[26:27], v218 offset:12288
    s_setprio 2
    s_waitcnt lgkmcnt(4)
    v_mfma_f32_16x16x32_bf16 v[112:115], v[16:19], v[72:75], v[112:115]
    ds_read_b64_tr_b16 v[28:29], v219 offset:8192
    v_mfma_f32_16x16x32_bf16 v[116:119], v[16:19], v[76:79], v[116:119]
    ds_read_b64_tr_b16 v[30:31], v219 offset:12288
    s_waitcnt lgkmcnt(4)
    v_mfma_f32_16x16x32_bf16 v[120:123], v[20:23], v[72:75], v[120:123]
    v_add_u32 v220, 0x10000, v220
    ds_read_b64_tr_b16 v[16:17], v220 offset:0
    v_mfma_f32_16x16x32_bf16 v[124:127], v[20:23], v[76:79], v[124:127]
    ds_read_b64_tr_b16 v[18:19], v220 offset:4096
    s_waitcnt lgkmcnt(4)
    v_mfma_f32_16x16x32_bf16 v[128:131], v[24:27], v[72:75], v[128:131]
    v_add_u32 v221, 0x10000, v221
    ds_read_b64_tr_b16 v[20:21], v221 offset:0
    v_mfma_f32_16x16x32_bf16 v[132:135], v[24:27], v[76:79], v[132:135]
    ds_read_b64_tr_b16 v[22:23], v221 offset:4096
    s_waitcnt lgkmcnt(4)
    v_mfma_f32_16x16x32_bf16 v[136:139], v[28:31], v[72:75], v[136:139]
    v_add_u32 v222, 0x10000, v222
    ds_read_b64_tr_b16 v[24:25], v222 offset:0
    v_mfma_f32_16x16x32_bf16 v[140:143], v[28:31], v[76:79], v[140:143]
    ds_read_b64_tr_b16 v[26:27], v222 offset:4096
    s_setprio 1
    s_waitcnt lgkmcnt(4)
    v_mfma_f32_16x16x32_bf16 v[112:115], v[16:19], v[96:99], v[112:115]
    v_add_u32 v223, 0x10000, v223
    ds_read_b64_tr_b16 v[28:29], v223 offset:0
    v_mfma_f32_16x16x32_bf16 v[116:119], v[16:19], v[100:103], v[116:119]
    ds_read_b64_tr_b16 v[30:31], v223 offset:4096
    s_waitcnt lgkmcnt(4)
    v_mfma_f32_16x16x32_bf16 v[120:123], v[20:23], v[96:99], v[120:123]
    ds_read_b64_tr_b16 v[16:17], v220 offset:8192
    v_mfma_f32_16x16x32_bf16 v[124:127], v[20:23], v[100:103], v[124:127]
    ds_read_b64_tr_b16 v[18:19], v220 offset:12288
    s_waitcnt lgkmcnt(4)
    v_mfma_f32_16x16x32_bf16 v[128:131], v[24:27], v[96:99], v[128:131]
    ds_read_b64_tr_b16 v[20:21], v221 offset:8192
    v_mfma_f32_16x16x32_bf16 v[132:135], v[24:27], v[100:103], v[132:135]
    ds_read_b64_tr_b16 v[22:23], v221 offset:12288
    s_waitcnt lgkmcnt(4)
    v_mfma_f32_16x16x32_bf16 v[136:139], v[28:31], v[96:99], v[136:139]
    ds_read_b64_tr_b16 v[24:25], v222 offset:8192
    v_mfma_f32_16x16x32_bf16 v[140:143], v[28:31], v[100:103], v[140:143]
    ds_read_b64_tr_b16 v[26:27], v222 offset:12288
    s_setprio 0
    s_waitcnt lgkmcnt(4)
    v_mfma_f32_16x16x32_bf16 v[112:115], v[16:19], v[104:107], v[112:115]
    ds_read_b64_tr_b16 v[28:29], v223 offset:8192
    v_mfma_f32_16x16x32_bf16 v[116:119], v[16:19], v[108:111], v[116:119]
    ds_read_b64_tr_b16 v[30:31], v223 offset:12288
    s_waitcnt lgkmcnt(4)
    v_mfma_f32_16x16x32_bf16 v[120:123], v[20:23], v[104:107], v[120:123]
    v_subrev_u32 v216, 0x20000, v216
    ds_read_b64_tr_b16 v[16:17], v216 offset:0
    v_mfma_f32_16x16x32_bf16 v[124:127], v[20:23], v[108:111], v[124:127]
    ds_read_b64_tr_b16 v[18:19], v216 offset:4096
    s_waitcnt lgkmcnt(4)
    v_mfma_f32_16x16x32_bf16 v[128:131], v[24:27], v[104:107], v[128:131]
    v_subrev_u32 v217, 0x20000, v217
    ds_read_b64_tr_b16 v[20:21], v217 offset:0
    v_mfma_f32_16x16x32_bf16 v[132:135], v[24:27], v[108:111], v[132:135]
    ds_read_b64_tr_b16 v[22:23], v217 offset:4096
    s_waitcnt lgkmcnt(4)
    v_mfma_f32_16x16x32_bf16 v[136:139], v[28:31], v[104:107], v[136:139]
    v_subrev_u32 v218, 0x20000, v218
    ds_read_b64_tr_b16 v[24:25], v218 offset:0
    v_mfma_f32_16x16x32_bf16 v[140:143], v[28:31], v[108:111], v[140:143]
    ds_read_b64_tr_b16 v[26:27], v218 offset:4096
    s_setprio 3
    s_waitcnt vmcnt(9)
    s_barrier
    s_waitcnt lgkmcnt(4)
    v_mfma_f32_16x16x32_bf16 v[144:147], v[16:19], v[48:51], 0
    v_subrev_u32 v219, 0x20000, v219
    ds_read_b64_tr_b16 v[28:29], v219 offset:0
    v_mfma_f32_16x16x32_bf16 v[148:151], v[16:19], v[52:55], 0
    ds_read_b64_tr_b16 v[30:31], v219 offset:4096
    s_waitcnt lgkmcnt(4)
    v_mfma_f32_16x16x32_bf16 v[152:155], v[20:23], v[48:51], 0
    ds_read_b64_tr_b16 v[16:17], v216 offset:8192
    v_mfma_f32_16x16x32_bf16 v[156:159], v[20:23], v[52:55], 0
    ds_read_b64_tr_b16 v[18:19], v216 offset:12288
    s_waitcnt lgkmcnt(4)
    v_mfma_f32_16x16x32_bf16 v[160:163], v[24:27], v[48:51], 0
    ds_read_b64_tr_b16 v[20:21], v217 offset:8192
    v_mfma_f32_16x16x32_bf16 v[164:167], v[24:27], v[52:55], 0
    ds_read_b64_tr_b16 v[22:23], v217 offset:12288
    v_cvt_pk_bf16_f32 v176, v112, v113
    s_waitcnt lgkmcnt(4)
    v_mfma_f32_16x16x32_bf16 v[168:171], v[28:31], v[48:51], 0
    ds_read_b64_tr_b16 v[24:25], v218 offset:8192
    v_cvt_pk_bf16_f32 v177, v114, v115
    v_mfma_f32_16x16x32_bf16 v[172:175], v[28:31], v[52:55], 0
    ds_read_b64_tr_b16 v[26:27], v218 offset:12288
    v_cvt_pk_bf16_f32 v178, v120, v121
    s_setprio 2
    s_waitcnt lgkmcnt(4)
    v_mfma_f32_16x16x32_bf16 v[144:147], v[16:19], v[56:59], v[144:147]
    ds_read_b64_tr_b16 v[28:29], v219 offset:8192
    v_cvt_pk_bf16_f32 v179, v122, v123
    v_mfma_f32_16x16x32_bf16 v[148:151], v[16:19], v[60:63], v[148:151]
    ds_read_b64_tr_b16 v[30:31], v219 offset:12288
    v_cvt_pk_bf16_f32 v180, v116, v117
    s_waitcnt lgkmcnt(4)
    v_mfma_f32_16x16x32_bf16 v[152:155], v[20:23], v[56:59], v[152:155]
    v_subrev_u32 v220, 0x20000, v220
    ds_read_b64_tr_b16 v[16:17], v220 offset:0
    v_cvt_pk_bf16_f32 v181, v118, v119
    v_mfma_f32_16x16x32_bf16 v[156:159], v[20:23], v[60:63], v[156:159]
    ds_read_b64_tr_b16 v[18:19], v220 offset:4096
    v_cvt_pk_bf16_f32 v182, v124, v125
    s_waitcnt lgkmcnt(4)
    v_mfma_f32_16x16x32_bf16 v[160:163], v[24:27], v[56:59], v[160:163]
    v_subrev_u32 v221, 0x20000, v221
    ds_read_b64_tr_b16 v[20:21], v221 offset:0
    v_cvt_pk_bf16_f32 v183, v126, v127
    v_mfma_f32_16x16x32_bf16 v[164:167], v[24:27], v[60:63], v[164:167]
    ds_read_b64_tr_b16 v[22:23], v221 offset:4096
    s_lshl_b32 s63, s36, 10
    s_add_u32 s63, s63, 4096
    buffer_store_dwordx4 v[176:179], v245, s[28:31], s63 offen sc1
    s_lshl_b32 s56, s36, 10
    s_add_u32 s56, s56, 299008
    buffer_store_dwordx4 v[180:183], v245, s[28:31], s56 offen sc1
    s_waitcnt lgkmcnt(4)
    v_mfma_f32_16x16x32_bf16 v[168:171], v[28:31], v[56:59], v[168:171]
    v_subrev_u32 v222, 0x20000, v222
    ds_read_b64_tr_b16 v[24:25], v222 offset:0
    v_cvt_pk_bf16_f32 v184, v128, v129
    v_mfma_f32_16x16x32_bf16 v[172:175], v[28:31], v[60:63], v[172:175]
    ds_read_b64_tr_b16 v[26:27], v222 offset:4096
    v_cvt_pk_bf16_f32 v185, v130, v131
    s_setprio 1
    s_waitcnt lgkmcnt(4)
    v_mfma_f32_16x16x32_bf16 v[144:147], v[16:19], v[80:83], v[144:147]
    v_subrev_u32 v223, 0x20000, v223
    ds_read_b64_tr_b16 v[28:29], v223 offset:0
    v_cvt_pk_bf16_f32 v186, v136, v137
    v_mfma_f32_16x16x32_bf16 v[148:151], v[16:19], v[84:87], v[148:151]
    ds_read_b64_tr_b16 v[30:31], v223 offset:4096
    v_cvt_pk_bf16_f32 v187, v138, v139
    s_waitcnt lgkmcnt(4)
    v_mfma_f32_16x16x32_bf16 v[152:155], v[20:23], v[80:83], v[152:155]
    ds_read_b64_tr_b16 v[16:17], v220 offset:8192
    v_cvt_pk_bf16_f32 v188, v132, v133
    v_mfma_f32_16x16x32_bf16 v[156:159], v[20:23], v[84:87], v[156:159]
    ds_read_b64_tr_b16 v[18:19], v220 offset:12288
    v_cvt_pk_bf16_f32 v189, v134, v135
    s_waitcnt lgkmcnt(4)
    v_mfma_f32_16x16x32_bf16 v[160:163], v[24:27], v[80:83], v[160:163]
    ds_read_b64_tr_b16 v[20:21], v221 offset:8192
    v_cvt_pk_bf16_f32 v190, v140, v141
    v_mfma_f32_16x16x32_bf16 v[164:167], v[24:27], v[84:87], v[164:167]
    ds_read_b64_tr_b16 v[22:23], v221 offset:12288
    v_cvt_pk_bf16_f32 v191, v142, v143
    s_waitcnt lgkmcnt(4)
    v_mfma_f32_16x16x32_bf16 v[168:171], v[28:31], v[80:83], v[168:171]
    ds_read_b64_tr_b16 v[24:25], v222 offset:8192
    v_mfma_f32_16x16x32_bf16 v[172:175], v[28:31], v[84:87], v[172:175]
    ds_read_b64_tr_b16 v[26:27], v222 offset:12288
    s_setprio 0
    s_waitcnt lgkmcnt(4)
    v_mfma_f32_16x16x32_bf16 v[144:147], v[16:19], v[88:91], v[144:147]
    ds_read_b64_tr_b16 v[28:29], v223 offset:8192
    v_mfma_f32_16x16x32_bf16 v[148:151], v[16:19], v[92:95], v[148:151]
    ds_read_b64_tr_b16 v[30:31], v223 offset:12288
    s_lshl_b32 s57, s36, 10
    s_add_u32 s57, s57, 4608
    buffer_store_dwordx4 v[184:187], v245, s[28:31], s57 offen sc1
    s_lshl_b32 s58, s36, 10
    s_add_u32 s58, s58, 299520
    buffer_store_dwordx4 v[188:191], v245, s[28:31], s58 offen sc1
    s_waitcnt lgkmcnt(4)
    v_mfma_f32_16x16x32_bf16 v[152:155], v[20:23], v[88:91], v[152:155]
    ds_read_b64_tr_b16 v[16:17], v216 offset:32768
    v_mfma_f32_16x16x32_bf16 v[156:159], v[20:23], v[92:95], v[156:159]
    ds_read_b64_tr_b16 v[18:19], v216 offset:36864
    s_waitcnt lgkmcnt(4)
    v_mfma_f32_16x16x32_bf16 v[160:163], v[24:27], v[88:91], v[160:163]
    ds_read_b64_tr_b16 v[20:21], v217 offset:32768
    v_mfma_f32_16x16x32_bf16 v[164:167], v[24:27], v[92:95], v[164:167]
    ds_read_b64_tr_b16 v[22:23], v217 offset:36864
    s_waitcnt lgkmcnt(4)
    v_mfma_f32_16x16x32_bf16 v[168:171], v[28:31], v[88:91], v[168:171]
    ds_read_b64_tr_b16 v[24:25], v218 offset:32768
    v_mfma_f32_16x16x32_bf16 v[172:175], v[28:31], v[92:95], v[172:175]
    ds_read_b64_tr_b16 v[26:27], v218 offset:36864
    s_setprio 3
    s_waitcnt vmcnt(9)
    s_barrier
    s_waitcnt lgkmcnt(4)
    v_mfma_f32_16x16x32_bf16 v[144:147], v[16:19], v[64:67], v[144:147]
    ds_read_b64_tr_b16 v[28:29], v219 offset:32768
    v_mfma_f32_16x16x32_bf16 v[148:151], v[16:19], v[68:71], v[148:151]
    ds_read_b64_tr_b16 v[30:31], v219 offset:36864
    s_waitcnt lgkmcnt(4)
    v_mfma_f32_16x16x32_bf16 v[152:155], v[20:23], v[64:67], v[152:155]
    ds_read_b64_tr_b16 v[16:17], v216 offset:40960
    v_mfma_f32_16x16x32_bf16 v[156:159], v[20:23], v[68:71], v[156:159]
    ds_read_b64_tr_b16 v[18:19], v216 offset:45056
    s_waitcnt lgkmcnt(4)
    v_mfma_f32_16x16x32_bf16 v[160:163], v[24:27], v[64:67], v[160:163]
    ds_read_b64_tr_b16 v[20:21], v217 offset:40960
    v_mfma_f32_16x16x32_bf16 v[164:167], v[24:27], v[68:71], v[164:167]
    ds_read_b64_tr_b16 v[22:23], v217 offset:45056
    s_waitcnt lgkmcnt(4)
    v_mfma_f32_16x16x32_bf16 v[168:171], v[28:31], v[64:67], v[168:171]
    ds_read_b64_tr_b16 v[24:25], v218 offset:40960
    v_mfma_f32_16x16x32_bf16 v[172:175], v[28:31], v[68:71], v[172:175]
    ds_read_b64_tr_b16 v[26:27], v218 offset:45056
    s_setprio 2
    s_waitcnt lgkmcnt(4)
    v_mfma_f32_16x16x32_bf16 v[144:147], v[16:19], v[72:75], v[144:147]
    ds_read_b64_tr_b16 v[28:29], v219 offset:40960
    v_mfma_f32_16x16x32_bf16 v[148:151], v[16:19], v[76:79], v[148:151]
    ds_read_b64_tr_b16 v[30:31], v219 offset:45056
    s_waitcnt lgkmcnt(4)
    v_mfma_f32_16x16x32_bf16 v[152:155], v[20:23], v[72:75], v[152:155]
    ds_read_b64_tr_b16 v[16:17], v220 offset:32768
    v_mfma_f32_16x16x32_bf16 v[156:159], v[20:23], v[76:79], v[156:159]
    ds_read_b64_tr_b16 v[18:19], v220 offset:36864
    s_waitcnt lgkmcnt(4)
    v_mfma_f32_16x16x32_bf16 v[160:163], v[24:27], v[72:75], v[160:163]
    ds_read_b64_tr_b16 v[20:21], v221 offset:32768
    v_mfma_f32_16x16x32_bf16 v[164:167], v[24:27], v[76:79], v[164:167]
    ds_read_b64_tr_b16 v[22:23], v221 offset:36864
    s_waitcnt lgkmcnt(4)
    v_mfma_f32_16x16x32_bf16 v[168:171], v[28:31], v[72:75], v[168:171]
    ds_read_b64_tr_b16 v[24:25], v222 offset:32768
    v_mfma_f32_16x16x32_bf16 v[172:175], v[28:31], v[76:79], v[172:175]
    ds_read_b64_tr_b16 v[26:27], v222 offset:36864
    s_setprio 1
    s_waitcnt lgkmcnt(4)
    v_mfma_f32_16x16x32_bf16 v[144:147], v[16:19], v[96:99], v[144:147]
    ds_read_b64_tr_b16 v[28:29], v223 offset:32768
    v_mfma_f32_16x16x32_bf16 v[148:151], v[16:19], v[100:103], v[148:151]
    ds_read_b64_tr_b16 v[30:31], v223 offset:36864
    s_waitcnt lgkmcnt(4)
    v_mfma_f32_16x16x32_bf16 v[152:155], v[20:23], v[96:99], v[152:155]
    ds_read_b64_tr_b16 v[16:17], v220 offset:40960
    v_mfma_f32_16x16x32_bf16 v[156:159], v[20:23], v[100:103], v[156:159]
    ds_read_b64_tr_b16 v[18:19], v220 offset:45056
    s_waitcnt lgkmcnt(4)
    v_mfma_f32_16x16x32_bf16 v[160:163], v[24:27], v[96:99], v[160:163]
    ds_read_b64_tr_b16 v[20:21], v221 offset:40960
    v_mfma_f32_16x16x32_bf16 v[164:167], v[24:27], v[100:103], v[164:167]
    ds_read_b64_tr_b16 v[22:23], v221 offset:45056
    s_waitcnt lgkmcnt(4)
    v_mfma_f32_16x16x32_bf16 v[168:171], v[28:31], v[96:99], v[168:171]
    ds_read_b64_tr_b16 v[24:25], v222 offset:40960
    v_mfma_f32_16x16x32_bf16 v[172:175], v[28:31], v[100:103], v[172:175]
    ds_read_b64_tr_b16 v[26:27], v222 offset:45056
    s_setprio 0
    s_waitcnt lgkmcnt(4)
    v_mfma_f32_16x16x32_bf16 v[144:147], v[16:19], v[104:107], v[144:147]
    ds_read_b64_tr_b16 v[28:29], v223 offset:40960
    v_mfma_f32_16x16x32_bf16 v[148:151], v[16:19], v[108:111], v[148:151]
    ds_read_b64_tr_b16 v[30:31], v223 offset:45056
    s_waitcnt lgkmcnt(4)
    v_mfma_f32_16x16x32_bf16 v[152:155], v[20:23], v[104:107], v[152:155]
    v_add_u32 v224, 0x10000, v224
    ds_read_b64_tr_b16 v[16:17], v224 offset:0
    v_mfma_f32_16x16x32_bf16 v[156:159], v[20:23], v[108:111], v[156:159]
    ds_read_b64_tr_b16 v[18:19], v224 offset:2048
    s_waitcnt lgkmcnt(4)
    v_mfma_f32_16x16x32_bf16 v[160:163], v[24:27], v[104:107], v[160:163]
    v_add_u32 v225, 0x10000, v225
    ds_read_b64_tr_b16 v[20:21], v225 offset:0
    v_mfma_f32_16x16x32_bf16 v[164:167], v[24:27], v[108:111], v[164:167]
    ds_read_b64_tr_b16 v[22:23], v225 offset:2048
    s_waitcnt lgkmcnt(4)
    v_mfma_f32_16x16x32_bf16 v[168:171], v[28:31], v[104:107], v[168:171]
    ds_read_b64_tr_b16 v[24:25], v224 offset:4096
    v_mfma_f32_16x16x32_bf16 v[172:175], v[28:31], v[108:111], v[172:175]
    ds_read_b64_tr_b16 v[26:27], v224 offset:6144
    s_setprio 3
    s_waitcnt vmcnt(8)
    s_barrier
    s_waitcnt lgkmcnt(4)
    v_mfma_f32_16x16x32_bf16 v[112:115], v[16:19], v[48:51], 0
    ds_read_b64_tr_b16 v[28:29], v225 offset:4096
    v_mfma_f32_16x16x32_bf16 v[116:119], v[16:19], v[52:55], 0
    ds_read_b64_tr_b16 v[30:31], v225 offset:6144
    s_waitcnt lgkmcnt(4)
    v_mfma_f32_16x16x32_bf16 v[120:123], v[20:23], v[48:51], 0
    ds_read_b64_tr_b16 v[16:17], v224 offset:8192
    v_mfma_f32_16x16x32_bf16 v[124:127], v[20:23], v[52:55], 0
    ds_read_b64_tr_b16 v[18:19], v224 offset:10240
    s_waitcnt lgkmcnt(4)
    v_mfma_f32_16x16x32_bf16 v[112:115], v[24:27], v[56:59], v[112:115]
    ds_read_b64_tr_b16 v[20:21], v225 offset:8192
    v_mfma_f32_16x16x32_bf16 v[116:119], v[24:27], v[60:63], v[116:119]
    ds_read_b64_tr_b16 v[22:23], v225 offset:10240
    v_cvt_pk_bf16_f32 v192, v144, v145
    s_waitcnt lgkmcnt(4)
    v_mfma_f32_16x16x32_bf16 v[120:123], v[28:31], v[56:59], v[120:123]
    ds_read_b64_tr_b16 v[24:25], v224 offset:12288
    v_cvt_pk_bf16_f32 v193, v146, v147
    v_mfma_f32_16x16x32_bf16 v[124:127], v[28:31], v[60:63], v[124:127]
    ds_read_b64_tr_b16 v[26:27], v224 offset:14336
    v_cvt_pk_bf16_f32 v194, v152, v153
    s_setprio 2
    s_waitcnt lgkmcnt(4)
    v_mfma_f32_16x16x32_bf16 v[112:115], v[16:19], v[64:67], v[112:115]
    ds_read_b64_tr_b16 v[28:29], v225 offset:12288
    v_cvt_pk_bf16_f32 v195, v154, v155
    v_mfma_f32_16x16x32_bf16 v[116:119], v[16:19], v[68:71], v[116:119]
    ds_read_b64_tr_b16 v[30:31], v225 offset:14336
    v_cvt_pk_bf16_f32 v196, v148, v149
    s_waitcnt lgkmcnt(4)
    v_mfma_f32_16x16x32_bf16 v[120:123], v[20:23], v[64:67], v[120:123]
    v_add_u32 v226, 0x10000, v226
    ds_read_b64_tr_b16 v[16:17], v226 offset:0
    v_cvt_pk_bf16_f32 v197, v150, v151
    v_mfma_f32_16x16x32_bf16 v[124:127], v[20:23], v[68:71], v[124:127]
    ds_read_b64_tr_b16 v[18:19], v226 offset:2048
    v_cvt_pk_bf16_f32 v198, v156, v157
    s_waitcnt lgkmcnt(4)
    v_mfma_f32_16x16x32_bf16 v[112:115], v[24:27], v[72:75], v[112:115]
    v_add_u32 v227, 0x10000, v227
    ds_read_b64_tr_b16 v[20:21], v227 offset:0
    v_cvt_pk_bf16_f32 v199, v158, v159
    v_mfma_f32_16x16x32_bf16 v[116:119], v[24:27], v[76:79], v[116:119]
    ds_read_b64_tr_b16 v[22:23], v227 offset:2048
    s_lshl_b32 s59, s36, 10
    s_add_u32 s59, s59, 6144
    buffer_store_dwordx4 v[192:195], v245, s[28:31], s59 offen sc1
    s_lshl_b32 s60, s36, 10
    s_add_u32 s60, s60, 301056
    buffer_store_dwordx4 v[196:199], v245, s[28:31], s60 offen sc1
    s_waitcnt lgkmcnt(4)
    v_mfma_f32_16x16x32_bf16 v[120:123], v[28:31], v[72:75], v[120:123]
    ds_read_b64_tr_b16 v[24:25], v226 offset:4096
    v_cvt_pk_bf16_f32 v200, v160, v161
    v_mfma_f32_16x16x32_bf16 v[124:127], v[28:31], v[76:79], v[124:127]
    ds_read_b64_tr_b16 v[26:27], v226 offset:6144
    v_cvt_pk_bf16_f32 v201, v162, v163
    s_setprio 1
    s_waitcnt lgkmcnt(4)
    v_mfma_f32_16x16x32_bf16 v[112:115], v[16:19], v[80:83], v[112:115]
    ds_read_b64_tr_b16 v[28:29], v227 offset:4096
    v_cvt_pk_bf16_f32 v202, v168, v169
    v_mfma_f32_16x16x32_bf16 v[116:119], v[16:19], v[84:87], v[116:119]
    ds_read_b64_tr_b16 v[30:31], v227 offset:6144
    v_cvt_pk_bf16_f32 v203, v170, v171
    s_waitcnt lgkmcnt(4)
    v_mfma_f32_16x16x32_bf16 v[120:123], v[20:23], v[80:83], v[120:123]
    ds_read_b64_tr_b16 v[16:17], v226 offset:8192
    v_cvt_pk_bf16_f32 v204, v164, v165
    v_mfma_f32_16x16x32_bf16 v[124:127], v[20:23], v[84:87], v[124:127]
    ds_read_b64_tr_b16 v[18:19], v226 offset:10240
    v_cvt_pk_bf16_f32 v205, v166, v167
    s_waitcnt lgkmcnt(4)
    v_mfma_f32_16x16x32_bf16 v[112:115], v[24:27], v[88:91], v[112:115]
    ds_read_b64_tr_b16 v[20:21], v227 offset:8192
    v_cvt_pk_bf16_f32 v206, v172, v173
    v_mfma_f32_16x16x32_bf16 v[116:119], v[24:27], v[92:95], v[116:119]
    ds_read_b64_tr_b16 v[22:23], v227 offset:10240
    v_cvt_pk_bf16_f32 v207, v174, v175
    s_waitcnt lgkmcnt(4)
    v_mfma_f32_16x16x32_bf16 v[120:123], v[28:31], v[88:91], v[120:123]
    ds_read_b64_tr_b16 v[24:25], v226 offset:12288
    v_mfma_f32_16x16x32_bf16 v[124:127], v[28:31], v[92:95], v[124:127]
    ds_read_b64_tr_b16 v[26:27], v226 offset:14336
    s_setprio 0
    s_waitcnt lgkmcnt(4)
    v_mfma_f32_16x16x32_bf16 v[112:115], v[16:19], v[96:99], v[112:115]
    ds_read_b64_tr_b16 v[28:29], v227 offset:12288
    v_mfma_f32_16x16x32_bf16 v[116:119], v[16:19], v[100:103], v[116:119]
    ds_read_b64_tr_b16 v[30:31], v227 offset:14336
    s_lshl_b32 s61, s36, 10
    s_add_u32 s61, s61, 6656
    buffer_store_dwordx4 v[200:203], v245, s[28:31], s61 offen sc1
    s_lshl_b32 s62, s36, 10
    s_add_u32 s62, s62, 301568
    buffer_store_dwordx4 v[204:207], v245, s[28:31], s62 offen sc1
    s_waitcnt lgkmcnt(4)
    v_mfma_f32_16x16x32_bf16 v[120:123], v[20:23], v[96:99], v[120:123]
    v_mfma_f32_16x16x32_bf16 v[124:127], v[20:23], v[100:103], v[124:127]
    s_waitcnt lgkmcnt(2)
    v_mfma_f32_16x16x32_bf16 v[112:115], v[24:27], v[104:107], v[112:115]
    v_mfma_f32_16x16x32_bf16 v[116:119], v[24:27], v[108:111], v[116:119]
    s_waitcnt lgkmcnt(0)
    v_mfma_f32_16x16x32_bf16 v[120:123], v[28:31], v[104:107], v[120:123]
    v_mfma_f32_16x16x32_bf16 v[124:127], v[28:31], v[108:111], v[124:127]
    s_nop 3
    v_cvt_pk_bf16_f32 v176, v112, v113
    v_cvt_pk_bf16_f32 v177, v114, v115
    s_nop 0
    v_cvt_pk_bf16_f32 v178, v120, v121
    v_cvt_pk_bf16_f32 v179, v122, v123
    v_cvt_pk_bf16_f32 v180, v116, v117
    v_cvt_pk_bf16_f32 v181, v118, v119
    v_cvt_pk_bf16_f32 v182, v124, v125
    v_cvt_pk_bf16_f32 v183, v126, v127
    s_lshl_b32 s63, s36, 9
    s_add_u32 s63, s63, 8192
    buffer_store_dwordx4 v[176:179], v245, s[28:31], s63 offen sc1
    s_lshl_b32 s56, s36, 9
    s_add_u32 s56, s56, 303104
    buffer_store_dwordx4 v[180:183], v245, s[28:31], s56 offen sc1
    s_setprio 0
    s_load_dwordx2 s[40:41], s[0:1], 48
    s_load_dwordx2 s[42:43], s[0:1], 56
    s_load_dwordx2 s[48:49], s[0:1], 104
    s_load_dwordx2 s[44:45], s[0:1], 64
    v_lshlrev_b32 v1, 4, v7
    s_lshl_b32 s39, s32, 10
    s_and_b32 s54, s33, 1
    s_lshl_b32 s55, s54, 6
    s_xor_b32 s54, s54, 1
    s_lshl_b32 s54, s54, 9
    s_mul_i32 s51, s35, 73728
    s_add_u32 s51, s51, s55
    v_lshrrev_b32 v64, 3, v7
    v_bfe_u32 v65, v64, 1, 2
    v_lshlrev_b32 v65, 1, v65
    v_and_b32 v2, 7, v7
    v_xor_b32 v2, v2, v65
    v_lshlrev_b32 v2, 4, v2
    s_mov_b32 s50, 9216
    v_mul_lo_u32 v64, v64, s50
    v_add_u32 v2, v2, v64
    v_add_u32 v2, s51, v2
    s_cmp_eq_u32 s36, 0
    s_waitcnt lgkmcnt(0)
    s_cselect_b32 s46, s40, s42
    s_cselect_b32 s47, s41, s43
    s_mul_i32 s50, s33, 576
    s_mov_b32 s8, s46
    s_mov_b32 s9, s47
    s_mov_b32 s10, 0x510000
    s_add_u32 s8, s8, s50
    s_addc_u32 s9, s9, 0
    s_sub_u32 s10, s10, s50
    s_mov_b32 s11, 0x00020000
    s_mul_i32 s50, s34, 147456
    s_add_u32 s24, s48, 0x500000
    s_addc_u32 s25, s49, 0
    s_mov_b32 s26, 0x240000
    s_add_u32 s24, s24, s50
    s_addc_u32 s25, s25, 0
    s_sub_u32 s26, s26, s50
    s_mov_b32 s27, 0x00020000
    v_and_b32 v246, 7, v7
    v_bfe_u32 v247, v7, 3, 2
    v_lshrrev_b32 v248, 5, v7
    s_lshl_b32 s50, s32, 1
    v_add_u32 v248, s50, v248
    s_lshr_b32 s50, s98, 2
    s_mul_i32 s50, s50, 36864
    s_bfe_u32 s51, s98, 0x10001
    s_lshl_b32 s51, s51, 10
    s_add_u32 s50, s50, s51
    s_and_b32 s51, s98, 1
    s_lshl_b32 s51, s51, 7
    s_add_u32 s50, s50, s51
    v_lshlrev_b32 v16, 11, v248
    v_lshl_add_u32 v16, v247, 8, v16
    v_lshl_add_u32 v16, v246, 4, v16
    v_add_u32 v16, s50, v16
    s_mul_i32 s50, s98, 9216
    v_mul_u32_u24 v17, 1152, v246
    v_lshl_add_u32 v17, v248, 6, v17
    v_lshl_add_u32 v17, v247, 3, v17
    v_add_u32 v17, s50, v17
    v_lshlrev_b32 v18, 7, v248
    v_lshl_add_u32 v18, v247, 4, v18
    s_cmp_lg_u32 s32, 0
    s_cbranch_scc1 L_itb_39
    buffer_load_dwordx2 v[24:25], v17, s[80:83], 0 offen offset:1024
    buffer_load_dwordx2 v[26:27], v17, s[80:83], 0 offen offset:1056
L_itb_39:
    buffer_load_dwordx2 v[20:21], v17, s[80:83], 0 offen offset:0
    buffer_load_dwordx2 v[22:23], v17, s[80:83], 0 offen offset:32
    s_cmp_lg_u32 s32, 0
    s_cbranch_scc1 L_itb_40
    s_mov_b32 s50, 4608
    buffer_load_dwordx4 v[36:39], v18, s[76:79], s50 offen offset:2048 sc1
    buffer_load_dwordx4 v[40:43], v18, s[76:79], s50 offen offset:2112 sc1
    s_mov_b32 s50, 9216
    buffer_load_dwordx4 v[52:55], v18, s[76:79], s50 offen offset:2048 sc1
    buffer_load_dwordx4 v[56:59], v18, s[76:79], s50 offen offset:2112 sc1
    s_mov_b32 s50, 6912
    buffer_load_dwordx4 v[68:71], v18, s[76:79], s50 offen offset:2048 sc1
    buffer_load_dwordx4 v[72:75], v18, s[76:79], s50 offen offset:2112 sc1
L_itb_40:
    s_mov_b32 s50, 4608
    buffer_load_dwordx4 v[28:31], v18, s[76:79], s50 offen offset:0 sc1
    buffer_load_dwordx4 v[32:35], v18, s[76:79], s50 offen offset:64 sc1
    s_mov_b32 s50, 9216
    buffer_load_dwordx4 v[44:47], v18, s[76:79], s50 offen offset:0 sc1
    buffer_load_dwordx4 v[48:51], v18, s[76:79], s50 offen offset:64 sc1
    s_mov_b32 s50, 6912
    buffer_load_dwordx4 v[60:63], v18, s[76:79], s50 offen offset:0 sc1
    buffer_load_dwordx4 v[64:67], v18, s[76:79], s50 offen offset:64 sc1
    v_bfe_u32 v246, v7, 2, 2
    v_lshrrev_b32 v247, 4, v7
    v_and_b32 v248, 1, v7
    v_lshlrev_b32 v248, 4, v248
    v_mov_b32 v249, 0x3f80
    v_lshlrev_b32 v249, v248, v249
    v_cmp_eq_u32 vcc, v246, v247
    s_nop 1
    v_cndmask_b32 v249, 0, v249, vcc
    v_bfe_u32 v248, v7, 1, 1
    v_cmp_eq_u32 vcc, 0, v248
    s_nop 1
    v_cndmask_b32 v242, 0, v249, vcc
    v_sub_u32 v243, v249, v242
    v_mov_b32 v240, 0
    v_mov_b32 v241, 0
    v_mov_b32 v244, 0
    v_mov_b32 v245, 0
    s_waitcnt vmcnt(0)
    s_barrier
    s_cmp_lg_u32 s32, 0
    s_cbranch_scc1 L_pub_41
    s_lshl_b32 s50, s98, 3
    s_add_u32 s50, s50, 34816
    v_mov_b32 v248, s96
    v_mov_b32 v249, s97
    v_mov_b32 v246, 0
    v_cmp_eq_u32 vcc, 0, v7
    s_nop 0
    s_and_saveexec_b64 s[4:5], vcc
    buffer_store_dwordx2 v[248:249], v246, s[76:79], s50 offen sc1
    s_mov_b64 exec, s[4:5]
L_pub_41:
    s_nop 1
    s_cmp_lg_u32 s32, 0
    s_cbranch_scc1 L_pt_42
    v_and_b32 v246, 15, v7
    v_lshlrev_b32 v246, 3, v246
    s_lshl_b32 s51, s34, 7
    s_add_u32 s51, s51, 34816
    s_mov_b32 s50, 0
L_ptl_43:
    buffer_load_dwordx2 v[248:249], v246, s[76:79], s51 offen sc1
    s_waitcnt vmcnt(0)
    v_cmp_ne_u64 vcc, s[96:97], v[248:249]
    s_add_u32 s50, s50, 1
    s_cbranch_vccz L_ptd_44
    s_cmp_ge_u32 s50, 20000
    s_cbranch_scc1 L_ptd_44
    s_sleep 1
    s_branch L_ptl_43
L_ptd_44:
L_pt_42:
    s_nop 1
    s_barrier
    s_mul_i32 s50, s98, 147456
    s_lshl_b32 s51, s32, 10
    s_add_u32 s50, s50, s51
    v_lshlrev_b32 v251, 4, v7
    v_add_u32 v251, s50, v251
    s_cmp_lg_u32 s32, 0
    s_cbranch_scc1 L_itb_45
    s_mov_b32 s56, 0x802000
    buffer_load_dwordx4 v[176:179], v251, s[76:79], s56 offen sc1
    s_mov_b32 s57, 0x804400
    buffer_load_dwordx4 v[180:183], v251, s[76:79], s57 offen sc1
    s_mov_b32 s58, 0x806800
    buffer_load_dwordx4 v[184:187], v251, s[76:79], s58 offen sc1
    s_mov_b32 s59, 0x808c00
    buffer_load_dwordx4 v[188:191], v251, s[76:79], s59 offen sc1
    s_mov_b32 s60, 0x80b000
    buffer_load_dwordx4 v[192:195], v251, s[76:79], s60 offen sc1
    s_mov_b32 s61, 0x80d400
    buffer_load_dwordx4 v[196:199], v251, s[76:79], s61 offen sc1
    s_mov_b32 s62, 0x80f800
    buffer_load_dwordx4 v[200:203], v251, s[76:79], s62 offen sc1
    s_mov_b32 s63, 0x811c00
    buffer_load_dwordx4 v[204:207], v251, s[76:79], s63 offen sc1
    s_mov_b32 s56, 0x814000
    buffer_load_dwordx4 v[208:211], v251, s[76:79], s56 offen sc1
    s_mov_b32 s57, 0x816400
    buffer_load_dwordx4 v[212:215], v251, s[76:79], s57 offen sc1
    s_mov_b32 s58, 0x818800
    buffer_load_dwordx4 v[216:219], v251, s[76:79], s58 offen sc1
    s_mov_b32 s59, 0x81ac00
    buffer_load_dwordx4 v[220:223], v251, s[76:79], s59 offen sc1
    s_mov_b32 s60, 0x81d000
    buffer_load_dwordx4 v[224:227], v251, s[76:79], s60 offen sc1
    s_mov_b32 s61, 0x81f400
    buffer_load_dwordx4 v[228:231], v251, s[76:79], s61 offen sc1
    s_mov_b32 s62, 0x821800
    buffer_load_dwordx4 v[232:235], v251, s[76:79], s62 offen sc1
    s_mov_b32 s63, 0x823c00
    buffer_load_dwordx4 v[236:239], v251, s[76:79], s63 offen sc1
L_itb_45:
    s_mov_b32 s56, 0x800000
    buffer_load_dwordx4 v[112:115], v251, s[76:79], s56 offen sc1
    s_mov_b32 s57, 0x802400
    buffer_load_dwordx4 v[116:119], v251, s[76:79], s57 offen sc1
    s_mov_b32 s58, 0x804800
    buffer_load_dwordx4 v[120:123], v251, s[76:79], s58 offen sc1
    s_mov_b32 s59, 0x806c00
    buffer_load_dwordx4 v[124:127], v251, s[76:79], s59 offen sc1
    s_mov_b32 s60, 0x809000
    buffer_load_dwordx4 v[128:131], v251, s[76:79], s60 offen sc1
    s_mov_b32 s61, 0x80b400
    buffer_load_dwordx4 v[132:135], v251, s[76:79], s61 offen sc1
    s_mov_b32 s62, 0x80d800
    buffer_load_dwordx4 v[136:139], v251, s[76:79], s62 offen sc1
    s_mov_b32 s63, 0x80fc00
    buffer_load_dwordx4 v[140:143], v251, s[76:79], s63 offen sc1
    s_mov_b32 s56, 0x812000
    buffer_load_dwordx4 v[144:147], v251, s[76:79], s56 offen sc1
    s_mov_b32 s57, 0x814400
    buffer_load_dwordx4 v[148:151], v251, s[76:79], s57 offen sc1
    s_mov_b32 s58, 0x816800
    buffer_load_dwordx4 v[152:155], v251, s[76:79], s58 offen sc1
    s_mov_b32 s59, 0x818c00
    buffer_load_dwordx4 v[156:159], v251, s[76:79], s59 offen sc1
    s_mov_b32 s60, 0x81b000
    buffer_load_dwordx4 v[160:163], v251, s[76:79], s60 offen sc1
    s_mov_b32 s61, 0x81d400
    buffer_load_dwordx4 v[164:167], v251, s[76:79], s61 offen sc1
    s_mov_b32 s62, 0x81f800
    buffer_load_dwordx4 v[168:171], v251, s[76:79], s62 offen sc1
    s_mov_b32 s63, 0x821c00
    buffer_load_dwordx4 v[172:175], v251, s[76:79], s63 offen sc1
    s_add_u32 m0, s39, 0x2000
    s_mov_b32 s57, 0x0
    buffer_load_dwordx4 v2, s[8:11], s57 offen lds
    s_add_u32 m0, s39, 0x6000
    s_mov_b32 s58, 0x48000
    buffer_load_dwordx4 v2, s[8:11], s58 offen lds
    s_add_u32 m0, s39, 0xa000
    s_mov_b32 s59, 0x90000
    buffer_load_dwordx4 v2, s[8:11], s59 offen lds
    s_add_u32 m0, s39, 0xe000
    s_mov_b32 s60, 0xd8000
    buffer_load_dwordx4 v2, s[8:11], s60 offen lds
    s_add_u32 m0, s39, 0x12000
    s_mov_b32 s61, 0x120000
    buffer_load_dwordx4 v2, s[8:11], s61 offen lds
    s_add_u32 m0, s39, 0x16000
    s_mov_b32 s62, 0x168000
    buffer_load_dwordx4 v2, s[8:11], s62 offen lds
    s_add_u32 m0, s39, 0x1a000
    s_mov_b32 s63, 0x1b0000
    buffer_load_dwordx4 v2, s[8:11], s63 offen lds
    s_add_u32 m0, s39, 0x1e000
    s_mov_b32 s56, 0x1f8000
    buffer_load_dwordx4 v2, s[8:11], s56 offen lds
    s_add_u32 m0, s39, 0x22000
    s_mov_b32 s57, 0x240000
    buffer_load_dwordx4 v2, s[8:11], s57 offen lds
    s_waitcnt vmcnt(24)
    v_mfma_f32_16x16x32_bf16 v[92:95], v[242:245], v[112:115], 0
    v_mfma_f32_16x16x32_bf16 v[96:99], v[240:243], v[112:115], 0
    s_waitcnt vmcnt(23)
    v_mfma_f32_16x16x32_bf16 v[92:95], v[242:245], v[116:119], v[92:95]
    v_mfma_f32_16x16x32_bf16 v[96:99], v[240:243], v[116:119], v[96:99]
    s_waitcnt vmcnt(22)
    v_mfma_f32_16x16x32_bf16 v[92:95], v[242:245], v[120:123], v[92:95]
    v_mfma_f32_16x16x32_bf16 v[96:99], v[240:243], v[120:123], v[96:99]
    s_waitcnt vmcnt(21)
    v_mfma_f32_16x16x32_bf16 v[92:95], v[242:245], v[124:127], v[92:95]
    v_mfma_f32_16x16x32_bf16 v[96:99], v[240:243], v[124:127], v[96:99]
    s_waitcnt vmcnt(20)
    v_mfma_f32_16x16x32_bf16 v[92:95], v[242:245], v[128:131], v[92:95]
    v_mfma_f32_16x16x32_bf16 v[96:99], v[240:243], v[128:131], v[96:99]
    s_waitcnt vmcnt(19)
    v_mfma_f32_16x16x32_bf16 v[92:95], v[242:245], v[132:135], v[92:95]
    v_mfma_f32_16x16x32_bf16 v[96:99], v[240:243], v[132:135], v[96:99]
    s_waitcnt vmcnt(18)
    v_mfma_f32_16x16x32_bf16 v[92:95], v[242:245], v[136:139], v[92:95]
    v_mfma_f32_16x16x32_bf16 v[96:99], v[240:243], v[136:139], v[96:99]
    s_waitcnt vmcnt(17)
    v_mfma_f32_16x16x32_bf16 v[92:95], v[242:245], v[140:143], v[92:95]
    v_mfma_f32_16x16x32_bf16 v[96:99], v[240:243], v[140:143], v[96:99]
    s_waitcnt vmcnt(16)
    v_mfma_f32_16x16x32_bf16 v[92:95], v[242:245], v[144:147], v[92:95]
    v_mfma_f32_16x16x32_bf16 v[96:99], v[240:243], v[144:147], v[96:99]
    s_waitcnt vmcnt(15)
    v_mfma_f32_16x16x32_bf16 v[92:95], v[242:245], v[148:151], v[92:95]
    v_mfma_f32_16x16x32_bf16 v[96:99], v[240:243], v[148:151], v[96:99]
    s_waitcnt vmcnt(14)
    v_mfma_f32_16x16x32_bf16 v[92:95], v[242:245], v[152:155], v[92:95]
    v_mfma_f32_16x16x32_bf16 v[96:99], v[240:243], v[152:155], v[96:99]
    s_waitcnt vmcnt(13)
    v_mfma_f32_16x16x32_bf16 v[92:95], v[242:245], v[156:159], v[92:95]
    v_mfma_f32_16x16x32_bf16 v[96:99], v[240:243], v[156:159], v[96:99]
    s_waitcnt vmcnt(12)
    v_mfma_f32_16x16x32_bf16 v[92:95], v[242:245], v[160:163], v[92:95]
    v_mfma_f32_16x16x32_bf16 v[96:99], v[240:243], v[160:163], v[96:99]
    s_waitcnt vmcnt(11)
    v_mfma_f32_16x16x32_bf16 v[92:95], v[242:245], v[164:167], v[92:95]
    v_mfma_f32_16x16x32_bf16 v[96:99], v[240:243], v[164:167], v[96:99]
    s_waitcnt vmcnt(10)
    v_mfma_f32_16x16x32_bf16 v[92:95], v[242:245], v[168:171], v[92:95]
    v_mfma_f32_16x16x32_bf16 v[96:99], v[240:243], v[168:171], v[96:99]
    s_waitcnt vmcnt(9)
    v_mfma_f32_16x16x32_bf16 v[92:95], v[242:245], v[172:175], v[92:95]
    v_mfma_f32_16x16x32_bf16 v[96:99], v[240:243], v[172:175], v[96:99]
    v_lshlrev_b32 v76, 16, v20
    v_and_b32 v77, 0xffff0000, v20
    v_lshlrev_b32 v78, 16, v21
    v_and_b32 v79, 0xffff0000, v21
    v_lshlrev_b32 v80, 16, v22
    v_and_b32 v81, 0xffff0000, v22
    v_lshlrev_b32 v82, 16, v23
    v_and_b32 v83, 0xffff0000, v23
    v_cvt_pk_bf16_f32 v246, v92, v93
    v_lshlrev_b32 v92, 16, v246
    v_and_b32 v93, 0xffff0000, v246
    v_cvt_pk_bf16_f32 v246, v94, v95
    v_lshlrev_b32 v94, 16, v246
    v_and_b32 v95, 0xffff0000, v246
    v_cvt_pk_bf16_f32 v246, v96, v97
    v_lshlrev_b32 v96, 16, v246
    v_and_b32 v97, 0xffff0000, v246
    v_cvt_pk_bf16_f32 v246, v98, v99
    v_lshlrev_b32 v98, 16, v246
    v_and_b32 v99, 0xffff0000, v246
    v_mul_f32 v92, v92, v28
    v_mul_f32 v93, v93, v29
    v_mul_f32 v94, v94, v30
    v_mul_f32 v95, v95, v31
    v_mul_f32 v96, v96, v32
    v_mul_f32 v97, v97, v33
    v_mul_f32 v98, v98, v34
    v_mul_f32 v99, v99, v35
    v_cvt_pk_bf16_f32 v246, v92, v93
    v_lshlrev_b32 v92, 16, v246
    v_and_b32 v93, 0xffff0000, v246
    v_cvt_pk_bf16_f32 v246, v94, v95
    v_lshlrev_b32 v94, 16, v246
    v_and_b32 v95, 0xffff0000, v246
    v_cvt_pk_bf16_f32 v246, v96, v97
    v_lshlrev_b32 v96, 16, v246
    v_and_b32 v97, 0xffff0000, v246
    v_cvt_pk_bf16_f32 v246, v98, v99
    v_lshlrev_b32 v98, 16, v246
    v_and_b32 v99, 0xffff0000, v246
    v_add_f32 v76, v76, v92
    v_add_f32 v77, v77, v93
    v_add_f32 v78, v78, v94
    v_add_f32 v79, v79, v95
    v_add_f32 v80, v80, v96
    v_add_f32 v81, v81, v97
    v_add_f32 v82, v82, v98
    v_add_f32 v83, v83, v99
    v_cvt_pk_bf16_f32 v20, v76, v77
    v_cvt_pk_bf16_f32 v21, v78, v79
    v_cvt_pk_bf16_f32 v22, v80, v81
    v_cvt_pk_bf16_f32 v23, v82, v83
    s_mov_b32 s50, 0x280000
    buffer_store_dwordx4 v[20:23], v16, s[76:79], s50 offen sc1
    s_cmp_lg_u32 s32, 0
    s_cbranch_scc1 L_itb_46
    v_mfma_f32_16x16x32_bf16 v[100:103], v[242:245], v[176:179], 0
    v_mfma_f32_16x16x32_bf16 v[104:107], v[240:243], v[176:179], 0
    v_mfma_f32_16x16x32_bf16 v[100:103], v[242:245], v[180:183], v[100:103]
    v_mfma_f32_16x16x32_bf16 v[104:107], v[240:243], v[180:183], v[104:107]
    v_mfma_f32_16x16x32_bf16 v[100:103], v[242:245], v[184:187], v[100:103]
    v_mfma_f32_16x16x32_bf16 v[104:107], v[240:243], v[184:187], v[104:107]
    v_mfma_f32_16x16x32_bf16 v[100:103], v[242:245], v[188:191], v[100:103]
    v_mfma_f32_16x16x32_bf16 v[104:107], v[240:243], v[188:191], v[104:107]
    v_mfma_f32_16x16x32_bf16 v[100:103], v[242:245], v[192:195], v[100:103]
    v_mfma_f32_16x16x32_bf16 v[104:107], v[240:243], v[192:195], v[104:107]
    v_mfma_f32_16x16x32_bf16 v[100:103], v[242:245], v[196:199], v[100:103]
    v_mfma_f32_16x16x32_bf16 v[104:107], v[240:243], v[196:199], v[104:107]
    v_mfma_f32_16x16x32_bf16 v[100:103], v[242:245], v[200:203], v[100:103]
    v_mfma_f32_16x16x32_bf16 v[104:107], v[240:243], v[200:203], v[104:107]
    v_mfma_f32_16x16x32_bf16 v[100:103], v[242:245], v[204:207], v[100:103]
    v_mfma_f32_16x16x32_bf16 v[104:107], v[240:243], v[204:207], v[104:107]
    v_mfma_f32_16x16x32_bf16 v[100:103], v[242:245], v[208:211], v[100:103]
    v_mfma_f32_16x16x32_bf16 v[104:107], v[240:243], v[208:211], v[104:107]
    v_mfma_f32_16x16x32_bf16 v[100:103], v[242:245], v[212:215], v[100:103]
    v_mfma_f32_16x16x32_bf16 v[104:107], v[240:243], v[212:215], v[104:107]
    v_mfma_f32_16x16x32_bf16 v[100:103], v[242:245], v[216:219], v[100:103]
    v_mfma_f32_16x16x32_bf16 v[104:107], v[240:243], v[216:219], v[104:107]
    v_mfma_f32_16x16x32_bf16 v[100:103], v[242:245], v[220:223], v[100:103]
    v_mfma_f32_16x16x32_bf16 v[104:107], v[240:243], v[220:223], v[104:107]
    v_mfma_f32_16x16x32_bf16 v[100:103], v[242:245], v[224:227], v[100:103]
    v_mfma_f32_16x16x32_bf16 v[104:107], v[240:243], v[224:227], v[104:107]
    v_mfma_f32_16x16x32_bf16 v[100:103], v[242:245], v[228:231], v[100:103]
    v_mfma_f32_16x16x32_bf16 v[104:107], v[240:243], v[228:231], v[104:107]
    v_mfma_f32_16x16x32_bf16 v[100:103], v[242:245], v[232:235], v[100:103]
    v_mfma_f32_16x16x32_bf16 v[104:107], v[240:243], v[232:235], v[104:107]
    v_mfma_f32_16x16x32_bf16 v[100:103], v[242:245], v[236:239], v[100:103]
    v_mfma_f32_16x16x32_bf16 v[104:107], v[240:243], v[236:239], v[104:107]
    v_lshlrev_b32 v84, 16, v24
    v_and_b32 v85, 0xffff0000, v24
    v_lshlrev_b32 v86, 16, v25
    v_and_b32 v87, 0xffff0000, v25
    v_lshlrev_b32 v88, 16, v26
    v_and_b32 v89, 0xffff0000, v26
    v_lshlrev_b32 v90, 16, v27
    v_and_b32 v91, 0xffff0000, v27
    v_cvt_pk_bf16_f32 v246, v100, v101
    v_lshlrev_b32 v100, 16, v246
    v_and_b32 v101, 0xffff0000, v246
    v_cvt_pk_bf16_f32 v246, v102, v103
    v_lshlrev_b32 v102, 16, v246
    v_and_b32 v103, 0xffff0000, v246
    v_cvt_pk_bf16_f32 v246, v104, v105
    v_lshlrev_b32 v104, 16, v246
    v_and_b32 v105, 0xffff0000, v246
    v_cvt_pk_bf16_f32 v246, v106, v107
    v_lshlrev_b32 v106, 16, v246
    v_and_b32 v107, 0xffff0000, v246
    v_mul_f32 v100, v100, v36
    v_mul_f32 v101, v101, v37
    v_mul_f32 v102, v102, v38
    v_mul_f32 v103, v103, v39
    v_mul_f32 v104, v104, v40
    v_mul_f32 v105, v105, v41
    v_mul_f32 v106, v106, v42
    v_mul_f32 v107, v107, v43
    v_cvt_pk_bf16_f32 v246, v100, v101
    v_lshlrev_b32 v100, 16, v246
    v_and_b32 v101, 0xffff0000, v246
    v_cvt_pk_bf16_f32 v246, v102, v103
    v_lshlrev_b32 v102, 16, v246
    v_and_b32 v103, 0xffff0000, v246
    v_cvt_pk_bf16_f32 v246, v104, v105
    v_lshlrev_b32 v104, 16, v246
    v_and_b32 v105, 0xffff0000, v246
    v_cvt_pk_bf16_f32 v246, v106, v107
    v_lshlrev_b32 v106, 16, v246
    v_and_b32 v107, 0xffff0000, v246
    v_add_f32 v84, v84, v100
    v_add_f32 v85, v85, v101
    v_add_f32 v86, v86, v102
    v_add_f32 v87, v87, v103
    v_add_f32 v88, v88, v104
    v_add_f32 v89, v89, v105
    v_add_f32 v90, v90, v106
    v_add_f32 v91, v91, v107
    v_cvt_pk_bf16_f32 v24, v84, v85
    v_cvt_pk_bf16_f32 v25, v86, v87
    v_cvt_pk_bf16_f32 v26, v88, v89
    v_cvt_pk_bf16_f32 v27, v90, v91
    s_mov_b32 s50, 0x288000
    buffer_store_dwordx4 v[24:27], v16, s[76:79], s50 offen sc1
L_itb_46:
    v_and_b32 v255, 7, v7
    v_lshlrev_b32 v255, 5, v255
    v_add_u32 v255, 155648, v255
    s_lshl_b32 s50, s32, 2
    v_add_u32 v254, s50, v255
    v_lshlrev_b32 v76, 16, v20
    v_and_b32 v77, 0xffff0000, v20
    v_lshlrev_b32 v78, 16, v21
    v_and_b32 v79, 0xffff0000, v21
    v_lshlrev_b32 v80, 16, v22
    v_and_b32 v81, 0xffff0000, v22
    v_lshlrev_b32 v82, 16, v23
    v_and_b32 v83, 0xffff0000, v23
    v_add_f32 v252, v76, v77
    v_add_f32 v252, v252, v78
    v_add_f32 v252, v252, v79
    v_add_f32 v252, v252, v80
    v_add_f32 v252, v252, v81
    v_add_f32 v252, v252, v82
    v_add_f32 v252, v252, v83
    s_cmp_lg_u32 s32, 0
    s_cbranch_scc1 L_itb_47
    v_lshlrev_b32 v84, 16, v24
    v_and_b32 v85, 0xffff0000, v24
    v_lshlrev_b32 v86, 16, v25
    v_and_b32 v87, 0xffff0000, v25
    v_lshlrev_b32 v88, 16, v26
    v_and_b32 v89, 0xffff0000, v26
    v_lshlrev_b32 v90, 16, v27
    v_and_b32 v91, 0xffff0000, v27
    v_add_f32 v252, v252, v84
    v_add_f32 v252, v252, v85
    v_add_f32 v252, v252, v86
    v_add_f32 v252, v252, v87
    v_add_f32 v252, v252, v88
    v_add_f32 v252, v252, v89
    v_add_f32 v252, v252, v90
    v_add_f32 v252, v252, v91
L_itb_47:
    s_nop 1
    v_add_f32_dpp v246, v252, v252 row_ror:8 row_mask:0xf bank_mask:0xf
    v_mov_b32 v252, v246
    s_nop 1
    v_permlane16_swap_b32 v252, v246
    v_add_f32 v252, v252, v246
    v_mov_b32 v246, v252
    s_nop 0
    s_nop 0
    v_permlane32_swap_b32 v252, v246
    v_add_f32 v252, v252, v246
    v_cmp_gt_u32 vcc, 8, v7
    s_nop 0
    s_and_saveexec_b64 s[50:51], vcc
    ds_write_b32 v254, v252 offset:0
    s_mov_b64 exec, s[50:51]
    s_waitcnt lgkmcnt(0)
    s_barrier
    ds_read_b128 v[92:95], v255 offset:0
    ds_read_b128 v[96:99], v255 offset:16
    s_waitcnt lgkmcnt(1)
    v_add_f32 v252, v92, v93
    v_add_f32 v252, v252, v94
    v_add_f32 v252, v252, v95
    s_waitcnt lgkmcnt(0)
    v_add_f32 v252, v252, v96
    v_add_f32 v252, v252, v97
    v_add_f32 v252, v252, v98
    v_add_f32 v252, v252, v99
    v_mul_f32 v253, 0x3ae38e39, v252
    v_sub_f32 v248, v76, v253
    v_mul_f32 v252, v248, v248
    v_sub_f32 v248, v77, v253
    v_fmac_f32 v252, v248, v248
    v_sub_f32 v248, v78, v253
    v_fmac_f32 v252, v248, v248
    v_sub_f32 v248, v79, v253
    v_fmac_f32 v252, v248, v248
    v_sub_f32 v248, v80, v253
    v_fmac_f32 v252, v248, v248
    v_sub_f32 v248, v81, v253
    v_fmac_f32 v252, v248, v248
    v_sub_f32 v248, v82, v253
    v_fmac_f32 v252, v248, v248
    v_sub_f32 v248, v83, v253
    v_fmac_f32 v252, v248, v248
    s_cmp_lg_u32 s32, 0
    s_cbranch_scc1 L_itb_48
    v_sub_f32 v248, v84, v253
    v_fmac_f32 v252, v248, v248
    v_sub_f32 v248, v85, v253
    v_fmac_f32 v252, v248, v248
    v_sub_f32 v248, v86, v253
    v_fmac_f32 v252, v248, v248
    v_sub_f32 v248, v87, v253
    v_fmac_f32 v252, v248, v248
    v_sub_f32 v248, v88, v253
    v_fmac_f32 v252, v248, v248
    v_sub_f32 v248, v89, v253
    v_fmac_f32 v252, v248, v248
    v_sub_f32 v248, v90, v253
    v_fmac_f32 v252, v248, v248
    v_sub_f32 v248, v91, v253
    v_fmac_f32 v252, v248, v248
L_itb_48:
    s_nop 1
    v_add_f32_dpp v246, v252, v252 row_ror:8 row_mask:0xf bank_mask:0xf
    v_mov_b32 v252, v246
    s_nop 1
    v_permlane16_swap_b32 v252, v246
    v_add_f32 v252, v252, v246
    v_mov_b32 v246, v252
    s_nop 0
    s_nop 0
    v_permlane32_swap_b32 v252, v246
    v_add_f32 v252, v252, v246
    v_cmp_gt_u32 vcc, 8, v7
    s_nop 0
    s_and_saveexec_b64 s[50:51], vcc
    ds_write_b32 v254, v252 offset:256
    s_mov_b64 exec, s[50:51]
    s_waitcnt lgkmcnt(0)
    s_barrier
    ds_read_b128 v[92:95], v255 offset:256
    ds_read_b128 v[96:99], v255 offset:272
    s_waitcnt lgkmcnt(1)
    v_add_f32 v252, v92, v93
    v_add_f32 v252, v252, v94
    v_add_f32 v252, v252, v95
    s_waitcnt lgkmcnt(0)
    v_add_f32 v252, v252, v96
    v_add_f32 v252, v252, v97
    v_add_f32 v252, v252, v98
    v_add_f32 v252, v252, v99
    v_mul_f32 v252, 0x3ae38e39, v252
    v_cvt_pk_bf16_f32 v246, v252, v253
    v_lshlrev_b32 v252, 16, v246
    v_and_b32 v253, 0xffff0000, v246
    v_add_f32 v252, 0x3727c5ac, v252
    v_cvt_pk_bf16_f32 v246, v252, v252
    v_and_b32 v252, 0xffff0000, v246
    v_sqrt_f32 v252, v252
    s_nop 0
    v_cvt_pk_bf16_f32 v246, v252, v252
    v_and_b32 v252, 0xffff0000, v246
    v_rcp_f32 v252, v252
    v_sub_f32 v76, v76, v253
    v_sub_f32 v77, v77, v253
    v_sub_f32 v78, v78, v253
    v_sub_f32 v79, v79, v253
    v_sub_f32 v80, v80, v253
    v_sub_f32 v81, v81, v253
    v_sub_f32 v82, v82, v253
    v_sub_f32 v83, v83, v253
    v_cvt_pk_bf16_f32 v246, v76, v77
    v_lshlrev_b32 v76, 16, v246
    v_and_b32 v77, 0xffff0000, v246
    v_cvt_pk_bf16_f32 v246, v78, v79
    v_lshlrev_b32 v78, 16, v246
    v_and_b32 v79, 0xffff0000, v246
    v_cvt_pk_bf16_f32 v246, v80, v81
    v_lshlrev_b32 v80, 16, v246
    v_and_b32 v81, 0xffff0000, v246
    v_cvt_pk_bf16_f32 v246, v82, v83
    v_lshlrev_b32 v82, 16, v246
    v_and_b32 v83, 0xffff0000, v246
    v_mul_f32 v76, v76, v252
    v_mul_f32 v77, v77, v252
    v_mul_f32 v78, v78, v252
    v_mul_f32 v79, v79, v252
    v_mul_f32 v80, v80, v252
    v_mul_f32 v81, v81, v252
    v_mul_f32 v82, v82, v252
    v_mul_f32 v83, v83, v252
    v_cvt_pk_bf16_f32 v246, v76, v77
    v_lshlrev_b32 v76, 16, v246
    v_and_b32 v77, 0xffff0000, v246
    v_cvt_pk_bf16_f32 v246, v78, v79
    v_lshlrev_b32 v78, 16, v246
    v_and_b32 v79, 0xffff0000, v246
    v_cvt_pk_bf16_f32 v246, v80, v81
    v_lshlrev_b32 v80, 16, v246
    v_and_b32 v81, 0xffff0000, v246
    v_cvt_pk_bf16_f32 v246, v82, v83
    v_lshlrev_b32 v82, 16, v246
    v_and_b32 v83, 0xffff0000, v246
    s_cmp_lg_u32 s32, 0
    s_cbranch_scc1 L_itb_49
    v_sub_f32 v84, v84, v253
    v_sub_f32 v85, v85, v253
    v_sub_f32 v86, v86, v253
    v_sub_f32 v87, v87, v253
    v_sub_f32 v88, v88, v253
    v_sub_f32 v89, v89, v253
    v_sub_f32 v90, v90, v253
    v_sub_f32 v91, v91, v253
    v_cvt_pk_bf16_f32 v246, v84, v85
    v_lshlrev_b32 v84, 16, v246
    v_and_b32 v85, 0xffff0000, v246
    v_cvt_pk_bf16_f32 v246, v86, v87
    v_lshlrev_b32 v86, 16, v246
    v_and_b32 v87, 0xffff0000, v246
    v_cvt_pk_bf16_f32 v246, v88, v89
    v_lshlrev_b32 v88, 16, v246
    v_and_b32 v89, 0xffff0000, v246
    v_cvt_pk_bf16_f32 v246, v90, v91
    v_lshlrev_b32 v90, 16, v246
    v_and_b32 v91, 0xffff0000, v246
    v_mul_f32 v84, v84, v252
    v_mul_f32 v85, v85, v252
    v_mul_f32 v86, v86, v252
    v_mul_f32 v87, v87, v252
    v_mul_f32 v88, v88, v252
    v_mul_f32 v89, v89, v252
    v_mul_f32 v90, v90, v252
    v_mul_f32 v91, v91, v252
    v_cvt_pk_bf16_f32 v246, v84, v85
    v_lshlrev_b32 v84, 16, v246
    v_and_b32 v85, 0xffff0000, v246
    v_cvt_pk_bf16_f32 v246, v86, v87
    v_lshlrev_b32 v86, 16, v246
    v_and_b32 v87, 0xffff0000, v246
    v_cvt_pk_bf16_f32 v246, v88, v89
    v_lshlrev_b32 v88, 16, v246
    v_and_b32 v89, 0xffff0000, v246
    v_cvt_pk_bf16_f32 v246, v90, v91
    v_lshlrev_b32 v90, 16, v246
    v_and_b32 v91, 0xffff0000, v246
L_itb_49:
    v_add_f32 v44, 1.0, v44
    v_add_f32 v45, 1.0, v45
    v_add_f32 v46, 1.0, v46
    v_add_f32 v47, 1.0, v47
    v_add_f32 v48, 1.0, v48
    v_add_f32 v49, 1.0, v49
    v_add_f32 v50, 1.0, v50
    v_add_f32 v51, 1.0, v51
    v_cvt_pk_bf16_f32 v246, v44, v45
    v_lshlrev_b32 v44, 16, v246
    v_and_b32 v45, 0xffff0000, v246
    v_cvt_pk_bf16_f32 v246, v46, v47
    v_lshlrev_b32 v46, 16, v246
    v_and_b32 v47, 0xffff0000, v246
    v_cvt_pk_bf16_f32 v246, v48, v49
    v_lshlrev_b32 v48, 16, v246
    v_and_b32 v49, 0xffff0000, v246
    v_cvt_pk_bf16_f32 v246, v50, v51
    v_lshlrev_b32 v50, 16, v246
    v_and_b32 v51, 0xffff0000, v246
    v_mul_f32 v76, v76, v44
    v_mul_f32 v77, v77, v45
    v_mul_f32 v78, v78, v46
    v_mul_f32 v79, v79, v47
    v_mul_f32 v80, v80, v48
    v_mul_f32 v81, v81, v49
    v_mul_f32 v82, v82, v50
    v_mul_f32 v83, v83, v51
    v_cvt_pk_bf16_f32 v246, v76, v77
    v_lshlrev_b32 v76, 16, v246
    v_and_b32 v77, 0xffff0000, v246
    v_cvt_pk_bf16_f32 v246, v78, v79
    v_lshlrev_b32 v78, 16, v246
    v_and_b32 v79, 0xffff0000, v246
    v_cvt_pk_bf16_f32 v246, v80, v81
    v_lshlrev_b32 v80, 16, v246
    v_and_b32 v81, 0xffff0000, v246
    v_cvt_pk_bf16_f32 v246, v82, v83
    v_lshlrev_b32 v82, 16, v246
    v_and_b32 v83, 0xffff0000, v246
    v_add_f32 v76, v76, v60
    v_add_f32 v77, v77, v61
    v_add_f32 v78, v78, v62
    v_add_f32 v79, v79, v63
    v_add_f32 v80, v80, v64
    v_add_f32 v81, v81, v65
    v_add_f32 v82, v82, v66
    v_add_f32 v83, v83, v67
    v_cvt_pk_bf16_f32 v44, v76, v77
    v_cvt_pk_bf16_f32 v45, v78, v79
    v_cvt_pk_bf16_f32 v46, v80, v81
    v_cvt_pk_bf16_f32 v47, v82, v83
    s_mov_b32 s50, 0x500000
    buffer_store_dwordx4 v[44:47], v16, s[76:79], s50 offen sc1
    s_cmp_lg_u32 s32, 0
    s_cbranch_scc1 L_itb_50
    v_add_f32 v52, 1.0, v52
    v_add_f32 v53, 1.0, v53
    v_add_f32 v54, 1.0, v54
    v_add_f32 v55, 1.0, v55
    v_add_f32 v56, 1.0, v56
    v_add_f32 v57, 1.0, v57
    v_add_f32 v58, 1.0, v58
    v_add_f32 v59, 1.0, v59
    v_cvt_pk_bf16_f32 v246, v52, v53
    v_lshlrev_b32 v52, 16, v246
    v_and_b32 v53, 0xffff0000, v246
    v_cvt_pk_bf16_f32 v246, v54, v55
    v_lshlrev_b32 v54, 16, v246
    v_and_b32 v55, 0xffff0000, v246
    v_cvt_pk_bf16_f32 v246, v56, v57
    v_lshlrev_b32 v56, 16, v246
    v_and_b32 v57, 0xffff0000, v246
    v_cvt_pk_bf16_f32 v246, v58, v59
    v_lshlrev_b32 v58, 16, v246
    v_and_b32 v59, 0xffff0000, v246
    v_mul_f32 v84, v84, v52
    v_mul_f32 v85, v85, v53
    v_mul_f32 v86, v86, v54
    v_mul_f32 v87, v87, v55
    v_mul_f32 v88, v88, v56
    v_mul_f32 v89, v89, v57
    v_mul_f32 v90, v90, v58
    v_mul_f32 v91, v91, v59
    v_cvt_pk_bf16_f32 v246, v84, v85
    v_lshlrev_b32 v84, 16, v246
    v_and_b32 v85, 0xffff0000, v246
    v_cvt_pk_bf16_f32 v246, v86, v87
    v_lshlrev_b32 v86, 16, v246
    v_and_b32 v87, 0xffff0000, v246
    v_cvt_pk_bf16_f32 v246, v88, v89
    v_lshlrev_b32 v88, 16, v246
    v_and_b32 v89, 0xffff0000, v246
    v_cvt_pk_bf16_f32 v246, v90, v91
    v_lshlrev_b32 v90, 16, v246
    v_and_b32 v91, 0xffff0000, v246
    v_add_f32 v84, v84, v68
    v_add_f32 v85, v85, v69
    v_add_f32 v86, v86, v70
    v_add_f32 v87, v87, v71
    v_add_f32 v88, v88, v72
    v_add_f32 v89, v89, v73
    v_add_f32 v90, v90, v74
    v_add_f32 v91, v91, v75
    v_cvt_pk_bf16_f32 v52, v84, v85
    v_cvt_pk_bf16_f32 v53, v86, v87
    v_cvt_pk_bf16_f32 v54, v88, v89
    v_cvt_pk_bf16_f32 v55, v90, v91
    s_mov_b32 s50, 0x508000
    buffer_store_dwordx4 v[52:55], v16, s[76:79], s50 offen sc1
L_itb_50:
    s_lshr_b32 s50, s33, 1
    s_mul_i32 s50, s50, 663552
    s_mov_b32 s16, s44
    s_mov_b32 s17, s45
    s_mov_b32 s18, 0x510000
    s_add_u32 s16, s16, s50
    s_addc_u32 s17, s17, 0
    s_sub_u32 s18, s18, s50
    s_mov_b32 s19, 0x00020000
    s_lshr_b32 s50, s32, 1
    s_mul_i32 s50, s50, 36864
    s_and_b32 s51, s32, 1
    s_lshl_b32 s51, s51, 10
    s_add_u32 s50, s50, s51
    v_add_u32 v96, s50, v1
    s_and_b32 s50, s38, 0xfe
    s_mul_i32 s50, s50, 73728
    s_add_u32 s12, s48, 0x5800000
    s_addc_u32 s13, s49, 0
    s_mov_b32 s14, 0x1200000
    s_add_u32 s12, s12, s50
    s_addc_u32 s13, s13, 0
    s_sub_u32 s14, s14, s50
    s_mov_b32 s15, 0x00020000
    s_and_b32 s52, s33, 1
    s_mul_i32 s20, s52, 73728
    s_sub_u32 s21, 73728, s20
    s_mul_i32 s44, s52, 368640
    s_mul_i32 s46, s52, -368640
    s_add_u32 s46, s46, 368640
    s_mul_i32 s50, s52, 36864
    s_add_u32 s50, s50, 294912
    s_mul_i32 s51, s52, -36864
    s_add_u32 s51, s51, 294912
    s_mul_i32 s22, s52, 5120
    s_mul_i32 s23, s52, 512
    s_add_u32 s23, s23, 4096
    s_mul_i32 s47, s52, 640
    s_mul_i32 s43, s52, 64
    s_add_u32 s43, s43, 512
    s_cmp_lt_u32 s32, 4
    s_cselect_b32 s45, s50, s51
    s_cmp_lt_u32 s32, 2
    s_cselect_b32 s42, s50, s51
    s_add_u32 s40, s44, s43
    s_add_u32 s41, s46, s43
    s_add_u32 s42, s42, s43
    s_add_u32 s44, s44, s47
    s_add_u32 s46, s46, s47
    s_add_u32 s45, s45, s47
    s_lshl_b32 s50, s36, 9
    s_add_u32 s22, s22, s50
    s_lshl_b32 s50, s36, 8
    s_add_u32 s23, s23, s50
    s_mov_b32 s53, 0xbfb8aa3b
    v_lshrrev_b32 v64, 2, v7
    v_bfe_u32 v65, v64, 2, 1
    v_lshlrev_b32 v65, 1, v65
    v_and_b32 v3, 3, v7
    v_xor_b32 v3, v3, v65
    v_lshlrev_b32 v3, 4, v3
    v_mul_u32_u24 v108, 1152, v64
    v_add_u32 v108, v108, v3
    s_mul_i32 s51, s32, 18432
    v_add_u32 v108, s51, v108
    s_movk_i32 s50, 9216
    v_mul_lo_u32 v64, v64, s50
    v_add_u32 v3, v3, v64
    s_mul_i32 s51, s35, 147456
    s_add_u32 s51, s51, s54
    v_add_u32 v3, s51, v3
    s_mul_i32 s51, s32, 9216
    v_lshrrev_b32 v64, 3, v7
    v_bfe_u32 v65, v64, 1, 2
    v_lshlrev_b32 v65, 1, v65
    v_and_b32 v5, 7, v7
    v_xor_b32 v5, v5, v65
    v_lshlrev_b32 v5, 4, v5
    s_mov_b32 s50, 1152
    v_mul_lo_u32 v64, v64, s50
    v_add_u32 v5, v5, v64
    v_add_u32 v5, s51, v5
    v_lshrrev_b32 v64, 2, v7
    v_bfe_u32 v65, v64, 1, 2
    v_xor_b32 v65, s36, v65
    v_lshlrev_b32 v65, 5, v65
    v_lshl_add_u32 v65, v64, 7, v65
    v_and_b32 v64, 3, v7
    v_lshl_add_u32 v8, v64, 3, v65
    v_xor_b32 v9, 64, v8
    v_lshrrev_b32 v64, 2, v7
    v_bfe_u32 v65, v64, 2, 1
    v_xor_b32 v65, s36, v65
    v_lshlrev_b32 v65, 5, v65
    v_lshl_add_u32 v65, v64, 6, v65
    v_and_b32 v64, 3, v7
    v_lshl_add_u32 v6, v64, 3, v65
    s_lshl_b32 s50, s36, 10
    s_xor_b32 s51, s50, 1024
    v_add_u32 v104, s50, v6
    v_add_u32 v105, s51, v6
    s_lshl_b32 s52, s36, 1
    v_lshrrev_b32 v64, 2, v7
    v_bfe_u32 v65, v64, 1, 2
    v_xor_b32 v65, s52, v65
    v_lshlrev_b32 v65, 5, v65
    v_lshl_add_u32 v65, v64, 7, v65
    v_and_b32 v64, 3, v7
    v_lshl_add_u32 v10, v64, 3, v65
    s_lshl_b32 s50, s36, 11
    s_xor_b32 s51, s50, 2048
    v_add_u32 v109, s51, v10
    v_add_u32 v10, s50, v10
    v_xor_b32 v111, 32, v10
    v_xor_b32 v110, 32, v109
    v_add_u32 v4, s39, v1
    v_mov_b32 v15, v4
    v_xor_b32 v107, 0x1000, v4
    s_lshl_b32 s50, s35, 11
    v_add_u32 v97, s50, v1
    s_mul_i32 s50, s37, 294912
    s_lshr_b32 s51, s33, 1
    s_mul_i32 s51, s51, 9216
    s_add_u32 s50, s50, s51
    s_add_u32 s28, s48, 0x3400000
    s_addc_u32 s29, s49, 0
    s_mov_b32 s30, 0x3600000
    s_add_u32 s28, s28, s50
    s_addc_u32 s29, s29, 0
    s_sub_u32 s30, s30, s50
    s_mov_b32 s31, 0x00020000
    v_bfe_u32 v64, v7, 3, 1
    s_mov_b32 s50, 73728
    v_mul_lo_u32 v106, v64, s50
    v_lshrrev_b32 v64, 4, v7
    v_lshl_add_u32 v106, v64, 7, v106
    v_and_b32 v64, 7, v7
    v_lshl_add_u32 v106, v64, 4, v106
    s_waitcnt vmcnt(0)
    s_barrier
    s_cmp_lg_u32 s32, 0
    s_cbranch_scc1 L_pub_51
    s_lshl_b32 s50, s98, 3
    s_add_u32 s50, s50, 36864
    v_mov_b32 v248, s96
    v_mov_b32 v249, s97
    v_mov_b32 v246, 0
    v_cmp_eq_u32 vcc, 0, v7
    s_nop 0
    s_and_saveexec_b64 s[4:5], vcc
    buffer_store_dwordx2 v[248:249], v246, s[76:79], s50 offen sc1
    s_mov_b64 exec, s[4:5]
L_pub_51:
    s_nop 1
    s_cmp_lg_u32 s32, 0
    s_cbranch_scc1 L_pt_52
    v_and_b32 v246, 15, v7
    v_lshlrev_b32 v246, 3, v246
    s_lshl_b32 s51, s34, 7
    s_add_u32 s51, s51, 36864
    s_mov_b32 s50, 0
L_ptl_53:
    buffer_load_dwordx2 v[248:249], v246, s[76:79], s51 offen sc1
    s_waitcnt vmcnt(0)
    v_cmp_ne_u64 vcc, s[96:97], v[248:249]
    s_add_u32 s50, s50, 1
    s_cbranch_vccz L_ptd_54
    s_cmp_ge_u32 s50, 20000
    s_cbranch_scc1 L_ptd_54
    s_sleep 1
    s_branch L_ptl_53
L_ptd_54:
L_pt_52:
    s_nop 1
    s_barrier
    s_add_u32 m0, s39, 0x0
    s_mov_b32 s58, 0x0
    buffer_load_dwordx4 v96, s[24:27], s58 offen sc1 lds
    s_add_u32 m0, s39, 0x4000
    s_mov_b32 s59, 0x800
    buffer_load_dwordx4 v96, s[24:27], s59 offen sc1 lds
    s_add_u32 m0, s39, 0x8000
    s_mov_b32 s60, 0x1000
    buffer_load_dwordx4 v96, s[24:27], s60 offen sc1 lds
    s_setprio 3
    s_waitcnt vmcnt(0)
    s_barrier
    ds_read_b128 v[112:115], v97 offset:0
    ds_read_b128 v[116:119], v97 offset:1024
    ds_read_b64_tr_b16 v[16:17], v8 offset:8192
    ds_read_b64_tr_b16 v[18:19], v8 offset:10240
    ds_read_b64_tr_b16 v[20:21], v8 offset:12288
    ds_read_b64_tr_b16 v[22:23], v8 offset:14336
    ds_read_b64_tr_b16 v[24:25], v9 offset:8192
    ds_read_b64_tr_b16 v[26:27], v9 offset:10240
    s_waitcnt lgkmcnt(4)
    v_mfma_f32_16x16x32_bf16 v[32:35], v[16:19], v[112:115], 0
    ds_read_b64_tr_b16 v[28:29], v9 offset:12288
    v_mfma_f32_16x16x32_bf16 v[36:39], v[16:19], v[116:119], 0
    ds_read_b64_tr_b16 v[30:31], v9 offset:14336
    s_add_u32 m0, s39, 0xc000
    s_mov_b32 s61, 0x1800
    buffer_load_dwordx4 v96, s[24:27], s61 offen sc1 lds
    s_waitcnt lgkmcnt(4)
    v_mfma_f32_16x16x32_bf16 v[40:43], v[20:23], v[112:115], 0
    ds_read_b128 v[120:123], v97 offset:16384
    ds_read_b128 v[124:127], v97 offset:17408
    ds_read_b64_tr_b16 v[16:17], v8 offset:24576
    v_mfma_f32_16x16x32_bf16 v[44:47], v[20:23], v[116:119], 0
    ds_read_b64_tr_b16 v[18:19], v8 offset:26624
    s_add_u32 m0, s39, 0x10000
    s_mov_b32 s62, 0x2000
    buffer_load_dwordx4 v96, s[24:27], s62 offen sc1 lds
    s_waitcnt lgkmcnt(6)
    v_mfma_f32_16x16x32_bf16 v[48:51], v[24:27], v[112:115], 0
    ds_read_b64_tr_b16 v[20:21], v8 offset:28672
    v_mfma_f32_16x16x32_bf16 v[52:55], v[24:27], v[116:119], 0
    ds_read_b64_tr_b16 v[22:23], v8 offset:30720
    s_add_u32 m0, s39, 0x14000
    s_mov_b32 s63, 0x2800
    buffer_load_dwordx4 v96, s[24:27], s63 offen sc1 lds
    s_setprio 2
    s_waitcnt lgkmcnt(6)
    v_mfma_f32_16x16x32_bf16 v[56:59], v[28:31], v[112:115], 0
    ds_read_b64_tr_b16 v[24:25], v9 offset:24576
    v_mfma_f32_16x16x32_bf16 v[60:63], v[28:31], v[116:119], 0
    ds_read_b64_tr_b16 v[26:27], v9 offset:26624
    s_add_u32 m0, s39, 0x18000
    s_mov_b32 s56, 0x3000
    buffer_load_dwordx4 v96, s[24:27], s56 offen sc1 lds
    s_waitcnt lgkmcnt(4)
    v_mfma_f32_16x16x32_bf16 v[32:35], v[16:19], v[120:123], v[32:35]
    ds_read_b64_tr_b16 v[28:29], v9 offset:28672
    v_mfma_f32_16x16x32_bf16 v[36:39], v[16:19], v[124:127], v[36:39]
    ds_read_b64_tr_b16 v[30:31], v9 offset:30720
    s_add_u32 m0, s39, 0x1c000
    s_mov_b32 s57, 0x3800
    buffer_load_dwordx4 v96, s[24:27], s57 offen sc1 lds
    s_waitcnt lgkmcnt(4)
    v_mfma_f32_16x16x32_bf16 v[40:43], v[20:23], v[120:123], v[40:43]
    ds_read_b128 v[128:131], v97 offset:32768
    ds_read_b128 v[132:135], v97 offset:33792
    ds_read_b64_tr_b16 v[16:17], v8 offset:40960
    v_mfma_f32_16x16x32_bf16 v[44:47], v[20:23], v[124:127], v[44:47]
    ds_read_b64_tr_b16 v[18:19], v8 offset:43008
    s_add_u32 m0, s39, 0x20000
    s_mov_b32 s58, 0x4000
    buffer_load_dwordx4 v96, s[24:27], s58 offen sc1 lds
    s_setprio 1
    s_waitcnt lgkmcnt(6)
    v_mfma_f32_16x16x32_bf16 v[48:51], v[24:27], v[120:123], v[48:51]
    ds_read_b64_tr_b16 v[20:21], v8 offset:45056
    v_mfma_f32_16x16x32_bf16 v[52:55], v[24:27], v[124:127], v[52:55]
    ds_read_b64_tr_b16 v[22:23], v8 offset:47104
    s_add_u32 m0, s39, 0x24000
    s_mov_b32 s59, 0x4800
    buffer_load_dwordx4 v96, s[24:27], s59 offen sc1 lds
    s_waitcnt lgkmcnt(6)
    v_mfma_f32_16x16x32_bf16 v[56:59], v[28:31], v[120:123], v[56:59]
    ds_read_b64_tr_b16 v[24:25], v9 offset:40960
    v_mfma_f32_16x16x32_bf16 v[60:63], v[28:31], v[124:127], v[60:63]
    ds_read_b64_tr_b16 v[26:27], v9 offset:43008
    s_add_u32 m0, s39, 0x26000
    s_mov_b32 s60, 0x288000
    buffer_load_dwordx4 v2, s[8:11], s60 offen lds
    s_waitcnt lgkmcnt(4)
    v_mfma_f32_16x16x32_bf16 v[32:35], v[16:19], v[128:131], v[32:35]
    ds_read_b64_tr_b16 v[28:29], v9 offset:45056
    v_mfma_f32_16x16x32_bf16 v[36:39], v[16:19], v[132:135], v[36:39]
    ds_read_b64_tr_b16 v[30:31], v9 offset:47104
    s_setprio 0
    s_waitcnt lgkmcnt(4)
    v_mfma_f32_16x16x32_bf16 v[40:43], v[20:23], v[128:131], v[40:43]
    v_mfma_f32_16x16x32_bf16 v[44:47], v[20:23], v[132:135], v[44:47]
    s_waitcnt lgkmcnt(2)
    v_mfma_f32_16x16x32_bf16 v[48:51], v[24:27], v[128:131], v[48:51]
    v_mfma_f32_16x16x32_bf16 v[52:55], v[24:27], v[132:135], v[52:55]
    s_waitcnt lgkmcnt(0)
    v_mfma_f32_16x16x32_bf16 v[56:59], v[28:31], v[128:131], v[56:59]
    v_mfma_f32_16x16x32_bf16 v[60:63], v[28:31], v[132:135], v[60:63]
    s_setprio 3
    s_waitcnt vmcnt(4)
    s_barrier
    ds_read_b128 v[136:139], v97 offset:49152
    ds_read_b128 v[140:143], v97 offset:50176
    ds_read_b64_tr_b16 v[16:17], v8 offset:57344
    ds_read_b64_tr_b16 v[18:19], v8 offset:59392
    ds_read_b64_tr_b16 v[20:21], v8 offset:61440
    ds_read_b64_tr_b16 v[22:23], v8 offset:63488
    ds_read_b64_tr_b16 v[24:25], v9 offset:57344
    ds_read_b64_tr_b16 v[26:27], v9 offset:59392
    s_waitcnt lgkmcnt(4)
    v_mfma_f32_16x16x32_bf16 v[32:35], v[16:19], v[136:139], v[32:35]
    ds_read_b64_tr_b16 v[28:29], v9 offset:61440
    v_mfma_f32_16x16x32_bf16 v[36:39], v[16:19], v[140:143], v[36:39]
    ds_read_b64_tr_b16 v[30:31], v9 offset:63488
    s_add_u32 m0, s39, 0x0
    s_mov_b32 s61, 0x5000
    buffer_load_dwordx4 v96, s[24:27], s61 offen sc1 lds
    s_waitcnt lgkmcnt(4)
    v_mfma_f32_16x16x32_bf16 v[40:43], v[20:23], v[136:139], v[40:43]
    v_add_u32 v97, 0x10000, v97
    ds_read_b128 v[144:147], v97 offset:0
    ds_read_b128 v[148:151], v97 offset:1024
    v_add_u32 v8, 0x10000, v8
    ds_read_b64_tr_b16 v[16:17], v8 offset:8192
    v_mfma_f32_16x16x32_bf16 v[44:47], v[20:23], v[140:143], v[44:47]
    ds_read_b64_tr_b16 v[18:19], v8 offset:10240
    s_waitcnt lgkmcnt(6)
    v_mfma_f32_16x16x32_bf16 v[48:51], v[24:27], v[136:139], v[48:51]
    ds_read_b64_tr_b16 v[20:21], v8 offset:12288
    v_mfma_f32_16x16x32_bf16 v[52:55], v[24:27], v[140:143], v[52:55]
    ds_read_b64_tr_b16 v[22:23], v8 offset:14336
    s_add_u32 m0, s39, 0x2000
    s_mov_b32 s62, 0x2d0000
    buffer_load_dwordx4 v2, s[8:11], s62 offen lds
    s_setprio 2
    s_waitcnt lgkmcnt(6)
    v_mfma_f32_16x16x32_bf16 v[56:59], v[28:31], v[136:139], v[56:59]
    v_add_u32 v9, 0x10000, v9
    ds_read_b64_tr_b16 v[24:25], v9 offset:8192
    v_mfma_f32_16x16x32_bf16 v[60:63], v[28:31], v[140:143], v[60:63]
    ds_read_b64_tr_b16 v[26:27], v9 offset:10240
    s_waitcnt lgkmcnt(4)
    v_mfma_f32_16x16x32_bf16 v[32:35], v[16:19], v[144:147], v[32:35]
    ds_read_b64_tr_b16 v[28:29], v9 offset:12288
    v_mfma_f32_16x16x32_bf16 v[36:39], v[16:19], v[148:151], v[36:39]
    ds_read_b64_tr_b16 v[30:31], v9 offset:14336
    s_add_u32 m0, s39, 0x4000
    s_mov_b32 s63, 0x5800
    buffer_load_dwordx4 v96, s[24:27], s63 offen sc1 lds
    s_waitcnt lgkmcnt(4)
    v_mfma_f32_16x16x32_bf16 v[40:43], v[20:23], v[144:147], v[40:43]
    ds_read_b128 v[152:155], v97 offset:16384
    ds_read_b128 v[156:159], v97 offset:17408
    ds_read_b64_tr_b16 v[16:17], v8 offset:24576
    v_mfma_f32_16x16x32_bf16 v[44:47], v[20:23], v[148:151], v[44:47]
    ds_read_b64_tr_b16 v[18:19], v8 offset:26624
    s_setprio 1
    s_waitcnt lgkmcnt(6)
    v_mfma_f32_16x16x32_bf16 v[48:51], v[24:27], v[144:147], v[48:51]
    ds_read_b64_tr_b16 v[20:21], v8 offset:28672
    v_mfma_f32_16x16x32_bf16 v[52:55], v[24:27], v[148:151], v[52:55]
    ds_read_b64_tr_b16 v[22:23], v8 offset:30720
    s_add_u32 m0, s39, 0x6000
    s_mov_b32 s56, 0x318000
    buffer_load_dwordx4 v2, s[8:11], s56 offen lds
    s_waitcnt lgkmcnt(6)
    v_mfma_f32_16x16x32_bf16 v[56:59], v[28:31], v[144:147], v[56:59]
    ds_read_b64_tr_b16 v[24:25], v9 offset:24576
    v_mfma_f32_16x16x32_bf16 v[60:63], v[28:31], v[148:151], v[60:63]
    ds_read_b64_tr_b16 v[26:27], v9 offset:26624
    s_waitcnt lgkmcnt(4)
    v_mfma_f32_16x16x32_bf16 v[32:35], v[16:19], v[152:155], v[32:35]
    ds_read_b64_tr_b16 v[28:29], v9 offset:28672
    v_mfma_f32_16x16x32_bf16 v[36:39], v[16:19], v[156:159], v[36:39]
    ds_read_b64_tr_b16 v[30:31], v9 offset:30720
    s_add_u32 m0, s39, 0x8000
    s_mov_b32 s57, 0x6000
    buffer_load_dwordx4 v96, s[24:27], s57 offen sc1 lds
    s_setprio 0
    s_waitcnt lgkmcnt(4)
    v_mfma_f32_16x16x32_bf16 v[40:43], v[20:23], v[152:155], v[40:43]
    ds_read_b128 v[160:163], v97 offset:32768
    ds_read_b128 v[164:167], v97 offset:33792
    ds_read_b64_tr_b16 v[16:17], v8 offset:40960
    v_mfma_f32_16x16x32_bf16 v[44:47], v[20:23], v[156:159], v[44:47]
    ds_read_b64_tr_b16 v[18:19], v8 offset:43008
    s_waitcnt lgkmcnt(6)
    v_mfma_f32_16x16x32_bf16 v[48:51], v[24:27], v[152:155], v[48:51]
    ds_read_b64_tr_b16 v[20:21], v8 offset:45056
    v_mfma_f32_16x16x32_bf16 v[52:55], v[24:27], v[156:159], v[52:55]
    ds_read_b64_tr_b16 v[22:23], v8 offset:47104
    s_add_u32 m0, s39, 0xa000
    s_mov_b32 s58, 0x360000
    buffer_load_dwordx4 v2, s[8:11], s58 offen lds
    s_waitcnt lgkmcnt(6)
    v_mfma_f32_16x16x32_bf16 v[56:59], v[28:31], v[152:155], v[56:59]
    ds_read_b64_tr_b16 v[24:25], v9 offset:40960
    v_mfma_f32_16x16x32_bf16 v[60:63], v[28:31], v[156:159], v[60:63]
    ds_read_b64_tr_b16 v[26:27], v9 offset:43008
    s_setprio 3
    s_waitcnt vmcnt(6)
    s_barrier
    s_waitcnt lgkmcnt(4)
    v_mfma_f32_16x16x32_bf16 v[32:35], v[16:19], v[160:163], v[32:35]
    ds_read_b64_tr_b16 v[28:29], v9 offset:45056
    v_mfma_f32_16x16x32_bf16 v[36:39], v[16:19], v[164:167], v[36:39]
    ds_read_b64_tr_b16 v[30:31], v9 offset:47104
    s_add_u32 m0, s39, 0xc000
    s_mov_b32 s59, 0x6800
    buffer_load_dwordx4 v96, s[24:27], s59 offen sc1 lds
    s_waitcnt lgkmcnt(4)
    v_mfma_f32_16x16x32_bf16 v[40:43], v[20:23], v[160:163], v[40:43]
    ds_read_b128 v[168:171], v97 offset:49152
    ds_read_b128 v[172:175], v97 offset:50176
    ds_read_b64_tr_b16 v[16:17], v8 offset:57344
    v_mfma_f32_16x16x32_bf16 v[44:47], v[20:23], v[164:167], v[44:47]
    ds_read_b64_tr_b16 v[18:19], v8 offset:59392
    s_waitcnt lgkmcnt(6)
    v_mfma_f32_16x16x32_bf16 v[48:51], v[24:27], v[160:163], v[48:51]
    ds_read_b64_tr_b16 v[20:21], v8 offset:61440
    v_mfma_f32_16x16x32_bf16 v[52:55], v[24:27], v[164:167], v[52:55]
    ds_read_b64_tr_b16 v[22:23], v8 offset:63488
    s_add_u32 m0, s39, 0xe000
    s_mov_b32 s60, 0x3a8000
    buffer_load_dwordx4 v2, s[8:11], s60 offen lds
    s_setprio 2
    s_waitcnt lgkmcnt(6)
    v_mfma_f32_16x16x32_bf16 v[56:59], v[28:31], v[160:163], v[56:59]
    ds_read_b64_tr_b16 v[24:25], v9 offset:57344
    v_mfma_f32_16x16x32_bf16 v[60:63], v[28:31], v[164:167], v[60:63]
    ds_read_b64_tr_b16 v[26:27], v9 offset:59392
    s_waitcnt lgkmcnt(4)
    v_mfma_f32_16x16x32_bf16 v[32:35], v[16:19], v[168:171], v[32:35]
    ds_read_b64_tr_b16 v[28:29], v9 offset:61440
    v_mfma_f32_16x16x32_bf16 v[36:39], v[16:19], v[172:175], v[36:39]
    ds_read_b64_tr_b16 v[30:31], v9 offset:63488
    s_add_u32 m0, s39, 0x10000
    s_mov_b32 s61, 0x7000
    buffer_load_dwordx4 v96, s[24:27], s61 offen sc1 lds
    s_waitcnt lgkmcnt(4)
    v_mfma_f32_16x16x32_bf16 v[40:43], v[20:23], v[168:171], v[40:43]
    v_add_u32 v97, 0x10000, v97
    ds_read_b128 v[176:179], v97 offset:0
    ds_read_b128 v[180:183], v97 offset:1024
    v_add_u32 v8, 0x10000, v8
    ds_read_b64_tr_b16 v[16:17], v8 offset:8192
    v_mfma_f32_16x16x32_bf16 v[44:47], v[20:23], v[172:175], v[44:47]
    ds_read_b64_tr_b16 v[18:19], v8 offset:10240
    s_setprio 1
    s_waitcnt lgkmcnt(6)
    v_mfma_f32_16x16x32_bf16 v[48:51], v[24:27], v[168:171], v[48:51]
    ds_read_b64_tr_b16 v[20:21], v8 offset:12288
    v_mfma_f32_16x16x32_bf16 v[52:55], v[24:27], v[172:175], v[52:55]
    ds_read_b64_tr_b16 v[22:23], v8 offset:14336
    s_add_u32 m0, s39, 0x12000
    s_mov_b32 s62, 0x3f0000
    buffer_load_dwordx4 v2, s[8:11], s62 offen lds
    s_waitcnt lgkmcnt(6)
    v_mfma_f32_16x16x32_bf16 v[56:59], v[28:31], v[168:171], v[56:59]
    v_add_u32 v9, 0x10000, v9
    ds_read_b64_tr_b16 v[24:25], v9 offset:8192
    v_mfma_f32_16x16x32_bf16 v[60:63], v[28:31], v[172:175], v[60:63]
    ds_read_b64_tr_b16 v[26:27], v9 offset:10240
    s_waitcnt lgkmcnt(4)
    v_mfma_f32_16x16x32_bf16 v[32:35], v[16:19], v[176:179], v[32:35]
    ds_read_b64_tr_b16 v[28:29], v9 offset:12288
    v_mfma_f32_16x16x32_bf16 v[36:39], v[16:19], v[180:183], v[36:39]
    ds_read_b64_tr_b16 v[30:31], v9 offset:14336
    s_add_u32 m0, s39, 0x14000
    s_mov_b32 s63, 0x7800
    buffer_load_dwordx4 v96, s[24:27], s63 offen sc1 lds
    s_setprio 0
    s_waitcnt lgkmcnt(4)
    v_mfma_f32_16x16x32_bf16 v[40:43], v[20:23], v[176:179], v[40:43]
    ds_read_b128 v[184:187], v97 offset:16384
    ds_read_b128 v[188:191], v97 offset:17408
    ds_read_b64_tr_b16 v[16:17], v8 offset:24576
    v_mfma_f32_16x16x32_bf16 v[44:47], v[20:23], v[180:183], v[44:47]
    ds_read_b64_tr_b16 v[18:19], v8 offset:26624
    s_waitcnt lgkmcnt(6)
    v_mfma_f32_16x16x32_bf16 v[48:51], v[24:27], v[176:179], v[48:51]
    ds_read_b64_tr_b16 v[20:21], v8 offset:28672
    v_mfma_f32_16x16x32_bf16 v[52:55], v[24:27], v[180:183], v[52:55]
    ds_read_b64_tr_b16 v[22:23], v8 offset:30720
    s_add_u32 m0, s39, 0x16000
    s_mov_b32 s56, 0x438000
    buffer_load_dwordx4 v2, s[8:11], s56 offen lds
    s_waitcnt lgkmcnt(6)
    v_mfma_f32_16x16x32_bf16 v[56:59], v[28:31], v[176:179], v[56:59]
    ds_read_b64_tr_b16 v[24:25], v9 offset:24576
    v_mfma_f32_16x16x32_bf16 v[60:63], v[28:31], v[180:183], v[60:63]
    ds_read_b64_tr_b16 v[26:27], v9 offset:26624
    s_setprio 3
    s_waitcnt vmcnt(6)
    s_barrier
    s_waitcnt lgkmcnt(4)
    v_mfma_f32_16x16x32_bf16 v[32:35], v[16:19], v[184:187], v[32:35]
    ds_read_b64_tr_b16 v[28:29], v9 offset:28672
    v_mfma_f32_16x16x32_bf16 v[36:39], v[16:19], v[188:191], v[36:39]
    ds_read_b64_tr_b16 v[30:31], v9 offset:30720
    s_add_u32 m0, s39, 0x18000
    s_mov_b32 s57, 0x8000
    buffer_load_dwordx4 v96, s[24:27], s57 offen sc1 lds
    s_waitcnt lgkmcnt(4)
    v_mfma_f32_16x16x32_bf16 v[40:43], v[20:23], v[184:187], v[40:43]
    v_subrev_u32 v97, 0x20000, v97
    ds_read_b128 v[192:195], v97 offset:0
    ds_read_b128 v[196:199], v97 offset:1024
    v_subrev_u32 v8, 0x20000, v8
    ds_read_b64_tr_b16 v[16:17], v8 offset:8192
    v_mfma_f32_16x16x32_bf16 v[44:47], v[20:23], v[188:191], v[44:47]
    ds_read_b64_tr_b16 v[18:19], v8 offset:10240
    s_waitcnt lgkmcnt(6)
    v_mfma_f32_16x16x32_bf16 v[48:51], v[24:27], v[184:187], v[48:51]
    ds_read_b64_tr_b16 v[20:21], v8 offset:12288
    v_mfma_f32_16x16x32_bf16 v[52:55], v[24:27], v[188:191], v[52:55]
    ds_read_b64_tr_b16 v[22:23], v8 offset:14336
    s_add_u32 m0, s39, 0x1a000
    s_mov_b32 s58, 0x480000
    buffer_load_dwordx4 v2, s[8:11], s58 offen lds
    s_setprio 2
    s_waitcnt lgkmcnt(6)
    v_mfma_f32_16x16x32_bf16 v[56:59], v[28:31], v[184:187], v[56:59]
    v_subrev_u32 v9, 0x20000, v9
    ds_read_b64_tr_b16 v[24:25], v9 offset:8192
    v_mfma_f32_16x16x32_bf16 v[60:63], v[28:31], v[188:191], v[60:63]
    ds_read_b64_tr_b16 v[26:27], v9 offset:10240
    s_waitcnt lgkmcnt(4)
    v_mfma_f32_16x16x32_bf16 v[32:35], v[16:19], v[192:195], v[32:35]
    ds_read_b64_tr_b16 v[28:29], v9 offset:12288
    v_mfma_f32_16x16x32_bf16 v[36:39], v[16:19], v[196:199], v[36:39]
    ds_read_b64_tr_b16 v[30:31], v9 offset:14336
    s_add_u32 m0, s39, 0x1c000
    s_mov_b32 s59, 0x8800
    buffer_load_dwordx4 v96, s[24:27], s59 offen sc1 lds
    s_waitcnt lgkmcnt(4)
    v_mfma_f32_16x16x32_bf16 v[40:43], v[20:23], v[192:195], v[40:43]
    ds_read_b128 v[200:203], v97 offset:16384
    ds_read_b128 v[204:207], v97 offset:17408
    ds_read_b64_tr_b16 v[16:17], v8 offset:24576
    v_mfma_f32_16x16x32_bf16 v[44:47], v[20:23], v[196:199], v[44:47]
    ds_read_b64_tr_b16 v[18:19], v8 offset:26624
    s_setprio 1
    s_waitcnt lgkmcnt(6)
    v_mfma_f32_16x16x32_bf16 v[48:51], v[24:27], v[192:195], v[48:51]
    ds_read_b64_tr_b16 v[20:21], v8 offset:28672
    v_mfma_f32_16x16x32_bf16 v[52:55], v[24:27], v[196:199], v[52:55]
    ds_read_b64_tr_b16 v[22:23], v8 offset:30720
    s_add_u32 m0, s39, 0x1e000
    s_mov_b32 s60, 0x4c8000
    buffer_load_dwordx4 v2, s[8:11], s60 offen lds
    s_waitcnt lgkmcnt(6)
    v_mfma_f32_16x16x32_bf16 v[56:59], v[28:31], v[192:195], v[56:59]
    ds_read_b64_tr_b16 v[24:25], v9 offset:24576
    v_mfma_f32_16x16x32_bf16 v[60:63], v[28:31], v[196:199], v[60:63]
    ds_read_b64_tr_b16 v[26:27], v9 offset:26624
    s_waitcnt lgkmcnt(4)
    v_mfma_f32_16x16x32_bf16 v[32:35], v[16:19], v[200:203], v[32:35]
    ds_read_b64_tr_b16 v[28:29], v9 offset:28672
    v_mfma_f32_16x16x32_bf16 v[36:39], v[16:19], v[204:207], v[36:39]
    ds_read_b64_tr_b16 v[30:31], v9 offset:30720
    s_add_u32 m0, s39, 0x20000
    s_mov_b32 s61, 0x80
    buffer_load_dwordx4 v2, s[8:11], s61 offen lds
    s_setprio 0
    s_waitcnt lgkmcnt(4)
    v_mfma_f32_16x16x32_bf16 v[40:43], v[20:23], v[200:203], v[40:43]
    ds_read_b128 v[208:211], v97 offset:32768
    ds_read_b128 v[212:215], v97 offset:33792
    ds_read_b64_tr_b16 v[16:17], v8 offset:40960
    v_mfma_f32_16x16x32_bf16 v[44:47], v[20:23], v[204:207], v[44:47]
    ds_read_b64_tr_b16 v[18:19], v8 offset:43008
    s_waitcnt lgkmcnt(6)
    v_mfma_f32_16x16x32_bf16 v[48:51], v[24:27], v[200:203], v[48:51]
    ds_read_b64_tr_b16 v[20:21], v8 offset:45056
    v_mfma_f32_16x16x32_bf16 v[52:55], v[24:27], v[204:207], v[52:55]
    ds_read_b64_tr_b16 v[22:23], v8 offset:47104
    s_add_u32 m0, s39, 0x22000
    s_mov_b32 s62, 0x48080
    buffer_load_dwordx4 v2, s[8:11], s62 offen lds
    s_waitcnt lgkmcnt(6)
    v_mfma_f32_16x16x32_bf16 v[56:59], v[28:31], v[200:203], v[56:59]
    ds_read_b64_tr_b16 v[24:25], v9 offset:40960
    v_mfma_f32_16x16x32_bf16 v[60:63], v[28:31], v[204:207], v[60:63]
    ds_read_b64_tr_b16 v[26:27], v9 offset:43008
    s_setprio 3
    s_waitcnt vmcnt(6)
    s_barrier
    s_waitcnt lgkmcnt(4)
    v_mfma_f32_16x16x32_bf16 v[32:35], v[16:19], v[208:211], v[32:35]
    ds_read_b64_tr_b16 v[28:29], v9 offset:45056
    v_mfma_f32_16x16x32_bf16 v[36:39], v[16:19], v[212:215], v[36:39]
    ds_read_b64_tr_b16 v[30:31], v9 offset:47104
    s_add_u32 m0, s39, 0x24000
    s_mov_b32 s63, 0x90080
    buffer_load_dwordx4 v2, s[8:11], s63 offen lds
    s_waitcnt lgkmcnt(4)
    v_mfma_f32_16x16x32_bf16 v[40:43], v[20:23], v[208:211], v[40:43]
    ds_read_b128 v[216:219], v97 offset:49152
    ds_read_b128 v[220:223], v97 offset:50176
    ds_read_b64_tr_b16 v[16:17], v8 offset:57344
    v_mfma_f32_16x16x32_bf16 v[44:47], v[20:23], v[212:215], v[44:47]
    ds_read_b64_tr_b16 v[18:19], v8 offset:59392
    s_waitcnt lgkmcnt(6)
    v_mfma_f32_16x16x32_bf16 v[48:51], v[24:27], v[208:211], v[48:51]
    ds_read_b64_tr_b16 v[20:21], v8 offset:61440
    v_mfma_f32_16x16x32_bf16 v[52:55], v[24:27], v[212:215], v[52:55]
    ds_read_b64_tr_b16 v[22:23], v8 offset:63488
    s_add_u32 m0, s39, 0x26000
    s_mov_b32 s56, 0xd8080
    buffer_load_dwordx4 v2, s[8:11], s56 offen lds
    s_setprio 2
    s_waitcnt lgkmcnt(6)
    v_mfma_f32_16x16x32_bf16 v[56:59], v[28:31], v[208:211], v[56:59]
    ds_read_b64_tr_b16 v[24:25], v9 offset:57344
    v_mfma_f32_16x16x32_bf16 v[60:63], v[28:31], v[212:215], v[60:63]
    ds_read_b64_tr_b16 v[26:27], v9 offset:59392
    s_waitcnt lgkmcnt(4)
    v_mfma_f32_16x16x32_bf16 v[32:35], v[16:19], v[216:219], v[32:35]
    ds_read_b64_tr_b16 v[28:29], v9 offset:61440
    v_mfma_f32_16x16x32_bf16 v[36:39], v[16:19], v[220:223], v[36:39]
    ds_read_b64_tr_b16 v[30:31], v9 offset:63488
    s_add_u32 m0, s39, 0x0
    s_mov_b32 s57, 0x120080
    buffer_load_dwordx4 v2, s[8:11], s57 offen lds
    s_waitcnt lgkmcnt(4)
    v_mfma_f32_16x16x32_bf16 v[40:43], v[20:23], v[216:219], v[40:43]
    v_add_u32 v97, 0x10000, v97
    ds_read_b128 v[224:227], v97 offset:0
    ds_read_b128 v[228:231], v97 offset:1024
    v_add_u32 v8, 0x10000, v8
    ds_read_b64_tr_b16 v[16:17], v8 offset:8192
    v_mfma_f32_16x16x32_bf16 v[44:47], v[20:23], v[220:223], v[44:47]
    ds_read_b64_tr_b16 v[18:19], v8 offset:10240
    s_setprio 1
    s_waitcnt lgkmcnt(6)
    v_mfma_f32_16x16x32_bf16 v[48:51], v[24:27], v[216:219], v[48:51]
    ds_read_b64_tr_b16 v[20:21], v8 offset:12288
    v_mfma_f32_16x16x32_bf16 v[52:55], v[24:27], v[220:223], v[52:55]
    ds_read_b64_tr_b16 v[22:23], v8 offset:14336
    s_add_u32 m0, s39, 0x2000
    s_mov_b32 s58, 0x168080
    buffer_load_dwordx4 v2, s[8:11], s58 offen lds
    s_waitcnt lgkmcnt(6)
    v_mfma_f32_16x16x32_bf16 v[56:59], v[28:31], v[216:219], v[56:59]
    v_add_u32 v9, 0x10000, v9
    ds_read_b64_tr_b16 v[24:25], v9 offset:8192
    v_mfma_f32_16x16x32_bf16 v[60:63], v[28:31], v[220:223], v[60:63]
    ds_read_b64_tr_b16 v[26:27], v9 offset:10240
    s_waitcnt lgkmcnt(4)
    v_mfma_f32_16x16x32_bf16 v[32:35], v[16:19], v[224:227], v[32:35]
    ds_read_b64_tr_b16 v[28:29], v9 offset:12288
    v_mfma_f32_16x16x32_bf16 v[36:39], v[16:19], v[228:231], v[36:39]
    ds_read_b64_tr_b16 v[30:31], v9 offset:14336
    s_add_u32 m0, s39, 0x4000
    s_mov_b32 s59, 0x1b0080
    buffer_load_dwordx4 v2, s[8:11], s59 offen lds
    s_setprio 0
    s_waitcnt lgkmcnt(4)
    v_mfma_f32_16x16x32_bf16 v[40:43], v[20:23], v[224:227], v[40:43]
    ds_read_b128 v[232:235], v97 offset:16384
    ds_read_b128 v[236:239], v97 offset:17408
    ds_read_b64_tr_b16 v[16:17], v8 offset:24576
    v_mfma_f32_16x16x32_bf16 v[44:47], v[20:23], v[228:231], v[44:47]
    ds_read_b64_tr_b16 v[18:19], v8 offset:26624
    s_waitcnt lgkmcnt(6)
    v_mfma_f32_16x16x32_bf16 v[48:51], v[24:27], v[224:227], v[48:51]
    ds_read_b64_tr_b16 v[20:21], v8 offset:28672
    v_mfma_f32_16x16x32_bf16 v[52:55], v[24:27], v[228:231], v[52:55]
    ds_read_b64_tr_b16 v[22:23], v8 offset:30720
    s_add_u32 m0, s39, 0x6000
    s_mov_b32 s60, 0x1f8080
    buffer_load_dwordx4 v2, s[8:11], s60 offen lds
    s_waitcnt lgkmcnt(6)
    v_mfma_f32_16x16x32_bf16 v[56:59], v[28:31], v[224:227], v[56:59]
    ds_read_b64_tr_b16 v[24:25], v9 offset:24576
    v_mfma_f32_16x16x32_bf16 v[60:63], v[28:31], v[228:231], v[60:63]
    ds_read_b64_tr_b16 v[26:27], v9 offset:26624
    s_setprio 3
    s_waitcnt vmcnt(4)
    s_barrier
    s_waitcnt lgkmcnt(4)
    v_mfma_f32_16x16x32_bf16 v[32:35], v[16:19], v[232:235], v[32:35]
    ds_read_b64_tr_b16 v[28:29], v9 offset:28672
    v_mfma_f32_16x16x32_bf16 v[36:39], v[16:19], v[236:239], v[36:39]
    ds_read_b64_tr_b16 v[30:31], v9 offset:30720
    s_add_u32 m0, s39, 0x8000
    s_mov_b32 s61, 0x240080
    buffer_load_dwordx4 v2, s[8:11], s61 offen lds
    s_waitcnt lgkmcnt(4)
    v_mfma_f32_16x16x32_bf16 v[40:43], v[20:23], v[232:235], v[40:43]
    ds_read_b128 v[240:243], v97 offset:32768
    ds_read_b128 v[244:247], v97 offset:33792
    ds_read_b64_tr_b16 v[16:17], v8 offset:40960
    v_mfma_f32_16x16x32_bf16 v[44:47], v[20:23], v[236:239], v[44:47]
    ds_read_b64_tr_b16 v[18:19], v8 offset:43008
    s_waitcnt lgkmcnt(6)
    v_mfma_f32_16x16x32_bf16 v[48:51], v[24:27], v[232:235], v[48:51]
    ds_read_b64_tr_b16 v[20:21], v8 offset:45056
    v_mfma_f32_16x16x32_bf16 v[52:55], v[24:27], v[236:239], v[52:55]
    ds_read_b64_tr_b16 v[22:23], v8 offset:47104
    s_add_u32 m0, s39, 0xa000
    s_mov_b32 s62, 0x288080
    buffer_load_dwordx4 v2, s[8:11], s62 offen lds
    s_waitcnt lgkmcnt(6)
    v_mfma_f32_16x16x32_bf16 v[56:59], v[28:31], v[232:235], v[56:59]
    ds_read_b64_tr_b16 v[24:25], v9 offset:40960
    v_mfma_f32_16x16x32_bf16 v[60:63], v[28:31], v[236:239], v[60:63]
    ds_read_b64_tr_b16 v[26:27], v9 offset:43008
    s_waitcnt lgkmcnt(4)
    v_mfma_f32_16x16x32_bf16 v[32:35], v[16:19], v[240:243], v[32:35]
    ds_read_b64_tr_b16 v[28:29], v9 offset:45056
    v_mfma_f32_16x16x32_bf16 v[36:39], v[16:19], v[244:247], v[36:39]
    ds_read_b64_tr_b16 v[30:31], v9 offset:47104
    s_add_u32 m0, s39, 0xc000
    s_mov_b32 s63, 0x2d0080
    buffer_load_dwordx4 v2, s[8:11], s63 offen lds
    s_waitcnt lgkmcnt(4)
    v_mfma_f32_16x16x32_bf16 v[40:43], v[20:23], v[240:243], v[40:43]
    ds_read_b128 v[248:251], v97 offset:49152
    ds_read_b128 v[252:255], v97 offset:50176
    ds_read_b64_tr_b16 v[16:17], v8 offset:57344
    v_mfma_f32_16x16x32_bf16 v[44:47], v[20:23], v[244:247], v[44:47]
    ds_read_b64_tr_b16 v[18:19], v8 offset:59392
    s_setprio 2
    s_waitcnt lgkmcnt(6)
    v_mfma_f32_16x16x32_bf16 v[48:51], v[24:27], v[240:243], v[48:51]
    ds_read_b64_tr_b16 v[20:21], v8 offset:61440
    v_mfma_f32_16x16x32_bf16 v[52:55], v[24:27], v[244:247], v[52:55]
    ds_read_b64_tr_b16 v[22:23], v8 offset:63488
    s_add_u32 m0, s39, 0xe000
    s_mov_b32 s56, 0x318080
    buffer_load_dwordx4 v2, s[8:11], s56 offen lds
    s_waitcnt lgkmcnt(6)
    v_mfma_f32_16x16x32_bf16 v[56:59], v[28:31], v[240:243], v[56:59]
    ds_read_b64_tr_b16 v[24:25], v9 offset:57344
    v_mfma_f32_16x16x32_bf16 v[60:63], v[28:31], v[244:247], v[60:63]
    ds_read_b64_tr_b16 v[26:27], v9 offset:59392
    s_waitcnt lgkmcnt(4)
    v_mfma_f32_16x16x32_bf16 v[32:35], v[16:19], v[248:251], v[32:35]
    ds_read_b64_tr_b16 v[28:29], v9 offset:61440
    v_mfma_f32_16x16x32_bf16 v[36:39], v[16:19], v[252:255], v[36:39]
    ds_read_b64_tr_b16 v[30:31], v9 offset:63488
    s_add_u32 m0, s39, 0x10000
    s_mov_b32 s57, 0x360080
    buffer_load_dwordx4 v2, s[8:11], s57 offen lds
    s_waitcnt lgkmcnt(4)
    v_mfma_f32_16x16x32_bf16 v[40:43], v[20:23], v[248:251], v[40:43]
    v_add_u32 v8, 0x10000, v8
    ds_read_b64_tr_b16 v[16:17], v8 offset:0
    v_mfma_f32_16x16x32_bf16 v[44:47], v[20:23], v[252:255], v[44:47]
    ds_read_b64_tr_b16 v[18:19], v8 offset:2048
    s_waitcnt lgkmcnt(4)
    v_mfma_f32_16x16x32_bf16 v[48:51], v[24:27], v[248:251], v[48:51]
    ds_read_b64_tr_b16 v[20:21], v8 offset:4096
    v_mfma_f32_16x16x32_bf16 v[52:55], v[24:27], v[252:255], v[52:55]
    ds_read_b64_tr_b16 v[22:23], v8 offset:6144
    s_add_u32 m0, s39, 0x12000
    s_mov_b32 s58, 0x3a8080
    buffer_load_dwordx4 v2, s[8:11], s58 offen lds
    s_waitcnt lgkmcnt(4)
    v_mfma_f32_16x16x32_bf16 v[56:59], v[28:31], v[248:251], v[56:59]
    v_add_u32 v9, 0x10000, v9
    ds_read_b64_tr_b16 v[24:25], v9 offset:0
    v_mfma_f32_16x16x32_bf16 v[60:63], v[28:31], v[252:255], v[60:63]
    ds_read_b64_tr_b16 v[26:27], v9 offset:2048
    s_setprio 1
    s_waitcnt lgkmcnt(4)
    v_mfma_f32_16x16x32_bf16 v[64:67], v[16:19], v[112:115], 0
    ds_read_b64_tr_b16 v[28:29], v9 offset:4096
    v_mfma_f32_16x16x32_bf16 v[68:71], v[16:19], v[116:119], 0
    ds_read_b64_tr_b16 v[30:31], v9 offset:6144
    s_waitcnt lgkmcnt(4)
    v_mfma_f32_16x16x32_bf16 v[72:75], v[20:23], v[112:115], 0
    ds_read_b64_tr_b16 v[16:17], v8 offset:8192
    v_mul_f32 v11, s53, v32
    v_mfma_f32_16x16x32_bf16 v[76:79], v[20:23], v[116:119], 0
    ds_read_b64_tr_b16 v[18:19], v8 offset:10240
    v_mul_f32 v12, s53, v33
    s_waitcnt lgkmcnt(4)
    v_mfma_f32_16x16x32_bf16 v[80:83], v[24:27], v[112:115], 0
    ds_read_b64_tr_b16 v[20:21], v8 offset:12288
    v_mul_f32 v13, s53, v34
    v_mfma_f32_16x16x32_bf16 v[84:87], v[24:27], v[116:119], 0
    ds_read_b64_tr_b16 v[22:23], v8 offset:14336
    v_mul_f32 v14, s53, v35
    s_waitcnt lgkmcnt(4)
    v_mfma_f32_16x16x32_bf16 v[88:91], v[28:31], v[112:115], 0
    ds_read_b64_tr_b16 v[24:25], v9 offset:8192
    v_exp_f32 v11, v11
    v_mfma_f32_16x16x32_bf16 v[92:95], v[28:31], v[116:119], 0
    ds_read_b64_tr_b16 v[26:27], v9 offset:10240
    v_exp_f32 v12, v12
    s_waitcnt lgkmcnt(4)
    v_mfma_f32_16x16x32_bf16 v[64:67], v[16:19], v[120:123], v[64:67]
    ds_read_b64_tr_b16 v[28:29], v9 offset:12288
    v_exp_f32 v13, v13
    v_mfma_f32_16x16x32_bf16 v[68:71], v[16:19], v[124:127], v[68:71]
    ds_read_b64_tr_b16 v[30:31], v9 offset:14336
    v_exp_f32 v14, v14
    s_waitcnt lgkmcnt(4)
    v_mfma_f32_16x16x32_bf16 v[72:75], v[20:23], v[120:123], v[72:75]
    ds_read_b64_tr_b16 v[16:17], v8 offset:16384
    v_mul_f32 v32, v32, v40
    v_mfma_f32_16x16x32_bf16 v[76:79], v[20:23], v[124:127], v[76:79]
    ds_read_b64_tr_b16 v[18:19], v8 offset:18432
    v_mul_f32 v33, v33, v41
    s_setprio 0
    s_waitcnt lgkmcnt(4)
    v_mfma_f32_16x16x32_bf16 v[80:83], v[24:27], v[120:123], v[80:83]
    ds_read_b64_tr_b16 v[20:21], v8 offset:20480
    v_mul_f32 v34, v34, v42
    v_mfma_f32_16x16x32_bf16 v[84:87], v[24:27], v[124:127], v[84:87]
    ds_read_b64_tr_b16 v[22:23], v8 offset:22528
    v_mul_f32 v35, v35, v43
    s_waitcnt lgkmcnt(4)
    v_mfma_f32_16x16x32_bf16 v[88:91], v[28:31], v[120:123], v[88:91]
    ds_read_b64_tr_b16 v[24:25], v9 offset:16384
    v_add_f32 v11, 1.0, v11
    v_mfma_f32_16x16x32_bf16 v[92:95], v[28:31], v[124:127], v[92:95]
    ds_read_b64_tr_b16 v[26:27], v9 offset:18432
    v_add_f32 v12, 1.0, v12
    s_waitcnt lgkmcnt(4)
    v_mfma_f32_16x16x32_bf16 v[64:67], v[16:19], v[128:131], v[64:67]
    ds_read_b64_tr_b16 v[28:29], v9 offset:20480
    v_add_f32 v13, 1.0, v13
    v_mfma_f32_16x16x32_bf16 v[68:71], v[16:19], v[132:135], v[68:71]
    ds_read_b64_tr_b16 v[30:31], v9 offset:22528
    v_add_f32 v14, 1.0, v14
    s_waitcnt lgkmcnt(4)
    v_mfma_f32_16x16x32_bf16 v[72:75], v[20:23], v[128:131], v[72:75]
    ds_read_b64_tr_b16 v[16:17], v8 offset:24576
    v_rcp_f32 v11, v11
    v_mfma_f32_16x16x32_bf16 v[76:79], v[20:23], v[132:135], v[76:79]
    ds_read_b64_tr_b16 v[18:19], v8 offset:26624
    v_rcp_f32 v12, v12
    s_waitcnt lgkmcnt(4)
    v_mfma_f32_16x16x32_bf16 v[80:83], v[24:27], v[128:131], v[80:83]
    ds_read_b64_tr_b16 v[20:21], v8 offset:28672
    v_rcp_f32 v13, v13
    v_mfma_f32_16x16x32_bf16 v[84:87], v[24:27], v[132:135], v[84:87]
    ds_read_b64_tr_b16 v[22:23], v8 offset:30720
    v_rcp_f32 v14, v14
    s_waitcnt lgkmcnt(4)
    v_mfma_f32_16x16x32_bf16 v[88:91], v[28:31], v[128:131], v[88:91]
    ds_read_b64_tr_b16 v[24:25], v9 offset:24576
    v_mul_f32 v32, v32, v11
    v_mfma_f32_16x16x32_bf16 v[92:95], v[28:31], v[132:135], v[92:95]
    ds_read_b64_tr_b16 v[26:27], v9 offset:26624
    v_mul_f32 v33, v33, v12
    s_setprio 3
    s_waitcnt vmcnt(4)
    s_barrier
    s_waitcnt lgkmcnt(4)
    v_mfma_f32_16x16x32_bf16 v[64:67], v[16:19], v[136:139], v[64:67]
    ds_read_b64_tr_b16 v[28:29], v9 offset:28672
    v_mul_f32 v34, v34, v13
    v_mfma_f32_16x16x32_bf16 v[68:71], v[16:19], v[140:143], v[68:71]
    ds_read_b64_tr_b16 v[30:31], v9 offset:30720
    v_mul_f32 v35, v35, v14
    s_add_u32 m0, s39, 0x14000
    s_mov_b32 s59, 0x3f0080
    buffer_load_dwordx4 v2, s[8:11], s59 offen lds
    s_waitcnt lgkmcnt(4)
    v_mfma_f32_16x16x32_bf16 v[72:75], v[20:23], v[136:139], v[72:75]
    v_subrev_u32 v8, 0x20000, v8
    ds_read_b64_tr_b16 v[16:17], v8 offset:0
    v_cvt_pk_bf16_f32 v96, v32, v33
    v_mfma_f32_16x16x32_bf16 v[76:79], v[20:23], v[140:143], v[76:79]
    ds_read_b64_tr_b16 v[18:19], v8 offset:2048
    v_cvt_pk_bf16_f32 v97, v34, v35
    s_waitcnt lgkmcnt(4)
    v_mfma_f32_16x16x32_bf16 v[80:83], v[24:27], v[136:139], v[80:83]
    ds_read_b64_tr_b16 v[20:21], v8 offset:4096
    v_mul_f32 v11, s53, v36
    v_mfma_f32_16x16x32_bf16 v[84:87], v[24:27], v[140:143], v[84:87]
    ds_read_b64_tr_b16 v[22:23], v8 offset:6144
    v_mul_f32 v12, s53, v37
    s_add_u32 m0, s39, 0x16000
    s_mov_b32 s60, 0x438080
    buffer_load_dwordx4 v2, s[8:11], s60 offen lds
    s_waitcnt lgkmcnt(4)
    v_mfma_f32_16x16x32_bf16 v[88:91], v[28:31], v[136:139], v[88:91]
    v_subrev_u32 v9, 0x20000, v9
    ds_read_b64_tr_b16 v[24:25], v9 offset:0
    v_mul_f32 v13, s53, v38
    v_mfma_f32_16x16x32_bf16 v[92:95], v[28:31], v[140:143], v[92:95]
    ds_read_b64_tr_b16 v[26:27], v9 offset:2048
    v_mul_f32 v14, s53, v39
    s_waitcnt lgkmcnt(4)
    v_mfma_f32_16x16x32_bf16 v[64:67], v[16:19], v[144:147], v[64:67]
    ds_read_b64_tr_b16 v[28:29], v9 offset:4096
    v_exp_f32 v11, v11
    v_mfma_f32_16x16x32_bf16 v[68:71], v[16:19], v[148:151], v[68:71]
    ds_read_b64_tr_b16 v[30:31], v9 offset:6144
    v_exp_f32 v12, v12
    s_add_u32 m0, s39, 0x18000
    s_mov_b32 s61, 0x480080
    buffer_load_dwordx4 v2, s[8:11], s61 offen lds
    s_waitcnt lgkmcnt(4)
    v_mfma_f32_16x16x32_bf16 v[72:75], v[20:23], v[144:147], v[72:75]
    ds_read_b64_tr_b16 v[16:17], v8 offset:8192
    v_exp_f32 v13, v13
    v_mfma_f32_16x16x32_bf16 v[76:79], v[20:23], v[148:151], v[76:79]
    ds_read_b64_tr_b16 v[18:19], v8 offset:10240
    v_exp_f32 v14, v14
    s_setprio 2
    s_waitcnt lgkmcnt(4)
    v_mfma_f32_16x16x32_bf16 v[80:83], v[24:27], v[144:147], v[80:83]
    ds_read_b64_tr_b16 v[20:21], v8 offset:12288
    v_mul_f32 v36, v36, v44
    v_mfma_f32_16x16x32_bf16 v[84:87], v[24:27], v[148:151], v[84:87]
    ds_read_b64_tr_b16 v[22:23], v8 offset:14336
    v_mul_f32 v37, v37, v45
    s_add_u32 m0, s39, 0x1a000
    s_mov_b32 s62, 0x4c8080
    buffer_load_dwordx4 v2, s[8:11], s62 offen lds
    s_waitcnt lgkmcnt(4)
    v_mfma_f32_16x16x32_bf16 v[88:91], v[28:31], v[144:147], v[88:91]
    ds_read_b64_tr_b16 v[24:25], v9 offset:8192
    v_mul_f32 v38, v38, v46
    v_mfma_f32_16x16x32_bf16 v[92:95], v[28:31], v[148:151], v[92:95]
    ds_read_b64_tr_b16 v[26:27], v9 offset:10240
    v_mul_f32 v39, v39, v47
    s_waitcnt lgkmcnt(4)
    v_mfma_f32_16x16x32_bf16 v[64:67], v[16:19], v[152:155], v[64:67]
    ds_read_b64_tr_b16 v[28:29], v9 offset:12288
    v_add_f32 v11, 1.0, v11
    v_mfma_f32_16x16x32_bf16 v[68:71], v[16:19], v[156:159], v[68:71]
    ds_read_b64_tr_b16 v[30:31], v9 offset:14336
    v_add_f32 v12, 1.0, v12
    s_add_u32 m0, s39, 0x1c000
    s_mov_b32 s63, 0x100
    buffer_load_dwordx4 v2, s[8:11], s63 offen lds
    s_waitcnt lgkmcnt(4)
    v_mfma_f32_16x16x32_bf16 v[72:75], v[20:23], v[152:155], v[72:75]
    ds_read_b64_tr_b16 v[16:17], v8 offset:16384
    v_add_f32 v13, 1.0, v13
    v_mfma_f32_16x16x32_bf16 v[76:79], v[20:23], v[156:159], v[76:79]
    ds_read_b64_tr_b16 v[18:19], v8 offset:18432
    v_add_f32 v14, 1.0, v14
    s_waitcnt lgkmcnt(4)
    v_mfma_f32_16x16x32_bf16 v[80:83], v[24:27], v[152:155], v[80:83]
    ds_read_b64_tr_b16 v[20:21], v8 offset:20480
    v_rcp_f32 v11, v11
    v_mfma_f32_16x16x32_bf16 v[84:87], v[24:27], v[156:159], v[84:87]
    ds_read_b64_tr_b16 v[22:23], v8 offset:22528
    v_rcp_f32 v12, v12
    s_add_u32 m0, s39, 0x1e000
    s_mov_b32 s56, 0x48100
    buffer_load_dwordx4 v2, s[8:11], s56 offen lds
    s_waitcnt lgkmcnt(4)
    v_mfma_f32_16x16x32_bf16 v[88:91], v[28:31], v[152:155], v[88:91]
    ds_read_b64_tr_b16 v[24:25], v9 offset:16384
    v_rcp_f32 v13, v13
    v_mfma_f32_16x16x32_bf16 v[92:95], v[28:31], v[156:159], v[92:95]
    ds_read_b64_tr_b16 v[26:27], v9 offset:18432
    v_rcp_f32 v14, v14
    s_setprio 1
    s_waitcnt lgkmcnt(4)
    v_mfma_f32_16x16x32_bf16 v[64:67], v[16:19], v[160:163], v[64:67]
    ds_read_b64_tr_b16 v[28:29], v9 offset:20480
    v_mul_f32 v36, v36, v11
    v_mfma_f32_16x16x32_bf16 v[68:71], v[16:19], v[164:167], v[68:71]
    ds_read_b64_tr_b16 v[30:31], v9 offset:22528
    v_mul_f32 v37, v37, v12
    s_add_u32 m0, s39, 0x20000
    s_mov_b32 s57, 0x90100
    buffer_load_dwordx4 v2, s[8:11], s57 offen lds
    s_waitcnt lgkmcnt(4)
    v_mfma_f32_16x16x32_bf16 v[72:75], v[20:23], v[160:163], v[72:75]
    ds_read_b64_tr_b16 v[16:17], v8 offset:24576
    v_mul_f32 v38, v38, v13
    v_mfma_f32_16x16x32_bf16 v[76:79], v[20:23], v[164:167], v[76:79]
    ds_read_b64_tr_b16 v[18:19], v8 offset:26624
    v_mul_f32 v39, v39, v14
    s_waitcnt lgkmcnt(4)
    v_mfma_f32_16x16x32_bf16 v[80:83], v[24:27], v[160:163], v[80:83]
    ds_read_b64_tr_b16 v[20:21], v8 offset:28672
    v_cvt_pk_bf16_f32 v98, v36, v37
    v_mfma_f32_16x16x32_bf16 v[84:87], v[24:27], v[164:167], v[84:87]
    ds_read_b64_tr_b16 v[22:23], v8 offset:30720
    v_cvt_pk_bf16_f32 v99, v38, v39
    s_add_u32 m0, s39, 0x22000
    s_mov_b32 s58, 0xd8100
    buffer_load_dwordx4 v2, s[8:11], s58 offen lds
    s_waitcnt lgkmcnt(4)
    v_mfma_f32_16x16x32_bf16 v[88:91], v[28:31], v[160:163], v[88:91]
    ds_read_b64_tr_b16 v[24:25], v9 offset:24576
    s_add_u32 s59, s20, 0
    buffer_store_dwordx4 v[96:99], v4, s[12:15], s59 offen sc1
    v_mfma_f32_16x16x32_bf16 v[92:95], v[28:31], v[164:167], v[92:95]
    ds_read_b64_tr_b16 v[26:27], v9 offset:26624
    v_mul_f32 v11, s53, v48
    s_waitcnt lgkmcnt(4)
    v_mfma_f32_16x16x32_bf16 v[64:67], v[16:19], v[168:171], v[64:67]
    ds_read_b64_tr_b16 v[28:29], v9 offset:28672
    v_mul_f32 v12, s53, v49
    v_mfma_f32_16x16x32_bf16 v[68:71], v[16:19], v[172:175], v[68:71]
    ds_read_b64_tr_b16 v[30:31], v9 offset:30720
    v_mul_f32 v13, s53, v50
    s_add_u32 m0, s39, 0x24000
    s_mov_b32 s60, 0x120100
    buffer_load_dwordx4 v2, s[8:11], s60 offen lds
    s_waitcnt lgkmcnt(4)
    v_mfma_f32_16x16x32_bf16 v[72:75], v[20:23], v[168:171], v[72:75]
    ds_read_b64_tr_b16 v[16:17], v8 offset:32768
    v_mul_f32 v14, s53, v51
    v_mfma_f32_16x16x32_bf16 v[76:79], v[20:23], v[172:175], v[76:79]
    ds_read_b64_tr_b16 v[18:19], v8 offset:34816
    v_exp_f32 v11, v11
    s_setprio 0
    s_waitcnt lgkmcnt(4)
    v_mfma_f32_16x16x32_bf16 v[80:83], v[24:27], v[168:171], v[80:83]
    ds_read_b64_tr_b16 v[20:21], v8 offset:36864
    v_exp_f32 v12, v12
    v_mfma_f32_16x16x32_bf16 v[84:87], v[24:27], v[172:175], v[84:87]
    ds_read_b64_tr_b16 v[22:23], v8 offset:38912
    v_exp_f32 v13, v13
    s_waitcnt lgkmcnt(4)
    v_mfma_f32_16x16x32_bf16 v[88:91], v[28:31], v[168:171], v[88:91]
    ds_read_b64_tr_b16 v[24:25], v9 offset:32768
    v_exp_f32 v14, v14
    v_mfma_f32_16x16x32_bf16 v[92:95], v[28:31], v[172:175], v[92:95]
    ds_read_b64_tr_b16 v[26:27], v9 offset:34816
    v_mul_f32 v48, v48, v56
    s_waitcnt lgkmcnt(4)
    v_mfma_f32_16x16x32_bf16 v[64:67], v[16:19], v[176:179], v[64:67]
    ds_read_b64_tr_b16 v[28:29], v9 offset:36864
    v_mul_f32 v49, v49, v57
    v_mfma_f32_16x16x32_bf16 v[68:71], v[16:19], v[180:183], v[68:71]
    ds_read_b64_tr_b16 v[30:31], v9 offset:38912
    v_mul_f32 v50, v50, v58
    s_waitcnt lgkmcnt(4)
    v_mfma_f32_16x16x32_bf16 v[72:75], v[20:23], v[176:179], v[72:75]
    ds_read_b64_tr_b16 v[16:17], v8 offset:40960
    v_mul_f32 v51, v51, v59
    v_mfma_f32_16x16x32_bf16 v[76:79], v[20:23], v[180:183], v[76:79]
    ds_read_b64_tr_b16 v[18:19], v8 offset:43008
    v_add_f32 v11, 1.0, v11
    s_waitcnt lgkmcnt(4)
    v_mfma_f32_16x16x32_bf16 v[80:83], v[24:27], v[176:179], v[80:83]
    ds_read_b64_tr_b16 v[20:21], v8 offset:45056
    v_add_f32 v12, 1.0, v12
    v_mfma_f32_16x16x32_bf16 v[84:87], v[24:27], v[180:183], v[84:87]
    ds_read_b64_tr_b16 v[22:23], v8 offset:47104
    v_add_f32 v13, 1.0, v13
    s_waitcnt lgkmcnt(4)
    v_mfma_f32_16x16x32_bf16 v[88:91], v[28:31], v[176:179], v[88:91]
    ds_read_b64_tr_b16 v[24:25], v9 offset:40960
    v_add_f32 v14, 1.0, v14
    v_mfma_f32_16x16x32_bf16 v[92:95], v[28:31], v[180:183], v[92:95]
    ds_read_b64_tr_b16 v[26:27], v9 offset:43008
    v_rcp_f32 v11, v11
    s_setprio 3
    s_waitcnt vmcnt(8)
    s_barrier
    s_waitcnt lgkmcnt(4)
    v_mfma_f32_16x16x32_bf16 v[64:67], v[16:19], v[184:187], v[64:67]
    ds_read_b64_tr_b16 v[28:29], v9 offset:45056
    v_rcp_f32 v12, v12
    v_mfma_f32_16x16x32_bf16 v[68:71], v[16:19], v[188:191], v[68:71]
    ds_read_b64_tr_b16 v[30:31], v9 offset:47104
    v_rcp_f32 v13, v13
    s_add_u32 m0, s39, 0x26000
    s_mov_b32 s61, 0x168100
    buffer_load_dwordx4 v2, s[8:11], s61 offen lds
    s_waitcnt lgkmcnt(4)
    v_mfma_f32_16x16x32_bf16 v[72:75], v[20:23], v[184:187], v[72:75]
    ds_read_b64_tr_b16 v[16:17], v8 offset:49152
    v_rcp_f32 v14, v14
    v_mfma_f32_16x16x32_bf16 v[76:79], v[20:23], v[188:191], v[76:79]
    ds_read_b64_tr_b16 v[18:19], v8 offset:51200
    v_mul_f32 v48, v48, v11
    s_waitcnt lgkmcnt(4)
    v_mfma_f32_16x16x32_bf16 v[80:83], v[24:27], v[184:187], v[80:83]
    ds_read_b64_tr_b16 v[20:21], v8 offset:53248
    v_mul_f32 v49, v49, v12
    v_mfma_f32_16x16x32_bf16 v[84:87], v[24:27], v[188:191], v[84:87]
    ds_read_b64_tr_b16 v[22:23], v8 offset:55296
    v_mul_f32 v50, v50, v13
    s_add_u32 m0, s39, 0x0
    s_mov_b32 s62, 0x1b0100
    buffer_load_dwordx4 v2, s[8:11], s62 offen lds
    s_waitcnt lgkmcnt(4)
    v_mfma_f32_16x16x32_bf16 v[88:91], v[28:31], v[184:187], v[88:91]
    ds_read_b64_tr_b16 v[24:25], v9 offset:49152
    v_mul_f32 v51, v51, v14
    v_mfma_f32_16x16x32_bf16 v[92:95], v[28:31], v[188:191], v[92:95]
    ds_read_b64_tr_b16 v[26:27], v9 offset:51200
    v_cvt_pk_bf16_f32 v100, v48, v49
    s_waitcnt lgkmcnt(4)
    v_mfma_f32_16x16x32_bf16 v[64:67], v[16:19], v[192:195], v[64:67]
    ds_read_b64_tr_b16 v[28:29], v9 offset:53248
    v_cvt_pk_bf16_f32 v101, v50, v51
    v_mfma_f32_16x16x32_bf16 v[68:71], v[16:19], v[196:199], v[68:71]
    ds_read_b64_tr_b16 v[30:31], v9 offset:55296
    v_mul_f32 v11, s53, v52
    s_add_u32 m0, s39, 0x2000
    s_mov_b32 s63, 0x1f8100
    buffer_load_dwordx4 v2, s[8:11], s63 offen lds
    s_waitcnt lgkmcnt(4)
    v_mfma_f32_16x16x32_bf16 v[72:75], v[20:23], v[192:195], v[72:75]
    ds_read_b64_tr_b16 v[16:17], v8 offset:57344
    v_mul_f32 v12, s53, v53
    v_mfma_f32_16x16x32_bf16 v[76:79], v[20:23], v[196:199], v[76:79]
    ds_read_b64_tr_b16 v[18:19], v8 offset:59392
    v_mul_f32 v13, s53, v54
    s_setprio 2
    s_waitcnt lgkmcnt(4)
    v_mfma_f32_16x16x32_bf16 v[80:83], v[24:27], v[192:195], v[80:83]
    ds_read_b64_tr_b16 v[20:21], v8 offset:61440
    v_mul_f32 v14, s53, v55
    v_mfma_f32_16x16x32_bf16 v[84:87], v[24:27], v[196:199], v[84:87]
    ds_read_b64_tr_b16 v[22:23], v8 offset:63488
    v_exp_f32 v11, v11
    s_add_u32 m0, s39, 0x4000
    s_mov_b32 s56, 0x240100
    buffer_load_dwordx4 v2, s[8:11], s56 offen lds
    s_waitcnt lgkmcnt(4)
    v_mfma_f32_16x16x32_bf16 v[88:91], v[28:31], v[192:195], v[88:91]
    ds_read_b64_tr_b16 v[24:25], v9 offset:57344
    v_exp_f32 v12, v12
    v_mfma_f32_16x16x32_bf16 v[92:95], v[28:31], v[196:199], v[92:95]
    ds_read_b64_tr_b16 v[26:27], v9 offset:59392
    v_exp_f32 v13, v13
    s_waitcnt lgkmcnt(4)
    v_mfma_f32_16x16x32_bf16 v[64:67], v[16:19], v[200:203], v[64:67]
    ds_read_b64_tr_b16 v[28:29], v9 offset:61440
    v_exp_f32 v14, v14
    v_mfma_f32_16x16x32_bf16 v[68:71], v[16:19], v[204:207], v[68:71]
    ds_read_b64_tr_b16 v[30:31], v9 offset:63488
    v_mul_f32 v52, v52, v60
    s_add_u32 m0, s39, 0x6000
    s_mov_b32 s57, 0x288100
    buffer_load_dwordx4 v2, s[8:11], s57 offen lds
    s_waitcnt lgkmcnt(4)
    v_mfma_f32_16x16x32_bf16 v[72:75], v[20:23], v[200:203], v[72:75]
    v_add_u32 v8, 0x10000, v8
    ds_read_b64_tr_b16 v[16:17], v8 offset:0
    v_mul_f32 v53, v53, v61
    v_mfma_f32_16x16x32_bf16 v[76:79], v[20:23], v[204:207], v[76:79]
    ds_read_b64_tr_b16 v[18:19], v8 offset:2048
    v_mul_f32 v54, v54, v62
    s_waitcnt lgkmcnt(4)
    v_mfma_f32_16x16x32_bf16 v[80:83], v[24:27], v[200:203], v[80:83]
    ds_read_b64_tr_b16 v[20:21], v8 offset:4096
    v_mul_f32 v55, v55, v63
    v_mfma_f32_16x16x32_bf16 v[84:87], v[24:27], v[204:207], v[84:87]
    ds_read_b64_tr_b16 v[22:23], v8 offset:6144
    v_add_f32 v11, 1.0, v11
    s_add_u32 m0, s39, 0x8000
    s_mov_b32 s58, 0x2d0100
    buffer_load_dwordx4 v2, s[8:11], s58 offen lds
    s_waitcnt lgkmcnt(4)
    v_mfma_f32_16x16x32_bf16 v[88:91], v[28:31], v[200:203], v[88:91]
    v_add_u32 v9, 0x10000, v9
    ds_read_b64_tr_b16 v[24:25], v9 offset:0
    v_add_f32 v12, 1.0, v12
    v_mfma_f32_16x16x32_bf16 v[92:95], v[28:31], v[204:207], v[92:95]
    ds_read_b64_tr_b16 v[26:27], v9 offset:2048
    v_add_f32 v13, 1.0, v13
    s_setprio 1
    s_waitcnt lgkmcnt(4)
    v_mfma_f32_16x16x32_bf16 v[64:67], v[16:19], v[208:211], v[64:67]
    ds_read_b64_tr_b16 v[28:29], v9 offset:4096
    v_add_f32 v14, 1.0, v14
    v_mfma_f32_16x16x32_bf16 v[68:71], v[16:19], v[212:215], v[68:71]
    ds_read_b64_tr_b16 v[30:31], v9 offset:6144
    v_rcp_f32 v11, v11
    s_waitcnt lgkmcnt(4)
    v_mfma_f32_16x16x32_bf16 v[72:75], v[20:23], v[208:211], v[72:75]
    ds_read_b64_tr_b16 v[16:17], v8 offset:8192
    v_rcp_f32 v12, v12
    v_mfma_f32_16x16x32_bf16 v[76:79], v[20:23], v[212:215], v[76:79]
    ds_read_b64_tr_b16 v[18:19], v8 offset:10240
    v_rcp_f32 v13, v13
    s_waitcnt lgkmcnt(4)
    v_mfma_f32_16x16x32_bf16 v[80:83], v[24:27], v[208:211], v[80:83]
    ds_read_b64_tr_b16 v[20:21], v8 offset:12288
    v_rcp_f32 v14, v14
    v_mfma_f32_16x16x32_bf16 v[84:87], v[24:27], v[212:215], v[84:87]
    ds_read_b64_tr_b16 v[22:23], v8 offset:14336
    v_mul_f32 v52, v52, v11
    s_waitcnt lgkmcnt(4)
    v_mfma_f32_16x16x32_bf16 v[88:91], v[28:31], v[208:211], v[88:91]
    ds_read_b64_tr_b16 v[24:25], v9 offset:8192
    v_mul_f32 v53, v53, v12
    v_mfma_f32_16x16x32_bf16 v[92:95], v[28:31], v[212:215], v[92:95]
    ds_read_b64_tr_b16 v[26:27], v9 offset:10240
    v_mul_f32 v54, v54, v13
    s_waitcnt lgkmcnt(4)
    v_mfma_f32_16x16x32_bf16 v[64:67], v[16:19], v[216:219], v[64:67]
    ds_read_b64_tr_b16 v[28:29], v9 offset:12288
    v_mul_f32 v55, v55, v14
    v_mfma_f32_16x16x32_bf16 v[68:71], v[16:19], v[220:223], v[68:71]
    ds_read_b64_tr_b16 v[30:31], v9 offset:14336
    v_cvt_pk_bf16_f32 v102, v52, v53
    s_waitcnt lgkmcnt(4)
    v_mfma_f32_16x16x32_bf16 v[72:75], v[20:23], v[216:219], v[72:75]
    ds_read_b64_tr_b16 v[16:17], v8 offset:16384
    v_cvt_pk_bf16_f32 v103, v54, v55
    v_mfma_f32_16x16x32_bf16 v[76:79], v[20:23], v[220:223], v[76:79]
    ds_read_b64_tr_b16 v[18:19], v8 offset:18432
    s_add_u32 s59, s20, 8192
    buffer_store_dwordx4 v[100:103], v4, s[12:15], s59 offen sc1
    s_setprio 0
    s_waitcnt lgkmcnt(4)
    v_mfma_f32_16x16x32_bf16 v[80:83], v[24:27], v[216:219], v[80:83]
    ds_read_b64_tr_b16 v[20:21], v8 offset:20480
    v_mfma_f32_16x16x32_bf16 v[84:87], v[24:27], v[220:223], v[84:87]
    ds_read_b64_tr_b16 v[22:23], v8 offset:22528
    s_waitcnt lgkmcnt(4)
    v_mfma_f32_16x16x32_bf16 v[88:91], v[28:31], v[216:219], v[88:91]
    ds_read_b64_tr_b16 v[24:25], v9 offset:16384
    v_mfma_f32_16x16x32_bf16 v[92:95], v[28:31], v[220:223], v[92:95]
    ds_read_b64_tr_b16 v[26:27], v9 offset:18432
    s_waitcnt lgkmcnt(4)
    v_mfma_f32_16x16x32_bf16 v[64:67], v[16:19], v[224:227], v[64:67]
    ds_read_b64_tr_b16 v[28:29], v9 offset:20480
    v_mfma_f32_16x16x32_bf16 v[68:71], v[16:19], v[228:231], v[68:71]
    ds_read_b64_tr_b16 v[30:31], v9 offset:22528
    s_waitcnt lgkmcnt(4)
    v_mfma_f32_16x16x32_bf16 v[72:75], v[20:23], v[224:227], v[72:75]
    ds_read_b64_tr_b16 v[16:17], v8 offset:24576
    v_mfma_f32_16x16x32_bf16 v[76:79], v[20:23], v[228:231], v[76:79]
    ds_read_b64_tr_b16 v[18:19], v8 offset:26624
    s_waitcnt lgkmcnt(4)
    v_mfma_f32_16x16x32_bf16 v[80:83], v[24:27], v[224:227], v[80:83]
    ds_read_b64_tr_b16 v[20:21], v8 offset:28672
    v_mfma_f32_16x16x32_bf16 v[84:87], v[24:27], v[228:231], v[84:87]
    ds_read_b64_tr_b16 v[22:23], v8 offset:30720
    s_waitcnt lgkmcnt(4)
    v_mfma_f32_16x16x32_bf16 v[88:91], v[28:31], v[224:227], v[88:91]
    ds_read_b64_tr_b16 v[24:25], v9 offset:24576
    v_mfma_f32_16x16x32_bf16 v[92:95], v[28:31], v[228:231], v[92:95]
    ds_read_b64_tr_b16 v[26:27], v9 offset:26624
    s_setprio 3
    s_waitcnt vmcnt(9)
    s_barrier
    s_waitcnt lgkmcnt(4)
    v_mfma_f32_16x16x32_bf16 v[64:67], v[16:19], v[232:235], v[64:67]
    ds_read_b64_tr_b16 v[28:29], v9 offset:28672
    v_mfma_f32_16x16x32_bf16 v[68:71], v[16:19], v[236:239], v[68:71]
    ds_read_b64_tr_b16 v[30:31], v9 offset:30720
    s_add_u32 m0, s39, 0xa000
    s_mov_b32 s60, 0x318100
    buffer_load_dwordx4 v2, s[8:11], s60 offen lds
    s_waitcnt lgkmcnt(4)
    v_mfma_f32_16x16x32_bf16 v[72:75], v[20:23], v[232:235], v[72:75]
    ds_read_b64_tr_b16 v[16:17], v8 offset:32768
    v_mfma_f32_16x16x32_bf16 v[76:79], v[20:23], v[236:239], v[76:79]
    ds_read_b64_tr_b16 v[18:19], v8 offset:34816
    s_waitcnt lgkmcnt(4)
    v_mfma_f32_16x16x32_bf16 v[80:83], v[24:27], v[232:235], v[80:83]
    ds_read_b64_tr_b16 v[20:21], v8 offset:36864
    v_mfma_f32_16x16x32_bf16 v[84:87], v[24:27], v[236:239], v[84:87]
    ds_read_b64_tr_b16 v[22:23], v8 offset:38912
    s_add_u32 m0, s39, 0xc000
    s_mov_b32 s61, 0x360100
    buffer_load_dwordx4 v2, s[8:11], s61 offen lds
    s_waitcnt lgkmcnt(4)
    v_mfma_f32_16x16x32_bf16 v[88:91], v[28:31], v[232:235], v[88:91]
    ds_read_b64_tr_b16 v[24:25], v9 offset:32768
    v_mfma_f32_16x16x32_bf16 v[92:95], v[28:31], v[236:239], v[92:95]
    ds_read_b64_tr_b16 v[26:27], v9 offset:34816
    s_waitcnt lgkmcnt(4)
    v_mfma_f32_16x16x32_bf16 v[64:67], v[16:19], v[240:243], v[64:67]
    ds_read_b64_tr_b16 v[28:29], v9 offset:36864
    v_mfma_f32_16x16x32_bf16 v[68:71], v[16:19], v[244:247], v[68:71]
    ds_read_b64_tr_b16 v[30:31], v9 offset:38912
    s_add_u32 m0, s39, 0xe000
    s_mov_b32 s62, 0x3a8100
    buffer_load_dwordx4 v2, s[8:11], s62 offen lds
    s_waitcnt lgkmcnt(4)
    v_mfma_f32_16x16x32_bf16 v[72:75], v[20:23], v[240:243], v[72:75]
    ds_read_b64_tr_b16 v[16:17], v8 offset:40960
    v_mfma_f32_16x16x32_bf16 v[76:79], v[20:23], v[244:247], v[76:79]
    ds_read_b64_tr_b16 v[18:19], v8 offset:43008
    s_setprio 2
    s_waitcnt lgkmcnt(4)
    v_mfma_f32_16x16x32_bf16 v[80:83], v[24:27], v[240:243], v[80:83]
    ds_read_b64_tr_b16 v[20:21], v8 offset:45056
    v_mfma_f32_16x16x32_bf16 v[84:87], v[24:27], v[244:247], v[84:87]
    ds_read_b64_tr_b16 v[22:23], v8 offset:47104
    s_add_u32 m0, s39, 0x10000
    s_mov_b32 s63, 0x3f0100
    buffer_load_dwordx4 v2, s[8:11], s63 offen lds
    s_waitcnt lgkmcnt(4)
    v_mfma_f32_16x16x32_bf16 v[88:91], v[28:31], v[240:243], v[88:91]
    ds_read_b64_tr_b16 v[24:25], v9 offset:40960
    v_mfma_f32_16x16x32_bf16 v[92:95], v[28:31], v[244:247], v[92:95]
    ds_read_b64_tr_b16 v[26:27], v9 offset:43008
    s_waitcnt lgkmcnt(4)
    v_mfma_f32_16x16x32_bf16 v[64:67], v[16:19], v[248:251], v[64:67]
    ds_read_b64_tr_b16 v[28:29], v9 offset:45056
    v_mfma_f32_16x16x32_bf16 v[68:71], v[16:19], v[252:255], v[68:71]
    ds_read_b64_tr_b16 v[30:31], v9 offset:47104
    s_add_u32 m0, s39, 0x12000
    s_mov_b32 s56, 0x438100
    buffer_load_dwordx4 v2, s[8:11], s56 offen lds
    s_waitcnt lgkmcnt(4)
    v_mfma_f32_16x16x32_bf16 v[72:75], v[20:23], v[248:251], v[72:75]
    ds_read_b64_tr_b16 v[16:17], v8 offset:49152
    v_mfma_f32_16x16x32_bf16 v[76:79], v[20:23], v[252:255], v[76:79]
    ds_read_b64_tr_b16 v[18:19], v8 offset:51200
    s_waitcnt lgkmcnt(4)
    v_mfma_f32_16x16x32_bf16 v[80:83], v[24:27], v[248:251], v[80:83]
    ds_read_b64_tr_b16 v[20:21], v8 offset:53248
    v_mfma_f32_16x16x32_bf16 v[84:87], v[24:27], v[252:255], v[84:87]
    ds_read_b64_tr_b16 v[22:23], v8 offset:55296
    s_add_u32 m0, s39, 0x14000
    s_mov_b32 s57, 0x480100
    buffer_load_dwordx4 v2, s[8:11], s57 offen lds
    s_waitcnt lgkmcnt(4)
    v_mfma_f32_16x16x32_bf16 v[88:91], v[28:31], v[248:251], v[88:91]
    ds_read_b64_tr_b16 v[24:25], v9 offset:49152
    v_mfma_f32_16x16x32_bf16 v[92:95], v[28:31], v[252:255], v[92:95]
    ds_read_b64_tr_b16 v[26:27], v9 offset:51200
    s_setprio 1
    s_waitcnt lgkmcnt(4)
    v_mfma_f32_16x16x32_bf16 v[32:35], v[16:19], v[112:115], 0
    ds_read_b64_tr_b16 v[28:29], v9 offset:53248
    v_mfma_f32_16x16x32_bf16 v[36:39], v[16:19], v[116:119], 0
    ds_read_b64_tr_b16 v[30:31], v9 offset:55296
    s_waitcnt lgkmcnt(4)
    v_mfma_f32_16x16x32_bf16 v[40:43], v[20:23], v[112:115], 0
    ds_read_b64_tr_b16 v[16:17], v8 offset:57344
    v_mul_f32 v11, s53, v64
    v_mfma_f32_16x16x32_bf16 v[44:47], v[20:23], v[116:119], 0
    ds_read_b64_tr_b16 v[18:19], v8 offset:59392
    v_mul_f32 v12, s53, v65
    s_waitcnt lgkmcnt(4)
    v_mfma_f32_16x16x32_bf16 v[48:51], v[24:27], v[112:115], 0
    ds_read_b64_tr_b16 v[20:21], v8 offset:61440
    v_mul_f32 v13, s53, v66
    v_mfma_f32_16x16x32_bf16 v[52:55], v[24:27], v[116:119], 0
    ds_read_b64_tr_b16 v[22:23], v8 offset:63488
    v_mul_f32 v14, s53, v67
    s_waitcnt lgkmcnt(4)
    v_mfma_f32_16x16x32_bf16 v[56:59], v[28:31], v[112:115], 0
    ds_read_b64_tr_b16 v[24:25], v9 offset:57344
    v_exp_f32 v11, v11
    v_mfma_f32_16x16x32_bf16 v[60:63], v[28:31], v[116:119], 0
    ds_read_b64_tr_b16 v[26:27], v9 offset:59392
    v_exp_f32 v12, v12
    s_waitcnt lgkmcnt(4)
    v_mfma_f32_16x16x32_bf16 v[32:35], v[16:19], v[120:123], v[32:35]
    ds_read_b64_tr_b16 v[28:29], v9 offset:61440
    v_exp_f32 v13, v13
    v_mfma_f32_16x16x32_bf16 v[36:39], v[16:19], v[124:127], v[36:39]
    ds_read_b64_tr_b16 v[30:31], v9 offset:63488
    v_exp_f32 v14, v14
    s_waitcnt lgkmcnt(4)
    v_mfma_f32_16x16x32_bf16 v[40:43], v[20:23], v[120:123], v[40:43]
    v_add_u32 v8, 0x10000, v8
    ds_read_b64_tr_b16 v[16:17], v8 offset:0
    v_mul_f32 v64, v64, v72
    v_mfma_f32_16x16x32_bf16 v[44:47], v[20:23], v[124:127], v[44:47]
    ds_read_b64_tr_b16 v[18:19], v8 offset:2048
    v_mul_f32 v65, v65, v73
    s_setprio 0
    s_waitcnt lgkmcnt(4)
    v_mfma_f32_16x16x32_bf16 v[48:51], v[24:27], v[120:123], v[48:51]
    ds_read_b64_tr_b16 v[20:21], v8 offset:4096
    v_mul_f32 v66, v66, v74
    v_mfma_f32_16x16x32_bf16 v[52:55], v[24:27], v[124:127], v[52:55]
    ds_read_b64_tr_b16 v[22:23], v8 offset:6144
    v_mul_f32 v67, v67, v75
    s_waitcnt lgkmcnt(4)
    v_mfma_f32_16x16x32_bf16 v[56:59], v[28:31], v[120:123], v[56:59]
    v_add_u32 v9, 0x10000, v9
    ds_read_b64_tr_b16 v[24:25], v9 offset:0
    v_add_f32 v11, 1.0, v11
    v_mfma_f32_16x16x32_bf16 v[60:63], v[28:31], v[124:127], v[60:63]
    ds_read_b64_tr_b16 v[26:27], v9 offset:2048
    v_add_f32 v12, 1.0, v12
    s_waitcnt lgkmcnt(4)
    v_mfma_f32_16x16x32_bf16 v[32:35], v[16:19], v[128:131], v[32:35]
    ds_read_b64_tr_b16 v[28:29], v9 offset:4096
    v_add_f32 v13, 1.0, v13
    v_mfma_f32_16x16x32_bf16 v[36:39], v[16:19], v[132:135], v[36:39]
    ds_read_b64_tr_b16 v[30:31], v9 offset:6144
    v_add_f32 v14, 1.0, v14
    s_waitcnt lgkmcnt(4)
    v_mfma_f32_16x16x32_bf16 v[40:43], v[20:23], v[128:131], v[40:43]
    ds_read_b64_tr_b16 v[16:17], v8 offset:8192
    v_rcp_f32 v11, v11
    v_mfma_f32_16x16x32_bf16 v[44:47], v[20:23], v[132:135], v[44:47]
    ds_read_b64_tr_b16 v[18:19], v8 offset:10240
    v_rcp_f32 v12, v12
    s_waitcnt lgkmcnt(4)
    v_mfma_f32_16x16x32_bf16 v[48:51], v[24:27], v[128:131], v[48:51]
    ds_read_b64_tr_b16 v[20:21], v8 offset:12288
    v_rcp_f32 v13, v13
    v_mfma_f32_16x16x32_bf16 v[52:55], v[24:27], v[132:135], v[52:55]
    ds_read_b64_tr_b16 v[22:23], v8 offset:14336
    v_rcp_f32 v14, v14
    s_waitcnt lgkmcnt(4)
    v_mfma_f32_16x16x32_bf16 v[56:59], v[28:31], v[128:131], v[56:59]
    ds_read_b64_tr_b16 v[24:25], v9 offset:8192
    v_mul_f32 v64, v64, v11
    v_mfma_f32_16x16x32_bf16 v[60:63], v[28:31], v[132:135], v[60:63]
    ds_read_b64_tr_b16 v[26:27], v9 offset:10240
    v_mul_f32 v65, v65, v12
    s_setprio 3
    s_waitcnt vmcnt(8)
    s_barrier
    s_waitcnt lgkmcnt(4)
    v_mfma_f32_16x16x32_bf16 v[32:35], v[16:19], v[136:139], v[32:35]
    ds_read_b64_tr_b16 v[28:29], v9 offset:12288
    v_mul_f32 v66, v66, v13
    v_mfma_f32_16x16x32_bf16 v[36:39], v[16:19], v[140:143], v[36:39]
    ds_read_b64_tr_b16 v[30:31], v9 offset:14336
    v_mul_f32 v67, v67, v14
    s_add_u32 m0, s39, 0x16000
    s_mov_b32 s58, 0x4c8100
    buffer_load_dwordx4 v2, s[8:11], s58 offen lds
    s_waitcnt lgkmcnt(4)
    v_mfma_f32_16x16x32_bf16 v[40:43], v[20:23], v[136:139], v[40:43]
    ds_read_b64_tr_b16 v[16:17], v8 offset:16384
    v_cvt_pk_bf16_f32 v96, v64, v65
    v_mfma_f32_16x16x32_bf16 v[44:47], v[20:23], v[140:143], v[44:47]
    ds_read_b64_tr_b16 v[18:19], v8 offset:18432
    v_cvt_pk_bf16_f32 v97, v66, v67
    s_waitcnt lgkmcnt(4)
    v_mfma_f32_16x16x32_bf16 v[48:51], v[24:27], v[136:139], v[48:51]
    ds_read_b64_tr_b16 v[20:21], v8 offset:20480
    v_mul_f32 v11, s53, v68
    v_mfma_f32_16x16x32_bf16 v[52:55], v[24:27], v[140:143], v[52:55]
    ds_read_b64_tr_b16 v[22:23], v8 offset:22528
    v_mul_f32 v12, s53, v69
    s_add_u32 m0, s39, 0x18000
    s_mov_b32 s59, 0x180
    buffer_load_dwordx4 v2, s[8:11], s59 offen lds
    s_waitcnt lgkmcnt(4)
    v_mfma_f32_16x16x32_bf16 v[56:59], v[28:31], v[136:139], v[56:59]
    ds_read_b64_tr_b16 v[24:25], v9 offset:16384
    v_mul_f32 v13, s53, v70
    v_mfma_f32_16x16x32_bf16 v[60:63], v[28:31], v[140:143], v[60:63]
    ds_read_b64_tr_b16 v[26:27], v9 offset:18432
    v_mul_f32 v14, s53, v71
    s_waitcnt lgkmcnt(4)
    v_mfma_f32_16x16x32_bf16 v[32:35], v[16:19], v[144:147], v[32:35]
    ds_read_b64_tr_b16 v[28:29], v9 offset:20480
    v_exp_f32 v11, v11
    v_mfma_f32_16x16x32_bf16 v[36:39], v[16:19], v[148:151], v[36:39]
    ds_read_b64_tr_b16 v[30:31], v9 offset:22528
    v_exp_f32 v12, v12
    s_add_u32 m0, s39, 0x1a000
    s_mov_b32 s60, 0x48180
    buffer_load_dwordx4 v2, s[8:11], s60 offen lds
    s_waitcnt lgkmcnt(4)
    v_mfma_f32_16x16x32_bf16 v[40:43], v[20:23], v[144:147], v[40:43]
    ds_read_b64_tr_b16 v[16:17], v8 offset:24576
    v_exp_f32 v13, v13
    v_mfma_f32_16x16x32_bf16 v[44:47], v[20:23], v[148:151], v[44:47]
    ds_read_b64_tr_b16 v[18:19], v8 offset:26624
    v_exp_f32 v14, v14
    s_setprio 2
    s_waitcnt lgkmcnt(4)
    v_mfma_f32_16x16x32_bf16 v[48:51], v[24:27], v[144:147], v[48:51]
    ds_read_b64_tr_b16 v[20:21], v8 offset:28672
    v_mul_f32 v68, v68, v76
    v_mfma_f32_16x16x32_bf16 v[52:55], v[24:27], v[148:151], v[52:55]
    ds_read_b64_tr_b16 v[22:23], v8 offset:30720
    v_mul_f32 v69, v69, v77
    s_add_u32 m0, s39, 0x1c000
    s_mov_b32 s61, 0x90180
    buffer_load_dwordx4 v2, s[8:11], s61 offen lds
    s_waitcnt lgkmcnt(4)
    v_mfma_f32_16x16x32_bf16 v[56:59], v[28:31], v[144:147], v[56:59]
    ds_read_b64_tr_b16 v[24:25], v9 offset:24576
    v_mul_f32 v70, v70, v78
    v_mfma_f32_16x16x32_bf16 v[60:63], v[28:31], v[148:151], v[60:63]
    ds_read_b64_tr_b16 v[26:27], v9 offset:26624
    v_mul_f32 v71, v71, v79
    s_waitcnt lgkmcnt(4)
    v_mfma_f32_16x16x32_bf16 v[32:35], v[16:19], v[152:155], v[32:35]
    ds_read_b64_tr_b16 v[28:29], v9 offset:28672
    v_add_f32 v11, 1.0, v11
    v_mfma_f32_16x16x32_bf16 v[36:39], v[16:19], v[156:159], v[36:39]
    ds_read_b64_tr_b16 v[30:31], v9 offset:30720
    v_add_f32 v12, 1.0, v12
    s_add_u32 m0, s39, 0x1e000
    s_mov_b32 s62, 0xd8180
    buffer_load_dwordx4 v2, s[8:11], s62 offen lds
    s_waitcnt lgkmcnt(4)
    v_mfma_f32_16x16x32_bf16 v[40:43], v[20:23], v[152:155], v[40:43]
    v_subrev_u32 v8, 0x20000, v8
    ds_read_b64_tr_b16 v[16:17], v8 offset:0
    v_add_f32 v13, 1.0, v13
    v_mfma_f32_16x16x32_bf16 v[44:47], v[20:23], v[156:159], v[44:47]
    ds_read_b64_tr_b16 v[18:19], v8 offset:2048
    v_add_f32 v14, 1.0, v14
    s_waitcnt lgkmcnt(4)
    v_mfma_f32_16x16x32_bf16 v[48:51], v[24:27], v[152:155], v[48:51]
    ds_read_b64_tr_b16 v[20:21], v8 offset:4096
    v_rcp_f32 v11, v11
    v_mfma_f32_16x16x32_bf16 v[52:55], v[24:27], v[156:159], v[52:55]
    ds_read_b64_tr_b16 v[22:23], v8 offset:6144
    v_rcp_f32 v12, v12
    s_add_u32 m0, s39, 0x20000
    s_mov_b32 s63, 0x120180
    buffer_load_dwordx4 v2, s[8:11], s63 offen lds
    s_waitcnt lgkmcnt(4)
    v_mfma_f32_16x16x32_bf16 v[56:59], v[28:31], v[152:155], v[56:59]
    v_subrev_u32 v9, 0x20000, v9
    ds_read_b64_tr_b16 v[24:25], v9 offset:0
    v_rcp_f32 v13, v13
    v_mfma_f32_16x16x32_bf16 v[60:63], v[28:31], v[156:159], v[60:63]
    ds_read_b64_tr_b16 v[26:27], v9 offset:2048
    v_rcp_f32 v14, v14
    s_setprio 1
    s_waitcnt lgkmcnt(4)
    v_mfma_f32_16x16x32_bf16 v[32:35], v[16:19], v[160:163], v[32:35]
    ds_read_b64_tr_b16 v[28:29], v9 offset:4096
    v_mul_f32 v68, v68, v11
    v_mfma_f32_16x16x32_bf16 v[36:39], v[16:19], v[164:167], v[36:39]
    ds_read_b64_tr_b16 v[30:31], v9 offset:6144
    v_mul_f32 v69, v69, v12
    s_waitcnt lgkmcnt(4)
    v_mfma_f32_16x16x32_bf16 v[40:43], v[20:23], v[160:163], v[40:43]
    ds_read_b64_tr_b16 v[16:17], v8 offset:8192
    v_mul_f32 v70, v70, v13
    v_mfma_f32_16x16x32_bf16 v[44:47], v[20:23], v[164:167], v[44:47]
    ds_read_b64_tr_b16 v[18:19], v8 offset:10240
    v_mul_f32 v71, v71, v14
    s_waitcnt lgkmcnt(4)
    v_mfma_f32_16x16x32_bf16 v[48:51], v[24:27], v[160:163], v[48:51]
    ds_read_b64_tr_b16 v[20:21], v8 offset:12288
    v_cvt_pk_bf16_f32 v98, v68, v69
    v_mfma_f32_16x16x32_bf16 v[52:55], v[24:27], v[164:167], v[52:55]
    ds_read_b64_tr_b16 v[22:23], v8 offset:14336
    v_cvt_pk_bf16_f32 v99, v70, v71
    s_waitcnt lgkmcnt(4)
    v_mfma_f32_16x16x32_bf16 v[56:59], v[28:31], v[160:163], v[56:59]
    ds_read_b64_tr_b16 v[24:25], v9 offset:8192
    s_add_u32 s56, s20, 16384
    buffer_store_dwordx4 v[96:99], v4, s[12:15], s56 offen sc1
    v_mfma_f32_16x16x32_bf16 v[60:63], v[28:31], v[164:167], v[60:63]
    ds_read_b64_tr_b16 v[26:27], v9 offset:10240
    v_mul_f32 v11, s53, v80
    s_waitcnt lgkmcnt(4)
    v_mfma_f32_16x16x32_bf16 v[32:35], v[16:19], v[168:171], v[32:35]
    ds_read_b64_tr_b16 v[28:29], v9 offset:12288
    v_mul_f32 v12, s53, v81
    v_mfma_f32_16x16x32_bf16 v[36:39], v[16:19], v[172:175], v[36:39]
    ds_read_b64_tr_b16 v[30:31], v9 offset:14336
    v_mul_f32 v13, s53, v82
    s_waitcnt lgkmcnt(4)
    v_mfma_f32_16x16x32_bf16 v[40:43], v[20:23], v[168:171], v[40:43]
    ds_read_b64_tr_b16 v[16:17], v8 offset:16384
    v_mul_f32 v14, s53, v83
    v_mfma_f32_16x16x32_bf16 v[44:47], v[20:23], v[172:175], v[44:47]
    ds_read_b64_tr_b16 v[18:19], v8 offset:18432
    v_exp_f32 v11, v11
    s_setprio 0
    s_waitcnt lgkmcnt(4)
    v_mfma_f32_16x16x32_bf16 v[48:51], v[24:27], v[168:171], v[48:51]
    ds_read_b64_tr_b16 v[20:21], v8 offset:20480
    v_exp_f32 v12, v12
    v_mfma_f32_16x16x32_bf16 v[52:55], v[24:27], v[172:175], v[52:55]
    ds_read_b64_tr_b16 v[22:23], v8 offset:22528
    v_exp_f32 v13, v13
    s_waitcnt lgkmcnt(4)
    v_mfma_f32_16x16x32_bf16 v[56:59], v[28:31], v[168:171], v[56:59]
    ds_read_b64_tr_b16 v[24:25], v9 offset:16384
    v_exp_f32 v14, v14
    v_mfma_f32_16x16x32_bf16 v[60:63], v[28:31], v[172:175], v[60:63]
    ds_read_b64_tr_b16 v[26:27], v9 offset:18432
    v_mul_f32 v80, v80, v88
    s_waitcnt lgkmcnt(4)
    v_mfma_f32_16x16x32_bf16 v[32:35], v[16:19], v[176:179], v[32:35]
    ds_read_b64_tr_b16 v[28:29], v9 offset:20480
    v_mul_f32 v81, v81, v89
    v_mfma_f32_16x16x32_bf16 v[36:39], v[16:19], v[180:183], v[36:39]
    ds_read_b64_tr_b16 v[30:31], v9 offset:22528
    v_mul_f32 v82, v82, v90
    s_waitcnt lgkmcnt(4)
    v_mfma_f32_16x16x32_bf16 v[40:43], v[20:23], v[176:179], v[40:43]
    ds_read_b64_tr_b16 v[16:17], v8 offset:24576
    v_mul_f32 v83, v83, v91
    v_mfma_f32_16x16x32_bf16 v[44:47], v[20:23], v[180:183], v[44:47]
    ds_read_b64_tr_b16 v[18:19], v8 offset:26624
    v_add_f32 v11, 1.0, v11
    s_waitcnt lgkmcnt(4)
    v_mfma_f32_16x16x32_bf16 v[48:51], v[24:27], v[176:179], v[48:51]
    ds_read_b64_tr_b16 v[20:21], v8 offset:28672
    v_add_f32 v12, 1.0, v12
    v_mfma_f32_16x16x32_bf16 v[52:55], v[24:27], v[180:183], v[52:55]
    ds_read_b64_tr_b16 v[22:23], v8 offset:30720
    v_add_f32 v13, 1.0, v13
    s_waitcnt lgkmcnt(4)
    v_mfma_f32_16x16x32_bf16 v[56:59], v[28:31], v[176:179], v[56:59]
    ds_read_b64_tr_b16 v[24:25], v9 offset:24576
    v_add_f32 v14, 1.0, v14
    v_mfma_f32_16x16x32_bf16 v[60:63], v[28:31], v[180:183], v[60:63]
    ds_read_b64_tr_b16 v[26:27], v9 offset:26624
    v_rcp_f32 v11, v11
    s_setprio 3
    s_waitcnt vmcnt(8)
    s_barrier
    s_waitcnt lgkmcnt(4)
    v_mfma_f32_16x16x32_bf16 v[32:35], v[16:19], v[184:187], v[32:35]
    ds_read_b64_tr_b16 v[28:29], v9 offset:28672
    v_rcp_f32 v12, v12
    v_mfma_f32_16x16x32_bf16 v[36:39], v[16:19], v[188:191], v[36:39]
    ds_read_b64_tr_b16 v[30:31], v9 offset:30720
    v_rcp_f32 v13, v13
    s_add_u32 m0, s39, 0x22000
    s_mov_b32 s57, 0x168180
    buffer_load_dwordx4 v2, s[8:11], s57 offen lds
    s_waitcnt lgkmcnt(4)
    v_mfma_f32_16x16x32_bf16 v[40:43], v[20:23], v[184:187], v[40:43]
    ds_read_b64_tr_b16 v[16:17], v8 offset:32768
    v_rcp_f32 v14, v14
    v_mfma_f32_16x16x32_bf16 v[44:47], v[20:23], v[188:191], v[44:47]
    ds_read_b64_tr_b16 v[18:19], v8 offset:34816
    v_mul_f32 v80, v80, v11
    s_waitcnt lgkmcnt(4)
    v_mfma_f32_16x16x32_bf16 v[48:51], v[24:27], v[184:187], v[48:51]
    ds_read_b64_tr_b16 v[20:21], v8 offset:36864
    v_mul_f32 v81, v81, v12
    v_mfma_f32_16x16x32_bf16 v[52:55], v[24:27], v[188:191], v[52:55]
    ds_read_b64_tr_b16 v[22:23], v8 offset:38912
    v_mul_f32 v82, v82, v13
    s_add_u32 m0, s39, 0x24000
    s_mov_b32 s58, 0x1b0180
    buffer_load_dwordx4 v2, s[8:11], s58 offen lds
    s_waitcnt lgkmcnt(4)
    v_mfma_f32_16x16x32_bf16 v[56:59], v[28:31], v[184:187], v[56:59]
    ds_read_b64_tr_b16 v[24:25], v9 offset:32768
    v_mul_f32 v83, v83, v14
    v_mfma_f32_16x16x32_bf16 v[60:63], v[28:31], v[188:191], v[60:63]
    ds_read_b64_tr_b16 v[26:27], v9 offset:34816
    v_cvt_pk_bf16_f32 v100, v80, v81
    s_waitcnt lgkmcnt(4)
    v_mfma_f32_16x16x32_bf16 v[32:35], v[16:19], v[192:195], v[32:35]
    ds_read_b64_tr_b16 v[28:29], v9 offset:36864
    v_cvt_pk_bf16_f32 v101, v82, v83
    v_mfma_f32_16x16x32_bf16 v[36:39], v[16:19], v[196:199], v[36:39]
    ds_read_b64_tr_b16 v[30:31], v9 offset:38912
    v_mul_f32 v11, s53, v84
    s_add_u32 m0, s39, 0x26000
    s_mov_b32 s59, 0x1f8180
    buffer_load_dwordx4 v2, s[8:11], s59 offen lds
    s_waitcnt lgkmcnt(4)
    v_mfma_f32_16x16x32_bf16 v[40:43], v[20:23], v[192:195], v[40:43]
    ds_read_b64_tr_b16 v[16:17], v8 offset:40960
    v_mul_f32 v12, s53, v85
    v_mfma_f32_16x16x32_bf16 v[44:47], v[20:23], v[196:199], v[44:47]
    ds_read_b64_tr_b16 v[18:19], v8 offset:43008
    v_mul_f32 v13, s53, v86
    s_setprio 2
    s_waitcnt lgkmcnt(4)
    v_mfma_f32_16x16x32_bf16 v[48:51], v[24:27], v[192:195], v[48:51]
    ds_read_b64_tr_b16 v[20:21], v8 offset:45056
    v_mul_f32 v14, s53, v87
    v_mfma_f32_16x16x32_bf16 v[52:55], v[24:27], v[196:199], v[52:55]
    ds_read_b64_tr_b16 v[22:23], v8 offset:47104
    v_exp_f32 v11, v11
    s_add_u32 m0, s39, 0x0
    s_mov_b32 s60, 0x240180
    buffer_load_dwordx4 v2, s[8:11], s60 offen lds
    s_waitcnt lgkmcnt(4)
    v_mfma_f32_16x16x32_bf16 v[56:59], v[28:31], v[192:195], v[56:59]
    ds_read_b64_tr_b16 v[24:25], v9 offset:40960
    v_exp_f32 v12, v12
    v_mfma_f32_16x16x32_bf16 v[60:63], v[28:31], v[196:199], v[60:63]
    ds_read_b64_tr_b16 v[26:27], v9 offset:43008
    v_exp_f32 v13, v13
    s_waitcnt lgkmcnt(4)
    v_mfma_f32_16x16x32_bf16 v[32:35], v[16:19], v[200:203], v[32:35]
    ds_read_b64_tr_b16 v[28:29], v9 offset:45056
    v_exp_f32 v14, v14
    v_mfma_f32_16x16x32_bf16 v[36:39], v[16:19], v[204:207], v[36:39]
    ds_read_b64_tr_b16 v[30:31], v9 offset:47104
    v_mul_f32 v84, v84, v92
    s_add_u32 m0, s39, 0x2000
    s_mov_b32 s61, 0x288180
    buffer_load_dwordx4 v2, s[8:11], s61 offen lds
    s_waitcnt lgkmcnt(4)
    v_mfma_f32_16x16x32_bf16 v[40:43], v[20:23], v[200:203], v[40:43]
    ds_read_b64_tr_b16 v[16:17], v8 offset:49152
    v_mul_f32 v85, v85, v93
    v_mfma_f32_16x16x32_bf16 v[44:47], v[20:23], v[204:207], v[44:47]
    ds_read_b64_tr_b16 v[18:19], v8 offset:51200
    v_mul_f32 v86, v86, v94
    s_waitcnt lgkmcnt(4)
    v_mfma_f32_16x16x32_bf16 v[48:51], v[24:27], v[200:203], v[48:51]
    ds_read_b64_tr_b16 v[20:21], v8 offset:53248
    v_mul_f32 v87, v87, v95
    v_mfma_f32_16x16x32_bf16 v[52:55], v[24:27], v[204:207], v[52:55]
    ds_read_b64_tr_b16 v[22:23], v8 offset:55296
    v_add_f32 v11, 1.0, v11
    s_add_u32 m0, s39, 0x4000
    s_mov_b32 s62, 0x2d0180
    buffer_load_dwordx4 v2, s[8:11], s62 offen lds
    s_waitcnt lgkmcnt(4)
    v_mfma_f32_16x16x32_bf16 v[56:59], v[28:31], v[200:203], v[56:59]
    ds_read_b64_tr_b16 v[24:25], v9 offset:49152
    v_add_f32 v12, 1.0, v12
    v_mfma_f32_16x16x32_bf16 v[60:63], v[28:31], v[204:207], v[60:63]
    ds_read_b64_tr_b16 v[26:27], v9 offset:51200
    v_add_f32 v13, 1.0, v13
    s_setprio 1
    s_waitcnt lgkmcnt(4)
    v_mfma_f32_16x16x32_bf16 v[32:35], v[16:19], v[208:211], v[32:35]
    ds_read_b64_tr_b16 v[28:29], v9 offset:53248
    v_add_f32 v14, 1.0, v14
    v_mfma_f32_16x16x32_bf16 v[36:39], v[16:19], v[212:215], v[36:39]
    ds_read_b64_tr_b16 v[30:31], v9 offset:55296
    v_rcp_f32 v11, v11
    s_waitcnt lgkmcnt(4)
    v_mfma_f32_16x16x32_bf16 v[40:43], v[20:23], v[208:211], v[40:43]
    ds_read_b64_tr_b16 v[16:17], v8 offset:57344
    v_rcp_f32 v12, v12
    v_mfma_f32_16x16x32_bf16 v[44:47], v[20:23], v[212:215], v[44:47]
    ds_read_b64_tr_b16 v[18:19], v8 offset:59392
    v_rcp_f32 v13, v13
    s_waitcnt lgkmcnt(4)
    v_mfma_f32_16x16x32_bf16 v[48:51], v[24:27], v[208:211], v[48:51]
    ds_read_b64_tr_b16 v[20:21], v8 offset:61440
    v_rcp_f32 v14, v14
    v_mfma_f32_16x16x32_bf16 v[52:55], v[24:27], v[212:215], v[52:55]
    ds_read_b64_tr_b16 v[22:23], v8 offset:63488
    v_mul_f32 v84, v84, v11
    s_waitcnt lgkmcnt(4)
    v_mfma_f32_16x16x32_bf16 v[56:59], v[28:31], v[208:211], v[56:59]
    ds_read_b64_tr_b16 v[24:25], v9 offset:57344
    v_mul_f32 v85, v85, v12
    v_mfma_f32_16x16x32_bf16 v[60:63], v[28:31], v[212:215], v[60:63]
    ds_read_b64_tr_b16 v[26:27], v9 offset:59392
    v_mul_f32 v86, v86, v13
    s_waitcnt lgkmcnt(4)
    v_mfma_f32_16x16x32_bf16 v[32:35], v[16:19], v[216:219], v[32:35]
    ds_read_b64_tr_b16 v[28:29], v9 offset:61440
    v_mul_f32 v87, v87, v14
    v_mfma_f32_16x16x32_bf16 v[36:39], v[16:19], v[220:223], v[36:39]
    ds_read_b64_tr_b16 v[30:31], v9 offset:63488
    v_cvt_pk_bf16_f32 v102, v84, v85
    s_waitcnt lgkmcnt(4)
    v_mfma_f32_16x16x32_bf16 v[40:43], v[20:23], v[216:219], v[40:43]
    v_add_u32 v8, 0x10000, v8
    ds_read_b64_tr_b16 v[16:17], v8 offset:0
    v_cvt_pk_bf16_f32 v103, v86, v87
    v_mfma_f32_16x16x32_bf16 v[44:47], v[20:23], v[220:223], v[44:47]
    ds_read_b64_tr_b16 v[18:19], v8 offset:2048
    s_add_u32 s63, s20, 24576
    buffer_store_dwordx4 v[100:103], v4, s[12:15], s63 offen sc1
    s_setprio 0
    s_waitcnt lgkmcnt(4)
    v_mfma_f32_16x16x32_bf16 v[48:51], v[24:27], v[216:219], v[48:51]
    ds_read_b64_tr_b16 v[20:21], v8 offset:4096
    v_mfma_f32_16x16x32_bf16 v[52:55], v[24:27], v[220:223], v[52:55]
    ds_read_b64_tr_b16 v[22:23], v8 offset:6144
    s_waitcnt lgkmcnt(4)
    v_mfma_f32_16x16x32_bf16 v[56:59], v[28:31], v[216:219], v[56:59]
    v_add_u32 v9, 0x10000, v9
    ds_read_b64_tr_b16 v[24:25], v9 offset:0
    v_mfma_f32_16x16x32_bf16 v[60:63], v[28:31], v[220:223], v[60:63]
    ds_read_b64_tr_b16 v[26:27], v9 offset:2048
    s_waitcnt lgkmcnt(4)
    v_mfma_f32_16x16x32_bf16 v[32:35], v[16:19], v[224:227], v[32:35]
    ds_read_b64_tr_b16 v[28:29], v9 offset:4096
    v_mfma_f32_16x16x32_bf16 v[36:39], v[16:19], v[228:231], v[36:39]
    ds_read_b64_tr_b16 v[30:31], v9 offset:6144
    s_waitcnt lgkmcnt(4)
    v_mfma_f32_16x16x32_bf16 v[40:43], v[20:23], v[224:227], v[40:43]
    ds_read_b64_tr_b16 v[16:17], v8 offset:8192
    v_mfma_f32_16x16x32_bf16 v[44:47], v[20:23], v[228:231], v[44:47]
    ds_read_b64_tr_b16 v[18:19], v8 offset:10240
    s_waitcnt lgkmcnt(4)
    v_mfma_f32_16x16x32_bf16 v[48:51], v[24:27], v[224:227], v[48:51]
    ds_read_b64_tr_b16 v[20:21], v8 offset:12288
    v_mfma_f32_16x16x32_bf16 v[52:55], v[24:27], v[228:231], v[52:55]
    ds_read_b64_tr_b16 v[22:23], v8 offset:14336
    s_waitcnt lgkmcnt(4)
    v_mfma_f32_16x16x32_bf16 v[56:59], v[28:31], v[224:227], v[56:59]
    ds_read_b64_tr_b16 v[24:25], v9 offset:8192
    v_mfma_f32_16x16x32_bf16 v[60:63], v[28:31], v[228:231], v[60:63]
    ds_read_b64_tr_b16 v[26:27], v9 offset:10240
    s_setprio 3
    s_waitcnt vmcnt(9)
    s_barrier
    s_waitcnt lgkmcnt(4)
    v_mfma_f32_16x16x32_bf16 v[32:35], v[16:19], v[232:235], v[32:35]
    ds_read_b64_tr_b16 v[28:29], v9 offset:12288
    v_mfma_f32_16x16x32_bf16 v[36:39], v[16:19], v[236:239], v[36:39]
    ds_read_b64_tr_b16 v[30:31], v9 offset:14336
    s_add_u32 m0, s39, 0x6000
    s_mov_b32 s56, 0x318180
    buffer_load_dwordx4 v2, s[8:11], s56 offen lds
    s_waitcnt lgkmcnt(4)
    v_mfma_f32_16x16x32_bf16 v[40:43], v[20:23], v[232:235], v[40:43]
    ds_read_b64_tr_b16 v[16:17], v8 offset:16384
    v_mfma_f32_16x16x32_bf16 v[44:47], v[20:23], v[236:239], v[44:47]
    ds_read_b64_tr_b16 v[18:19], v8 offset:18432
    s_waitcnt lgkmcnt(4)
    v_mfma_f32_16x16x32_bf16 v[48:51], v[24:27], v[232:235], v[48:51]
    ds_read_b64_tr_b16 v[20:21], v8 offset:20480
    v_mfma_f32_16x16x32_bf16 v[52:55], v[24:27], v[236:239], v[52:55]
    ds_read_b64_tr_b16 v[22:23], v8 offset:22528
    s_add_u32 m0, s39, 0x8000
    s_mov_b32 s57, 0x360180
    buffer_load_dwordx4 v2, s[8:11], s57 offen lds
    s_waitcnt lgkmcnt(4)
    v_mfma_f32_16x16x32_bf16 v[56:59], v[28:31], v[232:235], v[56:59]
    ds_read_b64_tr_b16 v[24:25], v9 offset:16384
    v_mfma_f32_16x16x32_bf16 v[60:63], v[28:31], v[236:239], v[60:63]
    ds_read_b64_tr_b16 v[26:27], v9 offset:18432
    s_waitcnt lgkmcnt(4)
    v_mfma_f32_16x16x32_bf16 v[32:35], v[16:19], v[240:243], v[32:35]
    ds_read_b64_tr_b16 v[28:29], v9 offset:20480
    v_mfma_f32_16x16x32_bf16 v[36:39], v[16:19], v[244:247], v[36:39]
    ds_read_b64_tr_b16 v[30:31], v9 offset:22528
    s_add_u32 m0, s39, 0xa000
    s_mov_b32 s58, 0x3a8180
    buffer_load_dwordx4 v2, s[8:11], s58 offen lds
    s_waitcnt lgkmcnt(4)
    v_mfma_f32_16x16x32_bf16 v[40:43], v[20:23], v[240:243], v[40:43]
    ds_read_b64_tr_b16 v[16:17], v8 offset:24576
    v_mfma_f32_16x16x32_bf16 v[44:47], v[20:23], v[244:247], v[44:47]
    ds_read_b64_tr_b16 v[18:19], v8 offset:26624
    s_setprio 2
    s_waitcnt lgkmcnt(4)
    v_mfma_f32_16x16x32_bf16 v[48:51], v[24:27], v[240:243], v[48:51]
    ds_read_b64_tr_b16 v[20:21], v8 offset:28672
    v_mfma_f32_16x16x32_bf16 v[52:55], v[24:27], v[244:247], v[52:55]
    ds_read_b64_tr_b16 v[22:23], v8 offset:30720
    s_add_u32 m0, s39, 0xc000
    s_mov_b32 s59, 0x3f0180
    buffer_load_dwordx4 v2, s[8:11], s59 offen lds
    s_waitcnt lgkmcnt(4)
    v_mfma_f32_16x16x32_bf16 v[56:59], v[28:31], v[240:243], v[56:59]
    ds_read_b64_tr_b16 v[24:25], v9 offset:24576
    v_mfma_f32_16x16x32_bf16 v[60:63], v[28:31], v[244:247], v[60:63]
    ds_read_b64_tr_b16 v[26:27], v9 offset:26624
    s_waitcnt lgkmcnt(4)
    v_mfma_f32_16x16x32_bf16 v[32:35], v[16:19], v[248:251], v[32:35]
    ds_read_b64_tr_b16 v[28:29], v9 offset:28672
    v_mfma_f32_16x16x32_bf16 v[36:39], v[16:19], v[252:255], v[36:39]
    ds_read_b64_tr_b16 v[30:31], v9 offset:30720
    s_add_u32 m0, s39, 0xe000
    s_mov_b32 s60, 0x438180
    buffer_load_dwordx4 v2, s[8:11], s60 offen lds
    s_waitcnt lgkmcnt(4)
    v_mfma_f32_16x16x32_bf16 v[40:43], v[20:23], v[248:251], v[40:43]
    ds_read_b64_tr_b16 v[16:17], v8 offset:32768
    v_mfma_f32_16x16x32_bf16 v[44:47], v[20:23], v[252:255], v[44:47]
    ds_read_b64_tr_b16 v[18:19], v8 offset:34816
    s_waitcnt lgkmcnt(4)
    v_mfma_f32_16x16x32_bf16 v[48:51], v[24:27], v[248:251], v[48:51]
    ds_read_b64_tr_b16 v[20:21], v8 offset:36864
    v_mfma_f32_16x16x32_bf16 v[52:55], v[24:27], v[252:255], v[52:55]
    ds_read_b64_tr_b16 v[22:23], v8 offset:38912
    s_add_u32 m0, s39, 0x10000
    s_mov_b32 s61, 0x480180
    buffer_load_dwordx4 v2, s[8:11], s61 offen lds
    s_waitcnt lgkmcnt(4)
    v_mfma_f32_16x16x32_bf16 v[56:59], v[28:31], v[248:251], v[56:59]
    ds_read_b64_tr_b16 v[24:25], v9 offset:32768
    v_mfma_f32_16x16x32_bf16 v[60:63], v[28:31], v[252:255], v[60:63]
    ds_read_b64_tr_b16 v[26:27], v9 offset:34816
    s_setprio 1
    s_waitcnt lgkmcnt(4)
    v_mfma_f32_16x16x32_bf16 v[64:67], v[16:19], v[112:115], 0
    ds_read_b64_tr_b16 v[28:29], v9 offset:36864
    v_mfma_f32_16x16x32_bf16 v[68:71], v[16:19], v[116:119], 0
    ds_read_b64_tr_b16 v[30:31], v9 offset:38912
    s_waitcnt lgkmcnt(4)
    v_mfma_f32_16x16x32_bf16 v[72:75], v[20:23], v[112:115], 0
    ds_read_b64_tr_b16 v[16:17], v8 offset:40960
    v_mul_f32 v11, s53, v32
    v_mfma_f32_16x16x32_bf16 v[76:79], v[20:23], v[116:119], 0
    ds_read_b64_tr_b16 v[18:19], v8 offset:43008
    v_mul_f32 v12, s53, v33
    s_waitcnt lgkmcnt(4)
    v_mfma_f32_16x16x32_bf16 v[80:83], v[24:27], v[112:115], 0
    ds_read_b64_tr_b16 v[20:21], v8 offset:45056
    v_mul_f32 v13, s53, v34
    v_mfma_f32_16x16x32_bf16 v[84:87], v[24:27], v[116:119], 0
    ds_read_b64_tr_b16 v[22:23], v8 offset:47104
    v_mul_f32 v14, s53, v35
    s_waitcnt lgkmcnt(4)
    v_mfma_f32_16x16x32_bf16 v[88:91], v[28:31], v[112:115], 0
    ds_read_b64_tr_b16 v[24:25], v9 offset:40960
    v_exp_f32 v11, v11
    v_mfma_f32_16x16x32_bf16 v[92:95], v[28:31], v[116:119], 0
    ds_read_b64_tr_b16 v[26:27], v9 offset:43008
    v_exp_f32 v12, v12
    s_waitcnt lgkmcnt(4)
    v_mfma_f32_16x16x32_bf16 v[64:67], v[16:19], v[120:123], v[64:67]
    ds_read_b64_tr_b16 v[28:29], v9 offset:45056
    v_exp_f32 v13, v13
    v_mfma_f32_16x16x32_bf16 v[68:71], v[16:19], v[124:127], v[68:71]
    ds_read_b64_tr_b16 v[30:31], v9 offset:47104
    v_exp_f32 v14, v14
    s_waitcnt lgkmcnt(4)
    v_mfma_f32_16x16x32_bf16 v[72:75], v[20:23], v[120:123], v[72:75]
    ds_read_b64_tr_b16 v[16:17], v8 offset:49152
    v_mul_f32 v32, v32, v40
    v_mfma_f32_16x16x32_bf16 v[76:79], v[20:23], v[124:127], v[76:79]
    ds_read_b64_tr_b16 v[18:19], v8 offset:51200
    v_mul_f32 v33, v33, v41
    s_setprio 0
    s_waitcnt lgkmcnt(4)
    v_mfma_f32_16x16x32_bf16 v[80:83], v[24:27], v[120:123], v[80:83]
    ds_read_b64_tr_b16 v[20:21], v8 offset:53248
    v_mul_f32 v34, v34, v42
    v_mfma_f32_16x16x32_bf16 v[84:87], v[24:27], v[124:127], v[84:87]
    ds_read_b64_tr_b16 v[22:23], v8 offset:55296
    v_mul_f32 v35, v35, v43
    s_waitcnt lgkmcnt(4)
    v_mfma_f32_16x16x32_bf16 v[88:91], v[28:31], v[120:123], v[88:91]
    ds_read_b64_tr_b16 v[24:25], v9 offset:49152
    v_add_f32 v11, 1.0, v11
    v_mfma_f32_16x16x32_bf16 v[92:95], v[28:31], v[124:127], v[92:95]
    ds_read_b64_tr_b16 v[26:27], v9 offset:51200
    v_add_f32 v12, 1.0, v12
    s_waitcnt lgkmcnt(4)
    v_mfma_f32_16x16x32_bf16 v[64:67], v[16:19], v[128:131], v[64:67]
    ds_read_b64_tr_b16 v[28:29], v9 offset:53248
    v_add_f32 v13, 1.0, v13
    v_mfma_f32_16x16x32_bf16 v[68:71], v[16:19], v[132:135], v[68:71]
    ds_read_b64_tr_b16 v[30:31], v9 offset:55296
    v_add_f32 v14, 1.0, v14
    s_waitcnt lgkmcnt(4)
    v_mfma_f32_16x16x32_bf16 v[72:75], v[20:23], v[128:131], v[72:75]
    ds_read_b64_tr_b16 v[16:17], v8 offset:57344
    v_rcp_f32 v11, v11
    v_mfma_f32_16x16x32_bf16 v[76:79], v[20:23], v[132:135], v[76:79]
    ds_read_b64_tr_b16 v[18:19], v8 offset:59392
    v_rcp_f32 v12, v12
    s_waitcnt lgkmcnt(4)
    v_mfma_f32_16x16x32_bf16 v[80:83], v[24:27], v[128:131], v[80:83]
    ds_read_b64_tr_b16 v[20:21], v8 offset:61440
    v_rcp_f32 v13, v13
    v_mfma_f32_16x16x32_bf16 v[84:87], v[24:27], v[132:135], v[84:87]
    ds_read_b64_tr_b16 v[22:23], v8 offset:63488
    v_rcp_f32 v14, v14
    s_waitcnt lgkmcnt(4)
    v_mfma_f32_16x16x32_bf16 v[88:91], v[28:31], v[128:131], v[88:91]
    ds_read_b64_tr_b16 v[24:25], v9 offset:57344
    v_mul_f32 v32, v32, v11
    v_mfma_f32_16x16x32_bf16 v[92:95], v[28:31], v[132:135], v[92:95]
    ds_read_b64_tr_b16 v[26:27], v9 offset:59392
    v_mul_f32 v33, v33, v12
    s_setprio 3
    s_waitcnt vmcnt(6)
    s_barrier
    s_cmp_lg_u32 s32, 0
    s_cbranch_scc1 L_sig_55
    s_lshl_b32 s50, s38, 5
    s_add_u32 s50, s50, 57344
    s_mov_b32 s51, 1
    s_atomic_add s51, s[76:77], s50
L_sig_55:
    s_waitcnt lgkmcnt(4)
    v_mfma_f32_16x16x32_bf16 v[64:67], v[16:19], v[136:139], v[64:67]
    ds_read_b64_tr_b16 v[28:29], v9 offset:61440
    v_mul_f32 v34, v34, v13
    v_mfma_f32_16x16x32_bf16 v[68:71], v[16:19], v[140:143], v[68:71]
    ds_read_b64_tr_b16 v[30:31], v9 offset:63488
    v_mul_f32 v35, v35, v14
    s_add_u32 m0, s39, 0x12000
    s_mov_b32 s62, 0x4c8180
    buffer_load_dwordx4 v2, s[8:11], s62 offen lds
    s_waitcnt lgkmcnt(4)
    v_mfma_f32_16x16x32_bf16 v[72:75], v[20:23], v[136:139], v[72:75]
    v_add_u32 v8, 0x10000, v8
    ds_read_b64_tr_b16 v[16:17], v8 offset:0
    v_cvt_pk_bf16_f32 v96, v32, v33
    v_mfma_f32_16x16x32_bf16 v[76:79], v[20:23], v[140:143], v[76:79]
    ds_read_b64_tr_b16 v[18:19], v8 offset:2048
    v_cvt_pk_bf16_f32 v97, v34, v35
    s_waitcnt lgkmcnt(4)
    v_mfma_f32_16x16x32_bf16 v[80:83], v[24:27], v[136:139], v[80:83]
    ds_read_b64_tr_b16 v[20:21], v8 offset:4096
    v_mul_f32 v11, s53, v36
    v_mfma_f32_16x16x32_bf16 v[84:87], v[24:27], v[140:143], v[84:87]
    ds_read_b64_tr_b16 v[22:23], v8 offset:6144
    v_mul_f32 v12, s53, v37
    s_add_u32 m0, s39, 0x14000
    s_mov_b32 s63, 0x0
    buffer_load_dwordx4 v3, s[8:11], s63 offen lds
    s_waitcnt lgkmcnt(4)
    v_mfma_f32_16x16x32_bf16 v[88:91], v[28:31], v[136:139], v[88:91]
    v_add_u32 v9, 0x10000, v9
    ds_read_b64_tr_b16 v[24:25], v9 offset:0
    v_mul_f32 v13, s53, v38
    v_mfma_f32_16x16x32_bf16 v[92:95], v[28:31], v[140:143], v[92:95]
    ds_read_b64_tr_b16 v[26:27], v9 offset:2048
    v_mul_f32 v14, s53, v39
    s_waitcnt lgkmcnt(4)
    v_mfma_f32_16x16x32_bf16 v[64:67], v[16:19], v[144:147], v[64:67]
    ds_read_b64_tr_b16 v[28:29], v9 offset:4096
    v_exp_f32 v11, v11
    v_mfma_f32_16x16x32_bf16 v[68:71], v[16:19], v[148:151], v[68:71]
    ds_read_b64_tr_b16 v[30:31], v9 offset:6144
    v_exp_f32 v12, v12
    s_add_u32 m0, s39, 0x16000
    s_mov_b32 s56, 0x90000
    buffer_load_dwordx4 v3, s[8:11], s56 offen lds
    s_waitcnt lgkmcnt(4)
    v_mfma_f32_16x16x32_bf16 v[72:75], v[20:23], v[144:147], v[72:75]
    ds_read_b64_tr_b16 v[16:17], v8 offset:8192
    v_exp_f32 v13, v13
    v_mfma_f32_16x16x32_bf16 v[76:79], v[20:23], v[148:151], v[76:79]
    ds_read_b64_tr_b16 v[18:19], v8 offset:10240
    v_exp_f32 v14, v14
    s_setprio 2
    s_waitcnt lgkmcnt(4)
    v_mfma_f32_16x16x32_bf16 v[80:83], v[24:27], v[144:147], v[80:83]
    ds_read_b64_tr_b16 v[20:21], v8 offset:12288
    v_mul_f32 v36, v36, v44
    v_mfma_f32_16x16x32_bf16 v[84:87], v[24:27], v[148:151], v[84:87]
    ds_read_b64_tr_b16 v[22:23], v8 offset:14336
    v_mul_f32 v37, v37, v45
    s_add_u32 m0, s39, 0x18000
    s_mov_b32 s57, 0x120000
    buffer_load_dwordx4 v3, s[8:11], s57 offen lds
    s_waitcnt lgkmcnt(4)
    v_mfma_f32_16x16x32_bf16 v[88:91], v[28:31], v[144:147], v[88:91]
    ds_read_b64_tr_b16 v[24:25], v9 offset:8192
    v_mul_f32 v38, v38, v46
    v_mfma_f32_16x16x32_bf16 v[92:95], v[28:31], v[148:151], v[92:95]
    ds_read_b64_tr_b16 v[26:27], v9 offset:10240
    v_mul_f32 v39, v39, v47
    s_waitcnt lgkmcnt(4)
    v_mfma_f32_16x16x32_bf16 v[64:67], v[16:19], v[152:155], v[64:67]
    ds_read_b64_tr_b16 v[28:29], v9 offset:12288
    v_add_f32 v11, 1.0, v11
    v_mfma_f32_16x16x32_bf16 v[68:71], v[16:19], v[156:159], v[68:71]
    ds_read_b64_tr_b16 v[30:31], v9 offset:14336
    v_add_f32 v12, 1.0, v12
    s_add_u32 m0, s39, 0x1a000
    s_add_u32 s58, s20, 0x0
    buffer_load_dwordx4 v4, s[12:15], s58 offen sc1 lds
    s_waitcnt lgkmcnt(4)
    v_mfma_f32_16x16x32_bf16 v[72:75], v[20:23], v[152:155], v[72:75]
    ds_read_b64_tr_b16 v[16:17], v8 offset:16384
    v_add_f32 v13, 1.0, v13
    v_mfma_f32_16x16x32_bf16 v[76:79], v[20:23], v[156:159], v[76:79]
    ds_read_b64_tr_b16 v[18:19], v8 offset:18432
    v_add_f32 v14, 1.0, v14
    s_waitcnt lgkmcnt(4)
    v_mfma_f32_16x16x32_bf16 v[80:83], v[24:27], v[152:155], v[80:83]
    ds_read_b64_tr_b16 v[20:21], v8 offset:20480
    v_rcp_f32 v11, v11
    v_mfma_f32_16x16x32_bf16 v[84:87], v[24:27], v[156:159], v[84:87]
    ds_read_b64_tr_b16 v[22:23], v8 offset:22528
    v_rcp_f32 v12, v12
    s_add_u32 m0, s39, 0x1c000
    s_add_u32 s59, s20, 0x2000
    buffer_load_dwordx4 v4, s[12:15], s59 offen sc1 lds
    s_waitcnt lgkmcnt(4)
    v_mfma_f32_16x16x32_bf16 v[88:91], v[28:31], v[152:155], v[88:91]
    ds_read_b64_tr_b16 v[24:25], v9 offset:16384
    v_rcp_f32 v13, v13
    v_mfma_f32_16x16x32_bf16 v[92:95], v[28:31], v[156:159], v[92:95]
    ds_read_b64_tr_b16 v[26:27], v9 offset:18432
    v_rcp_f32 v14, v14
    s_setprio 1
    s_waitcnt lgkmcnt(4)
    v_mfma_f32_16x16x32_bf16 v[64:67], v[16:19], v[160:163], v[64:67]
    ds_read_b64_tr_b16 v[28:29], v9 offset:20480
    v_mul_f32 v36, v36, v11
    v_mfma_f32_16x16x32_bf16 v[68:71], v[16:19], v[164:167], v[68:71]
    ds_read_b64_tr_b16 v[30:31], v9 offset:22528
    v_mul_f32 v37, v37, v12
    s_waitcnt lgkmcnt(4)
    v_mfma_f32_16x16x32_bf16 v[72:75], v[20:23], v[160:163], v[72:75]
    ds_read_b64_tr_b16 v[16:17], v8 offset:24576
    v_mul_f32 v38, v38, v13
    v_mfma_f32_16x16x32_bf16 v[76:79], v[20:23], v[164:167], v[76:79]
    ds_read_b64_tr_b16 v[18:19], v8 offset:26624
    v_mul_f32 v39, v39, v14
    s_waitcnt lgkmcnt(4)
    v_mfma_f32_16x16x32_bf16 v[80:83], v[24:27], v[160:163], v[80:83]
    ds_read_b64_tr_b16 v[20:21], v8 offset:28672
    v_cvt_pk_bf16_f32 v98, v36, v37
    v_mfma_f32_16x16x32_bf16 v[84:87], v[24:27], v[164:167], v[84:87]
    ds_read_b64_tr_b16 v[22:23], v8 offset:30720
    v_cvt_pk_bf16_f32 v99, v38, v39
    s_waitcnt lgkmcnt(4)
    v_mfma_f32_16x16x32_bf16 v[88:91], v[28:31], v[160:163], v[88:91]
    ds_read_b64_tr_b16 v[24:25], v9 offset:24576
    s_add_u32 s60, s20, 32768
    buffer_store_dwordx4 v[96:99], v4, s[12:15], s60 offen sc1
    v_mfma_f32_16x16x32_bf16 v[92:95], v[28:31], v[164:167], v[92:95]
    ds_read_b64_tr_b16 v[26:27], v9 offset:26624
    v_mul_f32 v11, s53, v48
    s_waitcnt lgkmcnt(4)
    v_mfma_f32_16x16x32_bf16 v[64:67], v[16:19], v[168:171], v[64:67]
    ds_read_b64_tr_b16 v[28:29], v9 offset:28672
    v_mul_f32 v12, s53, v49
    v_mfma_f32_16x16x32_bf16 v[68:71], v[16:19], v[172:175], v[68:71]
    ds_read_b64_tr_b16 v[30:31], v9 offset:30720
    v_mul_f32 v13, s53, v50
    s_waitcnt lgkmcnt(4)
    v_mfma_f32_16x16x32_bf16 v[72:75], v[20:23], v[168:171], v[72:75]
    v_subrev_u32 v8, 0x20000, v8
    ds_read_b64_tr_b16 v[16:17], v8 offset:0
    v_mul_f32 v14, s53, v51
    v_mfma_f32_16x16x32_bf16 v[76:79], v[20:23], v[172:175], v[76:79]
    ds_read_b64_tr_b16 v[18:19], v8 offset:2048
    v_exp_f32 v11, v11
    s_setprio 0
    s_waitcnt lgkmcnt(4)
    v_mfma_f32_16x16x32_bf16 v[80:83], v[24:27], v[168:171], v[80:83]
    ds_read_b64_tr_b16 v[20:21], v8 offset:4096
    v_exp_f32 v12, v12
    v_mfma_f32_16x16x32_bf16 v[84:87], v[24:27], v[172:175], v[84:87]
    ds_read_b64_tr_b16 v[22:23], v8 offset:6144
    v_exp_f32 v13, v13
    s_waitcnt lgkmcnt(4)
    v_mfma_f32_16x16x32_bf16 v[88:91], v[28:31], v[168:171], v[88:91]
    v_subrev_u32 v9, 0x20000, v9
    ds_read_b64_tr_b16 v[24:25], v9 offset:0
    v_exp_f32 v14, v14
    v_mfma_f32_16x16x32_bf16 v[92:95], v[28:31], v[172:175], v[92:95]
    ds_read_b64_tr_b16 v[26:27], v9 offset:2048
    v_mul_f32 v48, v48, v56
    s_waitcnt lgkmcnt(4)
    v_mfma_f32_16x16x32_bf16 v[64:67], v[16:19], v[176:179], v[64:67]
    ds_read_b64_tr_b16 v[28:29], v9 offset:4096
    v_mul_f32 v49, v49, v57
    v_mfma_f32_16x16x32_bf16 v[68:71], v[16:19], v[180:183], v[68:71]
    ds_read_b64_tr_b16 v[30:31], v9 offset:6144
    v_mul_f32 v50, v50, v58
    s_waitcnt lgkmcnt(4)
    v_mfma_f32_16x16x32_bf16 v[72:75], v[20:23], v[176:179], v[72:75]
    ds_read_b64_tr_b16 v[16:17], v8 offset:8192
    v_mul_f32 v51, v51, v59
    v_mfma_f32_16x16x32_bf16 v[76:79], v[20:23], v[180:183], v[76:79]
    ds_read_b64_tr_b16 v[18:19], v8 offset:10240
    v_add_f32 v11, 1.0, v11
    s_waitcnt lgkmcnt(4)
    v_mfma_f32_16x16x32_bf16 v[80:83], v[24:27], v[176:179], v[80:83]
    ds_read_b64_tr_b16 v[20:21], v8 offset:12288
    v_add_f32 v12, 1.0, v12
    v_mfma_f32_16x16x32_bf16 v[84:87], v[24:27], v[180:183], v[84:87]
    ds_read_b64_tr_b16 v[22:23], v8 offset:14336
    v_add_f32 v13, 1.0, v13
    s_waitcnt lgkmcnt(4)
    v_mfma_f32_16x16x32_bf16 v[88:91], v[28:31], v[176:179], v[88:91]
    ds_read_b64_tr_b16 v[24:25], v9 offset:8192
    v_add_f32 v14, 1.0, v14
    v_mfma_f32_16x16x32_bf16 v[92:95], v[28:31], v[180:183], v[92:95]
    ds_read_b64_tr_b16 v[26:27], v9 offset:10240
    v_rcp_f32 v11, v11
    s_setprio 3
    s_waitcnt vmcnt(8)
    s_barrier
    s_cmp_lg_u32 s32, 0
    s_cbranch_scc1 L_pi_56
    s_xor_b32 s6, s38, 1
    s_lshl_b32 s6, s6, 5
    s_add_u32 s6, s6, 57344
    s_mov_b32 s7, 0
    s_atomic_add s7, s[76:77], s6 glc
L_pi_56:
    s_waitcnt lgkmcnt(4)
    v_mfma_f32_16x16x32_bf16 v[64:67], v[16:19], v[184:187], v[64:67]
    ds_read_b64_tr_b16 v[28:29], v9 offset:12288
    v_rcp_f32 v12, v12
    v_mfma_f32_16x16x32_bf16 v[68:71], v[16:19], v[188:191], v[68:71]
    ds_read_b64_tr_b16 v[30:31], v9 offset:14336
    v_rcp_f32 v13, v13
    s_add_u32 m0, s39, 0x1e000
    s_add_u32 s61, s20, 0x4000
    buffer_load_dwordx4 v4, s[12:15], s61 offen sc1 lds
    s_waitcnt lgkmcnt(4)
    v_mfma_f32_16x16x32_bf16 v[72:75], v[20:23], v[184:187], v[72:75]
    ds_read_b64_tr_b16 v[16:17], v8 offset:16384
    v_rcp_f32 v14, v14
    v_mfma_f32_16x16x32_bf16 v[76:79], v[20:23], v[188:191], v[76:79]
    ds_read_b64_tr_b16 v[18:19], v8 offset:18432
    v_mul_f32 v48, v48, v11
    s_waitcnt lgkmcnt(4)
    v_mfma_f32_16x16x32_bf16 v[80:83], v[24:27], v[184:187], v[80:83]
    ds_read_b64_tr_b16 v[20:21], v8 offset:20480
    v_mul_f32 v49, v49, v12
    v_mfma_f32_16x16x32_bf16 v[84:87], v[24:27], v[188:191], v[84:87]
    ds_read_b64_tr_b16 v[22:23], v8 offset:22528
    v_mul_f32 v50, v50, v13
    s_add_u32 m0, s39, 0x20000
    s_add_u32 s62, s20, 0x6000
    buffer_load_dwordx4 v4, s[12:15], s62 offen sc1 lds
    s_waitcnt lgkmcnt(4)
    v_mfma_f32_16x16x32_bf16 v[88:91], v[28:31], v[184:187], v[88:91]
    ds_read_b64_tr_b16 v[24:25], v9 offset:16384
    v_mul_f32 v51, v51, v14
    v_mfma_f32_16x16x32_bf16 v[92:95], v[28:31], v[188:191], v[92:95]
    ds_read_b64_tr_b16 v[26:27], v9 offset:18432
    v_cvt_pk_bf16_f32 v100, v48, v49
    s_waitcnt lgkmcnt(4)
    v_mfma_f32_16x16x32_bf16 v[64:67], v[16:19], v[192:195], v[64:67]
    ds_read_b64_tr_b16 v[28:29], v9 offset:20480
    v_cvt_pk_bf16_f32 v101, v50, v51
    v_mfma_f32_16x16x32_bf16 v[68:71], v[16:19], v[196:199], v[68:71]
    ds_read_b64_tr_b16 v[30:31], v9 offset:22528
    v_mul_f32 v11, s53, v52
    s_add_u32 m0, s39, 0x22000
    s_mov_b32 s63, 0x1b0000
    buffer_load_dwordx4 v3, s[8:11], s63 offen lds
    s_waitcnt lgkmcnt(4)
    v_mfma_f32_16x16x32_bf16 v[72:75], v[20:23], v[192:195], v[72:75]
    ds_read_b64_tr_b16 v[16:17], v8 offset:24576
    v_mul_f32 v12, s53, v53
    v_mfma_f32_16x16x32_bf16 v[76:79], v[20:23], v[196:199], v[76:79]
    ds_read_b64_tr_b16 v[18:19], v8 offset:26624
    v_mul_f32 v13, s53, v54
    s_setprio 2
    s_waitcnt lgkmcnt(4)
    v_mfma_f32_16x16x32_bf16 v[80:83], v[24:27], v[192:195], v[80:83]
    ds_read_b64_tr_b16 v[20:21], v8 offset:28672
    v_mul_f32 v14, s53, v55
    v_mfma_f32_16x16x32_bf16 v[84:87], v[24:27], v[196:199], v[84:87]
    ds_read_b64_tr_b16 v[22:23], v8 offset:30720
    v_exp_f32 v11, v11
    s_add_u32 m0, s39, 0x24000
    s_mov_b32 s56, 0x240000
    buffer_load_dwordx4 v3, s[8:11], s56 offen lds
    s_waitcnt lgkmcnt(4)
    v_mfma_f32_16x16x32_bf16 v[88:91], v[28:31], v[192:195], v[88:91]
    ds_read_b64_tr_b16 v[24:25], v9 offset:24576
    v_exp_f32 v12, v12
    v_mfma_f32_16x16x32_bf16 v[92:95], v[28:31], v[196:199], v[92:95]
    ds_read_b64_tr_b16 v[26:27], v9 offset:26624
    v_exp_f32 v13, v13
    s_waitcnt lgkmcnt(4)
    v_mfma_f32_16x16x32_bf16 v[64:67], v[16:19], v[200:203], v[64:67]
    ds_read_b64_tr_b16 v[28:29], v9 offset:28672
    v_exp_f32 v14, v14
    v_mfma_f32_16x16x32_bf16 v[68:71], v[16:19], v[204:207], v[68:71]
    ds_read_b64_tr_b16 v[30:31], v9 offset:30720
    v_mul_f32 v52, v52, v60
    s_add_u32 m0, s39, 0x26000
    s_mov_b32 s57, 0x2d0000
    buffer_load_dwordx4 v3, s[8:11], s57 offen lds
    s_waitcnt lgkmcnt(4)
    v_mfma_f32_16x16x32_bf16 v[72:75], v[20:23], v[200:203], v[72:75]
    ds_read_b64_tr_b16 v[16:17], v8 offset:32768
    v_mul_f32 v53, v53, v61
    v_mfma_f32_16x16x32_bf16 v[76:79], v[20:23], v[204:207], v[76:79]
    ds_read_b64_tr_b16 v[18:19], v8 offset:34816
    v_mul_f32 v54, v54, v62
    s_waitcnt lgkmcnt(4)
    v_mfma_f32_16x16x32_bf16 v[80:83], v[24:27], v[200:203], v[80:83]
    ds_read_b64_tr_b16 v[20:21], v8 offset:36864
    v_mul_f32 v55, v55, v63
    v_mfma_f32_16x16x32_bf16 v[84:87], v[24:27], v[204:207], v[84:87]
    ds_read_b64_tr_b16 v[22:23], v8 offset:38912
    v_add_f32 v11, 1.0, v11
    s_waitcnt lgkmcnt(4)
    v_mfma_f32_16x16x32_bf16 v[88:91], v[28:31], v[200:203], v[88:91]
    ds_read_b64_tr_b16 v[24:25], v9 offset:32768
    v_add_f32 v12, 1.0, v12
    v_mfma_f32_16x16x32_bf16 v[92:95], v[28:31], v[204:207], v[92:95]
    ds_read_b64_tr_b16 v[26:27], v9 offset:34816
    v_add_f32 v13, 1.0, v13
    s_setprio 1
    s_waitcnt lgkmcnt(4)
    v_mfma_f32_16x16x32_bf16 v[64:67], v[16:19], v[208:211], v[64:67]
    ds_read_b64_tr_b16 v[28:29], v9 offset:36864
    v_add_f32 v14, 1.0, v14
    v_mfma_f32_16x16x32_bf16 v[68:71], v[16:19], v[212:215], v[68:71]
    ds_read_b64_tr_b16 v[30:31], v9 offset:38912
    v_rcp_f32 v11, v11
    s_waitcnt lgkmcnt(4)
    v_mfma_f32_16x16x32_bf16 v[72:75], v[20:23], v[208:211], v[72:75]
    ds_read_b64_tr_b16 v[16:17], v8 offset:40960
    v_rcp_f32 v12, v12
    v_mfma_f32_16x16x32_bf16 v[76:79], v[20:23], v[212:215], v[76:79]
    ds_read_b64_tr_b16 v[18:19], v8 offset:43008
    v_rcp_f32 v13, v13
    s_waitcnt lgkmcnt(4)
    v_mfma_f32_16x16x32_bf16 v[80:83], v[24:27], v[208:211], v[80:83]
    ds_read_b64_tr_b16 v[20:21], v8 offset:45056
    v_rcp_f32 v14, v14
    v_mfma_f32_16x16x32_bf16 v[84:87], v[24:27], v[212:215], v[84:87]
    ds_read_b64_tr_b16 v[22:23], v8 offset:47104
    v_mul_f32 v52, v52, v11
    s_waitcnt lgkmcnt(4)
    v_mfma_f32_16x16x32_bf16 v[88:91], v[28:31], v[208:211], v[88:91]
    ds_read_b64_tr_b16 v[24:25], v9 offset:40960
    v_mul_f32 v53, v53, v12
    v_mfma_f32_16x16x32_bf16 v[92:95], v[28:31], v[212:215], v[92:95]
    ds_read_b64_tr_b16 v[26:27], v9 offset:43008
    v_mul_f32 v54, v54, v13
    s_waitcnt lgkmcnt(4)
    v_mfma_f32_16x16x32_bf16 v[64:67], v[16:19], v[216:219], v[64:67]
    ds_read_b64_tr_b16 v[28:29], v9 offset:45056
    v_mul_f32 v55, v55, v14
    v_mfma_f32_16x16x32_bf16 v[68:71], v[16:19], v[220:223], v[68:71]
    ds_read_b64_tr_b16 v[30:31], v9 offset:47104
    v_cvt_pk_bf16_f32 v102, v52, v53
    s_waitcnt lgkmcnt(4)
    v_mfma_f32_16x16x32_bf16 v[72:75], v[20:23], v[216:219], v[72:75]
    ds_read_b64_tr_b16 v[16:17], v8 offset:49152
    v_cvt_pk_bf16_f32 v103, v54, v55
    v_mfma_f32_16x16x32_bf16 v[76:79], v[20:23], v[220:223], v[76:79]
    ds_read_b64_tr_b16 v[18:19], v8 offset:51200
    s_add_u32 s58, s20, 40960
    buffer_store_dwordx4 v[100:103], v4, s[12:15], s58 offen sc1
    s_setprio 0
    s_waitcnt lgkmcnt(4)
    v_mfma_f32_16x16x32_bf16 v[80:83], v[24:27], v[216:219], v[80:83]
    ds_read_b64_tr_b16 v[20:21], v8 offset:53248
    v_mfma_f32_16x16x32_bf16 v[84:87], v[24:27], v[220:223], v[84:87]
    ds_read_b64_tr_b16 v[22:23], v8 offset:55296
    s_waitcnt lgkmcnt(4)
    v_mfma_f32_16x16x32_bf16 v[88:91], v[28:31], v[216:219], v[88:91]
    ds_read_b64_tr_b16 v[24:25], v9 offset:49152
    v_mfma_f32_16x16x32_bf16 v[92:95], v[28:31], v[220:223], v[92:95]
    ds_read_b64_tr_b16 v[26:27], v9 offset:51200
    s_waitcnt lgkmcnt(4)
    v_mfma_f32_16x16x32_bf16 v[64:67], v[16:19], v[224:227], v[64:67]
    ds_read_b64_tr_b16 v[28:29], v9 offset:53248
    v_mfma_f32_16x16x32_bf16 v[68:71], v[16:19], v[228:231], v[68:71]
    ds_read_b64_tr_b16 v[30:31], v9 offset:55296
    s_waitcnt lgkmcnt(4)
    v_mfma_f32_16x16x32_bf16 v[72:75], v[20:23], v[224:227], v[72:75]
    ds_read_b64_tr_b16 v[16:17], v8 offset:57344
    v_mfma_f32_16x16x32_bf16 v[76:79], v[20:23], v[228:231], v[76:79]
    ds_read_b64_tr_b16 v[18:19], v8 offset:59392
    s_waitcnt lgkmcnt(4)
    v_mfma_f32_16x16x32_bf16 v[80:83], v[24:27], v[224:227], v[80:83]
    ds_read_b64_tr_b16 v[20:21], v8 offset:61440
    v_mfma_f32_16x16x32_bf16 v[84:87], v[24:27], v[228:231], v[84:87]
    ds_read_b64_tr_b16 v[22:23], v8 offset:63488
    s_waitcnt lgkmcnt(4)
    v_mfma_f32_16x16x32_bf16 v[88:91], v[28:31], v[224:227], v[88:91]
    ds_read_b64_tr_b16 v[24:25], v9 offset:57344
    v_mfma_f32_16x16x32_bf16 v[92:95], v[28:31], v[228:231], v[92:95]
    ds_read_b64_tr_b16 v[26:27], v9 offset:59392
    s_setprio 3
    s_cmp_lg_u32 s32, 0
    s_cbranch_scc1 L_pc_57
    s_mov_b32 s50, 0
L_pcl_58:
    s_waitcnt lgkmcnt(0)
    s_cmp_ge_u32 s7, 1
    s_cbranch_scc1 L_pc_57
    s_add_u32 s50, s50, 1
    s_cmp_ge_u32 s50, 20000
    s_cbranch_scc1 L_pc_57
    s_mov_b32 s7, 0
    s_atomic_add s7, s[76:77], s6 glc
    s_branch L_pcl_58
L_pc_57:
    s_waitcnt vmcnt(11)
    s_barrier
    s_waitcnt lgkmcnt(4)
    v_mfma_f32_16x16x32_bf16 v[64:67], v[16:19], v[232:235], v[64:67]
    ds_read_b64_tr_b16 v[28:29], v9 offset:61440
    v_mfma_f32_16x16x32_bf16 v[68:71], v[16:19], v[236:239], v[68:71]
    ds_read_b64_tr_b16 v[30:31], v9 offset:63488
    s_add_u32 m0, s39, 0x0
    s_add_u32 s59, s21, 0x0
    buffer_load_dwordx4 v4, s[12:15], s59 offen sc1 lds
    s_waitcnt lgkmcnt(4)
    v_mfma_f32_16x16x32_bf16 v[72:75], v[20:23], v[232:235], v[72:75]
    v_add_u32 v8, 0x10000, v8
    ds_read_b64_tr_b16 v[16:17], v8 offset:0
    v_mfma_f32_16x16x32_bf16 v[76:79], v[20:23], v[236:239], v[76:79]
    ds_read_b64_tr_b16 v[18:19], v8 offset:2048
    s_waitcnt lgkmcnt(4)
    v_mfma_f32_16x16x32_bf16 v[80:83], v[24:27], v[232:235], v[80:83]
    ds_read_b64_tr_b16 v[20:21], v8 offset:4096
    v_mfma_f32_16x16x32_bf16 v[84:87], v[24:27], v[236:239], v[84:87]
    ds_read_b64_tr_b16 v[22:23], v8 offset:6144
    s_add_u32 m0, s39, 0x2000
    s_add_u32 s60, s21, 0x2000
    buffer_load_dwordx4 v4, s[12:15], s60 offen sc1 lds
    s_setprio 2
    s_waitcnt lgkmcnt(4)
    v_mfma_f32_16x16x32_bf16 v[88:91], v[28:31], v[232:235], v[88:91]
    v_add_u32 v9, 0x10000, v9
    ds_read_b64_tr_b16 v[24:25], v9 offset:0
    v_mfma_f32_16x16x32_bf16 v[92:95], v[28:31], v[236:239], v[92:95]
    ds_read_b64_tr_b16 v[26:27], v9 offset:2048
    s_waitcnt lgkmcnt(4)
    v_mfma_f32_16x16x32_bf16 v[64:67], v[16:19], v[240:243], v[64:67]
    ds_read_b64_tr_b16 v[28:29], v9 offset:4096
    v_mfma_f32_16x16x32_bf16 v[68:71], v[16:19], v[244:247], v[68:71]
    ds_read_b64_tr_b16 v[30:31], v9 offset:6144
    s_add_u32 m0, s39, 0x4000
    s_add_u32 s61, s21, 0x4000
    buffer_load_dwordx4 v4, s[12:15], s61 offen sc1 lds
    s_waitcnt lgkmcnt(4)
    v_mfma_f32_16x16x32_bf16 v[72:75], v[20:23], v[240:243], v[72:75]
    ds_read_b64_tr_b16 v[16:17], v8 offset:8192
    v_mfma_f32_16x16x32_bf16 v[76:79], v[20:23], v[244:247], v[76:79]
    ds_read_b64_tr_b16 v[18:19], v8 offset:10240
    s_setprio 1
    s_waitcnt lgkmcnt(4)
    v_mfma_f32_16x16x32_bf16 v[80:83], v[24:27], v[240:243], v[80:83]
    ds_read_b64_tr_b16 v[20:21], v8 offset:12288
    v_mfma_f32_16x16x32_bf16 v[84:87], v[24:27], v[244:247], v[84:87]
    ds_read_b64_tr_b16 v[22:23], v8 offset:14336
    s_add_u32 m0, s39, 0x6000
    s_add_u32 s62, s21, 0x6000
    buffer_load_dwordx4 v4, s[12:15], s62 offen sc1 lds
    s_waitcnt lgkmcnt(4)
    v_mfma_f32_16x16x32_bf16 v[88:91], v[28:31], v[240:243], v[88:91]
    ds_read_b64_tr_b16 v[24:25], v9 offset:8192
    v_mfma_f32_16x16x32_bf16 v[92:95], v[28:31], v[244:247], v[92:95]
    ds_read_b64_tr_b16 v[26:27], v9 offset:10240
    s_waitcnt lgkmcnt(4)
    v_mfma_f32_16x16x32_bf16 v[64:67], v[16:19], v[248:251], v[64:67]
    ds_read_b64_tr_b16 v[28:29], v9 offset:12288
    v_mfma_f32_16x16x32_bf16 v[68:71], v[16:19], v[252:255], v[68:71]
    ds_read_b64_tr_b16 v[30:31], v9 offset:14336
    s_add_u32 m0, s39, 0x8000
    s_mov_b32 s63, 0x360000
    buffer_load_dwordx4 v3, s[8:11], s63 offen lds
    s_setprio 0
    s_waitcnt lgkmcnt(4)
    v_mfma_f32_16x16x32_bf16 v[72:75], v[20:23], v[248:251], v[72:75]
    v_add_u32 v6, 0x10000, v6
    ds_read_b64_tr_b16 v[16:17], v6 offset:16384
    v_mfma_f32_16x16x32_bf16 v[76:79], v[20:23], v[252:255], v[76:79]
    ds_read_b64_tr_b16 v[18:19], v6 offset:17408
    s_waitcnt lgkmcnt(4)
    v_mfma_f32_16x16x32_bf16 v[80:83], v[24:27], v[248:251], v[80:83]
    ds_read_b64_tr_b16 v[20:21], v6 offset:20480
    v_mfma_f32_16x16x32_bf16 v[84:87], v[24:27], v[252:255], v[84:87]
    ds_read_b64_tr_b16 v[22:23], v6 offset:21504
    s_add_u32 m0, s39, 0xa000
    s_mov_b32 s56, 0x3f0000
    buffer_load_dwordx4 v3, s[8:11], s56 offen lds
    s_waitcnt lgkmcnt(4)
    v_mfma_f32_16x16x32_bf16 v[88:91], v[28:31], v[248:251], v[88:91]
    ds_read_b64_tr_b16 v[24:25], v6 offset:18432
    v_mfma_f32_16x16x32_bf16 v[92:95], v[28:31], v[252:255], v[92:95]
    ds_read_b64_tr_b16 v[26:27], v6 offset:19456
    s_setprio 3
    s_waitcnt vmcnt(6)
    s_barrier
    s_cmp_lg_u32 s32, 0
    s_cbranch_scc1 L_sig_59
    s_lshl_b32 s50, s38, 5
    s_add_u32 s50, s50, 57344
    s_mov_b32 s51, 1
    s_atomic_add s51, s[76:77], s50
L_sig_59:
    s_waitcnt lgkmcnt(4)
    v_mfma_f32_16x16x32_bf16 v[32:35], v[16:19], v[112:115], 0
    ds_read_b64_tr_b16 v[28:29], v6 offset:22528
    v_mfma_f32_16x16x32_bf16 v[36:39], v[16:19], v[116:119], 0
    ds_read_b64_tr_b16 v[30:31], v6 offset:23552
    s_add_u32 m0, s39, 0xc000
    s_mov_b32 s57, 0x480000
    buffer_load_dwordx4 v3, s[8:11], s57 offen lds
    s_waitcnt lgkmcnt(4)
    v_mfma_f32_16x16x32_bf16 v[40:43], v[20:23], v[112:115], 0
    ds_read_b64_tr_b16 v[16:17], v6 offset:24576
    v_mul_f32 v11, s53, v64
    v_mul_f32 v12, s53, v65
    v_mfma_f32_16x16x32_bf16 v[44:47], v[20:23], v[116:119], 0
    ds_read_b64_tr_b16 v[18:19], v6 offset:25600
    v_mul_f32 v13, s53, v66
    v_mul_f32 v14, s53, v67
    s_waitcnt lgkmcnt(4)
    v_mfma_f32_16x16x32_bf16 v[32:35], v[24:27], v[120:123], v[32:35]
    ds_read_b64_tr_b16 v[20:21], v6 offset:28672
    v_exp_f32 v11, v11
    v_mfma_f32_16x16x32_bf16 v[36:39], v[24:27], v[124:127], v[36:39]
    ds_read_b64_tr_b16 v[22:23], v6 offset:29696
    v_exp_f32 v12, v12
    s_add_u32 m0, s39, 0xe000
    s_add_u32 s58, s20, 0x8000
    buffer_load_dwordx4 v4, s[12:15], s58 offen sc1 lds
    s_setprio 2
    s_waitcnt lgkmcnt(4)
    v_mfma_f32_16x16x32_bf16 v[40:43], v[28:31], v[120:123], v[40:43]
    ds_read_b64_tr_b16 v[24:25], v6 offset:26624
    v_exp_f32 v13, v13
    v_mfma_f32_16x16x32_bf16 v[44:47], v[28:31], v[124:127], v[44:47]
    ds_read_b64_tr_b16 v[26:27], v6 offset:27648
    v_exp_f32 v14, v14
    s_waitcnt lgkmcnt(4)
    v_mfma_f32_16x16x32_bf16 v[32:35], v[16:19], v[128:131], v[32:35]
    ds_read_b64_tr_b16 v[28:29], v6 offset:30720
    v_mul_f32 v64, v64, v72
    v_mul_f32 v65, v65, v73
    v_mfma_f32_16x16x32_bf16 v[36:39], v[16:19], v[132:135], v[36:39]
    ds_read_b64_tr_b16 v[30:31], v6 offset:31744
    v_mul_f32 v66, v66, v74
    v_mul_f32 v67, v67, v75
    s_add_u32 m0, s39, 0x10000
    s_add_u32 s59, s20, 0xa000
    buffer_load_dwordx4 v4, s[12:15], s59 offen sc1 lds
    s_waitcnt lgkmcnt(4)
    v_mfma_f32_16x16x32_bf16 v[40:43], v[20:23], v[128:131], v[40:43]
    ds_read_b64_tr_b16 v[16:17], v6 offset:32768
    v_add_f32 v11, 1.0, v11
    v_add_f32 v12, 1.0, v12
    v_mfma_f32_16x16x32_bf16 v[44:47], v[20:23], v[132:135], v[44:47]
    ds_read_b64_tr_b16 v[18:19], v6 offset:33792
    v_add_f32 v13, 1.0, v13
    v_add_f32 v14, 1.0, v14
    s_setprio 1
    s_waitcnt lgkmcnt(4)
    v_mfma_f32_16x16x32_bf16 v[32:35], v[24:27], v[136:139], v[32:35]
    ds_read_b64_tr_b16 v[20:21], v6 offset:36864
    v_rcp_f32 v11, v11
    v_mfma_f32_16x16x32_bf16 v[36:39], v[24:27], v[140:143], v[36:39]
    ds_read_b64_tr_b16 v[22:23], v6 offset:37888
    v_rcp_f32 v12, v12
    s_add_u32 m0, s39, 0x12000
    s_add_u32 s60, s44, 0x0
    buffer_load_dwordx4 v5, s[16:19], s60 offen lds
    s_waitcnt lgkmcnt(4)
    v_mfma_f32_16x16x32_bf16 v[40:43], v[28:31], v[136:139], v[40:43]
    ds_read_b64_tr_b16 v[24:25], v6 offset:34816
    v_rcp_f32 v13, v13
    v_mfma_f32_16x16x32_bf16 v[44:47], v[28:31], v[140:143], v[44:47]
    ds_read_b64_tr_b16 v[26:27], v6 offset:35840
    v_rcp_f32 v14, v14
    s_waitcnt lgkmcnt(4)
    v_mfma_f32_16x16x32_bf16 v[32:35], v[16:19], v[144:147], v[32:35]
    ds_read_b64_tr_b16 v[28:29], v6 offset:38912
    v_mul_f32 v64, v64, v11
    v_mul_f32 v65, v65, v12
    v_mfma_f32_16x16x32_bf16 v[36:39], v[16:19], v[148:151], v[36:39]
    ds_read_b64_tr_b16 v[30:31], v6 offset:39936
    v_mul_f32 v66, v66, v13
    v_mul_f32 v67, v67, v14
    s_setprio 0
    s_waitcnt lgkmcnt(4)
    v_mfma_f32_16x16x32_bf16 v[40:43], v[20:23], v[144:147], v[40:43]
    v_add_u32 v6, 0x10000, v6
    ds_read_b64_tr_b16 v[16:17], v6 offset:8192
    v_cvt_pk_bf16_f32 v96, v64, v65
    v_cvt_pk_bf16_f32 v97, v66, v67
    v_mfma_f32_16x16x32_bf16 v[44:47], v[20:23], v[148:151], v[44:47]
    ds_read_b64_tr_b16 v[18:19], v6 offset:9216
    v_mul_f32 v11, s53, v68
    v_mul_f32 v12, s53, v69
    s_waitcnt lgkmcnt(4)
    v_mfma_f32_16x16x32_bf16 v[32:35], v[24:27], v[152:155], v[32:35]
    ds_read_b64_tr_b16 v[20:21], v6 offset:12288
    v_mul_f32 v13, s53, v70
    v_mul_f32 v14, s53, v71
    v_mfma_f32_16x16x32_bf16 v[36:39], v[24:27], v[156:159], v[36:39]
    ds_read_b64_tr_b16 v[22:23], v6 offset:13312
    v_exp_f32 v11, v11
    s_waitcnt lgkmcnt(4)
    v_mfma_f32_16x16x32_bf16 v[40:43], v[28:31], v[152:155], v[40:43]
    ds_read_b64_tr_b16 v[24:25], v6 offset:10240
    v_exp_f32 v12, v12
    v_mfma_f32_16x16x32_bf16 v[44:47], v[28:31], v[156:159], v[44:47]
    ds_read_b64_tr_b16 v[26:27], v6 offset:11264
    v_exp_f32 v13, v13
    s_setprio 3
    s_waitcnt vmcnt(5)
    s_barrier
    s_cmp_lg_u32 s32, 0
    s_cbranch_scc1 L_pi_60
    s_xor_b32 s6, s38, 1
    s_lshl_b32 s6, s6, 5
    s_add_u32 s6, s6, 57344
    s_mov_b32 s7, 0
    s_atomic_add s7, s[76:77], s6 glc
L_pi_60:
    v_add_u32 v15, 0x10000, v15
    ds_read_b64 v[112:113], v15 offset:40960
    v_add_u32 v107, 0x10000, v107
    ds_read_b64 v[114:115], v107 offset:40960
    ds_read_b64 v[116:117], v15 offset:40968
    ds_read_b64 v[118:119], v107 offset:40968
    ds_read_b64 v[120:121], v15 offset:49152
    ds_read_b64 v[122:123], v107 offset:49152
    ds_read_b64 v[124:125], v15 offset:49160
    ds_read_b64 v[126:127], v107 offset:49160
    ds_read_b64 v[128:129], v15 offset:57344
    ds_read_b64 v[130:131], v107 offset:57344
    ds_read_b64 v[132:133], v15 offset:57352
    ds_read_b64 v[134:135], v107 offset:57352
    v_add_u32 v15, 0x10000, v15
    ds_read_b64 v[136:137], v15 offset:0
    v_add_u32 v107, 0x10000, v107
    ds_read_b64 v[138:139], v107 offset:0
    ds_read_b64 v[140:141], v15 offset:8
    ds_read_b64 v[142:143], v107 offset:8
    s_waitcnt lgkmcnt(15)
    v_mfma_f32_16x16x32_bf16 v[32:35], v[16:19], v[160:163], v[32:35]
    ds_read_b64_tr_b16 v[28:29], v6 offset:14336
    v_exp_f32 v14, v14
    v_mfma_f32_16x16x32_bf16 v[36:39], v[16:19], v[164:167], v[36:39]
    ds_read_b64_tr_b16 v[30:31], v6 offset:15360
    v_mul_f32 v68, v68, v76
    v_mul_f32 v69, v69, v77
    s_add_u32 m0, s39, 0x14000
    s_add_u32 s61, s46, 0x0
    buffer_load_dwordx4 v5, s[16:19], s61 offen lds
    v_mfma_f32_16x16x32_bf16 v[40:43], v[20:23], v[160:163], v[40:43]
    ds_read_b64_tr_b16 v[16:17], v6 offset:16384
    v_mul_f32 v70, v70, v78
    v_mul_f32 v71, v71, v79
    v_mfma_f32_16x16x32_bf16 v[44:47], v[20:23], v[164:167], v[44:47]
    ds_read_b64_tr_b16 v[18:19], v6 offset:17408
    v_add_f32 v11, 1.0, v11
    v_add_f32 v12, 1.0, v12
    v_mfma_f32_16x16x32_bf16 v[32:35], v[24:27], v[168:171], v[32:35]
    ds_read_b64_tr_b16 v[20:21], v6 offset:20480
    v_add_f32 v13, 1.0, v13
    v_add_f32 v14, 1.0, v14
    v_mfma_f32_16x16x32_bf16 v[36:39], v[24:27], v[172:175], v[36:39]
    ds_read_b64_tr_b16 v[22:23], v6 offset:21504
    v_rcp_f32 v11, v11
    s_add_u32 m0, s39, 0x16000
    s_add_u32 s62, s44, 0x12000
    buffer_load_dwordx4 v5, s[16:19], s62 offen lds
    s_setprio 2
    s_waitcnt lgkmcnt(4)
    v_mfma_f32_16x16x32_bf16 v[40:43], v[28:31], v[168:171], v[40:43]
    ds_read_b64_tr_b16 v[24:25], v6 offset:18432
    v_rcp_f32 v12, v12
    v_mfma_f32_16x16x32_bf16 v[44:47], v[28:31], v[172:175], v[44:47]
    ds_read_b64_tr_b16 v[26:27], v6 offset:19456
    v_rcp_f32 v13, v13
    s_waitcnt lgkmcnt(4)
    v_mfma_f32_16x16x32_bf16 v[32:35], v[16:19], v[176:179], v[32:35]
    ds_read_b64_tr_b16 v[28:29], v6 offset:22528
    v_rcp_f32 v14, v14
    v_mfma_f32_16x16x32_bf16 v[36:39], v[16:19], v[180:183], v[36:39]
    ds_read_b64_tr_b16 v[30:31], v6 offset:23552
    v_mul_f32 v68, v68, v11
    v_mul_f32 v69, v69, v12
    s_add_u32 m0, s39, 0x18000
    s_add_u32 s63, s46, 0x12000
    buffer_load_dwordx4 v5, s[16:19], s63 offen lds
    s_waitcnt lgkmcnt(4)
    v_mfma_f32_16x16x32_bf16 v[40:43], v[20:23], v[176:179], v[40:43]
    ds_read_b64_tr_b16 v[16:17], v6 offset:24576
    v_mul_f32 v70, v70, v13
    v_mul_f32 v71, v71, v14
    v_mfma_f32_16x16x32_bf16 v[44:47], v[20:23], v[180:183], v[44:47]
    ds_read_b64_tr_b16 v[18:19], v6 offset:25600
    v_cvt_pk_bf16_f32 v98, v68, v69
    v_cvt_pk_bf16_f32 v99, v70, v71
    s_setprio 1
    s_waitcnt lgkmcnt(4)
    v_mfma_f32_16x16x32_bf16 v[32:35], v[24:27], v[184:187], v[32:35]
    ds_read_b64_tr_b16 v[20:21], v6 offset:28672
    s_add_u32 s56, s20, 49152
    buffer_store_dwordx4 v[96:99], v4, s[12:15], s56 offen sc1
    v_mul_f32 v11, s53, v80
    v_mfma_f32_16x16x32_bf16 v[36:39], v[24:27], v[188:191], v[36:39]
    ds_read_b64_tr_b16 v[22:23], v6 offset:29696
    v_mul_f32 v12, s53, v81
    v_mul_f32 v13, s53, v82
    s_waitcnt lgkmcnt(4)
    v_mfma_f32_16x16x32_bf16 v[40:43], v[28:31], v[184:187], v[40:43]
    ds_read_b64_tr_b16 v[24:25], v6 offset:26624
    v_mul_f32 v14, s53, v83
    v_mfma_f32_16x16x32_bf16 v[44:47], v[28:31], v[188:191], v[44:47]
    ds_read_b64_tr_b16 v[26:27], v6 offset:27648
    v_exp_f32 v11, v11
    s_waitcnt lgkmcnt(4)
    v_mfma_f32_16x16x32_bf16 v[32:35], v[16:19], v[192:195], v[32:35]
    ds_read_b64_tr_b16 v[28:29], v6 offset:30720
    v_exp_f32 v12, v12
    v_mfma_f32_16x16x32_bf16 v[36:39], v[16:19], v[196:199], v[36:39]
    ds_read_b64_tr_b16 v[30:31], v6 offset:31744
    v_exp_f32 v13, v13
    s_setprio 0
    s_waitcnt lgkmcnt(4)
    v_mfma_f32_16x16x32_bf16 v[40:43], v[20:23], v[192:195], v[40:43]
    v_subrev_u32 v6, 0x20000, v6
    ds_read_b64_tr_b16 v[16:17], v6 offset:32768
    v_exp_f32 v14, v14
    v_mfma_f32_16x16x32_bf16 v[44:47], v[20:23], v[196:199], v[44:47]
    ds_read_b64_tr_b16 v[18:19], v6 offset:33792
    v_mul_f32 v80, v80, v88
    v_mul_f32 v81, v81, v89
    s_waitcnt lgkmcnt(4)
    v_mfma_f32_16x16x32_bf16 v[32:35], v[24:27], v[200:203], v[32:35]
    ds_read_b64_tr_b16 v[20:21], v6 offset:36864
    v_mul_f32 v82, v82, v90
    v_mul_f32 v83, v83, v91
    v_mfma_f32_16x16x32_bf16 v[36:39], v[24:27], v[204:207], v[36:39]
    ds_read_b64_tr_b16 v[22:23], v6 offset:37888
    v_add_f32 v11, 1.0, v11
    v_add_f32 v12, 1.0, v12
    s_waitcnt lgkmcnt(4)
    v_mfma_f32_16x16x32_bf16 v[40:43], v[28:31], v[200:203], v[40:43]
    ds_read_b64_tr_b16 v[24:25], v6 offset:34816
    v_add_f32 v13, 1.0, v13
    v_add_f32 v14, 1.0, v14
    v_mfma_f32_16x16x32_bf16 v[44:47], v[28:31], v[204:207], v[44:47]
    ds_read_b64_tr_b16 v[26:27], v6 offset:35840
    v_rcp_f32 v11, v11
    s_setprio 3
    s_cmp_lg_u32 s32, 0
    s_cbranch_scc1 L_pc_61
    s_mov_b32 s50, 0
L_pcl_62:
    s_waitcnt lgkmcnt(0)
    s_cmp_ge_u32 s7, 2
    s_cbranch_scc1 L_pc_61
    s_add_u32 s50, s50, 1
    s_cmp_ge_u32 s50, 20000
    s_cbranch_scc1 L_pc_61
    s_mov_b32 s7, 0
    s_atomic_add s7, s[76:77], s6 glc
    s_branch L_pcl_62
L_pc_61:
    s_waitcnt vmcnt(4)
    s_barrier
    v_subrev_u32 v15, 0x20000, v15
    ds_read_b64 v[144:145], v15 offset:0
    v_subrev_u32 v107, 0x20000, v107
    ds_read_b64 v[146:147], v107 offset:0
    ds_read_b64 v[148:149], v15 offset:8
    ds_read_b64 v[150:151], v107 offset:8
    ds_read_b64 v[152:153], v15 offset:8192
    ds_read_b64 v[154:155], v107 offset:8192
    ds_read_b64 v[156:157], v15 offset:8200
    ds_read_b64 v[158:159], v107 offset:8200
    ds_read_b64 v[160:161], v15 offset:16384
    ds_read_b64 v[162:163], v107 offset:16384
    ds_read_b64 v[164:165], v15 offset:16392
    ds_read_b64 v[166:167], v107 offset:16392
    ds_read_b64 v[168:169], v15 offset:24576
    ds_read_b64 v[170:171], v107 offset:24576
    ds_read_b64 v[172:173], v15 offset:24584
    ds_read_b64 v[174:175], v107 offset:24584
    s_waitcnt lgkmcnt(15)
    v_mfma_f32_16x16x32_bf16 v[32:35], v[16:19], v[208:211], v[32:35]
    ds_read_b64_tr_b16 v[28:29], v6 offset:38912
    v_rcp_f32 v12, v12
    v_mfma_f32_16x16x32_bf16 v[36:39], v[16:19], v[212:215], v[36:39]
    ds_read_b64_tr_b16 v[30:31], v6 offset:39936
    v_rcp_f32 v13, v13
    s_add_u32 m0, s39, 0x1a000
    s_add_u32 s57, s21, 0x8000
    buffer_load_dwordx4 v4, s[12:15], s57 offen sc1 lds
    v_mfma_f32_16x16x32_bf16 v[40:43], v[20:23], v[208:211], v[40:43]
    ds_read_b64_tr_b16 v[16:17], v6 offset:40960
    v_rcp_f32 v14, v14
    v_mfma_f32_16x16x32_bf16 v[44:47], v[20:23], v[212:215], v[44:47]
    ds_read_b64_tr_b16 v[18:19], v6 offset:41984
    v_mul_f32 v80, v80, v11
    v_mul_f32 v81, v81, v12
    v_mfma_f32_16x16x32_bf16 v[32:35], v[24:27], v[216:219], v[32:35]
    ds_read_b64_tr_b16 v[20:21], v6 offset:45056
    v_mul_f32 v82, v82, v13
    v_mul_f32 v83, v83, v14
    v_mfma_f32_16x16x32_bf16 v[36:39], v[24:27], v[220:223], v[36:39]
    ds_read_b64_tr_b16 v[22:23], v6 offset:46080
    v_cvt_pk_bf16_f32 v100, v80, v81
    v_cvt_pk_bf16_f32 v101, v82, v83
    s_add_u32 m0, s39, 0x1c000
    s_add_u32 s58, s21, 0xa000
    buffer_load_dwordx4 v4, s[12:15], s58 offen sc1 lds
    s_setprio 2
    s_waitcnt lgkmcnt(4)
    v_mfma_f32_16x16x32_bf16 v[40:43], v[28:31], v[216:219], v[40:43]
    ds_read_b64_tr_b16 v[24:25], v6 offset:43008
    v_mul_f32 v11, s53, v84
    v_mul_f32 v12, s53, v85
    v_mfma_f32_16x16x32_bf16 v[44:47], v[28:31], v[220:223], v[44:47]
    ds_read_b64_tr_b16 v[26:27], v6 offset:44032
    v_mul_f32 v13, s53, v86
    v_mul_f32 v14, s53, v87
    s_waitcnt lgkmcnt(4)
    v_mfma_f32_16x16x32_bf16 v[32:35], v[16:19], v[224:227], v[32:35]
    ds_read_b64_tr_b16 v[28:29], v6 offset:47104
    v_exp_f32 v11, v11
    v_mfma_f32_16x16x32_bf16 v[36:39], v[16:19], v[228:231], v[36:39]
    ds_read_b64_tr_b16 v[30:31], v6 offset:48128
    v_exp_f32 v12, v12
    s_add_u32 m0, s39, 0x1e000
    s_add_u32 s59, s44, 0x80
    buffer_load_dwordx4 v5, s[16:19], s59 offen lds
    s_waitcnt lgkmcnt(4)
    v_mfma_f32_16x16x32_bf16 v[40:43], v[20:23], v[224:227], v[40:43]
    ds_read_b64_tr_b16 v[16:17], v6 offset:49152
    v_exp_f32 v13, v13
    v_mfma_f32_16x16x32_bf16 v[44:47], v[20:23], v[228:231], v[44:47]
    ds_read_b64_tr_b16 v[18:19], v6 offset:50176
    v_exp_f32 v14, v14
    s_setprio 1
    s_waitcnt lgkmcnt(4)
    v_mfma_f32_16x16x32_bf16 v[32:35], v[24:27], v[232:235], v[32:35]
    ds_read_b64_tr_b16 v[20:21], v6 offset:53248
    v_mul_f32 v84, v84, v92
    v_mul_f32 v85, v85, v93
    v_mfma_f32_16x16x32_bf16 v[36:39], v[24:27], v[236:239], v[36:39]
    ds_read_b64_tr_b16 v[22:23], v6 offset:54272
    v_mul_f32 v86, v86, v94
    v_mul_f32 v87, v87, v95
    s_add_u32 m0, s39, 0x20000
    s_add_u32 s60, s46, 0x80
    buffer_load_dwordx4 v5, s[16:19], s60 offen lds
    s_waitcnt lgkmcnt(4)
    v_mfma_f32_16x16x32_bf16 v[40:43], v[28:31], v[232:235], v[40:43]
    ds_read_b64_tr_b16 v[24:25], v6 offset:51200
    v_add_f32 v11, 1.0, v11
    v_add_f32 v12, 1.0, v12
    v_mfma_f32_16x16x32_bf16 v[44:47], v[28:31], v[236:239], v[44:47]
    ds_read_b64_tr_b16 v[26:27], v6 offset:52224
    v_add_f32 v13, 1.0, v13
    v_add_f32 v14, 1.0, v14
    s_waitcnt lgkmcnt(4)
    v_mfma_f32_16x16x32_bf16 v[32:35], v[16:19], v[240:243], v[32:35]
    ds_read_b64_tr_b16 v[28:29], v6 offset:55296
    v_rcp_f32 v11, v11
    v_mfma_f32_16x16x32_bf16 v[36:39], v[16:19], v[244:247], v[36:39]
    ds_read_b64_tr_b16 v[30:31], v6 offset:56320
    v_rcp_f32 v12, v12
    s_add_u32 m0, s39, 0x22000
    s_add_u32 s61, s44, 0x12080
    buffer_load_dwordx4 v5, s[16:19], s61 offen lds
    s_setprio 0
    s_waitcnt lgkmcnt(4)
    v_mfma_f32_16x16x32_bf16 v[40:43], v[20:23], v[240:243], v[40:43]
    v_add_u32 v10, 0x10000, v10
    ds_read_b64_tr_b16 v[16:17], v10 offset:8192
    v_rcp_f32 v13, v13
    v_mfma_f32_16x16x32_bf16 v[44:47], v[20:23], v[244:247], v[44:47]
    v_add_u32 v109, 0x10000, v109
    ds_read_b64_tr_b16 v[18:19], v109 offset:8192
    v_rcp_f32 v14, v14
    s_waitcnt lgkmcnt(4)
    v_mfma_f32_16x16x32_bf16 v[32:35], v[24:27], v[248:251], v[32:35]
    v_add_u32 v111, 0x10000, v111
    ds_read_b64_tr_b16 v[20:21], v111 offset:8192
    v_mul_f32 v84, v84, v11
    v_mul_f32 v85, v85, v12
    v_mfma_f32_16x16x32_bf16 v[36:39], v[24:27], v[252:255], v[36:39]
    v_add_u32 v110, 0x10000, v110
    ds_read_b64_tr_b16 v[22:23], v110 offset:8192
    v_mul_f32 v86, v86, v13
    v_mul_f32 v87, v87, v14
    s_add_u32 m0, s39, 0x24000
    s_add_u32 s62, s46, 0x12080
    buffer_load_dwordx4 v5, s[16:19], s62 offen lds
    s_waitcnt lgkmcnt(4)
    v_mfma_f32_16x16x32_bf16 v[40:43], v[28:31], v[248:251], v[40:43]
    ds_read_b64_tr_b16 v[24:25], v10 offset:12288
    v_cvt_pk_bf16_f32 v102, v84, v85
    v_cvt_pk_bf16_f32 v103, v86, v87
    v_mfma_f32_16x16x32_bf16 v[44:47], v[28:31], v[252:255], v[44:47]
    ds_read_b64_tr_b16 v[26:27], v109 offset:12288
    s_add_u32 s63, s20, 57344
    buffer_store_dwordx4 v[100:103], v4, s[12:15], s63 offen sc1
    s_setprio 3
    s_waitcnt vmcnt(4)
    s_barrier
    ds_read_b64 v[176:177], v15 offset:57344
    ds_read_b64 v[178:179], v107 offset:57344
    ds_read_b64 v[180:181], v15 offset:57352
    ds_read_b64 v[182:183], v107 offset:57352
    v_add_u32 v15, 0x10000, v15
    ds_read_b64 v[184:185], v15 offset:0
    v_add_u32 v107, 0x10000, v107
    ds_read_b64 v[186:187], v107 offset:0
    ds_read_b64 v[188:189], v15 offset:8
    ds_read_b64 v[190:191], v107 offset:8
    s_waitcnt lgkmcnt(12)
    v_mfma_f32_16x16x32_bf16 v[48:51], v[16:19], v[112:115], 0
    ds_read_b64_tr_b16 v[28:29], v111 offset:12288
    v_mul_f32 v11, s53, v32
    v_mul_f32 v12, s53, v33
    v_mul_f32 v13, s53, v34
    v_mfma_f32_16x16x32_bf16 v[52:55], v[16:19], v[116:119], 0
    ds_read_b64_tr_b16 v[30:31], v110 offset:12288
    v_mul_f32 v14, s53, v35
    v_exp_f32 v11, v11
    s_add_u32 m0, s39, 0x26000
    s_add_u32 s56, s44, 0x100
    buffer_load_dwordx4 v5, s[16:19], s56 offen lds
    s_waitcnt lgkmcnt(12)
    v_mfma_f32_16x16x32_bf16 v[56:59], v[20:23], v[112:115], 0
    ds_read_b64_tr_b16 v[16:17], v10 offset:16384
    v_exp_f32 v12, v12
    v_mfma_f32_16x16x32_bf16 v[60:63], v[20:23], v[116:119], 0
    ds_read_b64_tr_b16 v[18:19], v109 offset:16384
    v_exp_f32 v13, v13
    s_waitcnt lgkmcnt(12)
    v_mfma_f32_16x16x32_bf16 v[48:51], v[24:27], v[120:123], v[48:51]
    ds_read_b64_tr_b16 v[20:21], v111 offset:16384
    v_exp_f32 v14, v14
    v_mul_f32 v32, v32, v40
    v_mfma_f32_16x16x32_bf16 v[52:55], v[24:27], v[124:127], v[52:55]
    ds_read_b64_tr_b16 v[22:23], v110 offset:16384
    v_mul_f32 v33, v33, v41
    v_mul_f32 v34, v34, v42
    v_mul_f32 v35, v35, v43
    s_add_u32 m0, s39, 0x0
    s_add_u32 s57, s46, 0x100
    buffer_load_dwordx4 v5, s[16:19], s57 offen lds
    s_waitcnt lgkmcnt(4)
    v_mfma_f32_16x16x32_bf16 v[56:59], v[28:31], v[120:123], v[56:59]
    ds_read_b64_tr_b16 v[24:25], v10 offset:20480
    v_add_f32 v11, 1.0, v11
    v_add_f32 v12, 1.0, v12
    v_add_f32 v13, 1.0, v13
    v_mfma_f32_16x16x32_bf16 v[60:63], v[28:31], v[124:127], v[60:63]
    ds_read_b64_tr_b16 v[26:27], v109 offset:20480
    v_add_f32 v14, 1.0, v14
    v_rcp_f32 v11, v11
    s_setprio 2
    s_waitcnt lgkmcnt(4)
    v_mfma_f32_16x16x32_bf16 v[48:51], v[16:19], v[144:147], v[48:51]
    ds_read_b64_tr_b16 v[28:29], v111 offset:20480
    v_rcp_f32 v12, v12
    v_mfma_f32_16x16x32_bf16 v[52:55], v[16:19], v[148:151], v[52:55]
    ds_read_b64_tr_b16 v[30:31], v110 offset:20480
    v_rcp_f32 v13, v13
    s_add_u32 m0, s39, 0x2000
    s_add_u32 s58, s44, 0x12100
    buffer_load_dwordx4 v5, s[16:19], s58 offen lds
    s_waitcnt lgkmcnt(4)
    v_mfma_f32_16x16x32_bf16 v[56:59], v[20:23], v[144:147], v[56:59]
    ds_read_b64_tr_b16 v[16:17], v10 offset:24576
    v_rcp_f32 v14, v14
    v_mul_f32 v32, v32, v11
    v_mfma_f32_16x16x32_bf16 v[60:63], v[20:23], v[148:151], v[60:63]
    ds_read_b64_tr_b16 v[18:19], v109 offset:24576
    v_mul_f32 v33, v33, v12
    v_mul_f32 v34, v34, v13
    v_mul_f32 v35, v35, v14
    s_waitcnt lgkmcnt(4)
    v_mfma_f32_16x16x32_bf16 v[48:51], v[24:27], v[152:155], v[48:51]
    ds_read_b64_tr_b16 v[20:21], v111 offset:24576
    v_cvt_pk_bf16_f32 v96, v32, v33
    v_cvt_pk_bf16_f32 v97, v34, v35
    v_mul_f32 v11, s53, v36
    v_mfma_f32_16x16x32_bf16 v[52:55], v[24:27], v[156:159], v[52:55]
    ds_read_b64_tr_b16 v[22:23], v110 offset:24576
    v_mul_f32 v12, s53, v37
    v_mul_f32 v13, s53, v38
    v_mul_f32 v14, s53, v39
    s_add_u32 m0, s39, 0x4000
    s_add_u32 s59, s46, 0x12100
    buffer_load_dwordx4 v5, s[16:19], s59 offen lds
    s_waitcnt lgkmcnt(4)
    v_mfma_f32_16x16x32_bf16 v[56:59], v[28:31], v[152:155], v[56:59]
    ds_read_b64_tr_b16 v[24:25], v10 offset:28672
    v_exp_f32 v11, v11
    v_mfma_f32_16x16x32_bf16 v[60:63], v[28:31], v[156:159], v[60:63]
    ds_read_b64_tr_b16 v[26:27], v109 offset:28672
    v_exp_f32 v12, v12
    s_setprio 1
    s_waitcnt lgkmcnt(4)
    v_mfma_f32_16x16x32_bf16 v[48:51], v[16:19], v[128:131], v[48:51]
    ds_read_b64_tr_b16 v[28:29], v111 offset:28672
    v_exp_f32 v13, v13
    v_mfma_f32_16x16x32_bf16 v[52:55], v[16:19], v[132:135], v[52:55]
    ds_read_b64_tr_b16 v[30:31], v110 offset:28672
    v_exp_f32 v14, v14
    v_mul_f32 v36, v36, v44
    s_add_u32 m0, s39, 0x6000
    s_add_u32 s60, s44, 0x24000
    buffer_load_dwordx4 v5, s[16:19], s60 offen lds
    s_waitcnt lgkmcnt(4)
    v_mfma_f32_16x16x32_bf16 v[56:59], v[20:23], v[128:131], v[56:59]
    ds_read_b64_tr_b16 v[16:17], v10 offset:32768
    v_mul_f32 v37, v37, v45
    v_mul_f32 v38, v38, v46
    v_mul_f32 v39, v39, v47
    v_mfma_f32_16x16x32_bf16 v[60:63], v[20:23], v[132:135], v[60:63]
    ds_read_b64_tr_b16 v[18:19], v109 offset:32768
    v_add_f32 v11, 1.0, v11
    v_add_f32 v12, 1.0, v12
    v_add_f32 v13, 1.0, v13
    s_waitcnt lgkmcnt(4)
    v_mfma_f32_16x16x32_bf16 v[48:51], v[24:27], v[136:139], v[48:51]
    ds_read_b64_tr_b16 v[20:21], v111 offset:32768
    v_add_f32 v14, 1.0, v14
    v_rcp_f32 v11, v11
    v_mfma_f32_16x16x32_bf16 v[52:55], v[24:27], v[140:143], v[52:55]
    ds_read_b64_tr_b16 v[22:23], v110 offset:32768
    v_rcp_f32 v12, v12
    s_add_u32 m0, s39, 0x8000
    s_add_u32 s61, s46, 0x24000
    buffer_load_dwordx4 v5, s[16:19], s61 offen lds
    s_waitcnt lgkmcnt(4)
    v_mfma_f32_16x16x32_bf16 v[56:59], v[28:31], v[136:139], v[56:59]
    ds_read_b64_tr_b16 v[24:25], v10 offset:36864
    v_rcp_f32 v13, v13
    v_mfma_f32_16x16x32_bf16 v[60:63], v[28:31], v[140:143], v[60:63]
    ds_read_b64_tr_b16 v[26:27], v109 offset:36864
    v_rcp_f32 v14, v14
    v_mul_f32 v36, v36, v11
    s_setprio 0
    s_waitcnt lgkmcnt(4)
    v_mfma_f32_16x16x32_bf16 v[48:51], v[16:19], v[160:163], v[48:51]
    ds_read_b64_tr_b16 v[28:29], v111 offset:36864
    v_mul_f32 v37, v37, v12
    v_mul_f32 v38, v38, v13
    v_mul_f32 v39, v39, v14
    v_mfma_f32_16x16x32_bf16 v[52:55], v[16:19], v[164:167], v[52:55]
    ds_read_b64_tr_b16 v[30:31], v110 offset:36864
    v_cvt_pk_bf16_f32 v98, v36, v37
    v_cvt_pk_bf16_f32 v99, v38, v39
    s_add_u32 s62, s20, 65536
    buffer_store_dwordx4 v[96:99], v4, s[12:15], s62 offen sc1
    s_add_u32 m0, s39, 0xa000
    s_add_u32 s63, s44, 0x24080
    buffer_load_dwordx4 v5, s[16:19], s63 offen lds
    s_waitcnt lgkmcnt(4)
    v_mfma_f32_16x16x32_bf16 v[56:59], v[20:23], v[160:163], v[56:59]
    ds_read_b64_tr_b16 v[16:17], v10 offset:57344
    v_mfma_f32_16x16x32_bf16 v[60:63], v[20:23], v[164:167], v[60:63]
    ds_read_b64_tr_b16 v[18:19], v109 offset:57344
    s_waitcnt lgkmcnt(4)
    v_mfma_f32_16x16x32_bf16 v[48:51], v[24:27], v[168:171], v[48:51]
    ds_read_b64_tr_b16 v[20:21], v111 offset:57344
    v_mfma_f32_16x16x32_bf16 v[52:55], v[24:27], v[172:175], v[52:55]
    ds_read_b64_tr_b16 v[22:23], v110 offset:57344
    s_add_u32 m0, s39, 0xc000
    s_add_u32 s56, s46, 0x24080
    buffer_load_dwordx4 v5, s[16:19], s56 offen lds
    s_waitcnt lgkmcnt(4)
    v_mfma_f32_16x16x32_bf16 v[56:59], v[28:31], v[168:171], v[56:59]
    ds_read_b64_tr_b16 v[24:25], v10 offset:61440
    v_mfma_f32_16x16x32_bf16 v[60:63], v[28:31], v[172:175], v[60:63]
    ds_read_b64_tr_b16 v[26:27], v109 offset:61440
    s_setprio 3
    s_waitcnt vmcnt(8)
    s_barrier
    ds_read_b64 v[216:217], v15 offset:40960
    ds_read_b64 v[218:219], v107 offset:40960
    ds_read_b64 v[220:221], v15 offset:40968
    ds_read_b64 v[222:223], v107 offset:40968
    ds_read_b64 v[224:225], v15 offset:49152
    ds_read_b64 v[226:227], v107 offset:49152
    ds_read_b64 v[228:229], v15 offset:49160
    ds_read_b64 v[230:231], v107 offset:49160
    s_waitcnt lgkmcnt(12)
    v_mfma_f32_16x16x32_bf16 v[64:67], v[16:19], v[112:115], 0
    ds_read_b64_tr_b16 v[28:29], v111 offset:61440
    v_mfma_f32_16x16x32_bf16 v[68:71], v[16:19], v[116:119], 0
    ds_read_b64_tr_b16 v[30:31], v110 offset:61440
    s_add_u32 m0, s39, 0x14000
    s_add_u32 s57, s44, 0x24100
    buffer_load_dwordx4 v5, s[16:19], s57 offen lds
    s_waitcnt lgkmcnt(12)
    v_mfma_f32_16x16x32_bf16 v[72:75], v[20:23], v[112:115], 0
    v_add_u32 v10, 0x10000, v10
    ds_read_b64_tr_b16 v[16:17], v10 offset:0
    v_mfma_f32_16x16x32_bf16 v[76:79], v[20:23], v[116:119], 0
    v_add_u32 v109, 0x10000, v109
    ds_read_b64_tr_b16 v[18:19], v109 offset:0
    s_waitcnt lgkmcnt(12)
    v_mfma_f32_16x16x32_bf16 v[64:67], v[24:27], v[120:123], v[64:67]
    v_add_u32 v111, 0x10000, v111
    ds_read_b64_tr_b16 v[20:21], v111 offset:0
    v_mfma_f32_16x16x32_bf16 v[68:71], v[24:27], v[124:127], v[68:71]
    v_add_u32 v110, 0x10000, v110
    ds_read_b64_tr_b16 v[22:23], v110 offset:0
    s_add_u32 m0, s39, 0x16000
    s_add_u32 s58, s46, 0x24100
    buffer_load_dwordx4 v5, s[16:19], s58 offen lds
    s_waitcnt lgkmcnt(4)
    v_mfma_f32_16x16x32_bf16 v[72:75], v[28:31], v[120:123], v[72:75]
    ds_read_b64_tr_b16 v[24:25], v10 offset:4096
    v_mfma_f32_16x16x32_bf16 v[76:79], v[28:31], v[124:127], v[76:79]
    ds_read_b64_tr_b16 v[26:27], v109 offset:4096
    s_setprio 2
    s_waitcnt lgkmcnt(4)
    v_mfma_f32_16x16x32_bf16 v[64:67], v[16:19], v[144:147], v[64:67]
    ds_read_b64_tr_b16 v[28:29], v111 offset:4096
    v_mfma_f32_16x16x32_bf16 v[68:71], v[16:19], v[148:151], v[68:71]
    ds_read_b64_tr_b16 v[30:31], v110 offset:4096
    s_add_u32 m0, s39, 0x18000
    s_add_u32 s59, s40, 0x0
    buffer_load_dwordx4 v108, s[16:19], s59 offen lds
    s_waitcnt lgkmcnt(4)
    v_mfma_f32_16x16x32_bf16 v[72:75], v[20:23], v[144:147], v[72:75]
    ds_read_b64_tr_b16 v[16:17], v10 offset:8192
    v_mfma_f32_16x16x32_bf16 v[76:79], v[20:23], v[148:151], v[76:79]
    ds_read_b64_tr_b16 v[18:19], v109 offset:8192
    s_waitcnt lgkmcnt(4)
    v_mfma_f32_16x16x32_bf16 v[64:67], v[24:27], v[152:155], v[64:67]
    ds_read_b64_tr_b16 v[20:21], v111 offset:8192
    v_mfma_f32_16x16x32_bf16 v[68:71], v[24:27], v[156:159], v[68:71]
    ds_read_b64_tr_b16 v[22:23], v110 offset:8192
    s_waitcnt lgkmcnt(4)
    v_mfma_f32_16x16x32_bf16 v[72:75], v[28:31], v[152:155], v[72:75]
    ds_read_b64_tr_b16 v[24:25], v10 offset:12288
    v_mfma_f32_16x16x32_bf16 v[76:79], v[28:31], v[156:159], v[76:79]
    ds_read_b64_tr_b16 v[26:27], v109 offset:12288
    s_setprio 1
    s_waitcnt lgkmcnt(4)
    v_mfma_f32_16x16x32_bf16 v[64:67], v[16:19], v[128:131], v[64:67]
    ds_read_b64_tr_b16 v[28:29], v111 offset:12288
    v_mfma_f32_16x16x32_bf16 v[68:71], v[16:19], v[132:135], v[68:71]
    ds_read_b64_tr_b16 v[30:31], v110 offset:12288
    s_waitcnt lgkmcnt(4)
    v_mfma_f32_16x16x32_bf16 v[72:75], v[20:23], v[128:131], v[72:75]
    ds_read_b64_tr_b16 v[16:17], v10 offset:16384
    v_mfma_f32_16x16x32_bf16 v[76:79], v[20:23], v[132:135], v[76:79]
    ds_read_b64_tr_b16 v[18:19], v109 offset:16384
    s_waitcnt lgkmcnt(4)
    v_mfma_f32_16x16x32_bf16 v[64:67], v[24:27], v[136:139], v[64:67]
    ds_read_b64_tr_b16 v[20:21], v111 offset:16384
    v_mfma_f32_16x16x32_bf16 v[68:71], v[24:27], v[140:143], v[68:71]
    ds_read_b64_tr_b16 v[22:23], v110 offset:16384
    s_waitcnt lgkmcnt(4)
    v_mfma_f32_16x16x32_bf16 v[72:75], v[28:31], v[136:139], v[72:75]
    ds_read_b64_tr_b16 v[24:25], v10 offset:20480
    v_mfma_f32_16x16x32_bf16 v[76:79], v[28:31], v[140:143], v[76:79]
    ds_read_b64_tr_b16 v[26:27], v109 offset:20480
    s_setprio 0
    s_waitcnt lgkmcnt(4)
    v_mfma_f32_16x16x32_bf16 v[64:67], v[16:19], v[160:163], v[64:67]
    ds_read_b64_tr_b16 v[28:29], v111 offset:20480
    v_mfma_f32_16x16x32_bf16 v[68:71], v[16:19], v[164:167], v[68:71]
    ds_read_b64_tr_b16 v[30:31], v110 offset:20480
    s_waitcnt lgkmcnt(4)
    v_mfma_f32_16x16x32_bf16 v[72:75], v[20:23], v[160:163], v[72:75]
    ds_read_b64_tr_b16 v[16:17], v10 offset:24576
    v_mfma_f32_16x16x32_bf16 v[76:79], v[20:23], v[164:167], v[76:79]
    ds_read_b64_tr_b16 v[18:19], v109 offset:24576
    s_waitcnt lgkmcnt(4)
    v_mfma_f32_16x16x32_bf16 v[64:67], v[24:27], v[168:171], v[64:67]
    ds_read_b64_tr_b16 v[20:21], v111 offset:24576
    v_mfma_f32_16x16x32_bf16 v[68:71], v[24:27], v[172:175], v[68:71]
    ds_read_b64_tr_b16 v[22:23], v110 offset:24576
    s_waitcnt lgkmcnt(4)
    v_mfma_f32_16x16x32_bf16 v[72:75], v[28:31], v[168:171], v[72:75]
    ds_read_b64_tr_b16 v[24:25], v10 offset:28672
    v_mfma_f32_16x16x32_bf16 v[76:79], v[28:31], v[172:175], v[76:79]
    ds_read_b64_tr_b16 v[26:27], v109 offset:28672
    s_setprio 3
    s_waitcnt vmcnt(5)
    s_barrier
    s_cmp_lg_u32 s32, 0
    s_cbranch_scc1 L_sig_63
    s_lshl_b32 s50, s38, 5
    s_add_u32 s50, s50, 57344
    s_mov_b32 s51, 1
    s_atomic_add s51, s[76:77], s50
L_sig_63:
    s_waitcnt lgkmcnt(4)
    v_mfma_f32_16x16x32_bf16 v[80:83], v[16:19], v[112:115], 0
    ds_read_b64_tr_b16 v[28:29], v111 offset:28672
    v_mfma_f32_16x16x32_bf16 v[84:87], v[16:19], v[116:119], 0
    ds_read_b64_tr_b16 v[30:31], v110 offset:28672
    s_add_u32 m0, s39, 0xe000
    s_add_u32 s60, s20, 0xc000
    buffer_load_dwordx4 v4, s[12:15], s60 offen sc1 lds
    s_waitcnt lgkmcnt(4)
    v_mfma_f32_16x16x32_bf16 v[88:91], v[20:23], v[112:115], 0
    v_subrev_u32 v10, 0x20000, v10
    ds_read_b64_tr_b16 v[16:17], v10 offset:0
    v_mfma_f32_16x16x32_bf16 v[92:95], v[20:23], v[116:119], 0
    v_subrev_u32 v109, 0x20000, v109
    ds_read_b64_tr_b16 v[18:19], v109 offset:0
    s_waitcnt lgkmcnt(4)
    v_mfma_f32_16x16x32_bf16 v[80:83], v[24:27], v[120:123], v[80:83]
    v_subrev_u32 v111, 0x20000, v111
    ds_read_b64_tr_b16 v[20:21], v111 offset:0
    v_mfma_f32_16x16x32_bf16 v[84:87], v[24:27], v[124:127], v[84:87]
    v_subrev_u32 v110, 0x20000, v110
    ds_read_b64_tr_b16 v[22:23], v110 offset:0
    s_add_u32 m0, s39, 0x10000
    s_add_u32 s61, s20, 0xe000
    buffer_load_dwordx4 v4, s[12:15], s61 offen sc1 lds
    s_waitcnt lgkmcnt(4)
    v_mfma_f32_16x16x32_bf16 v[88:91], v[28:31], v[120:123], v[88:91]
    ds_read_b64_tr_b16 v[24:25], v10 offset:4096
    v_mfma_f32_16x16x32_bf16 v[92:95], v[28:31], v[124:127], v[92:95]
    ds_read_b64_tr_b16 v[26:27], v109 offset:4096
    s_setprio 2
    s_waitcnt lgkmcnt(4)
    v_mfma_f32_16x16x32_bf16 v[80:83], v[16:19], v[144:147], v[80:83]
    ds_read_b64_tr_b16 v[28:29], v111 offset:4096
    v_mfma_f32_16x16x32_bf16 v[84:87], v[16:19], v[148:151], v[84:87]
    ds_read_b64_tr_b16 v[30:31], v110 offset:4096
    s_add_u32 m0, s39, 0x12000
    s_add_u32 s62, s20, 0x10000
    buffer_load_dwordx4 v4, s[12:15], s62 offen sc1 lds
    s_waitcnt lgkmcnt(4)
    v_mfma_f32_16x16x32_bf16 v[88:91], v[20:23], v[144:147], v[88:91]
    ds_read_b64_tr_b16 v[16:17], v10 offset:8192
    v_mfma_f32_16x16x32_bf16 v[92:95], v[20:23], v[148:151], v[92:95]
    ds_read_b64_tr_b16 v[18:19], v109 offset:8192
    s_waitcnt lgkmcnt(4)
    v_mfma_f32_16x16x32_bf16 v[80:83], v[24:27], v[152:155], v[80:83]
    ds_read_b64_tr_b16 v[20:21], v111 offset:8192
    v_mfma_f32_16x16x32_bf16 v[84:87], v[24:27], v[156:159], v[84:87]
    ds_read_b64_tr_b16 v[22:23], v110 offset:8192
    s_add_u32 m0, s39, 0x1a000
    s_add_u32 s63, s41, 0x0
    buffer_load_dwordx4 v108, s[16:19], s63 offen lds
    s_waitcnt lgkmcnt(4)
    v_mfma_f32_16x16x32_bf16 v[88:91], v[28:31], v[152:155], v[88:91]
    ds_read_b64_tr_b16 v[24:25], v10 offset:12288
    v_mfma_f32_16x16x32_bf16 v[92:95], v[28:31], v[156:159], v[92:95]
    ds_read_b64_tr_b16 v[26:27], v109 offset:12288
    s_setprio 1
    s_waitcnt lgkmcnt(4)
    v_mfma_f32_16x16x32_bf16 v[80:83], v[16:19], v[128:131], v[80:83]
    ds_read_b64_tr_b16 v[28:29], v111 offset:12288
    v_mfma_f32_16x16x32_bf16 v[84:87], v[16:19], v[132:135], v[84:87]
    ds_read_b64_tr_b16 v[30:31], v110 offset:12288
    s_add_u32 m0, s39, 0x1c000
    s_add_u32 s56, s44, 0x36000
    buffer_load_dwordx4 v5, s[16:19], s56 offen lds
    s_waitcnt lgkmcnt(4)
    v_mfma_f32_16x16x32_bf16 v[88:91], v[20:23], v[128:131], v[88:91]
    ds_read_b64_tr_b16 v[16:17], v10 offset:16384
    v_mfma_f32_16x16x32_bf16 v[92:95], v[20:23], v[132:135], v[92:95]
    ds_read_b64_tr_b16 v[18:19], v109 offset:16384
    s_waitcnt lgkmcnt(4)
    v_mfma_f32_16x16x32_bf16 v[80:83], v[24:27], v[136:139], v[80:83]
    ds_read_b64_tr_b16 v[20:21], v111 offset:16384
    v_mfma_f32_16x16x32_bf16 v[84:87], v[24:27], v[140:143], v[84:87]
    ds_read_b64_tr_b16 v[22:23], v110 offset:16384
    s_add_u32 m0, s39, 0x1e000
    s_add_u32 s57, s44, 0x36080
    buffer_load_dwordx4 v5, s[16:19], s57 offen lds
    s_waitcnt lgkmcnt(4)
    v_mfma_f32_16x16x32_bf16 v[88:91], v[28:31], v[136:139], v[88:91]
    ds_read_b64_tr_b16 v[24:25], v10 offset:20480
    v_mfma_f32_16x16x32_bf16 v[92:95], v[28:31], v[140:143], v[92:95]
    ds_read_b64_tr_b16 v[26:27], v109 offset:20480
    s_setprio 0
    s_waitcnt lgkmcnt(4)
    v_mfma_f32_16x16x32_bf16 v[80:83], v[16:19], v[160:163], v[80:83]
    ds_read_b64_tr_b16 v[28:29], v111 offset:20480
    v_mfma_f32_16x16x32_bf16 v[84:87], v[16:19], v[164:167], v[84:87]
    ds_read_b64_tr_b16 v[30:31], v110 offset:20480
    s_add_u32 m0, s39, 0x20000
    s_add_u32 s58, s44, 0x36100
    buffer_load_dwordx4 v5, s[16:19], s58 offen lds
    s_waitcnt lgkmcnt(4)
    v_mfma_f32_16x16x32_bf16 v[88:91], v[20:23], v[160:163], v[88:91]
    ds_read_b64_tr_b16 v[16:17], v10 offset:24576
    v_mfma_f32_16x16x32_bf16 v[92:95], v[20:23], v[164:167], v[92:95]
    ds_read_b64_tr_b16 v[18:19], v109 offset:24576
    s_waitcnt lgkmcnt(4)
    v_mfma_f32_16x16x32_bf16 v[80:83], v[24:27], v[168:171], v[80:83]
    ds_read_b64_tr_b16 v[20:21], v111 offset:24576
    v_mfma_f32_16x16x32_bf16 v[84:87], v[24:27], v[172:175], v[84:87]
    ds_read_b64_tr_b16 v[22:23], v110 offset:24576
    s_add_u32 m0, s39, 0x22000
    s_add_u32 s59, s44, 0x180
    buffer_load_dwordx4 v5, s[16:19], s59 offen lds
    s_waitcnt lgkmcnt(4)
    v_mfma_f32_16x16x32_bf16 v[88:91], v[28:31], v[168:171], v[88:91]
    ds_read_b64_tr_b16 v[24:25], v10 offset:28672
    v_mfma_f32_16x16x32_bf16 v[92:95], v[28:31], v[172:175], v[92:95]
    ds_read_b64_tr_b16 v[26:27], v109 offset:28672
    s_setprio 3
    s_waitcnt vmcnt(10)
    s_barrier
    s_cmp_lg_u32 s32, 0
    s_cbranch_scc1 L_pi_64
    s_xor_b32 s6, s38, 1
    s_lshl_b32 s6, s6, 5
    s_add_u32 s6, s6, 57344
    s_mov_b32 s7, 0
    s_atomic_add s7, s[76:77], s6 glc
L_pi_64:
    s_waitcnt lgkmcnt(4)
    v_mfma_f32_16x16x32_bf16 v[48:51], v[16:19], v[176:179], v[48:51]
    ds_read_b64_tr_b16 v[28:29], v111 offset:28672
    v_mfma_f32_16x16x32_bf16 v[52:55], v[16:19], v[180:183], v[52:55]
    ds_read_b64_tr_b16 v[30:31], v110 offset:28672
    s_add_u32 m0, s39, 0x2000
    s_add_u32 s60, s44, 0x12180
    buffer_load_dwordx4 v5, s[16:19], s60 offen lds
    s_waitcnt lgkmcnt(4)
    v_mfma_f32_16x16x32_bf16 v[56:59], v[20:23], v[176:179], v[56:59]
    ds_read_b64_tr_b16 v[16:17], v10 offset:32768
    v_mfma_f32_16x16x32_bf16 v[60:63], v[20:23], v[180:183], v[60:63]
    ds_read_b64_tr_b16 v[18:19], v109 offset:32768
    s_waitcnt lgkmcnt(4)
    v_mfma_f32_16x16x32_bf16 v[48:51], v[24:27], v[184:187], v[48:51]
    ds_read_b64_tr_b16 v[20:21], v111 offset:32768
    v_mfma_f32_16x16x32_bf16 v[52:55], v[24:27], v[188:191], v[52:55]
    ds_read_b64_tr_b16 v[22:23], v110 offset:32768
    s_add_u32 m0, s39, 0x4000
    s_add_u32 s61, s46, 0x36000
    buffer_load_dwordx4 v5, s[16:19], s61 offen lds
    s_waitcnt lgkmcnt(4)
    v_mfma_f32_16x16x32_bf16 v[56:59], v[28:31], v[184:187], v[56:59]
    ds_read_b64_tr_b16 v[24:25], v10 offset:36864
    v_mfma_f32_16x16x32_bf16 v[60:63], v[28:31], v[188:191], v[60:63]
    ds_read_b64_tr_b16 v[26:27], v109 offset:36864
    s_setprio 2
    s_waitcnt lgkmcnt(4)
    v_mfma_f32_16x16x32_bf16 v[48:51], v[16:19], v[216:219], v[48:51]
    ds_read_b64_tr_b16 v[28:29], v111 offset:36864
    v_mfma_f32_16x16x32_bf16 v[52:55], v[16:19], v[220:223], v[52:55]
    ds_read_b64_tr_b16 v[30:31], v110 offset:36864
    s_waitcnt lgkmcnt(4)
    v_mfma_f32_16x16x32_bf16 v[56:59], v[20:23], v[216:219], v[56:59]
    ds_read_b64_tr_b16 v[16:17], v10 offset:40960
    v_mfma_f32_16x16x32_bf16 v[60:63], v[20:23], v[220:223], v[60:63]
    ds_read_b64_tr_b16 v[18:19], v109 offset:40960
    s_waitcnt lgkmcnt(4)
    v_mfma_f32_16x16x32_bf16 v[48:51], v[24:27], v[224:227], v[48:51]
    ds_read_b64_tr_b16 v[20:21], v111 offset:40960
    v_mfma_f32_16x16x32_bf16 v[52:55], v[24:27], v[228:231], v[52:55]
    ds_read_b64_tr_b16 v[22:23], v110 offset:40960
    s_waitcnt lgkmcnt(4)
    v_mfma_f32_16x16x32_bf16 v[56:59], v[28:31], v[224:227], v[56:59]
    ds_read_b64_tr_b16 v[24:25], v10 offset:45056
    v_mfma_f32_16x16x32_bf16 v[60:63], v[28:31], v[228:231], v[60:63]
    ds_read_b64_tr_b16 v[26:27], v109 offset:45056
    s_setprio 1
    s_waitcnt lgkmcnt(4)
    v_mfma_f32_16x16x32_bf16 v[64:67], v[16:19], v[176:179], v[64:67]
    ds_read_b64_tr_b16 v[28:29], v111 offset:45056
    v_mfma_f32_16x16x32_bf16 v[68:71], v[16:19], v[180:183], v[68:71]
    ds_read_b64_tr_b16 v[30:31], v110 offset:45056
    s_waitcnt lgkmcnt(4)
    v_mfma_f32_16x16x32_bf16 v[72:75], v[20:23], v[176:179], v[72:75]
    ds_read_b64_tr_b16 v[16:17], v10 offset:49152
    v_mfma_f32_16x16x32_bf16 v[76:79], v[20:23], v[180:183], v[76:79]
    ds_read_b64_tr_b16 v[18:19], v109 offset:49152
    s_waitcnt lgkmcnt(4)
    v_mfma_f32_16x16x32_bf16 v[64:67], v[24:27], v[184:187], v[64:67]
    ds_read_b64_tr_b16 v[20:21], v111 offset:49152
    v_mfma_f32_16x16x32_bf16 v[68:71], v[24:27], v[188:191], v[68:71]
    ds_read_b64_tr_b16 v[22:23], v110 offset:49152
    s_waitcnt lgkmcnt(4)
    v_mfma_f32_16x16x32_bf16 v[72:75], v[28:31], v[184:187], v[72:75]
    ds_read_b64_tr_b16 v[24:25], v10 offset:53248
    v_mfma_f32_16x16x32_bf16 v[76:79], v[28:31], v[188:191], v[76:79]
    ds_read_b64_tr_b16 v[26:27], v109 offset:53248
    s_setprio 0
    s_waitcnt lgkmcnt(4)
    v_mfma_f32_16x16x32_bf16 v[64:67], v[16:19], v[216:219], v[64:67]
    ds_read_b64_tr_b16 v[28:29], v111 offset:53248
    v_mfma_f32_16x16x32_bf16 v[68:71], v[16:19], v[220:223], v[68:71]
    ds_read_b64_tr_b16 v[30:31], v110 offset:53248
    s_waitcnt lgkmcnt(4)
    v_mfma_f32_16x16x32_bf16 v[72:75], v[20:23], v[216:219], v[72:75]
    v_add_u32 v10, 0x10000, v10
    ds_read_b64_tr_b16 v[16:17], v10 offset:16384
    v_mfma_f32_16x16x32_bf16 v[76:79], v[20:23], v[220:223], v[76:79]
    v_add_u32 v109, 0x10000, v109
    ds_read_b64_tr_b16 v[18:19], v109 offset:16384
    s_waitcnt lgkmcnt(4)
    v_mfma_f32_16x16x32_bf16 v[64:67], v[24:27], v[224:227], v[64:67]
    v_add_u32 v111, 0x10000, v111
    ds_read_b64_tr_b16 v[20:21], v111 offset:16384
    v_mfma_f32_16x16x32_bf16 v[68:71], v[24:27], v[228:231], v[68:71]
    v_add_u32 v110, 0x10000, v110
    ds_read_b64_tr_b16 v[22:23], v110 offset:16384
    s_waitcnt lgkmcnt(4)
    v_mfma_f32_16x16x32_bf16 v[72:75], v[28:31], v[224:227], v[72:75]
    ds_read_b64_tr_b16 v[24:25], v10 offset:20480
    v_mfma_f32_16x16x32_bf16 v[76:79], v[28:31], v[228:231], v[76:79]
    ds_read_b64_tr_b16 v[26:27], v109 offset:20480
    s_setprio 3
    s_cmp_lg_u32 s32, 0
    s_cbranch_scc1 L_pc_65
    s_mov_b32 s50, 0
L_pcl_66:
    s_waitcnt lgkmcnt(0)
    s_cmp_ge_u32 s7, 3
    s_cbranch_scc1 L_pc_65
    s_add_u32 s50, s50, 1
    s_cmp_ge_u32 s50, 20000
    s_cbranch_scc1 L_pc_65
    s_mov_b32 s7, 0
    s_atomic_add s7, s[76:77], s6 glc
    s_branch L_pcl_66
L_pc_65:
    s_waitcnt vmcnt(5)
    s_barrier
    v_subrev_u32 v15, 0x10000, v15
    ds_read_b64 v[192:193], v15 offset:57344
    v_subrev_u32 v107, 0x10000, v107
    ds_read_b64 v[194:195], v107 offset:57344
    ds_read_b64 v[196:197], v15 offset:57352
    ds_read_b64 v[198:199], v107 offset:57352
    v_add_u32 v15, 0x10000, v15
    ds_read_b64 v[200:201], v15 offset:0
    v_add_u32 v107, 0x10000, v107
    ds_read_b64 v[202:203], v107 offset:0
    ds_read_b64 v[204:205], v15 offset:8
    ds_read_b64 v[206:207], v107 offset:8
    ds_read_b64 v[208:209], v15 offset:8192
    ds_read_b64 v[210:211], v107 offset:8192
    ds_read_b64 v[212:213], v15 offset:8200
    ds_read_b64 v[214:215], v107 offset:8200
    s_waitcnt lgkmcnt(15)
    v_mfma_f32_16x16x32_bf16 v[80:83], v[16:19], v[176:179], v[80:83]
    ds_read_b64_tr_b16 v[28:29], v111 offset:20480
    v_mfma_f32_16x16x32_bf16 v[84:87], v[16:19], v[180:183], v[84:87]
    ds_read_b64_tr_b16 v[30:31], v110 offset:20480
    s_add_u32 m0, s39, 0x24000
    s_add_u32 s62, s21, 0xc000
    buffer_load_dwordx4 v4, s[12:15], s62 offen sc1 lds
    s_waitcnt lgkmcnt(15)
    v_mfma_f32_16x16x32_bf16 v[88:91], v[20:23], v[176:179], v[88:91]
    ds_read_b64_tr_b16 v[16:17], v10 offset:24576
    v_mfma_f32_16x16x32_bf16 v[92:95], v[20:23], v[180:183], v[92:95]
    ds_read_b64_tr_b16 v[18:19], v109 offset:24576
    s_waitcnt lgkmcnt(15)
    v_mfma_f32_16x16x32_bf16 v[80:83], v[24:27], v[184:187], v[80:83]
    ds_read_b64_tr_b16 v[20:21], v111 offset:24576
    v_mfma_f32_16x16x32_bf16 v[84:87], v[24:27], v[188:191], v[84:87]
    ds_read_b64_tr_b16 v[22:23], v110 offset:24576
    s_add_u32 m0, s39, 0x26000
    s_add_u32 s63, s21, 0xe000
    buffer_load_dwordx4 v4, s[12:15], s63 offen sc1 lds
    s_waitcnt lgkmcnt(4)
    v_mfma_f32_16x16x32_bf16 v[88:91], v[28:31], v[184:187], v[88:91]
    ds_read_b64_tr_b16 v[24:25], v10 offset:28672
    v_mfma_f32_16x16x32_bf16 v[92:95], v[28:31], v[188:191], v[92:95]
    ds_read_b64_tr_b16 v[26:27], v109 offset:28672
    s_setprio 2
    s_waitcnt lgkmcnt(4)
    v_mfma_f32_16x16x32_bf16 v[80:83], v[16:19], v[216:219], v[80:83]
    ds_read_b64_tr_b16 v[28:29], v111 offset:28672
    v_mfma_f32_16x16x32_bf16 v[84:87], v[16:19], v[220:223], v[84:87]
    ds_read_b64_tr_b16 v[30:31], v110 offset:28672
    s_add_u32 m0, s39, 0x0
    s_add_u32 s56, s21, 0x10000
    buffer_load_dwordx4 v4, s[12:15], s56 offen sc1 lds
    s_waitcnt lgkmcnt(4)
    v_mfma_f32_16x16x32_bf16 v[88:91], v[20:23], v[216:219], v[88:91]
    v_add_u32 v104, 0x10000, v104
    ds_read_b64_tr_b16 v[16:17], v104 offset:32768
    v_mfma_f32_16x16x32_bf16 v[92:95], v[20:23], v[220:223], v[92:95]
    v_add_u32 v105, 0x10000, v105
    ds_read_b64_tr_b16 v[18:19], v105 offset:32768
    s_waitcnt lgkmcnt(4)
    v_mfma_f32_16x16x32_bf16 v[80:83], v[24:27], v[224:227], v[80:83]
    ds_read_b64_tr_b16 v[20:21], v104 offset:34816
    v_mfma_f32_16x16x32_bf16 v[84:87], v[24:27], v[228:231], v[84:87]
    ds_read_b64_tr_b16 v[22:23], v105 offset:34816
    s_add_u32 m0, s39, 0x6000
    s_add_u32 s57, s45, 0x0
    buffer_load_dwordx4 v5, s[16:19], s57 offen lds
    s_waitcnt lgkmcnt(4)
    v_mfma_f32_16x16x32_bf16 v[88:91], v[28:31], v[224:227], v[88:91]
    ds_read_b64_tr_b16 v[24:25], v104 offset:36864
    v_mfma_f32_16x16x32_bf16 v[92:95], v[28:31], v[228:231], v[92:95]
    ds_read_b64_tr_b16 v[26:27], v105 offset:36864
    s_setprio 1
    s_waitcnt lgkmcnt(4)
    v_mfma_f32_16x16x32_bf16 v[96:99], v[16:19], v[112:115], 0
    ds_read_b64_tr_b16 v[28:29], v104 offset:38912
    v_mfma_f32_16x16x32_bf16 v[100:103], v[16:19], v[116:119], 0
    ds_read_b64_tr_b16 v[30:31], v105 offset:38912
    s_add_u32 m0, s39, 0x8000
    s_add_u32 s58, s46, 0x36080
    buffer_load_dwordx4 v5, s[16:19], s58 offen lds
    s_waitcnt lgkmcnt(4)
    v_mfma_f32_16x16x32_bf16 v[96:99], v[20:23], v[120:123], v[96:99]
    ds_read_b64_tr_b16 v[16:17], v104 offset:40960
    v_mfma_f32_16x16x32_bf16 v[100:103], v[20:23], v[124:127], v[100:103]
    ds_read_b64_tr_b16 v[18:19], v105 offset:40960
    s_waitcnt lgkmcnt(4)
    v_mfma_f32_16x16x32_bf16 v[96:99], v[24:27], v[128:131], v[96:99]
    ds_read_b64_tr_b16 v[20:21], v104 offset:43008
    v_mfma_f32_16x16x32_bf16 v[100:103], v[24:27], v[132:135], v[100:103]
    ds_read_b64_tr_b16 v[22:23], v105 offset:43008
    s_add_u32 m0, s39, 0xa000
    s_add_u32 s59, s45, 0x80
    buffer_load_dwordx4 v5, s[16:19], s59 offen lds
    s_waitcnt lgkmcnt(4)
    v_mfma_f32_16x16x32_bf16 v[96:99], v[28:31], v[136:139], v[96:99]
    ds_read_b64_tr_b16 v[24:25], v104 offset:45056
    v_mfma_f32_16x16x32_bf16 v[100:103], v[28:31], v[140:143], v[100:103]
    ds_read_b64_tr_b16 v[26:27], v105 offset:45056
    s_setprio 0
    s_waitcnt lgkmcnt(4)
    v_mfma_f32_16x16x32_bf16 v[96:99], v[16:19], v[144:147], v[96:99]
    ds_read_b64_tr_b16 v[28:29], v104 offset:47104
    v_mfma_f32_16x16x32_bf16 v[100:103], v[16:19], v[148:151], v[100:103]
    ds_read_b64_tr_b16 v[30:31], v105 offset:47104
    s_add_u32 m0, s39, 0xc000
    s_add_u32 s60, s46, 0x36100
    buffer_load_dwordx4 v5, s[16:19], s60 offen lds
    s_waitcnt lgkmcnt(4)
    v_mfma_f32_16x16x32_bf16 v[96:99], v[20:23], v[152:155], v[96:99]
    ds_read_b64_tr_b16 v[16:17], v10 offset:49152
    v_mfma_f32_16x16x32_bf16 v[100:103], v[20:23], v[156:159], v[100:103]
    ds_read_b64_tr_b16 v[18:19], v109 offset:49152
    s_waitcnt lgkmcnt(4)
    v_mfma_f32_16x16x32_bf16 v[96:99], v[24:27], v[160:163], v[96:99]
    ds_read_b64_tr_b16 v[20:21], v111 offset:49152
    v_mfma_f32_16x16x32_bf16 v[100:103], v[24:27], v[164:167], v[100:103]
    ds_read_b64_tr_b16 v[22:23], v110 offset:49152
    s_waitcnt lgkmcnt(4)
    v_mfma_f32_16x16x32_bf16 v[96:99], v[28:31], v[168:171], v[96:99]
    ds_read_b64_tr_b16 v[24:25], v10 offset:53248
    v_mfma_f32_16x16x32_bf16 v[100:103], v[28:31], v[172:175], v[100:103]
    ds_read_b64_tr_b16 v[26:27], v109 offset:53248
    s_setprio 3
    s_waitcnt vmcnt(8)
    s_barrier
    s_waitcnt lgkmcnt(4)
    v_mfma_f32_16x16x32_bf16 v[48:51], v[16:19], v[192:195], v[48:51]
    ds_read_b64_tr_b16 v[28:29], v111 offset:53248
    v_mfma_f32_16x16x32_bf16 v[52:55], v[16:19], v[196:199], v[52:55]
    ds_read_b64_tr_b16 v[30:31], v110 offset:53248
    s_add_u32 m0, s39, 0xe000
    s_add_u32 s61, s45, 0x100
    buffer_load_dwordx4 v5, s[16:19], s61 offen lds
    s_waitcnt lgkmcnt(4)
    v_mfma_f32_16x16x32_bf16 v[56:59], v[20:23], v[192:195], v[56:59]
    ds_read_b64_tr_b16 v[16:17], v10 offset:57344
    v_mfma_f32_16x16x32_bf16 v[60:63], v[20:23], v[196:199], v[60:63]
    ds_read_b64_tr_b16 v[18:19], v109 offset:57344
    s_waitcnt lgkmcnt(4)
    v_mfma_f32_16x16x32_bf16 v[48:51], v[24:27], v[200:203], v[48:51]
    ds_read_b64_tr_b16 v[20:21], v111 offset:57344
    v_mfma_f32_16x16x32_bf16 v[52:55], v[24:27], v[204:207], v[52:55]
    ds_read_b64_tr_b16 v[22:23], v110 offset:57344
    s_add_u32 m0, s39, 0x10000
    s_add_u32 s62, s40, 0x24000
    buffer_load_dwordx4 v108, s[16:19], s62 offen lds
    s_waitcnt lgkmcnt(4)
    v_mfma_f32_16x16x32_bf16 v[56:59], v[28:31], v[200:203], v[56:59]
    ds_read_b64_tr_b16 v[24:25], v10 offset:61440
    v_mfma_f32_16x16x32_bf16 v[60:63], v[28:31], v[204:207], v[60:63]
    ds_read_b64_tr_b16 v[26:27], v109 offset:61440
    s_setprio 2
    s_waitcnt lgkmcnt(4)
    v_mfma_f32_16x16x32_bf16 v[64:67], v[16:19], v[192:195], v[64:67]
    ds_read_b64_tr_b16 v[28:29], v111 offset:61440
    v_mfma_f32_16x16x32_bf16 v[68:71], v[16:19], v[196:199], v[68:71]
    ds_read_b64_tr_b16 v[30:31], v110 offset:61440
    s_add_u32 m0, s39, 0x12000
    s_add_u32 s63, s41, 0x24000
    buffer_load_dwordx4 v108, s[16:19], s63 offen lds
    s_waitcnt lgkmcnt(4)
    v_mfma_f32_16x16x32_bf16 v[72:75], v[20:23], v[192:195], v[72:75]
    v_add_u32 v10, 0x10000, v10
    ds_read_b64_tr_b16 v[16:17], v10 offset:0
    v_mfma_f32_16x16x32_bf16 v[76:79], v[20:23], v[196:199], v[76:79]
    v_add_u32 v109, 0x10000, v109
    ds_read_b64_tr_b16 v[18:19], v109 offset:0
    s_waitcnt lgkmcnt(4)
    v_mfma_f32_16x16x32_bf16 v[64:67], v[24:27], v[200:203], v[64:67]
    v_add_u32 v111, 0x10000, v111
    ds_read_b64_tr_b16 v[20:21], v111 offset:0
    v_mfma_f32_16x16x32_bf16 v[68:71], v[24:27], v[204:207], v[68:71]
    v_add_u32 v110, 0x10000, v110
    ds_read_b64_tr_b16 v[22:23], v110 offset:0
    s_add_u32 m0, s39, 0x14000
    s_add_u32 s56, s42, 0x0
    buffer_load_dwordx4 v108, s[16:19], s56 offen lds
    s_waitcnt lgkmcnt(4)
    v_mfma_f32_16x16x32_bf16 v[72:75], v[28:31], v[200:203], v[72:75]
    ds_read_b64_tr_b16 v[24:25], v10 offset:4096
    v_mfma_f32_16x16x32_bf16 v[76:79], v[28:31], v[204:207], v[76:79]
    ds_read_b64_tr_b16 v[26:27], v109 offset:4096
    s_setprio 1
    s_waitcnt lgkmcnt(4)
    v_mfma_f32_16x16x32_bf16 v[80:83], v[16:19], v[192:195], v[80:83]
    ds_read_b64_tr_b16 v[28:29], v111 offset:4096
    v_mfma_f32_16x16x32_bf16 v[84:87], v[16:19], v[196:199], v[84:87]
    ds_read_b64_tr_b16 v[30:31], v110 offset:4096
    s_add_u32 m0, s39, 0x16000
    s_add_u32 s57, s44, 0x24180
    buffer_load_dwordx4 v5, s[16:19], s57 offen lds
    s_waitcnt lgkmcnt(4)
    v_mfma_f32_16x16x32_bf16 v[88:91], v[20:23], v[192:195], v[88:91]
    ds_read_b64_tr_b16 v[16:17], v10 offset:8192
    v_mfma_f32_16x16x32_bf16 v[92:95], v[20:23], v[196:199], v[92:95]
    ds_read_b64_tr_b16 v[18:19], v109 offset:8192
    s_waitcnt lgkmcnt(4)
    v_mfma_f32_16x16x32_bf16 v[80:83], v[24:27], v[200:203], v[80:83]
    ds_read_b64_tr_b16 v[20:21], v111 offset:8192
    v_mfma_f32_16x16x32_bf16 v[84:87], v[24:27], v[204:207], v[84:87]
    ds_read_b64_tr_b16 v[22:23], v110 offset:8192
    s_add_u32 m0, s39, 0x18000
    s_add_u32 s58, s44, 0x36180
    buffer_load_dwordx4 v5, s[16:19], s58 offen lds
    s_waitcnt lgkmcnt(4)
    v_mfma_f32_16x16x32_bf16 v[88:91], v[28:31], v[200:203], v[88:91]
    ds_read_b64_tr_b16 v[24:25], v10 offset:12288
    v_mfma_f32_16x16x32_bf16 v[92:95], v[28:31], v[204:207], v[92:95]
    ds_read_b64_tr_b16 v[26:27], v109 offset:12288
    s_setprio 0
    s_waitcnt lgkmcnt(4)
    v_mfma_f32_16x16x32_bf16 v[32:35], v[16:19], v[112:115], 0
    ds_read_b64_tr_b16 v[28:29], v111 offset:12288
    v_mfma_f32_16x16x32_bf16 v[36:39], v[16:19], v[116:119], 0
    ds_read_b64_tr_b16 v[30:31], v110 offset:12288
    s_add_u32 m0, s39, 0x1a000
    s_add_u32 s59, s46, 0x180
    buffer_load_dwordx4 v5, s[16:19], s59 offen lds
    s_waitcnt lgkmcnt(4)
    v_mfma_f32_16x16x32_bf16 v[40:43], v[20:23], v[112:115], 0
    v_subrev_u32 v10, 0x20000, v10
    ds_read_b64_tr_b16 v[16:17], v10 offset:8192
    v_mfma_f32_16x16x32_bf16 v[44:47], v[20:23], v[116:119], 0
    v_subrev_u32 v109, 0x20000, v109
    ds_read_b64_tr_b16 v[18:19], v109 offset:8192
    s_waitcnt lgkmcnt(4)
    v_mfma_f32_16x16x32_bf16 v[32:35], v[24:27], v[120:123], v[32:35]
    v_subrev_u32 v111, 0x20000, v111
    ds_read_b64_tr_b16 v[20:21], v111 offset:8192
    v_mfma_f32_16x16x32_bf16 v[36:39], v[24:27], v[124:127], v[36:39]
    v_subrev_u32 v110, 0x20000, v110
    ds_read_b64_tr_b16 v[22:23], v110 offset:8192
    s_waitcnt lgkmcnt(4)
    v_mfma_f32_16x16x32_bf16 v[40:43], v[28:31], v[120:123], v[40:43]
    ds_read_b64_tr_b16 v[24:25], v10 offset:12288
    v_mfma_f32_16x16x32_bf16 v[44:47], v[28:31], v[124:127], v[44:47]
    ds_read_b64_tr_b16 v[26:27], v109 offset:12288
    s_setprio 3
    s_waitcnt vmcnt(8)
    s_barrier
    v_add_u32 v15, 0x10000, v15
    ds_read_b64 v[232:233], v15 offset:16384
    v_add_u32 v107, 0x10000, v107
    ds_read_b64 v[234:235], v107 offset:16384
    ds_read_b64 v[236:237], v15 offset:16392
    ds_read_b64 v[238:239], v107 offset:16392
    ds_read_b64 v[240:241], v15 offset:24576
    ds_read_b64 v[242:243], v107 offset:24576
    ds_read_b64 v[244:245], v15 offset:24584
    ds_read_b64 v[246:247], v107 offset:24584
    v_subrev_u32 v15, 0x20000, v15
    ds_read_b64 v[248:249], v15 offset:0
    v_subrev_u32 v107, 0x20000, v107
    ds_read_b64 v[250:251], v107 offset:0
    ds_read_b64 v[252:253], v15 offset:8
    ds_read_b64 v[254:255], v107 offset:8
    s_waitcnt lgkmcnt(15)
    v_mfma_f32_16x16x32_bf16 v[32:35], v[16:19], v[128:131], v[32:35]
    ds_read_b64_tr_b16 v[28:29], v111 offset:12288
    v_mfma_f32_16x16x32_bf16 v[36:39], v[16:19], v[132:135], v[36:39]
    ds_read_b64_tr_b16 v[30:31], v110 offset:12288
    s_add_u32 m0, s39, 0x1c000
    s_add_u32 s60, s46, 0x12180
    buffer_load_dwordx4 v5, s[16:19], s60 offen lds
    s_waitcnt lgkmcnt(15)
    v_mfma_f32_16x16x32_bf16 v[40:43], v[20:23], v[128:131], v[40:43]
    ds_read_b64_tr_b16 v[16:17], v10 offset:16384
    v_mfma_f32_16x16x32_bf16 v[44:47], v[20:23], v[132:135], v[44:47]
    ds_read_b64_tr_b16 v[18:19], v109 offset:16384
    s_waitcnt lgkmcnt(15)
    v_mfma_f32_16x16x32_bf16 v[32:35], v[24:27], v[136:139], v[32:35]
    ds_read_b64_tr_b16 v[20:21], v111 offset:16384
    v_mfma_f32_16x16x32_bf16 v[36:39], v[24:27], v[140:143], v[36:39]
    ds_read_b64_tr_b16 v[22:23], v110 offset:16384
    s_add_u32 m0, s39, 0x1e000
    s_add_u32 s61, s46, 0x24180
    buffer_load_dwordx4 v5, s[16:19], s61 offen lds
    s_waitcnt lgkmcnt(4)
    v_mfma_f32_16x16x32_bf16 v[40:43], v[28:31], v[136:139], v[40:43]
    ds_read_b64_tr_b16 v[24:25], v10 offset:20480
    v_mfma_f32_16x16x32_bf16 v[44:47], v[28:31], v[140:143], v[44:47]
    ds_read_b64_tr_b16 v[26:27], v109 offset:20480
    s_setprio 2
    s_waitcnt lgkmcnt(4)
    v_mfma_f32_16x16x32_bf16 v[48:51], v[16:19], v[232:235], v[48:51]
    ds_read_b64_tr_b16 v[28:29], v111 offset:20480
    v_mfma_f32_16x16x32_bf16 v[52:55], v[16:19], v[236:239], v[52:55]
    ds_read_b64_tr_b16 v[30:31], v110 offset:20480
    s_add_u32 m0, s39, 0x20000
    s_add_u32 s62, s46, 0x36180
    buffer_load_dwordx4 v5, s[16:19], s62 offen lds
    s_waitcnt lgkmcnt(4)
    v_mfma_f32_16x16x32_bf16 v[56:59], v[20:23], v[232:235], v[56:59]
    ds_read_b64_tr_b16 v[16:17], v10 offset:24576
    v_mfma_f32_16x16x32_bf16 v[60:63], v[20:23], v[236:239], v[60:63]
    ds_read_b64_tr_b16 v[18:19], v109 offset:24576
    s_waitcnt lgkmcnt(4)
    v_mfma_f32_16x16x32_bf16 v[48:51], v[24:27], v[240:243], v[48:51]
    ds_read_b64_tr_b16 v[20:21], v111 offset:24576
    v_mfma_f32_16x16x32_bf16 v[52:55], v[24:27], v[244:247], v[52:55]
    ds_read_b64_tr_b16 v[22:23], v110 offset:24576
    s_add_u32 m0, s39, 0x22000
    s_add_u32 s63, s45, 0x180
    buffer_load_dwordx4 v5, s[16:19], s63 offen lds
    s_waitcnt lgkmcnt(4)
    v_mfma_f32_16x16x32_bf16 v[56:59], v[28:31], v[240:243], v[56:59]
    ds_read_b64_tr_b16 v[24:25], v10 offset:28672
    v_mfma_f32_16x16x32_bf16 v[60:63], v[28:31], v[244:247], v[60:63]
    ds_read_b64_tr_b16 v[26:27], v109 offset:28672
    s_setprio 1
    s_waitcnt lgkmcnt(4)
    v_mfma_f32_16x16x32_bf16 v[48:51], v[16:19], v[208:211], v[48:51]
    ds_read_b64_tr_b16 v[28:29], v111 offset:28672
    v_mfma_f32_16x16x32_bf16 v[52:55], v[16:19], v[212:215], v[52:55]
    ds_read_b64_tr_b16 v[30:31], v110 offset:28672
    s_waitcnt lgkmcnt(4)
    v_mfma_f32_16x16x32_bf16 v[56:59], v[20:23], v[208:211], v[56:59]
    ds_read_b64_tr_b16 v[16:17], v10 offset:32768
    v_mfma_f32_16x16x32_bf16 v[60:63], v[20:23], v[212:215], v[60:63]
    ds_read_b64_tr_b16 v[18:19], v109 offset:32768
    s_waitcnt lgkmcnt(4)
    v_mfma_f32_16x16x32_bf16 v[48:51], v[24:27], v[248:251], v[48:51]
    ds_read_b64_tr_b16 v[20:21], v111 offset:32768
    v_mfma_f32_16x16x32_bf16 v[52:55], v[24:27], v[252:255], v[52:55]
    ds_read_b64_tr_b16 v[22:23], v110 offset:32768
    s_waitcnt lgkmcnt(4)
    v_mfma_f32_16x16x32_bf16 v[56:59], v[28:31], v[248:251], v[56:59]
    ds_read_b64_tr_b16 v[24:25], v10 offset:36864
    v_mfma_f32_16x16x32_bf16 v[60:63], v[28:31], v[252:255], v[60:63]
    ds_read_b64_tr_b16 v[26:27], v109 offset:36864
    s_setprio 0
    s_waitcnt lgkmcnt(4)
    v_mfma_f32_16x16x32_bf16 v[64:67], v[16:19], v[232:235], v[64:67]
    ds_read_b64_tr_b16 v[28:29], v111 offset:36864
    v_mfma_f32_16x16x32_bf16 v[68:71], v[16:19], v[236:239], v[68:71]
    ds_read_b64_tr_b16 v[30:31], v110 offset:36864
    s_waitcnt lgkmcnt(4)
    v_mfma_f32_16x16x32_bf16 v[72:75], v[20:23], v[232:235], v[72:75]
    ds_read_b64_tr_b16 v[16:17], v10 offset:40960
    v_mfma_f32_16x16x32_bf16 v[76:79], v[20:23], v[236:239], v[76:79]
    ds_read_b64_tr_b16 v[18:19], v109 offset:40960
    s_waitcnt lgkmcnt(4)
    v_mfma_f32_16x16x32_bf16 v[64:67], v[24:27], v[240:243], v[64:67]
    ds_read_b64_tr_b16 v[20:21], v111 offset:40960
    v_cvt_pk_bf16_f32 v48, v48, v49
    v_mfma_f32_16x16x32_bf16 v[68:71], v[24:27], v[244:247], v[68:71]
    ds_read_b64_tr_b16 v[22:23], v110 offset:40960
    v_cvt_pk_bf16_f32 v49, v50, v51
    s_waitcnt lgkmcnt(4)
    v_mfma_f32_16x16x32_bf16 v[72:75], v[28:31], v[240:243], v[72:75]
    ds_read_b64_tr_b16 v[24:25], v10 offset:45056
    v_cvt_pk_bf16_f32 v50, v56, v57
    v_mfma_f32_16x16x32_bf16 v[76:79], v[28:31], v[244:247], v[76:79]
    ds_read_b64_tr_b16 v[26:27], v109 offset:45056
    v_cvt_pk_bf16_f32 v51, v58, v59
    s_setprio 3
    s_waitcnt vmcnt(8)
    s_barrier
    s_waitcnt lgkmcnt(4)
    v_mfma_f32_16x16x32_bf16 v[64:67], v[16:19], v[208:211], v[64:67]
    ds_read_b64_tr_b16 v[28:29], v111 offset:45056
    v_cvt_pk_bf16_f32 v52, v52, v53
    v_mfma_f32_16x16x32_bf16 v[68:71], v[16:19], v[212:215], v[68:71]
    ds_read_b64_tr_b16 v[30:31], v110 offset:45056
    v_cvt_pk_bf16_f32 v53, v54, v55
    s_waitcnt lgkmcnt(4)
    v_mfma_f32_16x16x32_bf16 v[72:75], v[20:23], v[208:211], v[72:75]
    ds_read_b64_tr_b16 v[16:17], v10 offset:49152
    v_cvt_pk_bf16_f32 v54, v60, v61
    v_mfma_f32_16x16x32_bf16 v[76:79], v[20:23], v[212:215], v[76:79]
    ds_read_b64_tr_b16 v[18:19], v109 offset:49152
    v_cvt_pk_bf16_f32 v55, v62, v63
    s_waitcnt lgkmcnt(4)
    v_mfma_f32_16x16x32_bf16 v[64:67], v[24:27], v[248:251], v[64:67]
    ds_read_b64_tr_b16 v[20:21], v111 offset:49152
    v_mfma_f32_16x16x32_bf16 v[68:71], v[24:27], v[252:255], v[68:71]
    ds_read_b64_tr_b16 v[22:23], v110 offset:49152
    s_add_u32 s56, s22, 0
    buffer_store_dwordx4 v[48:51], v106, s[28:31], s56 offen sc1
    s_add_u32 s57, s22, 147456
    buffer_store_dwordx4 v[52:55], v106, s[28:31], s57 offen sc1
    s_waitcnt lgkmcnt(4)
    v_mfma_f32_16x16x32_bf16 v[72:75], v[28:31], v[248:251], v[72:75]
    ds_read_b64_tr_b16 v[24:25], v10 offset:53248
    v_mfma_f32_16x16x32_bf16 v[76:79], v[28:31], v[252:255], v[76:79]
    ds_read_b64_tr_b16 v[26:27], v109 offset:53248
    s_setprio 2
    s_waitcnt lgkmcnt(4)
    v_mfma_f32_16x16x32_bf16 v[80:83], v[16:19], v[232:235], v[80:83]
    ds_read_b64_tr_b16 v[28:29], v111 offset:53248
    v_mfma_f32_16x16x32_bf16 v[84:87], v[16:19], v[236:239], v[84:87]
    ds_read_b64_tr_b16 v[30:31], v110 offset:53248
    s_waitcnt lgkmcnt(4)
    v_mfma_f32_16x16x32_bf16 v[88:91], v[20:23], v[232:235], v[88:91]
    ds_read_b64_tr_b16 v[16:17], v10 offset:57344
    v_mfma_f32_16x16x32_bf16 v[92:95], v[20:23], v[236:239], v[92:95]
    ds_read_b64_tr_b16 v[18:19], v109 offset:57344
    s_waitcnt lgkmcnt(4)
    v_mfma_f32_16x16x32_bf16 v[80:83], v[24:27], v[240:243], v[80:83]
    ds_read_b64_tr_b16 v[20:21], v111 offset:57344
    v_cvt_pk_bf16_f32 v64, v64, v65
    v_mfma_f32_16x16x32_bf16 v[84:87], v[24:27], v[244:247], v[84:87]
    ds_read_b64_tr_b16 v[22:23], v110 offset:57344
    v_cvt_pk_bf16_f32 v65, v66, v67
    s_waitcnt lgkmcnt(4)
    v_mfma_f32_16x16x32_bf16 v[88:91], v[28:31], v[240:243], v[88:91]
    ds_read_b64_tr_b16 v[24:25], v10 offset:61440
    v_cvt_pk_bf16_f32 v66, v72, v73
    v_mfma_f32_16x16x32_bf16 v[92:95], v[28:31], v[244:247], v[92:95]
    ds_read_b64_tr_b16 v[26:27], v109 offset:61440
    v_cvt_pk_bf16_f32 v67, v74, v75
    s_setprio 1
    s_waitcnt lgkmcnt(4)
    v_mfma_f32_16x16x32_bf16 v[80:83], v[16:19], v[208:211], v[80:83]
    ds_read_b64_tr_b16 v[28:29], v111 offset:61440
    v_cvt_pk_bf16_f32 v68, v68, v69
    v_mfma_f32_16x16x32_bf16 v[84:87], v[16:19], v[212:215], v[84:87]
    ds_read_b64_tr_b16 v[30:31], v110 offset:61440
    v_cvt_pk_bf16_f32 v69, v70, v71
    s_waitcnt lgkmcnt(4)
    v_mfma_f32_16x16x32_bf16 v[88:91], v[20:23], v[208:211], v[88:91]
    ds_read_b64_tr_b16 v[16:17], v104 offset:0
    v_cvt_pk_bf16_f32 v70, v76, v77
    v_mfma_f32_16x16x32_bf16 v[92:95], v[20:23], v[212:215], v[92:95]
    ds_read_b64_tr_b16 v[18:19], v105 offset:0
    v_cvt_pk_bf16_f32 v71, v78, v79
    s_waitcnt lgkmcnt(4)
    v_mfma_f32_16x16x32_bf16 v[80:83], v[24:27], v[248:251], v[80:83]
    ds_read_b64_tr_b16 v[20:21], v104 offset:2048
    v_mfma_f32_16x16x32_bf16 v[84:87], v[24:27], v[252:255], v[84:87]
    ds_read_b64_tr_b16 v[22:23], v105 offset:2048
    s_add_u32 s58, s22, 1024
    buffer_store_dwordx4 v[64:67], v106, s[28:31], s58 offen sc1
    s_add_u32 s59, s22, 148480
    buffer_store_dwordx4 v[68:71], v106, s[28:31], s59 offen sc1
    s_waitcnt lgkmcnt(4)
    v_mfma_f32_16x16x32_bf16 v[88:91], v[28:31], v[248:251], v[88:91]
    ds_read_b64_tr_b16 v[24:25], v104 offset:4096
    v_mfma_f32_16x16x32_bf16 v[92:95], v[28:31], v[252:255], v[92:95]
    ds_read_b64_tr_b16 v[26:27], v105 offset:4096
    s_setprio 0
    s_waitcnt lgkmcnt(4)
    v_mfma_f32_16x16x32_bf16 v[96:99], v[16:19], v[176:179], v[96:99]
    ds_read_b64_tr_b16 v[28:29], v104 offset:6144
    v_mfma_f32_16x16x32_bf16 v[100:103], v[16:19], v[180:183], v[100:103]
    ds_read_b64_tr_b16 v[30:31], v105 offset:6144
    s_waitcnt lgkmcnt(4)
    v_mfma_f32_16x16x32_bf16 v[96:99], v[20:23], v[184:187], v[96:99]
    ds_read_b64_tr_b16 v[16:17], v104 offset:8192
    v_mfma_f32_16x16x32_bf16 v[100:103], v[20:23], v[188:191], v[100:103]
    ds_read_b64_tr_b16 v[18:19], v105 offset:8192
    s_waitcnt lgkmcnt(4)
    v_mfma_f32_16x16x32_bf16 v[96:99], v[24:27], v[192:195], v[96:99]
    ds_read_b64_tr_b16 v[20:21], v104 offset:10240
    v_cvt_pk_bf16_f32 v80, v80, v81
    v_mfma_f32_16x16x32_bf16 v[100:103], v[24:27], v[196:199], v[100:103]
    ds_read_b64_tr_b16 v[22:23], v105 offset:10240
    v_cvt_pk_bf16_f32 v81, v82, v83
    s_waitcnt lgkmcnt(4)
    v_mfma_f32_16x16x32_bf16 v[96:99], v[28:31], v[200:203], v[96:99]
    ds_read_b64_tr_b16 v[24:25], v104 offset:12288
    v_cvt_pk_bf16_f32 v82, v88, v89
    v_mfma_f32_16x16x32_bf16 v[100:103], v[28:31], v[204:207], v[100:103]
    ds_read_b64_tr_b16 v[26:27], v105 offset:12288
    v_cvt_pk_bf16_f32 v83, v90, v91
    s_setprio 3
    s_waitcnt vmcnt(8)
    s_barrier
    s_waitcnt lgkmcnt(4)
    v_mfma_f32_16x16x32_bf16 v[96:99], v[16:19], v[216:219], v[96:99]
    ds_read_b64_tr_b16 v[28:29], v104 offset:14336
    v_cvt_pk_bf16_f32 v84, v84, v85
    v_mfma_f32_16x16x32_bf16 v[100:103], v[16:19], v[220:223], v[100:103]
    ds_read_b64_tr_b16 v[30:31], v105 offset:14336
    v_cvt_pk_bf16_f32 v85, v86, v87
    s_waitcnt lgkmcnt(4)
    v_mfma_f32_16x16x32_bf16 v[96:99], v[20:23], v[224:227], v[96:99]
    ds_read_b64_tr_b16 v[16:17], v104 offset:16384
    v_cvt_pk_bf16_f32 v86, v92, v93
    v_mfma_f32_16x16x32_bf16 v[100:103], v[20:23], v[228:231], v[100:103]
    ds_read_b64_tr_b16 v[18:19], v105 offset:16384
    v_cvt_pk_bf16_f32 v87, v94, v95
    s_waitcnt lgkmcnt(4)
    v_mfma_f32_16x16x32_bf16 v[96:99], v[24:27], v[232:235], v[96:99]
    ds_read_b64_tr_b16 v[20:21], v104 offset:18432
    v_mfma_f32_16x16x32_bf16 v[100:103], v[24:27], v[236:239], v[100:103]
    ds_read_b64_tr_b16 v[22:23], v105 offset:18432
    s_add_u32 s60, s22, 2048
    buffer_store_dwordx4 v[80:83], v106, s[28:31], s60 offen sc1
    s_add_u32 s61, s22, 149504
    buffer_store_dwordx4 v[84:87], v106, s[28:31], s61 offen sc1
    s_waitcnt lgkmcnt(4)
    v_mfma_f32_16x16x32_bf16 v[96:99], v[28:31], v[240:243], v[96:99]
    v_add_u32 v10, 0x10000, v10
    ds_read_b64_tr_b16 v[24:25], v10 offset:24576
    v_mfma_f32_16x16x32_bf16 v[100:103], v[28:31], v[244:247], v[100:103]
    v_add_u32 v109, 0x10000, v109
    ds_read_b64_tr_b16 v[26:27], v109 offset:24576
    s_setprio 2
    s_waitcnt lgkmcnt(4)
    v_mfma_f32_16x16x32_bf16 v[96:99], v[16:19], v[208:211], v[96:99]
    v_add_u32 v111, 0x10000, v111
    ds_read_b64_tr_b16 v[28:29], v111 offset:24576
    v_mfma_f32_16x16x32_bf16 v[100:103], v[16:19], v[212:215], v[100:103]
    v_add_u32 v110, 0x10000, v110
    ds_read_b64_tr_b16 v[30:31], v110 offset:24576
    s_waitcnt lgkmcnt(4)
    v_mfma_f32_16x16x32_bf16 v[96:99], v[20:23], v[248:251], v[96:99]
    ds_read_b64_tr_b16 v[16:17], v10 offset:28672
    v_mfma_f32_16x16x32_bf16 v[100:103], v[20:23], v[252:255], v[100:103]
    ds_read_b64_tr_b16 v[18:19], v109 offset:28672
    s_waitcnt lgkmcnt(4)
    v_mfma_f32_16x16x32_bf16 v[32:35], v[24:27], v[176:179], v[32:35]
    ds_read_b64_tr_b16 v[20:21], v111 offset:28672
    v_mfma_f32_16x16x32_bf16 v[36:39], v[24:27], v[180:183], v[36:39]
    ds_read_b64_tr_b16 v[22:23], v110 offset:28672
    s_setprio 1
    s_waitcnt lgkmcnt(4)
    v_mfma_f32_16x16x32_bf16 v[40:43], v[28:31], v[176:179], v[40:43]
    ds_read_b64_tr_b16 v[24:25], v10 offset:32768
    v_mfma_f32_16x16x32_bf16 v[44:47], v[28:31], v[180:183], v[44:47]
    ds_read_b64_tr_b16 v[26:27], v109 offset:32768
    s_waitcnt lgkmcnt(4)
    v_mfma_f32_16x16x32_bf16 v[32:35], v[16:19], v[184:187], v[32:35]
    ds_read_b64_tr_b16 v[28:29], v111 offset:32768
    v_and_b32 v11, 0x1ff, v106
    v_sub_u32 v12, v106, v11
    v_lshrrev_b32 v11, 1, v11
    v_add_u32 v11, v11, v12
    v_cvt_pk_bf16_f32 v96, v96, v97
    v_cvt_pk_bf16_f32 v97, v98, v99
    s_add_u32 s62, s23, 0
    buffer_store_dwordx2 v[96:97], v11, s[28:31], s62 offen sc1
    v_cvt_pk_bf16_f32 v100, v100, v101
    v_cvt_pk_bf16_f32 v101, v102, v103
    s_add_u32 s63, s23, 147456
    buffer_store_dwordx2 v[100:101], v11, s[28:31], s63 offen sc1
    v_mfma_f32_16x16x32_bf16 v[36:39], v[16:19], v[188:191], v[36:39]
    ds_read_b64_tr_b16 v[30:31], v110 offset:32768
    s_waitcnt lgkmcnt(4)
    v_mfma_f32_16x16x32_bf16 v[40:43], v[20:23], v[184:187], v[40:43]
    ds_read_b64_tr_b16 v[16:17], v10 offset:36864
    v_mfma_f32_16x16x32_bf16 v[44:47], v[20:23], v[188:191], v[44:47]
    ds_read_b64_tr_b16 v[18:19], v109 offset:36864
    s_waitcnt lgkmcnt(4)
    v_mfma_f32_16x16x32_bf16 v[32:35], v[24:27], v[192:195], v[32:35]
    ds_read_b64_tr_b16 v[20:21], v111 offset:36864
    v_mfma_f32_16x16x32_bf16 v[36:39], v[24:27], v[196:199], v[36:39]
    ds_read_b64_tr_b16 v[22:23], v110 offset:36864
    s_setprio 0
    s_waitcnt lgkmcnt(4)
    v_mfma_f32_16x16x32_bf16 v[40:43], v[28:31], v[192:195], v[40:43]
    ds_read_b64_tr_b16 v[24:25], v10 offset:40960
    v_mfma_f32_16x16x32_bf16 v[44:47], v[28:31], v[196:199], v[44:47]
    ds_read_b64_tr_b16 v[26:27], v109 offset:40960
    s_waitcnt lgkmcnt(4)
    v_mfma_f32_16x16x32_bf16 v[32:35], v[16:19], v[200:203], v[32:35]
    ds_read_b64_tr_b16 v[28:29], v111 offset:40960
    v_mfma_f32_16x16x32_bf16 v[36:39], v[16:19], v[204:207], v[36:39]
    ds_read_b64_tr_b16 v[30:31], v110 offset:40960
    s_waitcnt lgkmcnt(4)
    v_mfma_f32_16x16x32_bf16 v[40:43], v[20:23], v[200:203], v[40:43]
    ds_read_b64_tr_b16 v[16:17], v10 offset:45056
    v_mfma_f32_16x16x32_bf16 v[44:47], v[20:23], v[204:207], v[44:47]
    ds_read_b64_tr_b16 v[18:19], v109 offset:45056
    s_setprio 3
    s_waitcnt vmcnt(8)
    s_barrier
    s_waitcnt lgkmcnt(4)
    v_mfma_f32_16x16x32_bf16 v[32:35], v[24:27], v[144:147], v[32:35]
    ds_read_b64_tr_b16 v[20:21], v111 offset:45056
    v_mfma_f32_16x16x32_bf16 v[36:39], v[24:27], v[148:151], v[36:39]
    ds_read_b64_tr_b16 v[22:23], v110 offset:45056
    s_waitcnt lgkmcnt(4)
    v_mfma_f32_16x16x32_bf16 v[40:43], v[28:31], v[144:147], v[40:43]
    ds_read_b64_tr_b16 v[24:25], v10 offset:49152
    v_mfma_f32_16x16x32_bf16 v[44:47], v[28:31], v[148:151], v[44:47]
    ds_read_b64_tr_b16 v[26:27], v109 offset:49152
    s_waitcnt lgkmcnt(4)
    v_mfma_f32_16x16x32_bf16 v[32:35], v[16:19], v[152:155], v[32:35]
    ds_read_b64_tr_b16 v[28:29], v111 offset:49152
    v_mfma_f32_16x16x32_bf16 v[36:39], v[16:19], v[156:159], v[36:39]
    ds_read_b64_tr_b16 v[30:31], v110 offset:49152
    s_waitcnt lgkmcnt(4)
    v_mfma_f32_16x16x32_bf16 v[40:43], v[20:23], v[152:155], v[40:43]
    ds_read_b64_tr_b16 v[16:17], v10 offset:53248
    v_mfma_f32_16x16x32_bf16 v[44:47], v[20:23], v[156:159], v[44:47]
    ds_read_b64_tr_b16 v[18:19], v109 offset:53248
    s_setprio 2
    s_waitcnt lgkmcnt(4)
    v_mfma_f32_16x16x32_bf16 v[32:35], v[24:27], v[160:163], v[32:35]
    ds_read_b64_tr_b16 v[20:21], v111 offset:53248
    v_mfma_f32_16x16x32_bf16 v[36:39], v[24:27], v[164:167], v[36:39]
    ds_read_b64_tr_b16 v[22:23], v110 offset:53248
    s_waitcnt lgkmcnt(4)
    v_mfma_f32_16x16x32_bf16 v[40:43], v[28:31], v[160:163], v[40:43]
    ds_read_b64_tr_b16 v[24:25], v10 offset:57344
    v_mfma_f32_16x16x32_bf16 v[44:47], v[28:31], v[164:167], v[44:47]
    ds_read_b64_tr_b16 v[26:27], v109 offset:57344
    s_waitcnt lgkmcnt(4)
    v_mfma_f32_16x16x32_bf16 v[32:35], v[16:19], v[168:171], v[32:35]
    ds_read_b64_tr_b16 v[28:29], v111 offset:57344
    v_mfma_f32_16x16x32_bf16 v[36:39], v[16:19], v[172:175], v[36:39]
    ds_read_b64_tr_b16 v[30:31], v110 offset:57344
    s_waitcnt lgkmcnt(4)
    v_mfma_f32_16x16x32_bf16 v[40:43], v[20:23], v[168:171], v[40:43]
    ds_read_b64_tr_b16 v[16:17], v10 offset:61440
    v_mfma_f32_16x16x32_bf16 v[44:47], v[20:23], v[172:175], v[44:47]
    ds_read_b64_tr_b16 v[18:19], v109 offset:61440
    s_setprio 1
    s_waitcnt lgkmcnt(4)
    v_mfma_f32_16x16x32_bf16 v[32:35], v[24:27], v[216:219], v[32:35]
    ds_read_b64_tr_b16 v[20:21], v111 offset:61440
    v_mfma_f32_16x16x32_bf16 v[36:39], v[24:27], v[220:223], v[36:39]
    ds_read_b64_tr_b16 v[22:23], v110 offset:61440
    s_waitcnt lgkmcnt(4)
    v_mfma_f32_16x16x32_bf16 v[40:43], v[28:31], v[216:219], v[40:43]
    v_add_u32 v10, 0x10000, v10
    ds_read_b64_tr_b16 v[24:25], v10 offset:0
    v_mfma_f32_16x16x32_bf16 v[44:47], v[28:31], v[220:223], v[44:47]
    v_add_u32 v109, 0x10000, v109
    ds_read_b64_tr_b16 v[26:27], v109 offset:0
    s_waitcnt lgkmcnt(4)
    v_mfma_f32_16x16x32_bf16 v[32:35], v[16:19], v[224:227], v[32:35]
    v_add_u32 v111, 0x10000, v111
    ds_read_b64_tr_b16 v[28:29], v111 offset:0
    v_mfma_f32_16x16x32_bf16 v[36:39], v[16:19], v[228:231], v[36:39]
    v_add_u32 v110, 0x10000, v110
    ds_read_b64_tr_b16 v[30:31], v110 offset:0
    s_waitcnt lgkmcnt(4)
    v_mfma_f32_16x16x32_bf16 v[40:43], v[20:23], v[224:227], v[40:43]
    ds_read_b64_tr_b16 v[16:17], v10 offset:4096
    v_mfma_f32_16x16x32_bf16 v[44:47], v[20:23], v[228:231], v[44:47]
    ds_read_b64_tr_b16 v[18:19], v109 offset:4096
    s_setprio 0
    s_waitcnt lgkmcnt(4)
    v_mfma_f32_16x16x32_bf16 v[32:35], v[24:27], v[232:235], v[32:35]
    ds_read_b64_tr_b16 v[20:21], v111 offset:4096
    v_mfma_f32_16x16x32_bf16 v[36:39], v[24:27], v[236:239], v[36:39]
    ds_read_b64_tr_b16 v[22:23], v110 offset:4096
    s_waitcnt lgkmcnt(4)
    v_mfma_f32_16x16x32_bf16 v[40:43], v[28:31], v[232:235], v[40:43]
    ds_read_b64_tr_b16 v[24:25], v10 offset:8192
    v_mfma_f32_16x16x32_bf16 v[44:47], v[28:31], v[236:239], v[44:47]
    ds_read_b64_tr_b16 v[26:27], v109 offset:8192
    s_waitcnt lgkmcnt(4)
    v_mfma_f32_16x16x32_bf16 v[32:35], v[16:19], v[240:243], v[32:35]
    ds_read_b64_tr_b16 v[28:29], v111 offset:8192
    v_mfma_f32_16x16x32_bf16 v[36:39], v[16:19], v[244:247], v[36:39]
    ds_read_b64_tr_b16 v[30:31], v110 offset:8192
    s_waitcnt lgkmcnt(4)
    v_mfma_f32_16x16x32_bf16 v[40:43], v[20:23], v[240:243], v[40:43]
    ds_read_b64_tr_b16 v[16:17], v10 offset:12288
    v_mfma_f32_16x16x32_bf16 v[44:47], v[20:23], v[244:247], v[44:47]
    ds_read_b64_tr_b16 v[18:19], v109 offset:12288
    s_setprio 3
    s_barrier
    s_waitcnt lgkmcnt(4)
    v_mfma_f32_16x16x32_bf16 v[32:35], v[24:27], v[208:211], v[32:35]
    ds_read_b64_tr_b16 v[20:21], v111 offset:12288
    v_mfma_f32_16x16x32_bf16 v[36:39], v[24:27], v[212:215], v[36:39]
    ds_read_b64_tr_b16 v[22:23], v110 offset:12288
    s_setprio 2
    s_waitcnt lgkmcnt(4)
    v_mfma_f32_16x16x32_bf16 v[40:43], v[28:31], v[208:211], v[40:43]
    v_mfma_f32_16x16x32_bf16 v[44:47], v[28:31], v[212:215], v[44:47]
    s_setprio 1
    s_waitcnt lgkmcnt(2)
    v_mfma_f32_16x16x32_bf16 v[32:35], v[16:19], v[248:251], v[32:35]
    v_mfma_f32_16x16x32_bf16 v[36:39], v[16:19], v[252:255], v[36:39]
    s_setprio 0
    s_waitcnt lgkmcnt(0)
    v_mfma_f32_16x16x32_bf16 v[40:43], v[20:23], v[248:251], v[40:43]
    v_mfma_f32_16x16x32_bf16 v[44:47], v[20:23], v[252:255], v[44:47]
    s_nop 2
    v_cvt_pk_bf16_f32 v32, v32, v33
    v_cvt_pk_bf16_f32 v33, v34, v35
    s_nop 1
    v_cvt_pk_bf16_f32 v34, v40, v41
    v_cvt_pk_bf16_f32 v35, v42, v43
    v_cvt_pk_bf16_f32 v36, v36, v37
    v_cvt_pk_bf16_f32 v37, v38, v39
    v_cvt_pk_bf16_f32 v38, v44, v45
    v_cvt_pk_bf16_f32 v39, v46, v47
    s_add_u32 s56, s22, 3072
    buffer_store_dwordx4 v[32:35], v106, s[28:31], s56 offen sc1
    s_add_u32 s57, s22, 150528
    buffer_store_dwordx4 v[36:39], v106, s[28:31], s57 offen sc1
    s_setprio 0
    v_and_b32 v246, 7, v7
    v_bfe_u32 v247, v7, 3, 2
    v_lshrrev_b32 v248, 5, v7
    s_lshl_b32 s50, s32, 1
    v_add_u32 v248, s50, v248
    s_lshr_b32 s50, s98, 2
    s_mul_i32 s50, s50, 36864
    s_bfe_u32 s51, s98, 0x10001
    s_lshl_b32 s51, s51, 10
    s_add_u32 s50, s50, s51
    s_and_b32 s51, s98, 1
    s_lshl_b32 s51, s51, 7
    s_add_u32 s50, s50, s51
    v_lshlrev_b32 v16, 11, v248
    v_lshl_add_u32 v16, v247, 8, v16
    v_lshl_add_u32 v16, v246, 4, v16
    v_add_u32 v16, s50, v16
    s_mul_i32 s50, s98, 9216
    v_mul_u32_u24 v17, 1152, v246
    v_lshl_add_u32 v17, v248, 6, v17
    v_lshl_add_u32 v17, v247, 3, v17
    v_add_u32 v17, s50, v17
    v_lshlrev_b32 v18, 7, v248
    v_lshl_add_u32 v18, v247, 4, v18
    s_cmp_lg_u32 s32, 0
    s_cbranch_scc1 L_itb_67
    s_mov_b32 s50, 0x288000
    buffer_load_dwordx4 v[24:27], v16, s[76:79], s50 offen sc1
L_itb_67:
    s_mov_b32 s50, 0x280000
    buffer_load_dwordx4 v[20:23], v16, s[76:79], s50 offen sc1
    s_cmp_lg_u32 s32, 0
    s_cbranch_scc1 L_itb_68
    s_mov_b32 s50, 11520
    buffer_load_dwordx4 v[36:39], v18, s[76:79], s50 offen offset:2048 sc1
    buffer_load_dwordx4 v[40:43], v18, s[76:79], s50 offen offset:2112 sc1
L_itb_68:
    s_mov_b32 s50, 11520
    buffer_load_dwordx4 v[28:31], v18, s[76:79], s50 offen offset:0 sc1
    buffer_load_dwordx4 v[32:35], v18, s[76:79], s50 offen offset:64 sc1
    v_bfe_u32 v246, v7, 2, 2
    v_lshrrev_b32 v247, 4, v7
    v_and_b32 v248, 1, v7
    v_lshlrev_b32 v248, 4, v248
    v_mov_b32 v249, 0x3f80
    v_lshlrev_b32 v249, v248, v249
    v_cmp_eq_u32 vcc, v246, v247
    s_nop 1
    v_cndmask_b32 v249, 0, v249, vcc
    v_bfe_u32 v248, v7, 1, 1
    v_cmp_eq_u32 vcc, 0, v248
    s_nop 1
    v_cndmask_b32 v242, 0, v249, vcc
    v_sub_u32 v243, v249, v242
    v_mov_b32 v240, 0
    v_mov_b32 v241, 0
    v_mov_b32 v244, 0
    v_mov_b32 v245, 0
    s_waitcnt vmcnt(0)
    s_barrier
    s_cmp_lg_u32 s32, 0
    s_cbranch_scc1 L_pub_69
    s_lshl_b32 s50, s98, 3
    s_add_u32 s50, s50, 38912
    v_mov_b32 v248, s96
    v_mov_b32 v249, s97
    v_mov_b32 v246, 0
    v_cmp_eq_u32 vcc, 0, v7
    s_nop 0
    s_and_saveexec_b64 s[4:5], vcc
    buffer_store_dwordx2 v[248:249], v246, s[76:79], s50 offen sc1
    s_mov_b64 exec, s[4:5]
L_pub_69:
    s_nop 1
    s_cmp_lg_u32 s32, 0
    s_cbranch_scc1 L_pt_70
    v_and_b32 v246, 15, v7
    v_lshlrev_b32 v246, 3, v246
    s_lshl_b32 s51, s34, 7
    s_add_u32 s51, s51, 38912
    s_mov_b32 s50, 0
L_ptl_71:
    buffer_load_dwordx2 v[248:249], v246, s[76:79], s51 offen sc1
    s_waitcnt vmcnt(0)
    v_cmp_ne_u64 vcc, s[96:97], v[248:249]
    s_add_u32 s50, s50, 1
    s_cbranch_vccz L_ptd_72
    s_cmp_ge_u32 s50, 20000
    s_cbranch_scc1 L_ptd_72
    s_sleep 1
    s_branch L_ptl_71
L_ptd_72:
L_pt_70:
    s_nop 1
    s_barrier
    s_mul_i32 s50, s98, 73728
    s_lshl_b32 s51, s32, 10
    s_add_u32 s50, s50, s51
    v_lshlrev_b32 v251, 4, v7
    v_add_u32 v251, s50, v251
    s_cmp_lg_u32 s32, 0
    s_cbranch_scc1 L_itb_73
    s_mov_b32 s56, 0x3402000
    buffer_load_dwordx4 v[176:179], v251, s[76:79], s56 offen sc1
    s_mov_b32 s57, 0x3404400
    buffer_load_dwordx4 v[180:183], v251, s[76:79], s57 offen sc1
    s_mov_b32 s58, 0x3406800
    buffer_load_dwordx4 v[184:187], v251, s[76:79], s58 offen sc1
    s_mov_b32 s59, 0x3408c00
    buffer_load_dwordx4 v[188:191], v251, s[76:79], s59 offen sc1
    s_mov_b32 s60, 0x340b000
    buffer_load_dwordx4 v[192:195], v251, s[76:79], s60 offen sc1
    s_mov_b32 s61, 0x340d400
    buffer_load_dwordx4 v[196:199], v251, s[76:79], s61 offen sc1
    s_mov_b32 s62, 0x340f800
    buffer_load_dwordx4 v[200:203], v251, s[76:79], s62 offen sc1
    s_mov_b32 s63, 0x3411c00
    buffer_load_dwordx4 v[204:207], v251, s[76:79], s63 offen sc1
L_itb_73:
    s_cmp_lg_u32 s32, 4
    s_cbranch_scc1 L_s4a_74
    v_lshrrev_b32 v250, 5, v7
    v_lshlrev_b32 v250, 8, v250
    v_lshl_add_u32 v250, v7, 3, v250
    s_mul_i32 s50, s98, 73728
    v_add_u32 v250, s50, v250
    s_mov_b32 s56, 0x3401000
    buffer_load_dwordx2 v[112:113], v250, s[76:79], s56 offen offset:0 sc1
    buffer_load_dwordx2 v[114:115], v250, s[76:79], s56 offen offset:256 sc1
    s_mov_b32 s57, 0x3403400
    buffer_load_dwordx2 v[116:117], v250, s[76:79], s57 offen offset:0 sc1
    buffer_load_dwordx2 v[118:119], v250, s[76:79], s57 offen offset:256 sc1
    s_mov_b32 s58, 0x3405800
    buffer_load_dwordx2 v[120:121], v250, s[76:79], s58 offen offset:0 sc1
    buffer_load_dwordx2 v[122:123], v250, s[76:79], s58 offen offset:256 sc1
    s_mov_b32 s59, 0x3407c00
    buffer_load_dwordx2 v[124:125], v250, s[76:79], s59 offen offset:0 sc1
    buffer_load_dwordx2 v[126:127], v250, s[76:79], s59 offen offset:256 sc1
    s_mov_b32 s60, 0x340a000
    buffer_load_dwordx2 v[128:129], v250, s[76:79], s60 offen offset:0 sc1
    buffer_load_dwordx2 v[130:131], v250, s[76:79], s60 offen offset:256 sc1
    s_mov_b32 s61, 0x340c400
    buffer_load_dwordx2 v[132:133], v250, s[76:79], s61 offen offset:0 sc1
    buffer_load_dwordx2 v[134:135], v250, s[76:79], s61 offen offset:256 sc1
    s_mov_b32 s62, 0x340e800
    buffer_load_dwordx2 v[136:137], v250, s[76:79], s62 offen offset:0 sc1
    buffer_load_dwordx2 v[138:139], v250, s[76:79], s62 offen offset:256 sc1
    s_mov_b32 s63, 0x3410c00
    buffer_load_dwordx2 v[140:141], v250, s[76:79], s63 offen offset:0 sc1
    buffer_load_dwordx2 v[142:143], v250, s[76:79], s63 offen offset:256 sc1
    s_waitcnt vmcnt(0)
    s_branch L_s4b_75
L_s4a_74:
    s_mov_b32 s56, 0x3400000
    buffer_load_dwordx4 v[112:115], v251, s[76:79], s56 offen sc1
    s_mov_b32 s57, 0x3402400
    buffer_load_dwordx4 v[116:119], v251, s[76:79], s57 offen sc1
    s_mov_b32 s58, 0x3404800
    buffer_load_dwordx4 v[120:123], v251, s[76:79], s58 offen sc1
    s_mov_b32 s59, 0x3406c00
    buffer_load_dwordx4 v[124:127], v251, s[76:79], s59 offen sc1
    s_mov_b32 s60, 0x3409000
    buffer_load_dwordx4 v[128:131], v251, s[76:79], s60 offen sc1
    s_mov_b32 s61, 0x340b400
    buffer_load_dwordx4 v[132:135], v251, s[76:79], s61 offen sc1
    s_mov_b32 s62, 0x340d800
    buffer_load_dwordx4 v[136:139], v251, s[76:79], s62 offen sc1
    s_mov_b32 s63, 0x340fc00
    buffer_load_dwordx4 v[140:143], v251, s[76:79], s63 offen sc1
L_s4b_75:
    s_nop 1
    s_waitcnt vmcnt(7)
    v_mfma_f32_16x16x32_bf16 v[92:95], v[242:245], v[112:115], 0
    v_mfma_f32_16x16x32_bf16 v[96:99], v[240:243], v[112:115], 0
    s_waitcnt vmcnt(6)
    v_mfma_f32_16x16x32_bf16 v[92:95], v[242:245], v[116:119], v[92:95]
    v_mfma_f32_16x16x32_bf16 v[96:99], v[240:243], v[116:119], v[96:99]
    s_waitcnt vmcnt(5)
    v_mfma_f32_16x16x32_bf16 v[92:95], v[242:245], v[120:123], v[92:95]
    v_mfma_f32_16x16x32_bf16 v[96:99], v[240:243], v[120:123], v[96:99]
    s_waitcnt vmcnt(4)
    v_mfma_f32_16x16x32_bf16 v[92:95], v[242:245], v[124:127], v[92:95]
    v_mfma_f32_16x16x32_bf16 v[96:99], v[240:243], v[124:127], v[96:99]
    s_waitcnt vmcnt(3)
    v_mfma_f32_16x16x32_bf16 v[92:95], v[242:245], v[128:131], v[92:95]
    v_mfma_f32_16x16x32_bf16 v[96:99], v[240:243], v[128:131], v[96:99]
    s_waitcnt vmcnt(2)
    v_mfma_f32_16x16x32_bf16 v[92:95], v[242:245], v[132:135], v[92:95]
    v_mfma_f32_16x16x32_bf16 v[96:99], v[240:243], v[132:135], v[96:99]
    s_waitcnt vmcnt(1)
    v_mfma_f32_16x16x32_bf16 v[92:95], v[242:245], v[136:139], v[92:95]
    v_mfma_f32_16x16x32_bf16 v[96:99], v[240:243], v[136:139], v[96:99]
    s_waitcnt vmcnt(0)
    v_mfma_f32_16x16x32_bf16 v[92:95], v[242:245], v[140:143], v[92:95]
    v_mfma_f32_16x16x32_bf16 v[96:99], v[240:243], v[140:143], v[96:99]
    v_lshlrev_b32 v76, 16, v20
    v_and_b32 v77, 0xffff0000, v20
    v_lshlrev_b32 v78, 16, v21
    v_and_b32 v79, 0xffff0000, v21
    v_lshlrev_b32 v80, 16, v22
    v_and_b32 v81, 0xffff0000, v22
    v_lshlrev_b32 v82, 16, v23
    v_and_b32 v83, 0xffff0000, v23
    v_cvt_pk_bf16_f32 v246, v92, v93
    v_lshlrev_b32 v92, 16, v246
    v_and_b32 v93, 0xffff0000, v246
    v_cvt_pk_bf16_f32 v246, v94, v95
    v_lshlrev_b32 v94, 16, v246
    v_and_b32 v95, 0xffff0000, v246
    v_cvt_pk_bf16_f32 v246, v96, v97
    v_lshlrev_b32 v96, 16, v246
    v_and_b32 v97, 0xffff0000, v246
    v_cvt_pk_bf16_f32 v246, v98, v99
    v_lshlrev_b32 v98, 16, v246
    v_and_b32 v99, 0xffff0000, v246
    v_mul_f32 v92, v92, v28
    v_mul_f32 v93, v93, v29
    v_mul_f32 v94, v94, v30
    v_mul_f32 v95, v95, v31
    v_mul_f32 v96, v96, v32
    v_mul_f32 v97, v97, v33
    v_mul_f32 v98, v98, v34
    v_mul_f32 v99, v99, v35
    v_cvt_pk_bf16_f32 v246, v92, v93
    v_lshlrev_b32 v92, 16, v246
    v_and_b32 v93, 0xffff0000, v246
    v_cvt_pk_bf16_f32 v246, v94, v95
    v_lshlrev_b32 v94, 16, v246
    v_and_b32 v95, 0xffff0000, v246
    v_cvt_pk_bf16_f32 v246, v96, v97
    v_lshlrev_b32 v96, 16, v246
    v_and_b32 v97, 0xffff0000, v246
    v_cvt_pk_bf16_f32 v246, v98, v99
    v_lshlrev_b32 v98, 16, v246
    v_and_b32 v99, 0xffff0000, v246
    v_add_f32 v76, v76, v92
    v_add_f32 v77, v77, v93
    v_add_f32 v78, v78, v94
    v_add_f32 v79, v79, v95
    v_add_f32 v80, v80, v96
    v_add_f32 v81, v81, v97
    v_add_f32 v82, v82, v98
    v_add_f32 v83, v83, v99
    v_cvt_pk_bf16_f32 v20, v76, v77
    v_cvt_pk_bf16_f32 v21, v78, v79
    v_cvt_pk_bf16_f32 v22, v80, v81
    v_cvt_pk_bf16_f32 v23, v82, v83
    buffer_store_dwordx2 v[20:21], v17, s[84:87], 0 offen offset:0
    buffer_store_dwordx2 v[22:23], v17, s[84:87], 0 offen offset:32
    s_cmp_lg_u32 s32, 0
    s_cbranch_scc1 L_itb_76
    v_mfma_f32_16x16x32_bf16 v[100:103], v[242:245], v[176:179], 0
    v_mfma_f32_16x16x32_bf16 v[104:107], v[240:243], v[176:179], 0
    v_mfma_f32_16x16x32_bf16 v[100:103], v[242:245], v[180:183], v[100:103]
    v_mfma_f32_16x16x32_bf16 v[104:107], v[240:243], v[180:183], v[104:107]
    v_mfma_f32_16x16x32_bf16 v[100:103], v[242:245], v[184:187], v[100:103]
    v_mfma_f32_16x16x32_bf16 v[104:107], v[240:243], v[184:187], v[104:107]
    v_mfma_f32_16x16x32_bf16 v[100:103], v[242:245], v[188:191], v[100:103]
    v_mfma_f32_16x16x32_bf16 v[104:107], v[240:243], v[188:191], v[104:107]
    v_mfma_f32_16x16x32_bf16 v[100:103], v[242:245], v[192:195], v[100:103]
    v_mfma_f32_16x16x32_bf16 v[104:107], v[240:243], v[192:195], v[104:107]
    v_mfma_f32_16x16x32_bf16 v[100:103], v[242:245], v[196:199], v[100:103]
    v_mfma_f32_16x16x32_bf16 v[104:107], v[240:243], v[196:199], v[104:107]
    v_mfma_f32_16x16x32_bf16 v[100:103], v[242:245], v[200:203], v[100:103]
    v_mfma_f32_16x16x32_bf16 v[104:107], v[240:243], v[200:203], v[104:107]
    v_mfma_f32_16x16x32_bf16 v[100:103], v[242:245], v[204:207], v[100:103]
    v_mfma_f32_16x16x32_bf16 v[104:107], v[240:243], v[204:207], v[104:107]
    v_lshlrev_b32 v84, 16, v24
    v_and_b32 v85, 0xffff0000, v24
    v_lshlrev_b32 v86, 16, v25
    v_and_b32 v87, 0xffff0000, v25
    v_lshlrev_b32 v88, 16, v26
    v_and_b32 v89, 0xffff0000, v26
    v_lshlrev_b32 v90, 16, v27
    v_and_b32 v91, 0xffff0000, v27
    v_cvt_pk_bf16_f32 v246, v100, v101
    v_lshlrev_b32 v100, 16, v246
    v_and_b32 v101, 0xffff0000, v246
    v_cvt_pk_bf16_f32 v246, v102, v103
    v_lshlrev_b32 v102, 16, v246
    v_and_b32 v103, 0xffff0000, v246
    v_cvt_pk_bf16_f32 v246, v104, v105
    v_lshlrev_b32 v104, 16, v246
    v_and_b32 v105, 0xffff0000, v246
    v_cvt_pk_bf16_f32 v246, v106, v107
    v_lshlrev_b32 v106, 16, v246
    v_and_b32 v107, 0xffff0000, v246
    v_mul_f32 v100, v100, v36
    v_mul_f32 v101, v101, v37
    v_mul_f32 v102, v102, v38
    v_mul_f32 v103, v103, v39
    v_mul_f32 v104, v104, v40
    v_mul_f32 v105, v105, v41
    v_mul_f32 v106, v106, v42
    v_mul_f32 v107, v107, v43
    v_cvt_pk_bf16_f32 v246, v100, v101
    v_lshlrev_b32 v100, 16, v246
    v_and_b32 v101, 0xffff0000, v246
    v_cvt_pk_bf16_f32 v246, v102, v103
    v_lshlrev_b32 v102, 16, v246
    v_and_b32 v103, 0xffff0000, v246
    v_cvt_pk_bf16_f32 v246, v104, v105
    v_lshlrev_b32 v104, 16, v246
    v_and_b32 v105, 0xffff0000, v246
    v_cvt_pk_bf16_f32 v246, v106, v107
    v_lshlrev_b32 v106, 16, v246
    v_and_b32 v107, 0xffff0000, v246
    v_add_f32 v84, v84, v100
    v_add_f32 v85, v85, v101
    v_add_f32 v86, v86, v102
    v_add_f32 v87, v87, v103
    v_add_f32 v88, v88, v104
    v_add_f32 v89, v89, v105
    v_add_f32 v90, v90, v106
    v_add_f32 v91, v91, v107
    v_cvt_pk_bf16_f32 v24, v84, v85
    v_cvt_pk_bf16_f32 v25, v86, v87
    v_cvt_pk_bf16_f32 v26, v88, v89
    v_cvt_pk_bf16_f32 v27, v90, v91
    buffer_store_dwordx2 v[24:25], v17, s[84:87], 0 offen offset:1024
    buffer_store_dwordx2 v[26:27], v17, s[84:87], 0 offen offset:1056
L_itb_76:
    s_load_dwordx2 s[48:49], s[0:1], 104
    s_endpgm
L_main_end:
L_slow_1:
    s_nop 15
    v_max3_f32 v36, v64, v65, v66
    v_max3_f32 v36, v36, v67, v72
    v_max3_f32 v36, v36, v73, v74
    v_max_f32 v36, v36, v75
    v_mov_b32 v38, v36
    s_nop 0
    s_nop 0
    v_permlane16_swap_b32 v36, v38
    v_max_f32 v36, v36, v38
    v_mov_b32 v38, v36
    s_nop 0
    s_nop 0
    v_permlane32_swap_b32 v36, v38
    v_max_f32 v36, v36, v38
    v_ceil_f32 v36, v36
    v_max_f32 v36, 0, v36
    v_sub_f32 v39, 0, v36
    v_exp_f32 v39, v39
    s_nop 0
    v_mul_f32 v144, v144, v39
    v_mul_f32 v145, v145, v39
    v_mul_f32 v146, v146, v39
    v_mul_f32 v147, v147, v39
    v_mul_f32 v152, v152, v39
    v_mul_f32 v153, v153, v39
    v_mul_f32 v154, v154, v39
    v_mul_f32 v155, v155, v39
    v_mul_f32 v160, v160, v39
    v_mul_f32 v161, v161, v39
    v_mul_f32 v162, v162, v39
    v_mul_f32 v163, v163, v39
    v_mul_f32 v168, v168, v39
    v_mul_f32 v169, v169, v39
    v_mul_f32 v170, v170, v39
    v_mul_f32 v171, v171, v39
    v_mul_f32 v176, v176, v39
    v_mul_f32 v177, v177, v39
    v_mul_f32 v178, v178, v39
    v_mul_f32 v179, v179, v39
    v_mul_f32 v184, v184, v39
    v_mul_f32 v185, v185, v39
    v_mul_f32 v186, v186, v39
    v_mul_f32 v187, v187, v39
    v_mul_f32 v192, v192, v39
    v_mul_f32 v193, v193, v39
    v_mul_f32 v194, v194, v39
    v_mul_f32 v195, v195, v39
    v_mul_f32 v200, v200, v39
    v_mul_f32 v201, v201, v39
    v_mul_f32 v202, v202, v39
    v_mul_f32 v203, v203, v39
    v_mul_f32 v32, v32, v39
    v_sub_f32 v96, v96, v36
    v_sub_f32 v97, v97, v36
    v_sub_f32 v98, v98, v36
    v_sub_f32 v99, v99, v36
    v_sub_f32 v64, v64, v36
    v_sub_f32 v65, v65, v36
    v_sub_f32 v66, v66, v36
    v_sub_f32 v67, v67, v36
    v_sub_f32 v72, v72, v36
    v_sub_f32 v73, v73, v36
    v_sub_f32 v74, v74, v36
    v_sub_f32 v75, v75, v36
    v_max3_f32 v37, v68, v69, v70
    v_max3_f32 v37, v37, v71, v76
    v_max3_f32 v37, v37, v77, v78
    v_max_f32 v37, v37, v79
    v_mov_b32 v38, v37
    s_nop 0
    s_nop 0
    v_permlane16_swap_b32 v37, v38
    v_max_f32 v37, v37, v38
    v_mov_b32 v38, v37
    s_nop 0
    s_nop 0
    v_permlane32_swap_b32 v37, v38
    v_max_f32 v37, v37, v38
    v_ceil_f32 v37, v37
    v_max_f32 v37, 0, v37
    v_sub_f32 v39, 0, v37
    v_exp_f32 v39, v39
    s_nop 0
    v_mul_f32 v148, v148, v39
    v_mul_f32 v149, v149, v39
    v_mul_f32 v150, v150, v39
    v_mul_f32 v151, v151, v39
    v_mul_f32 v156, v156, v39
    v_mul_f32 v157, v157, v39
    v_mul_f32 v158, v158, v39
    v_mul_f32 v159, v159, v39
    v_mul_f32 v164, v164, v39
    v_mul_f32 v165, v165, v39
    v_mul_f32 v166, v166, v39
    v_mul_f32 v167, v167, v39
    v_mul_f32 v172, v172, v39
    v_mul_f32 v173, v173, v39
    v_mul_f32 v174, v174, v39
    v_mul_f32 v175, v175, v39
    v_mul_f32 v180, v180, v39
    v_mul_f32 v181, v181, v39
    v_mul_f32 v182, v182, v39
    v_mul_f32 v183, v183, v39
    v_mul_f32 v188, v188, v39
    v_mul_f32 v189, v189, v39
    v_mul_f32 v190, v190, v39
    v_mul_f32 v191, v191, v39
    v_mul_f32 v196, v196, v39
    v_mul_f32 v197, v197, v39
    v_mul_f32 v198, v198, v39
    v_mul_f32 v199, v199, v39
    v_mul_f32 v204, v204, v39
    v_mul_f32 v205, v205, v39
    v_mul_f32 v206, v206, v39
    v_mul_f32 v207, v207, v39
    v_mul_f32 v33, v33, v39
    v_sub_f32 v100, v100, v37
    v_sub_f32 v101, v101, v37
    v_sub_f32 v102, v102, v37
    v_sub_f32 v103, v103, v37
    v_sub_f32 v68, v68, v37
    v_sub_f32 v69, v69, v37
    v_sub_f32 v70, v70, v37
    v_sub_f32 v71, v71, v37
    v_sub_f32 v76, v76, v37
    v_sub_f32 v77, v77, v37
    v_sub_f32 v78, v78, v37
    v_sub_f32 v79, v79, v37
    v_exp_f32 v40, v64
    v_exp_f32 v41, v65
    v_exp_f32 v42, v66
    v_exp_f32 v43, v67
    v_add_f32 v34, v40, v41
    v_cvt_pk_bf16_f32 v88, v40, v41
    v_add_f32 v34, v34, v42
    v_cvt_pk_bf16_f32 v89, v42, v43
    v_add_f32 v34, v34, v43
    v_exp_f32 v44, v72
    v_exp_f32 v45, v73
    v_exp_f32 v46, v74
    v_exp_f32 v47, v75
    v_add_f32 v34, v34, v44
    v_cvt_pk_bf16_f32 v90, v44, v45
    v_add_f32 v34, v34, v45
    v_cvt_pk_bf16_f32 v91, v46, v47
    v_add_f32 v34, v34, v46
    v_add_f32 v34, v34, v47
    v_exp_f32 v40, v68
    v_exp_f32 v41, v69
    v_exp_f32 v42, v70
    v_exp_f32 v43, v71
    v_add_f32 v35, v40, v41
    v_cvt_pk_bf16_f32 v92, v40, v41
    v_add_f32 v35, v35, v42
    v_cvt_pk_bf16_f32 v93, v42, v43
    v_add_f32 v35, v35, v43
    v_exp_f32 v44, v76
    v_exp_f32 v45, v77
    v_exp_f32 v46, v78
    v_exp_f32 v47, v79
    v_add_f32 v35, v35, v44
    v_cvt_pk_bf16_f32 v94, v44, v45
    v_add_f32 v35, v35, v45
    v_cvt_pk_bf16_f32 v95, v46, v47
    v_add_f32 v35, v35, v46
    v_add_f32 v35, v35, v47
    v_sub_f32 v48, v48, v36
    v_sub_f32 v49, v49, v36
    v_sub_f32 v50, v50, v36
    v_sub_f32 v51, v51, v36
    v_sub_f32 v56, v56, v36
    v_sub_f32 v57, v57, v36
    v_sub_f32 v58, v58, v36
    v_sub_f32 v59, v59, v36
    v_sub_f32 v52, v52, v37
    v_sub_f32 v53, v53, v37
    v_sub_f32 v54, v54, v37
    v_sub_f32 v55, v55, v37
    v_sub_f32 v60, v60, v37
    v_sub_f32 v61, v61, v37
    v_sub_f32 v62, v62, v37
    v_sub_f32 v63, v63, v37
    s_nop 3
    s_branch L_back_1
L_slow_2:
    s_nop 15
    v_max3_f32 v36, v48, v49, v50
    v_max3_f32 v36, v36, v51, v56
    v_max3_f32 v36, v36, v57, v58
    v_max_f32 v36, v36, v59
    v_mov_b32 v38, v36
    s_nop 0
    s_nop 0
    v_permlane16_swap_b32 v36, v38
    v_max_f32 v36, v36, v38
    v_mov_b32 v38, v36
    s_nop 0
    s_nop 0
    v_permlane32_swap_b32 v36, v38
    v_max_f32 v36, v36, v38
    v_ceil_f32 v36, v36
    v_max_f32 v36, 0, v36
    v_sub_f32 v39, 0, v36
    v_exp_f32 v39, v39
    s_nop 0
    v_mul_f32 v144, v144, v39
    v_mul_f32 v145, v145, v39
    v_mul_f32 v146, v146, v39
    v_mul_f32 v147, v147, v39
    v_mul_f32 v152, v152, v39
    v_mul_f32 v153, v153, v39
    v_mul_f32 v154, v154, v39
    v_mul_f32 v155, v155, v39
    v_mul_f32 v160, v160, v39
    v_mul_f32 v161, v161, v39
    v_mul_f32 v162, v162, v39
    v_mul_f32 v163, v163, v39
    v_mul_f32 v168, v168, v39
    v_mul_f32 v169, v169, v39
    v_mul_f32 v170, v170, v39
    v_mul_f32 v171, v171, v39
    v_mul_f32 v176, v176, v39
    v_mul_f32 v177, v177, v39
    v_mul_f32 v178, v178, v39
    v_mul_f32 v179, v179, v39
    v_mul_f32 v184, v184, v39
    v_mul_f32 v185, v185, v39
    v_mul_f32 v186, v186, v39
    v_mul_f32 v187, v187, v39
    v_mul_f32 v192, v192, v39
    v_mul_f32 v193, v193, v39
    v_mul_f32 v194, v194, v39
    v_mul_f32 v195, v195, v39
    v_mul_f32 v200, v200, v39
    v_mul_f32 v201, v201, v39
    v_mul_f32 v202, v202, v39
    v_mul_f32 v203, v203, v39
    v_mul_f32 v32, v32, v39
    v_sub_f32 v96, v96, v36
    v_sub_f32 v97, v97, v36
    v_sub_f32 v98, v98, v36
    v_sub_f32 v99, v99, v36
    v_sub_f32 v48, v48, v36
    v_sub_f32 v49, v49, v36
    v_sub_f32 v50, v50, v36
    v_sub_f32 v51, v51, v36
    v_sub_f32 v56, v56, v36
    v_sub_f32 v57, v57, v36
    v_sub_f32 v58, v58, v36
    v_sub_f32 v59, v59, v36
    v_max3_f32 v37, v52, v53, v54
    v_max3_f32 v37, v37, v55, v60
    v_max3_f32 v37, v37, v61, v62
    v_max_f32 v37, v37, v63
    v_mov_b32 v38, v37
    s_nop 0
    s_nop 0
    v_permlane16_swap_b32 v37, v38
    v_max_f32 v37, v37, v38
    v_mov_b32 v38, v37
    s_nop 0
    s_nop 0
    v_permlane32_swap_b32 v37, v38
    v_max_f32 v37, v37, v38
    v_ceil_f32 v37, v37
    v_max_f32 v37, 0, v37
    v_sub_f32 v39, 0, v37
    v_exp_f32 v39, v39
    s_nop 0
    v_mul_f32 v148, v148, v39
    v_mul_f32 v149, v149, v39
    v_mul_f32 v150, v150, v39
    v_mul_f32 v151, v151, v39
    v_mul_f32 v156, v156, v39
    v_mul_f32 v157, v157, v39
    v_mul_f32 v158, v158, v39
    v_mul_f32 v159, v159, v39
    v_mul_f32 v164, v164, v39
    v_mul_f32 v165, v165, v39
    v_mul_f32 v166, v166, v39
    v_mul_f32 v167, v167, v39
    v_mul_f32 v172, v172, v39
    v_mul_f32 v173, v173, v39
    v_mul_f32 v174, v174, v39
    v_mul_f32 v175, v175, v39
    v_mul_f32 v180, v180, v39
    v_mul_f32 v181, v181, v39
    v_mul_f32 v182, v182, v39
    v_mul_f32 v183, v183, v39
    v_mul_f32 v188, v188, v39
    v_mul_f32 v189, v189, v39
    v_mul_f32 v190, v190, v39
    v_mul_f32 v191, v191, v39
    v_mul_f32 v196, v196, v39
    v_mul_f32 v197, v197, v39
    v_mul_f32 v198, v198, v39
    v_mul_f32 v199, v199, v39
    v_mul_f32 v204, v204, v39
    v_mul_f32 v205, v205, v39
    v_mul_f32 v206, v206, v39
    v_mul_f32 v207, v207, v39
    v_mul_f32 v33, v33, v39
    v_sub_f32 v100, v100, v37
    v_sub_f32 v101, v101, v37
    v_sub_f32 v102, v102, v37
    v_sub_f32 v103, v103, v37
    v_sub_f32 v52, v52, v37
    v_sub_f32 v53, v53, v37
    v_sub_f32 v54, v54, v37
    v_sub_f32 v55, v55, v37
    v_sub_f32 v60, v60, v37
    v_sub_f32 v61, v61, v37
    v_sub_f32 v62, v62, v37
    v_sub_f32 v63, v63, v37
    v_exp_f32 v40, v48
    v_exp_f32 v41, v49
    v_exp_f32 v42, v50
    v_exp_f32 v43, v51
    v_add_f32 v34, v40, v41
    v_cvt_pk_bf16_f32 v80, v40, v41
    v_add_f32 v34, v34, v42
    v_cvt_pk_bf16_f32 v81, v42, v43
    v_add_f32 v34, v34, v43
    v_exp_f32 v44, v56
    v_exp_f32 v45, v57
    v_exp_f32 v46, v58
    v_exp_f32 v47, v59
    v_add_f32 v34, v34, v44
    v_cvt_pk_bf16_f32 v82, v44, v45
    v_add_f32 v34, v34, v45
    v_cvt_pk_bf16_f32 v83, v46, v47
    v_add_f32 v34, v34, v46
    v_add_f32 v34, v34, v47
    v_exp_f32 v40, v52
    v_exp_f32 v41, v53
    v_exp_f32 v42, v54
    v_exp_f32 v43, v55
    v_add_f32 v35, v40, v41
    v_cvt_pk_bf16_f32 v84, v40, v41
    v_add_f32 v35, v35, v42
    v_cvt_pk_bf16_f32 v85, v42, v43
    v_add_f32 v35, v35, v43
    v_exp_f32 v44, v60
    v_exp_f32 v45, v61
    v_exp_f32 v46, v62
    v_exp_f32 v47, v63
    v_add_f32 v35, v35, v44
    v_cvt_pk_bf16_f32 v86, v44, v45
    v_add_f32 v35, v35, v45
    v_cvt_pk_bf16_f32 v87, v46, v47
    v_add_f32 v35, v35, v46
    v_add_f32 v35, v35, v47
    v_sub_f32 v64, v64, v36
    v_sub_f32 v65, v65, v36
    v_sub_f32 v66, v66, v36
    v_sub_f32 v67, v67, v36
    v_sub_f32 v72, v72, v36
    v_sub_f32 v73, v73, v36
    v_sub_f32 v74, v74, v36
    v_sub_f32 v75, v75, v36
    v_sub_f32 v68, v68, v37
    v_sub_f32 v69, v69, v37
    v_sub_f32 v70, v70, v37
    v_sub_f32 v71, v71, v37
    v_sub_f32 v76, v76, v37
    v_sub_f32 v77, v77, v37
    v_sub_f32 v78, v78, v37
    v_sub_f32 v79, v79, v37
    s_nop 3
    s_branch L_back_2
L_slow_3:
    s_nop 15
    v_max3_f32 v36, v64, v65, v66
    v_max3_f32 v36, v36, v67, v72
    v_max3_f32 v36, v36, v73, v74
    v_max_f32 v36, v36, v75
    v_mov_b32 v38, v36
    s_nop 0
    s_nop 0
    v_permlane16_swap_b32 v36, v38
    v_max_f32 v36, v36, v38
    v_mov_b32 v38, v36
    s_nop 0
    s_nop 0
    v_permlane32_swap_b32 v36, v38
    v_max_f32 v36, v36, v38
    v_ceil_f32 v36, v36
    v_max_f32 v36, 0, v36
    v_sub_f32 v39, 0, v36
    v_exp_f32 v39, v39
    s_nop 0
    v_mul_f32 v144, v144, v39
    v_mul_f32 v145, v145, v39
    v_mul_f32 v146, v146, v39
    v_mul_f32 v147, v147, v39
    v_mul_f32 v152, v152, v39
    v_mul_f32 v153, v153, v39
    v_mul_f32 v154, v154, v39
    v_mul_f32 v155, v155, v39
    v_mul_f32 v160, v160, v39
    v_mul_f32 v161, v161, v39
    v_mul_f32 v162, v162, v39
    v_mul_f32 v163, v163, v39
    v_mul_f32 v168, v168, v39
    v_mul_f32 v169, v169, v39
    v_mul_f32 v170, v170, v39
    v_mul_f32 v171, v171, v39
    v_mul_f32 v176, v176, v39
    v_mul_f32 v177, v177, v39
    v_mul_f32 v178, v178, v39
    v_mul_f32 v179, v179, v39
    v_mul_f32 v184, v184, v39
    v_mul_f32 v185, v185, v39
    v_mul_f32 v186, v186, v39
    v_mul_f32 v187, v187, v39
    v_mul_f32 v192, v192, v39
    v_mul_f32 v193, v193, v39
    v_mul_f32 v194, v194, v39
    v_mul_f32 v195, v195, v39
    v_mul_f32 v200, v200, v39
    v_mul_f32 v201, v201, v39
    v_mul_f32 v202, v202, v39
    v_mul_f32 v203, v203, v39
    v_mul_f32 v32, v32, v39
    v_sub_f32 v96, v96, v36
    v_sub_f32 v97, v97, v36
    v_sub_f32 v98, v98, v36
    v_sub_f32 v99, v99, v36
    v_sub_f32 v64, v64, v36
    v_sub_f32 v65, v65, v36
    v_sub_f32 v66, v66, v36
    v_sub_f32 v67, v67, v36
    v_sub_f32 v72, v72, v36
    v_sub_f32 v73, v73, v36
    v_sub_f32 v74, v74, v36
    v_sub_f32 v75, v75, v36
    v_max3_f32 v37, v68, v69, v70
    v_max3_f32 v37, v37, v71, v76
    v_max3_f32 v37, v37, v77, v78
    v_max_f32 v37, v37, v79
    v_mov_b32 v38, v37
    s_nop 0
    s_nop 0
    v_permlane16_swap_b32 v37, v38
    v_max_f32 v37, v37, v38
    v_mov_b32 v38, v37
    s_nop 0
    s_nop 0
    v_permlane32_swap_b32 v37, v38
    v_max_f32 v37, v37, v38
    v_ceil_f32 v37, v37
    v_max_f32 v37, 0, v37
    v_sub_f32 v39, 0, v37
    v_exp_f32 v39, v39
    s_nop 0
    v_mul_f32 v148, v148, v39
    v_mul_f32 v149, v149, v39
    v_mul_f32 v150, v150, v39
    v_mul_f32 v151, v151, v39
    v_mul_f32 v156, v156, v39
    v_mul_f32 v157, v157, v39
    v_mul_f32 v158, v158, v39
    v_mul_f32 v159, v159, v39
    v_mul_f32 v164, v164, v39
    v_mul_f32 v165, v165, v39
    v_mul_f32 v166, v166, v39
    v_mul_f32 v167, v167, v39
    v_mul_f32 v172, v172, v39
    v_mul_f32 v173, v173, v39
    v_mul_f32 v174, v174, v39
    v_mul_f32 v175, v175, v39
    v_mul_f32 v180, v180, v39
    v_mul_f32 v181, v181, v39
    v_mul_f32 v182, v182, v39
    v_mul_f32 v183, v183, v39
    v_mul_f32 v188, v188, v39
    v_mul_f32 v189, v189, v39
    v_mul_f32 v190, v190, v39
    v_mul_f32 v191, v191, v39
    v_mul_f32 v196, v196, v39
    v_mul_f32 v197, v197, v39
    v_mul_f32 v198, v198, v39
    v_mul_f32 v199, v199, v39
    v_mul_f32 v204, v204, v39
    v_mul_f32 v205, v205, v39
    v_mul_f32 v206, v206, v39
    v_mul_f32 v207, v207, v39
    v_mul_f32 v33, v33, v39
    v_sub_f32 v100, v100, v37
    v_sub_f32 v101, v101, v37
    v_sub_f32 v102, v102, v37
    v_sub_f32 v103, v103, v37
    v_sub_f32 v68, v68, v37
    v_sub_f32 v69, v69, v37
    v_sub_f32 v70, v70, v37
    v_sub_f32 v71, v71, v37
    v_sub_f32 v76, v76, v37
    v_sub_f32 v77, v77, v37
    v_sub_f32 v78, v78, v37
    v_sub_f32 v79, v79, v37
    v_exp_f32 v40, v64
    v_exp_f32 v41, v65
    v_exp_f32 v42, v66
    v_exp_f32 v43, v67
    v_add_f32 v34, v40, v41
    v_cvt_pk_bf16_f32 v88, v40, v41
    v_add_f32 v34, v34, v42
    v_cvt_pk_bf16_f32 v89, v42, v43
    v_add_f32 v34, v34, v43
    v_exp_f32 v44, v72
    v_exp_f32 v45, v73
    v_exp_f32 v46, v74
    v_exp_f32 v47, v75
    v_add_f32 v34, v34, v44
    v_cvt_pk_bf16_f32 v90, v44, v45
    v_add_f32 v34, v34, v45
    v_cvt_pk_bf16_f32 v91, v46, v47
    v_add_f32 v34, v34, v46
    v_add_f32 v34, v34, v47
    v_exp_f32 v40, v68
    v_exp_f32 v41, v69
    v_exp_f32 v42, v70
    v_exp_f32 v43, v71
    v_add_f32 v35, v40, v41
    v_cvt_pk_bf16_f32 v92, v40, v41
    v_add_f32 v35, v35, v42
    v_cvt_pk_bf16_f32 v93, v42, v43
    v_add_f32 v35, v35, v43
    v_exp_f32 v44, v76
    v_exp_f32 v45, v77
    v_exp_f32 v46, v78
    v_exp_f32 v47, v79
    v_add_f32 v35, v35, v44
    v_cvt_pk_bf16_f32 v94, v44, v45
    v_add_f32 v35, v35, v45
    v_cvt_pk_bf16_f32 v95, v46, v47
    v_add_f32 v35, v35, v46
    v_add_f32 v35, v35, v47
    v_sub_f32 v48, v48, v36
    v_sub_f32 v49, v49, v36
    v_sub_f32 v50, v50, v36
    v_sub_f32 v51, v51, v36
    v_sub_f32 v56, v56, v36
    v_sub_f32 v57, v57, v36
    v_sub_f32 v58, v58, v36
    v_sub_f32 v59, v59, v36
    v_sub_f32 v52, v52, v37
    v_sub_f32 v53, v53, v37
    v_sub_f32 v54, v54, v37
    v_sub_f32 v55, v55, v37
    v_sub_f32 v60, v60, v37
    v_sub_f32 v61, v61, v37
    v_sub_f32 v62, v62, v37
    v_sub_f32 v63, v63, v37
    s_nop 3
    s_branch L_back_3
L_slow_4:
    s_nop 15
    v_max3_f32 v36, v48, v49, v50
    v_max3_f32 v36, v36, v51, v56
    v_max3_f32 v36, v36, v57, v58
    v_max_f32 v36, v36, v59
    v_mov_b32 v38, v36
    s_nop 0
    s_nop 0
    v_permlane16_swap_b32 v36, v38
    v_max_f32 v36, v36, v38
    v_mov_b32 v38, v36
    s_nop 0
    s_nop 0
    v_permlane32_swap_b32 v36, v38
    v_max_f32 v36, v36, v38
    v_ceil_f32 v36, v36
    v_max_f32 v36, 0, v36
    v_sub_f32 v39, 0, v36
    v_exp_f32 v39, v39
    s_nop 0
    v_mul_f32 v144, v144, v39
    v_mul_f32 v145, v145, v39
    v_mul_f32 v146, v146, v39
    v_mul_f32 v147, v147, v39
    v_mul_f32 v152, v152, v39
    v_mul_f32 v153, v153, v39
    v_mul_f32 v154, v154, v39
    v_mul_f32 v155, v155, v39
    v_mul_f32 v160, v160, v39
    v_mul_f32 v161, v161, v39
    v_mul_f32 v162, v162, v39
    v_mul_f32 v163, v163, v39
    v_mul_f32 v168, v168, v39
    v_mul_f32 v169, v169, v39
    v_mul_f32 v170, v170, v39
    v_mul_f32 v171, v171, v39
    v_mul_f32 v176, v176, v39
    v_mul_f32 v177, v177, v39
    v_mul_f32 v178, v178, v39
    v_mul_f32 v179, v179, v39
    v_mul_f32 v184, v184, v39
    v_mul_f32 v185, v185, v39
    v_mul_f32 v186, v186, v39
    v_mul_f32 v187, v187, v39
    v_mul_f32 v192, v192, v39
    v_mul_f32 v193, v193, v39
    v_mul_f32 v194, v194, v39
    v_mul_f32 v195, v195, v39
    v_mul_f32 v200, v200, v39
    v_mul_f32 v201, v201, v39
    v_mul_f32 v202, v202, v39
    v_mul_f32 v203, v203, v39
    v_mul_f32 v32, v32, v39
    v_sub_f32 v96, v96, v36
    v_sub_f32 v97, v97, v36
    v_sub_f32 v98, v98, v36
    v_sub_f32 v99, v99, v36
    v_sub_f32 v48, v48, v36
    v_sub_f32 v49, v49, v36
    v_sub_f32 v50, v50, v36
    v_sub_f32 v51, v51, v36
    v_sub_f32 v56, v56, v36
    v_sub_f32 v57, v57, v36
    v_sub_f32 v58, v58, v36
    v_sub_f32 v59, v59, v36
    v_max3_f32 v37, v52, v53, v54
    v_max3_f32 v37, v37, v55, v60
    v_max3_f32 v37, v37, v61, v62
    v_max_f32 v37, v37, v63
    v_mov_b32 v38, v37
    s_nop 0
    s_nop 0
    v_permlane16_swap_b32 v37, v38
    v_max_f32 v37, v37, v38
    v_mov_b32 v38, v37
    s_nop 0
    s_nop 0
    v_permlane32_swap_b32 v37, v38
    v_max_f32 v37, v37, v38
    v_ceil_f32 v37, v37
    v_max_f32 v37, 0, v37
    v_sub_f32 v39, 0, v37
    v_exp_f32 v39, v39
    s_nop 0
    v_mul_f32 v148, v148, v39
    v_mul_f32 v149, v149, v39
    v_mul_f32 v150, v150, v39
    v_mul_f32 v151, v151, v39
    v_mul_f32 v156, v156, v39
    v_mul_f32 v157, v157, v39
    v_mul_f32 v158, v158, v39
    v_mul_f32 v159, v159, v39
    v_mul_f32 v164, v164, v39
    v_mul_f32 v165, v165, v39
    v_mul_f32 v166, v166, v39
    v_mul_f32 v167, v167, v39
    v_mul_f32 v172, v172, v39
    v_mul_f32 v173, v173, v39
    v_mul_f32 v174, v174, v39
    v_mul_f32 v175, v175, v39
    v_mul_f32 v180, v180, v39
    v_mul_f32 v181, v181, v39
    v_mul_f32 v182, v182, v39
    v_mul_f32 v183, v183, v39
    v_mul_f32 v188, v188, v39
    v_mul_f32 v189, v189, v39
    v_mul_f32 v190, v190, v39
    v_mul_f32 v191, v191, v39
    v_mul_f32 v196, v196, v39
    v_mul_f32 v197, v197, v39
    v_mul_f32 v198, v198, v39
    v_mul_f32 v199, v199, v39
    v_mul_f32 v204, v204, v39
    v_mul_f32 v205, v205, v39
    v_mul_f32 v206, v206, v39
    v_mul_f32 v207, v207, v39
    v_mul_f32 v33, v33, v39
    v_sub_f32 v100, v100, v37
    v_sub_f32 v101, v101, v37
    v_sub_f32 v102, v102, v37
    v_sub_f32 v103, v103, v37
    v_sub_f32 v52, v52, v37
    v_sub_f32 v53, v53, v37
    v_sub_f32 v54, v54, v37
    v_sub_f32 v55, v55, v37
    v_sub_f32 v60, v60, v37
    v_sub_f32 v61, v61, v37
    v_sub_f32 v62, v62, v37
    v_sub_f32 v63, v63, v37
    v_exp_f32 v40, v48
    v_exp_f32 v41, v49
    v_exp_f32 v42, v50
    v_exp_f32 v43, v51
    v_add_f32 v34, v40, v41
    v_cvt_pk_bf16_f32 v80, v40, v41
    v_add_f32 v34, v34, v42
    v_cvt_pk_bf16_f32 v81, v42, v43
    v_add_f32 v34, v34, v43
    v_exp_f32 v44, v56
    v_exp_f32 v45, v57
    v_exp_f32 v46, v58
    v_exp_f32 v47, v59
    v_add_f32 v34, v34, v44
    v_cvt_pk_bf16_f32 v82, v44, v45
    v_add_f32 v34, v34, v45
    v_cvt_pk_bf16_f32 v83, v46, v47
    v_add_f32 v34, v34, v46
    v_add_f32 v34, v34, v47
    v_exp_f32 v40, v52
    v_exp_f32 v41, v53
    v_exp_f32 v42, v54
    v_exp_f32 v43, v55
    v_add_f32 v35, v40, v41
    v_cvt_pk_bf16_f32 v84, v40, v41
    v_add_f32 v35, v35, v42
    v_cvt_pk_bf16_f32 v85, v42, v43
    v_add_f32 v35, v35, v43
    v_exp_f32 v44, v60
    v_exp_f32 v45, v61
    v_exp_f32 v46, v62
    v_exp_f32 v47, v63
    v_add_f32 v35, v35, v44
    v_cvt_pk_bf16_f32 v86, v44, v45
    v_add_f32 v35, v35, v45
    v_cvt_pk_bf16_f32 v87, v46, v47
    v_add_f32 v35, v35, v46
    v_add_f32 v35, v35, v47
    v_sub_f32 v64, v64, v36
    v_sub_f32 v65, v65, v36
    v_sub_f32 v66, v66, v36
    v_sub_f32 v67, v67, v36
    v_sub_f32 v72, v72, v36
    v_sub_f32 v73, v73, v36
    v_sub_f32 v74, v74, v36
    v_sub_f32 v75, v75, v36
    v_sub_f32 v68, v68, v37
    v_sub_f32 v69, v69, v37
    v_sub_f32 v70, v70, v37
    v_sub_f32 v71, v71, v37
    v_sub_f32 v76, v76, v37
    v_sub_f32 v77, v77, v37
    v_sub_f32 v78, v78, v37
    v_sub_f32 v79, v79, v37
    s_nop 3
    s_branch L_back_4
L_slow_5:
    s_nop 15
    v_max3_f32 v36, v64, v65, v66
    v_max3_f32 v36, v36, v67, v72
    v_max3_f32 v36, v36, v73, v74
    v_max_f32 v36, v36, v75
    v_mov_b32 v38, v36
    s_nop 0
    s_nop 0
    v_permlane16_swap_b32 v36, v38
    v_max_f32 v36, v36, v38
    v_mov_b32 v38, v36
    s_nop 0
    s_nop 0
    v_permlane32_swap_b32 v36, v38
    v_max_f32 v36, v36, v38
    v_ceil_f32 v36, v36
    v_max_f32 v36, 0, v36
    v_sub_f32 v39, 0, v36
    v_exp_f32 v39, v39
    s_nop 0
    v_mul_f32 v144, v144, v39
    v_mul_f32 v145, v145, v39
    v_mul_f32 v146, v146, v39
    v_mul_f32 v147, v147, v39
    v_mul_f32 v152, v152, v39
    v_mul_f32 v153, v153, v39
    v_mul_f32 v154, v154, v39
    v_mul_f32 v155, v155, v39
    v_mul_f32 v160, v160, v39
    v_mul_f32 v161, v161, v39
    v_mul_f32 v162, v162, v39
    v_mul_f32 v163, v163, v39
    v_mul_f32 v168, v168, v39
    v_mul_f32 v169, v169, v39
    v_mul_f32 v170, v170, v39
    v_mul_f32 v171, v171, v39
    v_mul_f32 v176, v176, v39
    v_mul_f32 v177, v177, v39
    v_mul_f32 v178, v178, v39
    v_mul_f32 v179, v179, v39
    v_mul_f32 v184, v184, v39
    v_mul_f32 v185, v185, v39
    v_mul_f32 v186, v186, v39
    v_mul_f32 v187, v187, v39
    v_mul_f32 v192, v192, v39
    v_mul_f32 v193, v193, v39
    v_mul_f32 v194, v194, v39
    v_mul_f32 v195, v195, v39
    v_mul_f32 v200, v200, v39
    v_mul_f32 v201, v201, v39
    v_mul_f32 v202, v202, v39
    v_mul_f32 v203, v203, v39
    v_mul_f32 v32, v32, v39
    v_sub_f32 v96, v96, v36
    v_sub_f32 v97, v97, v36
    v_sub_f32 v98, v98, v36
    v_sub_f32 v99, v99, v36
    v_sub_f32 v64, v64, v36
    v_sub_f32 v65, v65, v36
    v_sub_f32 v66, v66, v36
    v_sub_f32 v67, v67, v36
    v_sub_f32 v72, v72, v36
    v_sub_f32 v73, v73, v36
    v_sub_f32 v74, v74, v36
    v_sub_f32 v75, v75, v36
    v_max3_f32 v37, v68, v69, v70
    v_max3_f32 v37, v37, v71, v76
    v_max3_f32 v37, v37, v77, v78
    v_max_f32 v37, v37, v79
    v_mov_b32 v38, v37
    s_nop 0
    s_nop 0
    v_permlane16_swap_b32 v37, v38
    v_max_f32 v37, v37, v38
    v_mov_b32 v38, v37
    s_nop 0
    s_nop 0
    v_permlane32_swap_b32 v37, v38
    v_max_f32 v37, v37, v38
    v_ceil_f32 v37, v37
    v_max_f32 v37, 0, v37
    v_sub_f32 v39, 0, v37
    v_exp_f32 v39, v39
    s_nop 0
    v_mul_f32 v148, v148, v39
    v_mul_f32 v149, v149, v39
    v_mul_f32 v150, v150, v39
    v_mul_f32 v151, v151, v39
    v_mul_f32 v156, v156, v39
    v_mul_f32 v157, v157, v39
    v_mul_f32 v158, v158, v39
    v_mul_f32 v159, v159, v39
    v_mul_f32 v164, v164, v39
    v_mul_f32 v165, v165, v39
    v_mul_f32 v166, v166, v39
    v_mul_f32 v167, v167, v39
    v_mul_f32 v172, v172, v39
    v_mul_f32 v173, v173, v39
    v_mul_f32 v174, v174, v39
    v_mul_f32 v175, v175, v39
    v_mul_f32 v180, v180, v39
    v_mul_f32 v181, v181, v39
    v_mul_f32 v182, v182, v39
    v_mul_f32 v183, v183, v39
    v_mul_f32 v188, v188, v39
    v_mul_f32 v189, v189, v39
    v_mul_f32 v190, v190, v39
    v_mul_f32 v191, v191, v39
    v_mul_f32 v196, v196, v39
    v_mul_f32 v197, v197, v39
    v_mul_f32 v198, v198, v39
    v_mul_f32 v199, v199, v39
    v_mul_f32 v204, v204, v39
    v_mul_f32 v205, v205, v39
    v_mul_f32 v206, v206, v39
    v_mul_f32 v207, v207, v39
    v_mul_f32 v33, v33, v39
    v_sub_f32 v100, v100, v37
    v_sub_f32 v101, v101, v37
    v_sub_f32 v102, v102, v37
    v_sub_f32 v103, v103, v37
    v_sub_f32 v68, v68, v37
    v_sub_f32 v69, v69, v37
    v_sub_f32 v70, v70, v37
    v_sub_f32 v71, v71, v37
    v_sub_f32 v76, v76, v37
    v_sub_f32 v77, v77, v37
    v_sub_f32 v78, v78, v37
    v_sub_f32 v79, v79, v37
    v_exp_f32 v40, v64
    v_exp_f32 v41, v65
    v_exp_f32 v42, v66
    v_exp_f32 v43, v67
    v_add_f32 v34, v40, v41
    v_cvt_pk_bf16_f32 v88, v40, v41
    v_add_f32 v34, v34, v42
    v_cvt_pk_bf16_f32 v89, v42, v43
    v_add_f32 v34, v34, v43
    v_exp_f32 v44, v72
    v_exp_f32 v45, v73
    v_exp_f32 v46, v74
    v_exp_f32 v47, v75
    v_add_f32 v34, v34, v44
    v_cvt_pk_bf16_f32 v90, v44, v45
    v_add_f32 v34, v34, v45
    v_cvt_pk_bf16_f32 v91, v46, v47
    v_add_f32 v34, v34, v46
    v_add_f32 v34, v34, v47
    v_exp_f32 v40, v68
    v_exp_f32 v41, v69
    v_exp_f32 v42, v70
    v_exp_f32 v43, v71
    v_add_f32 v35, v40, v41
    v_cvt_pk_bf16_f32 v92, v40, v41
    v_add_f32 v35, v35, v42
    v_cvt_pk_bf16_f32 v93, v42, v43
    v_add_f32 v35, v35, v43
    v_exp_f32 v44, v76
    v_exp_f32 v45, v77
    v_exp_f32 v46, v78
    v_exp_f32 v47, v79
    v_add_f32 v35, v35, v44
    v_cvt_pk_bf16_f32 v94, v44, v45
    v_add_f32 v35, v35, v45
    v_cvt_pk_bf16_f32 v95, v46, v47
    v_add_f32 v35, v35, v46
    v_add_f32 v35, v35, v47
    v_sub_f32 v48, v48, v36
    v_sub_f32 v49, v49, v36
    v_sub_f32 v50, v50, v36
    v_sub_f32 v51, v51, v36
    v_sub_f32 v56, v56, v36
    v_sub_f32 v57, v57, v36
    v_sub_f32 v58, v58, v36
    v_sub_f32 v59, v59, v36
    v_sub_f32 v52, v52, v37
    v_sub_f32 v53, v53, v37
    v_sub_f32 v54, v54, v37
    v_sub_f32 v55, v55, v37
    v_sub_f32 v60, v60, v37
    v_sub_f32 v61, v61, v37
    v_sub_f32 v62, v62, v37
    v_sub_f32 v63, v63, v37
    s_nop 3
    s_branch L_back_5
L_slow_6:
    s_nop 15
    v_max3_f32 v36, v48, v49, v50
    v_max3_f32 v36, v36, v51, v56
    v_max3_f32 v36, v36, v57, v58
    v_max_f32 v36, v36, v59
    v_mov_b32 v38, v36
    s_nop 0
    s_nop 0
    v_permlane16_swap_b32 v36, v38
    v_max_f32 v36, v36, v38
    v_mov_b32 v38, v36
    s_nop 0
    s_nop 0
    v_permlane32_swap_b32 v36, v38
    v_max_f32 v36, v36, v38
    v_ceil_f32 v36, v36
    v_max_f32 v36, 0, v36
    v_sub_f32 v39, 0, v36
    v_exp_f32 v39, v39
    s_nop 0
    v_mul_f32 v144, v144, v39
    v_mul_f32 v145, v145, v39
    v_mul_f32 v146, v146, v39
    v_mul_f32 v147, v147, v39
    v_mul_f32 v152, v152, v39
    v_mul_f32 v153, v153, v39
    v_mul_f32 v154, v154, v39
    v_mul_f32 v155, v155, v39
    v_mul_f32 v160, v160, v39
    v_mul_f32 v161, v161, v39
    v_mul_f32 v162, v162, v39
    v_mul_f32 v163, v163, v39
    v_mul_f32 v168, v168, v39
    v_mul_f32 v169, v169, v39
    v_mul_f32 v170, v170, v39
    v_mul_f32 v171, v171, v39
    v_mul_f32 v176, v176, v39
    v_mul_f32 v177, v177, v39
    v_mul_f32 v178, v178, v39
    v_mul_f32 v179, v179, v39
    v_mul_f32 v184, v184, v39
    v_mul_f32 v185, v185, v39
    v_mul_f32 v186, v186, v39
    v_mul_f32 v187, v187, v39
    v_mul_f32 v192, v192, v39
    v_mul_f32 v193, v193, v39
    v_mul_f32 v194, v194, v39
    v_mul_f32 v195, v195, v39
    v_mul_f32 v200, v200, v39
    v_mul_f32 v201, v201, v39
    v_mul_f32 v202, v202, v39
    v_mul_f32 v203, v203, v39
    v_mul_f32 v32, v32, v39
    v_sub_f32 v96, v96, v36
    v_sub_f32 v97, v97, v36
    v_sub_f32 v98, v98, v36
    v_sub_f32 v99, v99, v36
    v_sub_f32 v48, v48, v36
    v_sub_f32 v49, v49, v36
    v_sub_f32 v50, v50, v36
    v_sub_f32 v51, v51, v36
    v_sub_f32 v56, v56, v36
    v_sub_f32 v57, v57, v36
    v_sub_f32 v58, v58, v36
    v_sub_f32 v59, v59, v36
    v_max3_f32 v37, v52, v53, v54
    v_max3_f32 v37, v37, v55, v60
    v_max3_f32 v37, v37, v61, v62
    v_max_f32 v37, v37, v63
    v_mov_b32 v38, v37
    s_nop 0
    s_nop 0
    v_permlane16_swap_b32 v37, v38
    v_max_f32 v37, v37, v38
    v_mov_b32 v38, v37
    s_nop 0
    s_nop 0
    v_permlane32_swap_b32 v37, v38
    v_max_f32 v37, v37, v38
    v_ceil_f32 v37, v37
    v_max_f32 v37, 0, v37
    v_sub_f32 v39, 0, v37
    v_exp_f32 v39, v39
    s_nop 0
    v_mul_f32 v148, v148, v39
    v_mul_f32 v149, v149, v39
    v_mul_f32 v150, v150, v39
    v_mul_f32 v151, v151, v39
    v_mul_f32 v156, v156, v39
    v_mul_f32 v157, v157, v39
    v_mul_f32 v158, v158, v39
    v_mul_f32 v159, v159, v39
    v_mul_f32 v164, v164, v39
    v_mul_f32 v165, v165, v39
    v_mul_f32 v166, v166, v39
    v_mul_f32 v167, v167, v39
    v_mul_f32 v172, v172, v39
    v_mul_f32 v173, v173, v39
    v_mul_f32 v174, v174, v39
    v_mul_f32 v175, v175, v39
    v_mul_f32 v180, v180, v39
    v_mul_f32 v181, v181, v39
    v_mul_f32 v182, v182, v39
    v_mul_f32 v183, v183, v39
    v_mul_f32 v188, v188, v39
    v_mul_f32 v189, v189, v39
    v_mul_f32 v190, v190, v39
    v_mul_f32 v191, v191, v39
    v_mul_f32 v196, v196, v39
    v_mul_f32 v197, v197, v39
    v_mul_f32 v198, v198, v39
    v_mul_f32 v199, v199, v39
    v_mul_f32 v204, v204, v39
    v_mul_f32 v205, v205, v39
    v_mul_f32 v206, v206, v39
    v_mul_f32 v207, v207, v39
    v_mul_f32 v33, v33, v39
    v_sub_f32 v100, v100, v37
    v_sub_f32 v101, v101, v37
    v_sub_f32 v102, v102, v37
    v_sub_f32 v103, v103, v37
    v_sub_f32 v52, v52, v37
    v_sub_f32 v53, v53, v37
    v_sub_f32 v54, v54, v37
    v_sub_f32 v55, v55, v37
    v_sub_f32 v60, v60, v37
    v_sub_f32 v61, v61, v37
    v_sub_f32 v62, v62, v37
    v_sub_f32 v63, v63, v37
    v_exp_f32 v40, v48
    v_exp_f32 v41, v49
    v_exp_f32 v42, v50
    v_exp_f32 v43, v51
    v_add_f32 v34, v40, v41
    v_cvt_pk_bf16_f32 v80, v40, v41
    v_add_f32 v34, v34, v42
    v_cvt_pk_bf16_f32 v81, v42, v43
    v_add_f32 v34, v34, v43
    v_exp_f32 v44, v56
    v_exp_f32 v45, v57
    v_exp_f32 v46, v58
    v_exp_f32 v47, v59
    v_add_f32 v34, v34, v44
    v_cvt_pk_bf16_f32 v82, v44, v45
    v_add_f32 v34, v34, v45
    v_cvt_pk_bf16_f32 v83, v46, v47
    v_add_f32 v34, v34, v46
    v_add_f32 v34, v34, v47
    v_exp_f32 v40, v52
    v_exp_f32 v41, v53
    v_exp_f32 v42, v54
    v_exp_f32 v43, v55
    v_add_f32 v35, v40, v41
    v_cvt_pk_bf16_f32 v84, v40, v41
    v_add_f32 v35, v35, v42
    v_cvt_pk_bf16_f32 v85, v42, v43
    v_add_f32 v35, v35, v43
    v_exp_f32 v44, v60
    v_exp_f32 v45, v61
    v_exp_f32 v46, v62
    v_exp_f32 v47, v63
    v_add_f32 v35, v35, v44
    v_cvt_pk_bf16_f32 v86, v44, v45
    v_add_f32 v35, v35, v45
    v_cvt_pk_bf16_f32 v87, v46, v47
    v_add_f32 v35, v35, v46
    v_add_f32 v35, v35, v47
    v_sub_f32 v64, v64, v36
    v_sub_f32 v65, v65, v36
    v_sub_f32 v66, v66, v36
    v_sub_f32 v67, v67, v36
    v_sub_f32 v72, v72, v36
    v_sub_f32 v73, v73, v36
    v_sub_f32 v74, v74, v36
    v_sub_f32 v75, v75, v36
    v_sub_f32 v68, v68, v37
    v_sub_f32 v69, v69, v37
    v_sub_f32 v70, v70, v37
    v_sub_f32 v71, v71, v37
    v_sub_f32 v76, v76, v37
    v_sub_f32 v77, v77, v37
    v_sub_f32 v78, v78, v37
    v_sub_f32 v79, v79, v37
    s_nop 3
    s_branch L_back_6
L_slow_7:
    s_nop 15
    v_max3_f32 v36, v64, v65, v66
    v_max3_f32 v36, v36, v67, v72
    v_max3_f32 v36, v36, v73, v74
    v_max_f32 v36, v36, v75
    v_mov_b32 v38, v36
    s_nop 0
    s_nop 0
    v_permlane16_swap_b32 v36, v38
    v_max_f32 v36, v36, v38
    v_mov_b32 v38, v36
    s_nop 0
    s_nop 0
    v_permlane32_swap_b32 v36, v38
    v_max_f32 v36, v36, v38
    v_ceil_f32 v36, v36
    v_max_f32 v36, 0, v36
    v_sub_f32 v39, 0, v36
    v_exp_f32 v39, v39
    s_nop 0
    v_mul_f32 v144, v144, v39
    v_mul_f32 v145, v145, v39
    v_mul_f32 v146, v146, v39
    v_mul_f32 v147, v147, v39
    v_mul_f32 v152, v152, v39
    v_mul_f32 v153, v153, v39
    v_mul_f32 v154, v154, v39
    v_mul_f32 v155, v155, v39
    v_mul_f32 v160, v160, v39
    v_mul_f32 v161, v161, v39
    v_mul_f32 v162, v162, v39
    v_mul_f32 v163, v163, v39
    v_mul_f32 v168, v168, v39
    v_mul_f32 v169, v169, v39
    v_mul_f32 v170, v170, v39
    v_mul_f32 v171, v171, v39
    v_mul_f32 v176, v176, v39
    v_mul_f32 v177, v177, v39
    v_mul_f32 v178, v178, v39
    v_mul_f32 v179, v179, v39
    v_mul_f32 v184, v184, v39
    v_mul_f32 v185, v185, v39
    v_mul_f32 v186, v186, v39
    v_mul_f32 v187, v187, v39
    v_mul_f32 v192, v192, v39
    v_mul_f32 v193, v193, v39
    v_mul_f32 v194, v194, v39
    v_mul_f32 v195, v195, v39
    v_mul_f32 v200, v200, v39
    v_mul_f32 v201, v201, v39
    v_mul_f32 v202, v202, v39
    v_mul_f32 v203, v203, v39
    v_mul_f32 v32, v32, v39
    v_sub_f32 v96, v96, v36
    v_sub_f32 v97, v97, v36
    v_sub_f32 v98, v98, v36
    v_sub_f32 v99, v99, v36
    v_sub_f32 v64, v64, v36
    v_sub_f32 v65, v65, v36
    v_sub_f32 v66, v66, v36
    v_sub_f32 v67, v67, v36
    v_sub_f32 v72, v72, v36
    v_sub_f32 v73, v73, v36
    v_sub_f32 v74, v74, v36
    v_sub_f32 v75, v75, v36
    v_max3_f32 v37, v68, v69, v70
    v_max3_f32 v37, v37, v71, v76
    v_max3_f32 v37, v37, v77, v78
    v_max_f32 v37, v37, v79
    v_mov_b32 v38, v37
    s_nop 0
    s_nop 0
    v_permlane16_swap_b32 v37, v38
    v_max_f32 v37, v37, v38
    v_mov_b32 v38, v37
    s_nop 0
    s_nop 0
    v_permlane32_swap_b32 v37, v38
    v_max_f32 v37, v37, v38
    v_ceil_f32 v37, v37
    v_max_f32 v37, 0, v37
    v_sub_f32 v39, 0, v37
    v_exp_f32 v39, v39
    s_nop 0
    v_mul_f32 v148, v148, v39
    v_mul_f32 v149, v149, v39
    v_mul_f32 v150, v150, v39
    v_mul_f32 v151, v151, v39
    v_mul_f32 v156, v156, v39
    v_mul_f32 v157, v157, v39
    v_mul_f32 v158, v158, v39
    v_mul_f32 v159, v159, v39
    v_mul_f32 v164, v164, v39
    v_mul_f32 v165, v165, v39
    v_mul_f32 v166, v166, v39
    v_mul_f32 v167, v167, v39
    v_mul_f32 v172, v172, v39
    v_mul_f32 v173, v173, v39
    v_mul_f32 v174, v174, v39
    v_mul_f32 v175, v175, v39
    v_mul_f32 v180, v180, v39
    v_mul_f32 v181, v181, v39
    v_mul_f32 v182, v182, v39
    v_mul_f32 v183, v183, v39
    v_mul_f32 v188, v188, v39
    v_mul_f32 v189, v189, v39
    v_mul_f32 v190, v190, v39
    v_mul_f32 v191, v191, v39
    v_mul_f32 v196, v196, v39
    v_mul_f32 v197, v197, v39
    v_mul_f32 v198, v198, v39
    v_mul_f32 v199, v199, v39
    v_mul_f32 v204, v204, v39
    v_mul_f32 v205, v205, v39
    v_mul_f32 v206, v206, v39
    v_mul_f32 v207, v207, v39
    v_mul_f32 v33, v33, v39
    v_sub_f32 v100, v100, v37
    v_sub_f32 v101, v101, v37
    v_sub_f32 v102, v102, v37
    v_sub_f32 v103, v103, v37
    v_sub_f32 v68, v68, v37
    v_sub_f32 v69, v69, v37
    v_sub_f32 v70, v70, v37
    v_sub_f32 v71, v71, v37
    v_sub_f32 v76, v76, v37
    v_sub_f32 v77, v77, v37
    v_sub_f32 v78, v78, v37
    v_sub_f32 v79, v79, v37
    v_exp_f32 v40, v64
    v_exp_f32 v41, v65
    v_exp_f32 v42, v66
    v_exp_f32 v43, v67
    v_add_f32 v34, v40, v41
    v_cvt_pk_bf16_f32 v88, v40, v41
    v_add_f32 v34, v34, v42
    v_cvt_pk_bf16_f32 v89, v42, v43
    v_add_f32 v34, v34, v43
    v_exp_f32 v44, v72
    v_exp_f32 v45, v73
    v_exp_f32 v46, v74
    v_exp_f32 v47, v75
    v_add_f32 v34, v34, v44
    v_cvt_pk_bf16_f32 v90, v44, v45
    v_add_f32 v34, v34, v45
    v_cvt_pk_bf16_f32 v91, v46, v47
    v_add_f32 v34, v34, v46
    v_add_f32 v34, v34, v47
    v_exp_f32 v40, v68
    v_exp_f32 v41, v69
    v_exp_f32 v42, v70
    v_exp_f32 v43, v71
    v_add_f32 v35, v40, v41
    v_cvt_pk_bf16_f32 v92, v40, v41
    v_add_f32 v35, v35, v42
    v_cvt_pk_bf16_f32 v93, v42, v43
    v_add_f32 v35, v35, v43
    v_exp_f32 v44, v76
    v_exp_f32 v45, v77
    v_exp_f32 v46, v78
    v_exp_f32 v47, v79
    v_add_f32 v35, v35, v44
    v_cvt_pk_bf16_f32 v94, v44, v45
    v_add_f32 v35, v35, v45
    v_cvt_pk_bf16_f32 v95, v46, v47
    v_add_f32 v35, v35, v46
    v_add_f32 v35, v35, v47
    v_sub_f32 v48, v48, v36
    v_sub_f32 v49, v49, v36
    v_sub_f32 v50, v50, v36
    v_sub_f32 v51, v51, v36
    v_sub_f32 v56, v56, v36
    v_sub_f32 v57, v57, v36
    v_sub_f32 v58, v58, v36
    v_sub_f32 v59, v59, v36
    v_sub_f32 v52, v52, v37
    v_sub_f32 v53, v53, v37
    v_sub_f32 v54, v54, v37
    v_sub_f32 v55, v55, v37
    v_sub_f32 v60, v60, v37
    v_sub_f32 v61, v61, v37
    v_sub_f32 v62, v62, v37
    v_sub_f32 v63, v63, v37
    s_nop 3
    s_branch L_back_7
L_slow_8:
    s_nop 15
    v_max3_f32 v36, v48, v49, v50
    v_max3_f32 v36, v36, v51, v56
    v_max3_f32 v36, v36, v57, v58
    v_max_f32 v36, v36, v59
    v_mov_b32 v38, v36
    s_nop 0
    s_nop 0
    v_permlane16_swap_b32 v36, v38
    v_max_f32 v36, v36, v38
    v_mov_b32 v38, v36
    s_nop 0
    s_nop 0
    v_permlane32_swap_b32 v36, v38
    v_max_f32 v36, v36, v38
    v_ceil_f32 v36, v36
    v_max_f32 v36, 0, v36
    v_sub_f32 v39, 0, v36
    v_exp_f32 v39, v39
    s_nop 0
    v_mul_f32 v144, v144, v39
    v_mul_f32 v145, v145, v39
    v_mul_f32 v146, v146, v39
    v_mul_f32 v147, v147, v39
    v_mul_f32 v152, v152, v39
    v_mul_f32 v153, v153, v39
    v_mul_f32 v154, v154, v39
    v_mul_f32 v155, v155, v39
    v_mul_f32 v160, v160, v39
    v_mul_f32 v161, v161, v39
    v_mul_f32 v162, v162, v39
    v_mul_f32 v163, v163, v39
    v_mul_f32 v168, v168, v39
    v_mul_f32 v169, v169, v39
    v_mul_f32 v170, v170, v39
    v_mul_f32 v171, v171, v39
    v_mul_f32 v176, v176, v39
    v_mul_f32 v177, v177, v39
    v_mul_f32 v178, v178, v39
    v_mul_f32 v179, v179, v39
    v_mul_f32 v184, v184, v39
    v_mul_f32 v185, v185, v39
    v_mul_f32 v186, v186, v39
    v_mul_f32 v187, v187, v39
    v_mul_f32 v192, v192, v39
    v_mul_f32 v193, v193, v39
    v_mul_f32 v194, v194, v39
    v_mul_f32 v195, v195, v39
    v_mul_f32 v200, v200, v39
    v_mul_f32 v201, v201, v39
    v_mul_f32 v202, v202, v39
    v_mul_f32 v203, v203, v39
    v_mul_f32 v32, v32, v39
    v_sub_f32 v96, v96, v36
    v_sub_f32 v97, v97, v36
    v_sub_f32 v98, v98, v36
    v_sub_f32 v99, v99, v36
    v_sub_f32 v48, v48, v36
    v_sub_f32 v49, v49, v36
    v_sub_f32 v50, v50, v36
    v_sub_f32 v51, v51, v36
    v_sub_f32 v56, v56, v36
    v_sub_f32 v57, v57, v36
    v_sub_f32 v58, v58, v36
    v_sub_f32 v59, v59, v36
    v_max3_f32 v37, v52, v53, v54
    v_max3_f32 v37, v37, v55, v60
    v_max3_f32 v37, v37, v61, v62
    v_max_f32 v37, v37, v63
    v_mov_b32 v38, v37
    s_nop 0
    s_nop 0
    v_permlane16_swap_b32 v37, v38
    v_max_f32 v37, v37, v38
    v_mov_b32 v38, v37
    s_nop 0
    s_nop 0
    v_permlane32_swap_b32 v37, v38
    v_max_f32 v37, v37, v38
    v_ceil_f32 v37, v37
    v_max_f32 v37, 0, v37
    v_sub_f32 v39, 0, v37
    v_exp_f32 v39, v39
    s_nop 0
    v_mul_f32 v148, v148, v39
    v_mul_f32 v149, v149, v39
    v_mul_f32 v150, v150, v39
    v_mul_f32 v151, v151, v39
    v_mul_f32 v156, v156, v39
    v_mul_f32 v157, v157, v39
    v_mul_f32 v158, v158, v39
    v_mul_f32 v159, v159, v39
    v_mul_f32 v164, v164, v39
    v_mul_f32 v165, v165, v39
    v_mul_f32 v166, v166, v39
    v_mul_f32 v167, v167, v39
    v_mul_f32 v172, v172, v39
    v_mul_f32 v173, v173, v39
    v_mul_f32 v174, v174, v39
    v_mul_f32 v175, v175, v39
    v_mul_f32 v180, v180, v39
    v_mul_f32 v181, v181, v39
    v_mul_f32 v182, v182, v39
    v_mul_f32 v183, v183, v39
    v_mul_f32 v188, v188, v39
    v_mul_f32 v189, v189, v39
    v_mul_f32 v190, v190, v39
    v_mul_f32 v191, v191, v39
    v_mul_f32 v196, v196, v39
    v_mul_f32 v197, v197, v39
    v_mul_f32 v198, v198, v39
    v_mul_f32 v199, v199, v39
    v_mul_f32 v204, v204, v39
    v_mul_f32 v205, v205, v39
    v_mul_f32 v206, v206, v39
    v_mul_f32 v207, v207, v39
    v_mul_f32 v33, v33, v39
    v_sub_f32 v100, v100, v37
    v_sub_f32 v101, v101, v37
    v_sub_f32 v102, v102, v37
    v_sub_f32 v103, v103, v37
    v_sub_f32 v52, v52, v37
    v_sub_f32 v53, v53, v37
    v_sub_f32 v54, v54, v37
    v_sub_f32 v55, v55, v37
    v_sub_f32 v60, v60, v37
    v_sub_f32 v61, v61, v37
    v_sub_f32 v62, v62, v37
    v_sub_f32 v63, v63, v37
    v_exp_f32 v40, v48
    v_exp_f32 v41, v49
    v_exp_f32 v42, v50
    v_exp_f32 v43, v51
    v_add_f32 v34, v40, v41
    v_cvt_pk_bf16_f32 v80, v40, v41
    v_add_f32 v34, v34, v42
    v_cvt_pk_bf16_f32 v81, v42, v43
    v_add_f32 v34, v34, v43
    v_exp_f32 v44, v56
    v_exp_f32 v45, v57
    v_exp_f32 v46, v58
    v_exp_f32 v47, v59
    v_add_f32 v34, v34, v44
    v_cvt_pk_bf16_f32 v82, v44, v45
    v_add_f32 v34, v34, v45
    v_cvt_pk_bf16_f32 v83, v46, v47
    v_add_f32 v34, v34, v46
    v_add_f32 v34, v34, v47
    v_exp_f32 v40, v52
    v_exp_f32 v41, v53
    v_exp_f32 v42, v54
    v_exp_f32 v43, v55
    v_add_f32 v35, v40, v41
    v_cvt_pk_bf16_f32 v84, v40, v41
    v_add_f32 v35, v35, v42
    v_cvt_pk_bf16_f32 v85, v42, v43
    v_add_f32 v35, v35, v43
    v_exp_f32 v44, v60
    v_exp_f32 v45, v61
    v_exp_f32 v46, v62
    v_exp_f32 v47, v63
    v_add_f32 v35, v35, v44
    v_cvt_pk_bf16_f32 v86, v44, v45
    v_add_f32 v35, v35, v45
    v_cvt_pk_bf16_f32 v87, v46, v47
    v_add_f32 v35, v35, v46
    v_add_f32 v35, v35, v47
    v_sub_f32 v64, v64, v36
    v_sub_f32 v65, v65, v36
    v_sub_f32 v66, v66, v36
    v_sub_f32 v67, v67, v36
    v_sub_f32 v72, v72, v36
    v_sub_f32 v73, v73, v36
    v_sub_f32 v74, v74, v36
    v_sub_f32 v75, v75, v36
    v_sub_f32 v68, v68, v37
    v_sub_f32 v69, v69, v37
    v_sub_f32 v70, v70, v37
    v_sub_f32 v71, v71, v37
    v_sub_f32 v76, v76, v37
    v_sub_f32 v77, v77, v37
    v_sub_f32 v78, v78, v37
    v_sub_f32 v79, v79, v37
    s_nop 3
    s_branch L_back_8
L_slow_9:
    s_nop 15
    v_max3_f32 v36, v64, v65, v66
    v_max3_f32 v36, v36, v67, v72
    v_max3_f32 v36, v36, v73, v74
    v_max_f32 v36, v36, v75
    v_mov_b32 v38, v36
    s_nop 0
    s_nop 0
    v_permlane16_swap_b32 v36, v38
    v_max_f32 v36, v36, v38
    v_mov_b32 v38, v36
    s_nop 0
    s_nop 0
    v_permlane32_swap_b32 v36, v38
    v_max_f32 v36, v36, v38
    v_ceil_f32 v36, v36
    v_max_f32 v36, 0, v36
    v_sub_f32 v39, 0, v36
    v_exp_f32 v39, v39
    s_nop 0
    v_mul_f32 v144, v144, v39
    v_mul_f32 v145, v145, v39
    v_mul_f32 v146, v146, v39
    v_mul_f32 v147, v147, v39
    v_mul_f32 v152, v152, v39
    v_mul_f32 v153, v153, v39
    v_mul_f32 v154, v154, v39
    v_mul_f32 v155, v155, v39
    v_mul_f32 v160, v160, v39
    v_mul_f32 v161, v161, v39
    v_mul_f32 v162, v162, v39
    v_mul_f32 v163, v163, v39
    v_mul_f32 v168, v168, v39
    v_mul_f32 v169, v169, v39
    v_mul_f32 v170, v170, v39
    v_mul_f32 v171, v171, v39
    v_mul_f32 v176, v176, v39
    v_mul_f32 v177, v177, v39
    v_mul_f32 v178, v178, v39
    v_mul_f32 v179, v179, v39
    v_mul_f32 v184, v184, v39
    v_mul_f32 v185, v185, v39
    v_mul_f32 v186, v186, v39
    v_mul_f32 v187, v187, v39
    v_mul_f32 v192, v192, v39
    v_mul_f32 v193, v193, v39
    v_mul_f32 v194, v194, v39
    v_mul_f32 v195, v195, v39
    v_mul_f32 v200, v200, v39
    v_mul_f32 v201, v201, v39
    v_mul_f32 v202, v202, v39
    v_mul_f32 v203, v203, v39
    v_mul_f32 v32, v32, v39
    v_sub_f32 v96, v96, v36
    v_sub_f32 v97, v97, v36
    v_sub_f32 v98, v98, v36
    v_sub_f32 v99, v99, v36
    v_sub_f32 v64, v64, v36
    v_sub_f32 v65, v65, v36
    v_sub_f32 v66, v66, v36
    v_sub_f32 v67, v67, v36
    v_sub_f32 v72, v72, v36
    v_sub_f32 v73, v73, v36
    v_sub_f32 v74, v74, v36
    v_sub_f32 v75, v75, v36
    v_max3_f32 v37, v68, v69, v70
    v_max3_f32 v37, v37, v71, v76
    v_max3_f32 v37, v37, v77, v78
    v_max_f32 v37, v37, v79
    v_mov_b32 v38, v37
    s_nop 0
    s_nop 0
    v_permlane16_swap_b32 v37, v38
    v_max_f32 v37, v37, v38
    v_mov_b32 v38, v37
    s_nop 0
    s_nop 0
    v_permlane32_swap_b32 v37, v38
    v_max_f32 v37, v37, v38
    v_ceil_f32 v37, v37
    v_max_f32 v37, 0, v37
    v_sub_f32 v39, 0, v37
    v_exp_f32 v39, v39
    s_nop 0
    v_mul_f32 v148, v148, v39
    v_mul_f32 v149, v149, v39
    v_mul_f32 v150, v150, v39
    v_mul_f32 v151, v151, v39
    v_mul_f32 v156, v156, v39
    v_mul_f32 v157, v157, v39
    v_mul_f32 v158, v158, v39
    v_mul_f32 v159, v159, v39
    v_mul_f32 v164, v164, v39
    v_mul_f32 v165, v165, v39
    v_mul_f32 v166, v166, v39
    v_mul_f32 v167, v167, v39
    v_mul_f32 v172, v172, v39
    v_mul_f32 v173, v173, v39
    v_mul_f32 v174, v174, v39
    v_mul_f32 v175, v175, v39
    v_mul_f32 v180, v180, v39
    v_mul_f32 v181, v181, v39
    v_mul_f32 v182, v182, v39
    v_mul_f32 v183, v183, v39
    v_mul_f32 v188, v188, v39
    v_mul_f32 v189, v189, v39
    v_mul_f32 v190, v190, v39
    v_mul_f32 v191, v191, v39
    v_mul_f32 v196, v196, v39
    v_mul_f32 v197, v197, v39
    v_mul_f32 v198, v198, v39
    v_mul_f32 v199, v199, v39
    v_mul_f32 v204, v204, v39
    v_mul_f32 v205, v205, v39
    v_mul_f32 v206, v206, v39
    v_mul_f32 v207, v207, v39
    v_mul_f32 v33, v33, v39
    v_sub_f32 v100, v100, v37
    v_sub_f32 v101, v101, v37
    v_sub_f32 v102, v102, v37
    v_sub_f32 v103, v103, v37
    v_sub_f32 v68, v68, v37
    v_sub_f32 v69, v69, v37
    v_sub_f32 v70, v70, v37
    v_sub_f32 v71, v71, v37
    v_sub_f32 v76, v76, v37
    v_sub_f32 v77, v77, v37
    v_sub_f32 v78, v78, v37
    v_sub_f32 v79, v79, v37
    v_exp_f32 v40, v64
    v_exp_f32 v41, v65
    v_exp_f32 v42, v66
    v_exp_f32 v43, v67
    v_add_f32 v34, v40, v41
    v_cvt_pk_bf16_f32 v88, v40, v41
    v_add_f32 v34, v34, v42
    v_cvt_pk_bf16_f32 v89, v42, v43
    v_add_f32 v34, v34, v43
    v_exp_f32 v44, v72
    v_exp_f32 v45, v73
    v_exp_f32 v46, v74
    v_exp_f32 v47, v75
    v_add_f32 v34, v34, v44
    v_cvt_pk_bf16_f32 v90, v44, v45
    v_add_f32 v34, v34, v45
    v_cvt_pk_bf16_f32 v91, v46, v47
    v_add_f32 v34, v34, v46
    v_add_f32 v34, v34, v47
    v_exp_f32 v40, v68
    v_exp_f32 v41, v69
    v_exp_f32 v42, v70
    v_exp_f32 v43, v71
    v_add_f32 v35, v40, v41
    v_cvt_pk_bf16_f32 v92, v40, v41
    v_add_f32 v35, v35, v42
    v_cvt_pk_bf16_f32 v93, v42, v43
    v_add_f32 v35, v35, v43
    v_exp_f32 v44, v76
    v_exp_f32 v45, v77
    v_exp_f32 v46, v78
    v_exp_f32 v47, v79
    v_add_f32 v35, v35, v44
    v_cvt_pk_bf16_f32 v94, v44, v45
    v_add_f32 v35, v35, v45
    v_cvt_pk_bf16_f32 v95, v46, v47
    v_add_f32 v35, v35, v46
    v_add_f32 v35, v35, v47
    v_sub_f32 v48, v48, v36
    v_sub_f32 v49, v49, v36
    v_sub_f32 v50, v50, v36
    v_sub_f32 v51, v51, v36
    v_sub_f32 v56, v56, v36
    v_sub_f32 v57, v57, v36
    v_sub_f32 v58, v58, v36
    v_sub_f32 v59, v59, v36
    v_sub_f32 v52, v52, v37
    v_sub_f32 v53, v53, v37
    v_sub_f32 v54, v54, v37
    v_sub_f32 v55, v55, v37
    v_sub_f32 v60, v60, v37
    v_sub_f32 v61, v61, v37
    v_sub_f32 v62, v62, v37
    v_sub_f32 v63, v63, v37
    s_nop 3
    s_branch L_back_9
L_slow_10:
    s_nop 15
    v_max3_f32 v36, v48, v49, v50
    v_max3_f32 v36, v36, v51, v56
    v_max3_f32 v36, v36, v57, v58
    v_max_f32 v36, v36, v59
    v_mov_b32 v38, v36
    s_nop 0
    s_nop 0
    v_permlane16_swap_b32 v36, v38
    v_max_f32 v36, v36, v38
    v_mov_b32 v38, v36
    s_nop 0
    s_nop 0
    v_permlane32_swap_b32 v36, v38
    v_max_f32 v36, v36, v38
    v_ceil_f32 v36, v36
    v_max_f32 v36, 0, v36
    v_sub_f32 v39, 0, v36
    v_exp_f32 v39, v39
    s_nop 0
    v_mul_f32 v144, v144, v39
    v_mul_f32 v145, v145, v39
    v_mul_f32 v146, v146, v39
    v_mul_f32 v147, v147, v39
    v_mul_f32 v152, v152, v39
    v_mul_f32 v153, v153, v39
    v_mul_f32 v154, v154, v39
    v_mul_f32 v155, v155, v39
    v_mul_f32 v160, v160, v39
    v_mul_f32 v161, v161, v39
    v_mul_f32 v162, v162, v39
    v_mul_f32 v163, v163, v39
    v_mul_f32 v168, v168, v39
    v_mul_f32 v169, v169, v39
    v_mul_f32 v170, v170, v39
    v_mul_f32 v171, v171, v39
    v_mul_f32 v176, v176, v39
    v_mul_f32 v177, v177, v39
    v_mul_f32 v178, v178, v39
    v_mul_f32 v179, v179, v39
    v_mul_f32 v184, v184, v39
    v_mul_f32 v185, v185, v39
    v_mul_f32 v186, v186, v39
    v_mul_f32 v187, v187, v39
    v_mul_f32 v192, v192, v39
    v_mul_f32 v193, v193, v39
    v_mul_f32 v194, v194, v39
    v_mul_f32 v195, v195, v39
    v_mul_f32 v200, v200, v39
    v_mul_f32 v201, v201, v39
    v_mul_f32 v202, v202, v39
    v_mul_f32 v203, v203, v39
    v_mul_f32 v32, v32, v39
    v_sub_f32 v96, v96, v36
    v_sub_f32 v97, v97, v36
    v_sub_f32 v98, v98, v36
    v_sub_f32 v99, v99, v36
    v_sub_f32 v48, v48, v36
    v_sub_f32 v49, v49, v36
    v_sub_f32 v50, v50, v36
    v_sub_f32 v51, v51, v36
    v_sub_f32 v56, v56, v36
    v_sub_f32 v57, v57, v36
    v_sub_f32 v58, v58, v36
    v_sub_f32 v59, v59, v36
    v_max3_f32 v37, v52, v53, v54
    v_max3_f32 v37, v37, v55, v60
    v_max3_f32 v37, v37, v61, v62
    v_max_f32 v37, v37, v63
    v_mov_b32 v38, v37
    s_nop 0
    s_nop 0
    v_permlane16_swap_b32 v37, v38
    v_max_f32 v37, v37, v38
    v_mov_b32 v38, v37
    s_nop 0
    s_nop 0
    v_permlane32_swap_b32 v37, v38
    v_max_f32 v37, v37, v38
    v_ceil_f32 v37, v37
    v_max_f32 v37, 0, v37
    v_sub_f32 v39, 0, v37
    v_exp_f32 v39, v39
    s_nop 0
    v_mul_f32 v148, v148, v39
    v_mul_f32 v149, v149, v39
    v_mul_f32 v150, v150, v39
    v_mul_f32 v151, v151, v39
    v_mul_f32 v156, v156, v39
    v_mul_f32 v157, v157, v39
    v_mul_f32 v158, v158, v39
    v_mul_f32 v159, v159, v39
    v_mul_f32 v164, v164, v39
    v_mul_f32 v165, v165, v39
    v_mul_f32 v166, v166, v39
    v_mul_f32 v167, v167, v39
    v_mul_f32 v172, v172, v39
    v_mul_f32 v173, v173, v39
    v_mul_f32 v174, v174, v39
    v_mul_f32 v175, v175, v39
    v_mul_f32 v180, v180, v39
    v_mul_f32 v181, v181, v39
    v_mul_f32 v182, v182, v39
    v_mul_f32 v183, v183, v39
    v_mul_f32 v188, v188, v39
    v_mul_f32 v189, v189, v39
    v_mul_f32 v190, v190, v39
    v_mul_f32 v191, v191, v39
    v_mul_f32 v196, v196, v39
    v_mul_f32 v197, v197, v39
    v_mul_f32 v198, v198, v39
    v_mul_f32 v199, v199, v39
    v_mul_f32 v204, v204, v39
    v_mul_f32 v205, v205, v39
    v_mul_f32 v206, v206, v39
    v_mul_f32 v207, v207, v39
    v_mul_f32 v33, v33, v39
    v_sub_f32 v100, v100, v37
    v_sub_f32 v101, v101, v37
    v_sub_f32 v102, v102, v37
    v_sub_f32 v103, v103, v37
    v_sub_f32 v52, v52, v37
    v_sub_f32 v53, v53, v37
    v_sub_f32 v54, v54, v37
    v_sub_f32 v55, v55, v37
    v_sub_f32 v60, v60, v37
    v_sub_f32 v61, v61, v37
    v_sub_f32 v62, v62, v37
    v_sub_f32 v63, v63, v37
    v_exp_f32 v40, v48
    v_exp_f32 v41, v49
    v_exp_f32 v42, v50
    v_exp_f32 v43, v51
    v_add_f32 v34, v40, v41
    v_cvt_pk_bf16_f32 v80, v40, v41
    v_add_f32 v34, v34, v42
    v_cvt_pk_bf16_f32 v81, v42, v43
    v_add_f32 v34, v34, v43
    v_exp_f32 v44, v56
    v_exp_f32 v45, v57
    v_exp_f32 v46, v58
    v_exp_f32 v47, v59
    v_add_f32 v34, v34, v44
    v_cvt_pk_bf16_f32 v82, v44, v45
    v_add_f32 v34, v34, v45
    v_cvt_pk_bf16_f32 v83, v46, v47
    v_add_f32 v34, v34, v46
    v_add_f32 v34, v34, v47
    v_exp_f32 v40, v52
    v_exp_f32 v41, v53
    v_exp_f32 v42, v54
    v_exp_f32 v43, v55
    v_add_f32 v35, v40, v41
    v_cvt_pk_bf16_f32 v84, v40, v41
    v_add_f32 v35, v35, v42
    v_cvt_pk_bf16_f32 v85, v42, v43
    v_add_f32 v35, v35, v43
    v_exp_f32 v44, v60
    v_exp_f32 v45, v61
    v_exp_f32 v46, v62
    v_exp_f32 v47, v63
    v_add_f32 v35, v35, v44
    v_cvt_pk_bf16_f32 v86, v44, v45
    v_add_f32 v35, v35, v45
    v_cvt_pk_bf16_f32 v87, v46, v47
    v_add_f32 v35, v35, v46
    v_add_f32 v35, v35, v47
    v_sub_f32 v64, v64, v36
    v_sub_f32 v65, v65, v36
    v_sub_f32 v66, v66, v36
    v_sub_f32 v67, v67, v36
    v_sub_f32 v72, v72, v36
    v_sub_f32 v73, v73, v36
    v_sub_f32 v74, v74, v36
    v_sub_f32 v75, v75, v36
    v_sub_f32 v68, v68, v37
    v_sub_f32 v69, v69, v37
    v_sub_f32 v70, v70, v37
    v_sub_f32 v71, v71, v37
    v_sub_f32 v76, v76, v37
    v_sub_f32 v77, v77, v37
    v_sub_f32 v78, v78, v37
    v_sub_f32 v79, v79, v37
    s_nop 3
    s_branch L_back_10
L_slow_11:
    s_nop 15
    v_max3_f32 v36, v64, v65, v66
    v_max3_f32 v36, v36, v67, v72
    v_max3_f32 v36, v36, v73, v74
    v_max_f32 v36, v36, v75
    v_mov_b32 v38, v36
    s_nop 0
    s_nop 0
    v_permlane16_swap_b32 v36, v38
    v_max_f32 v36, v36, v38
    v_mov_b32 v38, v36
    s_nop 0
    s_nop 0
    v_permlane32_swap_b32 v36, v38
    v_max_f32 v36, v36, v38
    v_ceil_f32 v36, v36
    v_max_f32 v36, 0, v36
    v_sub_f32 v39, 0, v36
    v_exp_f32 v39, v39
    s_nop 0
    v_mul_f32 v144, v144, v39
    v_mul_f32 v145, v145, v39
    v_mul_f32 v146, v146, v39
    v_mul_f32 v147, v147, v39
    v_mul_f32 v152, v152, v39
    v_mul_f32 v153, v153, v39
    v_mul_f32 v154, v154, v39
    v_mul_f32 v155, v155, v39
    v_mul_f32 v160, v160, v39
    v_mul_f32 v161, v161, v39
    v_mul_f32 v162, v162, v39
    v_mul_f32 v163, v163, v39
    v_mul_f32 v168, v168, v39
    v_mul_f32 v169, v169, v39
    v_mul_f32 v170, v170, v39
    v_mul_f32 v171, v171, v39
    v_mul_f32 v176, v176, v39
    v_mul_f32 v177, v177, v39
    v_mul_f32 v178, v178, v39
    v_mul_f32 v179, v179, v39
    v_mul_f32 v184, v184, v39
    v_mul_f32 v185, v185, v39
    v_mul_f32 v186, v186, v39
    v_mul_f32 v187, v187, v39
    v_mul_f32 v192, v192, v39
    v_mul_f32 v193, v193, v39
    v_mul_f32 v194, v194, v39
    v_mul_f32 v195, v195, v39
    v_mul_f32 v200, v200, v39
    v_mul_f32 v201, v201, v39
    v_mul_f32 v202, v202, v39
    v_mul_f32 v203, v203, v39
    v_mul_f32 v32, v32, v39
    v_sub_f32 v96, v96, v36
    v_sub_f32 v97, v97, v36
    v_sub_f32 v98, v98, v36
    v_sub_f32 v99, v99, v36
    v_sub_f32 v64, v64, v36
    v_sub_f32 v65, v65, v36
    v_sub_f32 v66, v66, v36
    v_sub_f32 v67, v67, v36
    v_sub_f32 v72, v72, v36
    v_sub_f32 v73, v73, v36
    v_sub_f32 v74, v74, v36
    v_sub_f32 v75, v75, v36
    v_max3_f32 v37, v68, v69, v70
    v_max3_f32 v37, v37, v71, v76
    v_max3_f32 v37, v37, v77, v78
    v_max_f32 v37, v37, v79
    v_mov_b32 v38, v37
    s_nop 0
    s_nop 0
    v_permlane16_swap_b32 v37, v38
    v_max_f32 v37, v37, v38
    v_mov_b32 v38, v37
    s_nop 0
    s_nop 0
    v_permlane32_swap_b32 v37, v38
    v_max_f32 v37, v37, v38
    v_ceil_f32 v37, v37
    v_max_f32 v37, 0, v37
    v_sub_f32 v39, 0, v37
    v_exp_f32 v39, v39
    s_nop 0
    v_mul_f32 v148, v148, v39
    v_mul_f32 v149, v149, v39
    v_mul_f32 v150, v150, v39
    v_mul_f32 v151, v151, v39
    v_mul_f32 v156, v156, v39
    v_mul_f32 v157, v157, v39
    v_mul_f32 v158, v158, v39
    v_mul_f32 v159, v159, v39
    v_mul_f32 v164, v164, v39
    v_mul_f32 v165, v165, v39
    v_mul_f32 v166, v166, v39
    v_mul_f32 v167, v167, v39
    v_mul_f32 v172, v172, v39
    v_mul_f32 v173, v173, v39
    v_mul_f32 v174, v174, v39
    v_mul_f32 v175, v175, v39
    v_mul_f32 v180, v180, v39
    v_mul_f32 v181, v181, v39
    v_mul_f32 v182, v182, v39
    v_mul_f32 v183, v183, v39
    v_mul_f32 v188, v188, v39
    v_mul_f32 v189, v189, v39
    v_mul_f32 v190, v190, v39
    v_mul_f32 v191, v191, v39
    v_mul_f32 v196, v196, v39
    v_mul_f32 v197, v197, v39
    v_mul_f32 v198, v198, v39
    v_mul_f32 v199, v199, v39
    v_mul_f32 v204, v204, v39
    v_mul_f32 v205, v205, v39
    v_mul_f32 v206, v206, v39
    v_mul_f32 v207, v207, v39
    v_mul_f32 v33, v33, v39
    v_sub_f32 v100, v100, v37
    v_sub_f32 v101, v101, v37
    v_sub_f32 v102, v102, v37
    v_sub_f32 v103, v103, v37
    v_sub_f32 v68, v68, v37
    v_sub_f32 v69, v69, v37
    v_sub_f32 v70, v70, v37
    v_sub_f32 v71, v71, v37
    v_sub_f32 v76, v76, v37
    v_sub_f32 v77, v77, v37
    v_sub_f32 v78, v78, v37
    v_sub_f32 v79, v79, v37
    v_exp_f32 v40, v64
    v_exp_f32 v41, v65
    v_exp_f32 v42, v66
    v_exp_f32 v43, v67
    v_add_f32 v34, v40, v41
    v_cvt_pk_bf16_f32 v88, v40, v41
    v_add_f32 v34, v34, v42
    v_cvt_pk_bf16_f32 v89, v42, v43
    v_add_f32 v34, v34, v43
    v_exp_f32 v44, v72
    v_exp_f32 v45, v73
    v_exp_f32 v46, v74
    v_exp_f32 v47, v75
    v_add_f32 v34, v34, v44
    v_cvt_pk_bf16_f32 v90, v44, v45
    v_add_f32 v34, v34, v45
    v_cvt_pk_bf16_f32 v91, v46, v47
    v_add_f32 v34, v34, v46
    v_add_f32 v34, v34, v47
    v_exp_f32 v40, v68
    v_exp_f32 v41, v69
    v_exp_f32 v42, v70
    v_exp_f32 v43, v71
    v_add_f32 v35, v40, v41
    v_cvt_pk_bf16_f32 v92, v40, v41
    v_add_f32 v35, v35, v42
    v_cvt_pk_bf16_f32 v93, v42, v43
    v_add_f32 v35, v35, v43
    v_exp_f32 v44, v76
    v_exp_f32 v45, v77
    v_exp_f32 v46, v78
    v_exp_f32 v47, v79
    v_add_f32 v35, v35, v44
    v_cvt_pk_bf16_f32 v94, v44, v45
    v_add_f32 v35, v35, v45
    v_cvt_pk_bf16_f32 v95, v46, v47
    v_add_f32 v35, v35, v46
    v_add_f32 v35, v35, v47
    v_sub_f32 v48, v48, v36
    v_sub_f32 v49, v49, v36
    v_sub_f32 v50, v50, v36
    v_sub_f32 v51, v51, v36
    v_sub_f32 v56, v56, v36
    v_sub_f32 v57, v57, v36
    v_sub_f32 v58, v58, v36
    v_sub_f32 v59, v59, v36
    v_sub_f32 v52, v52, v37
    v_sub_f32 v53, v53, v37
    v_sub_f32 v54, v54, v37
    v_sub_f32 v55, v55, v37
    v_sub_f32 v60, v60, v37
    v_sub_f32 v61, v61, v37
    v_sub_f32 v62, v62, v37
    v_sub_f32 v63, v63, v37
    s_nop 3
    s_branch L_back_11
L_slow_12:
    s_nop 15
    v_max3_f32 v36, v48, v49, v50
    v_max3_f32 v36, v36, v51, v56
    v_max3_f32 v36, v36, v57, v58
    v_max_f32 v36, v36, v59
    v_mov_b32 v38, v36
    s_nop 0
    s_nop 0
    v_permlane16_swap_b32 v36, v38
    v_max_f32 v36, v36, v38
    v_mov_b32 v38, v36
    s_nop 0
    s_nop 0
    v_permlane32_swap_b32 v36, v38
    v_max_f32 v36, v36, v38
    v_ceil_f32 v36, v36
    v_max_f32 v36, 0, v36
    v_sub_f32 v39, 0, v36
    v_exp_f32 v39, v39
    s_nop 0
    v_mul_f32 v144, v144, v39
    v_mul_f32 v145, v145, v39
    v_mul_f32 v146, v146, v39
    v_mul_f32 v147, v147, v39
    v_mul_f32 v152, v152, v39
    v_mul_f32 v153, v153, v39
    v_mul_f32 v154, v154, v39
    v_mul_f32 v155, v155, v39
    v_mul_f32 v160, v160, v39
    v_mul_f32 v161, v161, v39
    v_mul_f32 v162, v162, v39
    v_mul_f32 v163, v163, v39
    v_mul_f32 v168, v168, v39
    v_mul_f32 v169, v169, v39
    v_mul_f32 v170, v170, v39
    v_mul_f32 v171, v171, v39
    v_mul_f32 v176, v176, v39
    v_mul_f32 v177, v177, v39
    v_mul_f32 v178, v178, v39
    v_mul_f32 v179, v179, v39
    v_mul_f32 v184, v184, v39
    v_mul_f32 v185, v185, v39
    v_mul_f32 v186, v186, v39
    v_mul_f32 v187, v187, v39
    v_mul_f32 v192, v192, v39
    v_mul_f32 v193, v193, v39
    v_mul_f32 v194, v194, v39
    v_mul_f32 v195, v195, v39
    v_mul_f32 v200, v200, v39
    v_mul_f32 v201, v201, v39
    v_mul_f32 v202, v202, v39
    v_mul_f32 v203, v203, v39
    v_mul_f32 v32, v32, v39
    v_sub_f32 v96, v96, v36
    v_sub_f32 v97, v97, v36
    v_sub_f32 v98, v98, v36
    v_sub_f32 v99, v99, v36
    v_sub_f32 v48, v48, v36
    v_sub_f32 v49, v49, v36
    v_sub_f32 v50, v50, v36
    v_sub_f32 v51, v51, v36
    v_sub_f32 v56, v56, v36
    v_sub_f32 v57, v57, v36
    v_sub_f32 v58, v58, v36
    v_sub_f32 v59, v59, v36
    v_max3_f32 v37, v52, v53, v54
    v_max3_f32 v37, v37, v55, v60
    v_max3_f32 v37, v37, v61, v62
    v_max_f32 v37, v37, v63
    v_mov_b32 v38, v37
    s_nop 0
    s_nop 0
    v_permlane16_swap_b32 v37, v38
    v_max_f32 v37, v37, v38
    v_mov_b32 v38, v37
    s_nop 0
    s_nop 0
    v_permlane32_swap_b32 v37, v38
    v_max_f32 v37, v37, v38
    v_ceil_f32 v37, v37
    v_max_f32 v37, 0, v37
    v_sub_f32 v39, 0, v37
    v_exp_f32 v39, v39
    s_nop 0
    v_mul_f32 v148, v148, v39
    v_mul_f32 v149, v149, v39
    v_mul_f32 v150, v150, v39
    v_mul_f32 v151, v151, v39
    v_mul_f32 v156, v156, v39
    v_mul_f32 v157, v157, v39
    v_mul_f32 v158, v158, v39
    v_mul_f32 v159, v159, v39
    v_mul_f32 v164, v164, v39
    v_mul_f32 v165, v165, v39
    v_mul_f32 v166, v166, v39
    v_mul_f32 v167, v167, v39
    v_mul_f32 v172, v172, v39
    v_mul_f32 v173, v173, v39
    v_mul_f32 v174, v174, v39
    v_mul_f32 v175, v175, v39
    v_mul_f32 v180, v180, v39
    v_mul_f32 v181, v181, v39
    v_mul_f32 v182, v182, v39
    v_mul_f32 v183, v183, v39
    v_mul_f32 v188, v188, v39
    v_mul_f32 v189, v189, v39
    v_mul_f32 v190, v190, v39
    v_mul_f32 v191, v191, v39
    v_mul_f32 v196, v196, v39
    v_mul_f32 v197, v197, v39
    v_mul_f32 v198, v198, v39
    v_mul_f32 v199, v199, v39
    v_mul_f32 v204, v204, v39
    v_mul_f32 v205, v205, v39
    v_mul_f32 v206, v206, v39
    v_mul_f32 v207, v207, v39
    v_mul_f32 v33, v33, v39
    v_sub_f32 v100, v100, v37
    v_sub_f32 v101, v101, v37
    v_sub_f32 v102, v102, v37
    v_sub_f32 v103, v103, v37
    v_sub_f32 v52, v52, v37
    v_sub_f32 v53, v53, v37
    v_sub_f32 v54, v54, v37
    v_sub_f32 v55, v55, v37
    v_sub_f32 v60, v60, v37
    v_sub_f32 v61, v61, v37
    v_sub_f32 v62, v62, v37
    v_sub_f32 v63, v63, v37
    v_exp_f32 v40, v48
    v_exp_f32 v41, v49
    v_exp_f32 v42, v50
    v_exp_f32 v43, v51
    v_add_f32 v34, v40, v41
    v_cvt_pk_bf16_f32 v80, v40, v41
    v_add_f32 v34, v34, v42
    v_cvt_pk_bf16_f32 v81, v42, v43
    v_add_f32 v34, v34, v43
    v_exp_f32 v44, v56
    v_exp_f32 v45, v57
    v_exp_f32 v46, v58
    v_exp_f32 v47, v59
    v_add_f32 v34, v34, v44
    v_cvt_pk_bf16_f32 v82, v44, v45
    v_add_f32 v34, v34, v45
    v_cvt_pk_bf16_f32 v83, v46, v47
    v_add_f32 v34, v34, v46
    v_add_f32 v34, v34, v47
    v_exp_f32 v40, v52
    v_exp_f32 v41, v53
    v_exp_f32 v42, v54
    v_exp_f32 v43, v55
    v_add_f32 v35, v40, v41
    v_cvt_pk_bf16_f32 v84, v40, v41
    v_add_f32 v35, v35, v42
    v_cvt_pk_bf16_f32 v85, v42, v43
    v_add_f32 v35, v35, v43
    v_exp_f32 v44, v60
    v_exp_f32 v45, v61
    v_exp_f32 v46, v62
    v_exp_f32 v47, v63
    v_add_f32 v35, v35, v44
    v_cvt_pk_bf16_f32 v86, v44, v45
    v_add_f32 v35, v35, v45
    v_cvt_pk_bf16_f32 v87, v46, v47
    v_add_f32 v35, v35, v46
    v_add_f32 v35, v35, v47
    v_sub_f32 v64, v64, v36
    v_sub_f32 v65, v65, v36
    v_sub_f32 v66, v66, v36
    v_sub_f32 v67, v67, v36
    v_sub_f32 v72, v72, v36
    v_sub_f32 v73, v73, v36
    v_sub_f32 v74, v74, v36
    v_sub_f32 v75, v75, v36
    v_sub_f32 v68, v68, v37
    v_sub_f32 v69, v69, v37
    v_sub_f32 v70, v70, v37
    v_sub_f32 v71, v71, v37
    v_sub_f32 v76, v76, v37
    v_sub_f32 v77, v77, v37
    v_sub_f32 v78, v78, v37
    v_sub_f32 v79, v79, v37
    s_nop 3
    s_branch L_back_12
L_slow_13:
    s_nop 15
    v_max3_f32 v36, v64, v65, v66
    v_max3_f32 v36, v36, v67, v72
    v_max3_f32 v36, v36, v73, v74
    v_max_f32 v36, v36, v75
    v_mov_b32 v38, v36
    s_nop 0
    s_nop 0
    v_permlane16_swap_b32 v36, v38
    v_max_f32 v36, v36, v38
    v_mov_b32 v38, v36
    s_nop 0
    s_nop 0
    v_permlane32_swap_b32 v36, v38
    v_max_f32 v36, v36, v38
    v_ceil_f32 v36, v36
    v_max_f32 v36, 0, v36
    v_sub_f32 v39, 0, v36
    v_exp_f32 v39, v39
    s_nop 0
    v_mul_f32 v144, v144, v39
    v_mul_f32 v145, v145, v39
    v_mul_f32 v146, v146, v39
    v_mul_f32 v147, v147, v39
    v_mul_f32 v152, v152, v39
    v_mul_f32 v153, v153, v39
    v_mul_f32 v154, v154, v39
    v_mul_f32 v155, v155, v39
    v_mul_f32 v160, v160, v39
    v_mul_f32 v161, v161, v39
    v_mul_f32 v162, v162, v39
    v_mul_f32 v163, v163, v39
    v_mul_f32 v168, v168, v39
    v_mul_f32 v169, v169, v39
    v_mul_f32 v170, v170, v39
    v_mul_f32 v171, v171, v39
    v_mul_f32 v176, v176, v39
    v_mul_f32 v177, v177, v39
    v_mul_f32 v178, v178, v39
    v_mul_f32 v179, v179, v39
    v_mul_f32 v184, v184, v39
    v_mul_f32 v185, v185, v39
    v_mul_f32 v186, v186, v39
    v_mul_f32 v187, v187, v39
    v_mul_f32 v192, v192, v39
    v_mul_f32 v193, v193, v39
    v_mul_f32 v194, v194, v39
    v_mul_f32 v195, v195, v39
    v_mul_f32 v200, v200, v39
    v_mul_f32 v201, v201, v39
    v_mul_f32 v202, v202, v39
    v_mul_f32 v203, v203, v39
    v_mul_f32 v32, v32, v39
    v_sub_f32 v96, v96, v36
    v_sub_f32 v97, v97, v36
    v_sub_f32 v98, v98, v36
    v_sub_f32 v99, v99, v36
    v_sub_f32 v64, v64, v36
    v_sub_f32 v65, v65, v36
    v_sub_f32 v66, v66, v36
    v_sub_f32 v67, v67, v36
    v_sub_f32 v72, v72, v36
    v_sub_f32 v73, v73, v36
    v_sub_f32 v74, v74, v36
    v_sub_f32 v75, v75, v36
    v_max3_f32 v37, v68, v69, v70
    v_max3_f32 v37, v37, v71, v76
    v_max3_f32 v37, v37, v77, v78
    v_max_f32 v37, v37, v79
    v_mov_b32 v38, v37
    s_nop 0
    s_nop 0
    v_permlane16_swap_b32 v37, v38
    v_max_f32 v37, v37, v38
    v_mov_b32 v38, v37
    s_nop 0
    s_nop 0
    v_permlane32_swap_b32 v37, v38
    v_max_f32 v37, v37, v38
    v_ceil_f32 v37, v37
    v_max_f32 v37, 0, v37
    v_sub_f32 v39, 0, v37
    v_exp_f32 v39, v39
    s_nop 0
    v_mul_f32 v148, v148, v39
    v_mul_f32 v149, v149, v39
    v_mul_f32 v150, v150, v39
    v_mul_f32 v151, v151, v39
    v_mul_f32 v156, v156, v39
    v_mul_f32 v157, v157, v39
    v_mul_f32 v158, v158, v39
    v_mul_f32 v159, v159, v39
    v_mul_f32 v164, v164, v39
    v_mul_f32 v165, v165, v39
    v_mul_f32 v166, v166, v39
    v_mul_f32 v167, v167, v39
    v_mul_f32 v172, v172, v39
    v_mul_f32 v173, v173, v39
    v_mul_f32 v174, v174, v39
    v_mul_f32 v175, v175, v39
    v_mul_f32 v180, v180, v39
    v_mul_f32 v181, v181, v39
    v_mul_f32 v182, v182, v39
    v_mul_f32 v183, v183, v39
    v_mul_f32 v188, v188, v39
    v_mul_f32 v189, v189, v39
    v_mul_f32 v190, v190, v39
    v_mul_f32 v191, v191, v39
    v_mul_f32 v196, v196, v39
    v_mul_f32 v197, v197, v39
    v_mul_f32 v198, v198, v39
    v_mul_f32 v199, v199, v39
    v_mul_f32 v204, v204, v39
    v_mul_f32 v205, v205, v39
    v_mul_f32 v206, v206, v39
    v_mul_f32 v207, v207, v39
    v_mul_f32 v33, v33, v39
    v_sub_f32 v100, v100, v37
    v_sub_f32 v101, v101, v37
    v_sub_f32 v102, v102, v37
    v_sub_f32 v103, v103, v37
    v_sub_f32 v68, v68, v37
    v_sub_f32 v69, v69, v37
    v_sub_f32 v70, v70, v37
    v_sub_f32 v71, v71, v37
    v_sub_f32 v76, v76, v37
    v_sub_f32 v77, v77, v37
    v_sub_f32 v78, v78, v37
    v_sub_f32 v79, v79, v37
    v_exp_f32 v40, v64
    v_exp_f32 v41, v65
    v_exp_f32 v42, v66
    v_exp_f32 v43, v67
    v_add_f32 v34, v40, v41
    v_cvt_pk_bf16_f32 v88, v40, v41
    v_add_f32 v34, v34, v42
    v_cvt_pk_bf16_f32 v89, v42, v43
    v_add_f32 v34, v34, v43
    v_exp_f32 v44, v72
    v_exp_f32 v45, v73
    v_exp_f32 v46, v74
    v_exp_f32 v47, v75
    v_add_f32 v34, v34, v44
    v_cvt_pk_bf16_f32 v90, v44, v45
    v_add_f32 v34, v34, v45
    v_cvt_pk_bf16_f32 v91, v46, v47
    v_add_f32 v34, v34, v46
    v_add_f32 v34, v34, v47
    v_exp_f32 v40, v68
    v_exp_f32 v41, v69
    v_exp_f32 v42, v70
    v_exp_f32 v43, v71
    v_add_f32 v35, v40, v41
    v_cvt_pk_bf16_f32 v92, v40, v41
    v_add_f32 v35, v35, v42
    v_cvt_pk_bf16_f32 v93, v42, v43
    v_add_f32 v35, v35, v43
    v_exp_f32 v44, v76
    v_exp_f32 v45, v77
    v_exp_f32 v46, v78
    v_exp_f32 v47, v79
    v_add_f32 v35, v35, v44
    v_cvt_pk_bf16_f32 v94, v44, v45
    v_add_f32 v35, v35, v45
    v_cvt_pk_bf16_f32 v95, v46, v47
    v_add_f32 v35, v35, v46
    v_add_f32 v35, v35, v47
    v_sub_f32 v48, v48, v36
    v_sub_f32 v49, v49, v36
    v_sub_f32 v50, v50, v36
    v_sub_f32 v51, v51, v36
    v_sub_f32 v56, v56, v36
    v_sub_f32 v57, v57, v36
    v_sub_f32 v58, v58, v36
    v_sub_f32 v59, v59, v36
    v_sub_f32 v52, v52, v37
    v_sub_f32 v53, v53, v37
    v_sub_f32 v54, v54, v37
    v_sub_f32 v55, v55, v37
    v_sub_f32 v60, v60, v37
    v_sub_f32 v61, v61, v37
    v_sub_f32 v62, v62, v37
    v_sub_f32 v63, v63, v37
    s_nop 3
    s_branch L_back_13
L_slow_14:
    s_nop 15
    v_max3_f32 v36, v48, v49, v50
    v_max3_f32 v36, v36, v51, v56
    v_max3_f32 v36, v36, v57, v58
    v_max_f32 v36, v36, v59
    v_mov_b32 v38, v36
    s_nop 0
    s_nop 0
    v_permlane16_swap_b32 v36, v38
    v_max_f32 v36, v36, v38
    v_mov_b32 v38, v36
    s_nop 0
    s_nop 0
    v_permlane32_swap_b32 v36, v38
    v_max_f32 v36, v36, v38
    v_ceil_f32 v36, v36
    v_max_f32 v36, 0, v36
    v_sub_f32 v39, 0, v36
    v_exp_f32 v39, v39
    s_nop 0
    v_mul_f32 v144, v144, v39
    v_mul_f32 v145, v145, v39
    v_mul_f32 v146, v146, v39
    v_mul_f32 v147, v147, v39
    v_mul_f32 v152, v152, v39
    v_mul_f32 v153, v153, v39
    v_mul_f32 v154, v154, v39
    v_mul_f32 v155, v155, v39
    v_mul_f32 v160, v160, v39
    v_mul_f32 v161, v161, v39
    v_mul_f32 v162, v162, v39
    v_mul_f32 v163, v163, v39
    v_mul_f32 v168, v168, v39
    v_mul_f32 v169, v169, v39
    v_mul_f32 v170, v170, v39
    v_mul_f32 v171, v171, v39
    v_mul_f32 v176, v176, v39
    v_mul_f32 v177, v177, v39
    v_mul_f32 v178, v178, v39
    v_mul_f32 v179, v179, v39
    v_mul_f32 v184, v184, v39
    v_mul_f32 v185, v185, v39
    v_mul_f32 v186, v186, v39
    v_mul_f32 v187, v187, v39
    v_mul_f32 v192, v192, v39
    v_mul_f32 v193, v193, v39
    v_mul_f32 v194, v194, v39
    v_mul_f32 v195, v195, v39
    v_mul_f32 v200, v200, v39
    v_mul_f32 v201, v201, v39
    v_mul_f32 v202, v202, v39
    v_mul_f32 v203, v203, v39
    v_mul_f32 v32, v32, v39
    v_sub_f32 v96, v96, v36
    v_sub_f32 v97, v97, v36
    v_sub_f32 v98, v98, v36
    v_sub_f32 v99, v99, v36
    v_sub_f32 v48, v48, v36
    v_sub_f32 v49, v49, v36
    v_sub_f32 v50, v50, v36
    v_sub_f32 v51, v51, v36
    v_sub_f32 v56, v56, v36
    v_sub_f32 v57, v57, v36
    v_sub_f32 v58, v58, v36
    v_sub_f32 v59, v59, v36
    v_max3_f32 v37, v52, v53, v54
    v_max3_f32 v37, v37, v55, v60
    v_max3_f32 v37, v37, v61, v62
    v_max_f32 v37, v37, v63
    v_mov_b32 v38, v37
    s_nop 0
    s_nop 0
    v_permlane16_swap_b32 v37, v38
    v_max_f32 v37, v37, v38
    v_mov_b32 v38, v37
    s_nop 0
    s_nop 0
    v_permlane32_swap_b32 v37, v38
    v_max_f32 v37, v37, v38
    v_ceil_f32 v37, v37
    v_max_f32 v37, 0, v37
    v_sub_f32 v39, 0, v37
    v_exp_f32 v39, v39
    s_nop 0
    v_mul_f32 v148, v148, v39
    v_mul_f32 v149, v149, v39
    v_mul_f32 v150, v150, v39
    v_mul_f32 v151, v151, v39
    v_mul_f32 v156, v156, v39
    v_mul_f32 v157, v157, v39
    v_mul_f32 v158, v158, v39
    v_mul_f32 v159, v159, v39
    v_mul_f32 v164, v164, v39
    v_mul_f32 v165, v165, v39
    v_mul_f32 v166, v166, v39
    v_mul_f32 v167, v167, v39
    v_mul_f32 v172, v172, v39
    v_mul_f32 v173, v173, v39
    v_mul_f32 v174, v174, v39
    v_mul_f32 v175, v175, v39
    v_mul_f32 v180, v180, v39
    v_mul_f32 v181, v181, v39
    v_mul_f32 v182, v182, v39
    v_mul_f32 v183, v183, v39
    v_mul_f32 v188, v188, v39
    v_mul_f32 v189, v189, v39
    v_mul_f32 v190, v190, v39
    v_mul_f32 v191, v191, v39
    v_mul_f32 v196, v196, v39
    v_mul_f32 v197, v197, v39
    v_mul_f32 v198, v198, v39
    v_mul_f32 v199, v199, v39
    v_mul_f32 v204, v204, v39
    v_mul_f32 v205, v205, v39
    v_mul_f32 v206, v206, v39
    v_mul_f32 v207, v207, v39
    v_mul_f32 v33, v33, v39
    v_sub_f32 v100, v100, v37
    v_sub_f32 v101, v101, v37
    v_sub_f32 v102, v102, v37
    v_sub_f32 v103, v103, v37
    v_sub_f32 v52, v52, v37
    v_sub_f32 v53, v53, v37
    v_sub_f32 v54, v54, v37
    v_sub_f32 v55, v55, v37
    v_sub_f32 v60, v60, v37
    v_sub_f32 v61, v61, v37
    v_sub_f32 v62, v62, v37
    v_sub_f32 v63, v63, v37
    v_exp_f32 v40, v48
    v_exp_f32 v41, v49
    v_exp_f32 v42, v50
    v_exp_f32 v43, v51
    v_add_f32 v34, v40, v41
    v_cvt_pk_bf16_f32 v80, v40, v41
    v_add_f32 v34, v34, v42
    v_cvt_pk_bf16_f32 v81, v42, v43
    v_add_f32 v34, v34, v43
    v_exp_f32 v44, v56
    v_exp_f32 v45, v57
    v_exp_f32 v46, v58
    v_exp_f32 v47, v59
    v_add_f32 v34, v34, v44
    v_cvt_pk_bf16_f32 v82, v44, v45
    v_add_f32 v34, v34, v45
    v_cvt_pk_bf16_f32 v83, v46, v47
    v_add_f32 v34, v34, v46
    v_add_f32 v34, v34, v47
    v_exp_f32 v40, v52
    v_exp_f32 v41, v53
    v_exp_f32 v42, v54
    v_exp_f32 v43, v55
    v_add_f32 v35, v40, v41
    v_cvt_pk_bf16_f32 v84, v40, v41
    v_add_f32 v35, v35, v42
    v_cvt_pk_bf16_f32 v85, v42, v43
    v_add_f32 v35, v35, v43
    v_exp_f32 v44, v60
    v_exp_f32 v45, v61
    v_exp_f32 v46, v62
    v_exp_f32 v47, v63
    v_add_f32 v35, v35, v44
    v_cvt_pk_bf16_f32 v86, v44, v45
    v_add_f32 v35, v35, v45
    v_cvt_pk_bf16_f32 v87, v46, v47
    v_add_f32 v35, v35, v46
    v_add_f32 v35, v35, v47
    v_sub_f32 v64, v64, v36
    v_sub_f32 v65, v65, v36
    v_sub_f32 v66, v66, v36
    v_sub_f32 v67, v67, v36
    v_sub_f32 v72, v72, v36
    v_sub_f32 v73, v73, v36
    v_sub_f32 v74, v74, v36
    v_sub_f32 v75, v75, v36
    v_sub_f32 v68, v68, v37
    v_sub_f32 v69, v69, v37
    v_sub_f32 v70, v70, v37
    v_sub_f32 v71, v71, v37
    v_sub_f32 v76, v76, v37
    v_sub_f32 v77, v77, v37
    v_sub_f32 v78, v78, v37
    v_sub_f32 v79, v79, v37
    s_nop 3
    s_branch L_back_14
L_slow_15:
    s_nop 15
    v_max3_f32 v36, v64, v65, v66
    v_max3_f32 v36, v36, v67, v72
    v_max3_f32 v36, v36, v73, v74
    v_max_f32 v36, v36, v75
    v_mov_b32 v38, v36
    s_nop 0
    s_nop 0
    v_permlane16_swap_b32 v36, v38
    v_max_f32 v36, v36, v38
    v_mov_b32 v38, v36
    s_nop 0
    s_nop 0
    v_permlane32_swap_b32 v36, v38
    v_max_f32 v36, v36, v38
    v_ceil_f32 v36, v36
    v_max_f32 v36, 0, v36
    v_sub_f32 v39, 0, v36
    v_exp_f32 v39, v39
    s_nop 0
    v_mul_f32 v144, v144, v39
    v_mul_f32 v145, v145, v39
    v_mul_f32 v146, v146, v39
    v_mul_f32 v147, v147, v39
    v_mul_f32 v152, v152, v39
    v_mul_f32 v153, v153, v39
    v_mul_f32 v154, v154, v39
    v_mul_f32 v155, v155, v39
    v_mul_f32 v160, v160, v39
    v_mul_f32 v161, v161, v39
    v_mul_f32 v162, v162, v39
    v_mul_f32 v163, v163, v39
    v_mul_f32 v168, v168, v39
    v_mul_f32 v169, v169, v39
    v_mul_f32 v170, v170, v39
    v_mul_f32 v171, v171, v39
    v_mul_f32 v176, v176, v39
    v_mul_f32 v177, v177, v39
    v_mul_f32 v178, v178, v39
    v_mul_f32 v179, v179, v39
    v_mul_f32 v184, v184, v39
    v_mul_f32 v185, v185, v39
    v_mul_f32 v186, v186, v39
    v_mul_f32 v187, v187, v39
    v_mul_f32 v192, v192, v39
    v_mul_f32 v193, v193, v39
    v_mul_f32 v194, v194, v39
    v_mul_f32 v195, v195, v39
    v_mul_f32 v200, v200, v39
    v_mul_f32 v201, v201, v39
    v_mul_f32 v202, v202, v39
    v_mul_f32 v203, v203, v39
    v_mul_f32 v32, v32, v39
    v_sub_f32 v96, v96, v36
    v_sub_f32 v97, v97, v36
    v_sub_f32 v98, v98, v36
    v_sub_f32 v99, v99, v36
    v_sub_f32 v64, v64, v36
    v_sub_f32 v65, v65, v36
    v_sub_f32 v66, v66, v36
    v_sub_f32 v67, v67, v36
    v_sub_f32 v72, v72, v36
    v_sub_f32 v73, v73, v36
    v_sub_f32 v74, v74, v36
    v_sub_f32 v75, v75, v36
    v_max3_f32 v37, v68, v69, v70
    v_max3_f32 v37, v37, v71, v76
    v_max3_f32 v37, v37, v77, v78
    v_max_f32 v37, v37, v79
    v_mov_b32 v38, v37
    s_nop 0
    s_nop 0
    v_permlane16_swap_b32 v37, v38
    v_max_f32 v37, v37, v38
    v_mov_b32 v38, v37
    s_nop 0
    s_nop 0
    v_permlane32_swap_b32 v37, v38
    v_max_f32 v37, v37, v38
    v_ceil_f32 v37, v37
    v_max_f32 v37, 0, v37
    v_sub_f32 v39, 0, v37
    v_exp_f32 v39, v39
    s_nop 0
    v_mul_f32 v148, v148, v39
    v_mul_f32 v149, v149, v39
    v_mul_f32 v150, v150, v39
    v_mul_f32 v151, v151, v39
    v_mul_f32 v156, v156, v39
    v_mul_f32 v157, v157, v39
    v_mul_f32 v158, v158, v39
    v_mul_f32 v159, v159, v39
    v_mul_f32 v164, v164, v39
    v_mul_f32 v165, v165, v39
    v_mul_f32 v166, v166, v39
    v_mul_f32 v167, v167, v39
    v_mul_f32 v172, v172, v39
    v_mul_f32 v173, v173, v39
    v_mul_f32 v174, v174, v39
    v_mul_f32 v175, v175, v39
    v_mul_f32 v180, v180, v39
    v_mul_f32 v181, v181, v39
    v_mul_f32 v182, v182, v39
    v_mul_f32 v183, v183, v39
    v_mul_f32 v188, v188, v39
    v_mul_f32 v189, v189, v39
    v_mul_f32 v190, v190, v39
    v_mul_f32 v191, v191, v39
    v_mul_f32 v196, v196, v39
    v_mul_f32 v197, v197, v39
    v_mul_f32 v198, v198, v39
    v_mul_f32 v199, v199, v39
    v_mul_f32 v204, v204, v39
    v_mul_f32 v205, v205, v39
    v_mul_f32 v206, v206, v39
    v_mul_f32 v207, v207, v39
    v_mul_f32 v33, v33, v39
    v_sub_f32 v100, v100, v37
    v_sub_f32 v101, v101, v37
    v_sub_f32 v102, v102, v37
    v_sub_f32 v103, v103, v37
    v_sub_f32 v68, v68, v37
    v_sub_f32 v69, v69, v37
    v_sub_f32 v70, v70, v37
    v_sub_f32 v71, v71, v37
    v_sub_f32 v76, v76, v37
    v_sub_f32 v77, v77, v37
    v_sub_f32 v78, v78, v37
    v_sub_f32 v79, v79, v37
    v_exp_f32 v40, v64
    v_exp_f32 v41, v65
    v_exp_f32 v42, v66
    v_exp_f32 v43, v67
    v_add_f32 v34, v40, v41
    v_cvt_pk_bf16_f32 v88, v40, v41
    v_add_f32 v34, v34, v42
    v_cvt_pk_bf16_f32 v89, v42, v43
    v_add_f32 v34, v34, v43
    v_exp_f32 v44, v72
    v_exp_f32 v45, v73
    v_exp_f32 v46, v74
    v_exp_f32 v47, v75
    v_add_f32 v34, v34, v44
    v_cvt_pk_bf16_f32 v90, v44, v45
    v_add_f32 v34, v34, v45
    v_cvt_pk_bf16_f32 v91, v46, v47
    v_add_f32 v34, v34, v46
    v_add_f32 v34, v34, v47
    v_exp_f32 v40, v68
    v_exp_f32 v41, v69
    v_exp_f32 v42, v70
    v_exp_f32 v43, v71
    v_add_f32 v35, v40, v41
    v_cvt_pk_bf16_f32 v92, v40, v41
    v_add_f32 v35, v35, v42
    v_cvt_pk_bf16_f32 v93, v42, v43
    v_add_f32 v35, v35, v43
    v_exp_f32 v44, v76
    v_exp_f32 v45, v77
    v_exp_f32 v46, v78
    v_exp_f32 v47, v79
    v_add_f32 v35, v35, v44
    v_cvt_pk_bf16_f32 v94, v44, v45
    v_add_f32 v35, v35, v45
    v_cvt_pk_bf16_f32 v95, v46, v47
    v_add_f32 v35, v35, v46
    v_add_f32 v35, v35, v47
    s_nop 3
    s_branch L_back_15
L_mega_end:
    s_endpgm
.section .rodata,"a"
.p2align 6
.p2align 6
.amdhsa_kernel adaLN_cond__sliding_block_cached__swiglu_ffn__prompt_kernel
  .amdhsa_next_free_vgpr 256
  .amdhsa_next_free_sgpr 99
  .amdhsa_accum_offset 256
  .amdhsa_group_segment_fixed_size 0
  .amdhsa_kernarg_size 112
  .amdhsa_user_sgpr_count 2
  .amdhsa_user_sgpr_kernarg_segment_ptr 1
  .amdhsa_system_sgpr_workgroup_id_x 1
  .amdhsa_float_denorm_mode_32 3
  .amdhsa_float_denorm_mode_16_64 3
.end_amdhsa_kernel
```
